```python
import torch

def _softmax(x, axis=-1):
    return torch.softmax(x, dim=axis)
def _gelu(x):
    return torch.nn.functional.gelu(x, approximate="tanh")
def _silu(x):
    return torch.nn.functional.silu(x)
def _sigmoid(x):
    return torch.sigmoid(x)
def _layernorm(x, axis=-1, eps=1e-5):
    m = x.mean(dim=axis, keepdim=True)
    v = x.var(dim=axis, keepdim=True, unbiased=False)
    return (x - m) / torch.sqrt(v + eps)
def _scatter_add(tgt, idx, src, axis=0):
    return tgt.clone().index_add_(axis, idx, src)
def _segment_sum(src, seg, n):
    out = torch.zeros((n,) + src.shape[1:], dtype=src.dtype)
    return out.index_add_(0, seg, src)
def _pad(x, pw):
    flat = tuple(v for pair in reversed(pw) for v in pair)
    return torch.nn.functional.pad(x, flat)

kernel_name = 'standalone__mha_softmax__near_ridge'

def setup_inputs():

    _w = (lambda a: (lambda t: t.to(torch.bfloat16) if t.is_floating_point() else t)(torch.as_tensor(a)))
    B, H, Sq, Sk, D = 16, 32, 368, 1024, 128
    return {
        "q": _w((lambda *s: torch.randn(*s, dtype=torch.bfloat16) * 0.8)(B, H, Sq, D)),
        "k": _w((lambda *s: torch.randn(*s, dtype=torch.bfloat16) * 0.8)(B, H, Sk, D)),
        "v": _w((lambda *s: torch.randn(*s, dtype=torch.bfloat16) * 0.05)(B, H, Sk, D)),
    }

def reference(q, k, v):
    scale = q.shape[-1] ** -0.5
    scores = torch.einsum("bhqd,bhkd->bhqk", q, k) * scale
    p = _softmax(scores, axis=-1)
    return torch.einsum("bhqk,bhkd->bhqd", p, v)
```

```asm
; @launch grid=(256,1,1) block=(256,1,1) lds=162816
.amdgcn_target "amdgcn-amd-amdhsa--gfx950"
.text
.globl standalone__mha_softmax__near_ridge_kernel
.p2align 8
.type standalone__mha_softmax__near_ridge_kernel,@function
standalone__mha_softmax__near_ridge_kernel:
  s_cmp_ge_u32 s2, 256
  s_cbranch_scc1 EXIT
  s_load_dwordx4 s[68:71], s[0:1], 0
  s_load_dwordx4 s[72:75], s[0:1], 16
  v_lshrrev_b32 v12, 6, v0
  v_and_b32 v0, 63, v0
  v_readfirstlane_b32 s44, v12
  v_lshlrev_b32 v1, 4, v0
  s_mov_b32 s3, s2
  s_lshl_b32 s3, s3, 19
  s_mul_i32 s63, s2, 188416
  s_mul_i32 s45, s44, 24576
  s_mul_i32 s64, s44, 2112
  s_lshl_b32 s29, s44, 11
  s_mov_b32 s6, 0x80000
  s_mov_b32 s7, 0x20000
  s_mov_b32 s10, 0x80000
  s_mov_b32 s11, 0x20000
  s_mov_b32 s14, 188416
  s_mov_b32 s15, 0x20000
  s_mov_b32 s62, 0x40000000
  v_and_b32 v12, 15, v0
  v_lshrrev_b32 v13, 4, v0
  v_xor_b32 v14, v12, v13
  v_lshlrev_b32 v14, 4, v14
  v_lshl_add_u32 v148, v13, 8, v14
  v_xor_b32 v149, 64, v148
  v_xor_b32 v150, 0x80, v148
  v_xor_b32 v151, 0xc0, v148
  s_lshr_b32 s66, s2, 3
  s_lshl_b32 s66, s66, 13
  s_add_u32 s29, s29, s66
  s_xor_b32 s28, s29, 0x2000
  s_getreg_b32 s91, hwreg(20, 0, 1)
  v_lshrrev_b32 v15, 5, v0
  v_lshlrev_b32 v15, 18, v15
  v_and_b32 v16, 1, v13
  v_mul_u32_u24 v16, 1280, v16
  v_lshl_add_u32 v15, v12, 4, v15
  v_add_u32 v15, v15, v16
  s_getpc_b64 s[52:53]
  s_and_b32 s52, s52, 0xffffff00
  s_mov_b32 s54, 77824
  s_mov_b32 s55, 0x20000
  s_lshr_b32 s50, s2, 3
  s_lshl_b32 s50, s50, 2
  s_add_u32 s50, s50, s44
  s_lshl_b32 s50, s50, 10
  s_mov_b32 m0, 161792
  s_nop 0
  buffer_load_dwordx4 v1, s[52:55], s50 offen lds
  s_waitcnt lgkmcnt(0)
  s_add_u32 s4, s70, s3
  s_addc_u32 s5, s71, 0
  s_add_u32 s12, s68, s63
  s_addc_u32 s13, s69, 0
  s_add_u32 m0, s64, 94208
  s_nop 0
  buffer_load_dwordx4 v1, s[4:7], s29 offen offset:0 nt lds
  s_add_u32 m0, s64, 94240
  s_nop 0
  buffer_load_dwordx4 v1, s[4:7], s29 offen offset:1024 nt lds
  s_add_u32 s8, s72, s3
  s_addc_u32 s9, s73, 0
  buffer_load_dwordx4 v[224:227], v15, s[8:11], s66 offen offset:0
  buffer_load_dwordx4 v[228:231], v15, s[8:11], s66 offen offset:256
  buffer_load_dwordx4 v[232:235], v15, s[8:11], s66 offen offset:512
  buffer_load_dwordx4 v[236:239], v15, s[8:11], s66 offen offset:768
  buffer_load_dwordx4 v[240:243], v15, s[8:11], s66 offen offset:1024
  s_cmp_eq_u32 s91, 0
  s_cbranch_scc1 EVEN
  s_add_u32 m0, s64, 102656
  s_nop 0
  buffer_load_dwordx4 v1, s[4:7], s28 offen offset:0 nt lds
  s_add_u32 m0, s64, 102688
  s_nop 0
  buffer_load_dwordx4 v1, s[4:7], s28 offen offset:1024 nt lds
  s_add_u32 m0, s45, 0
  s_nop 0
  buffer_load_dwordx4 v148, s[12:15], m0 offen offset:0 nt lds
  buffer_load_dwordx4 v149, s[12:15], m0 offen offset:1024 nt lds
  buffer_load_dwordx4 v150, s[12:15], m0 offen offset:2048 nt lds
  buffer_load_dwordx4 v151, s[12:15], m0 offen offset:3072 nt lds
  s_add_u32 m0, s45, 4096
  s_nop 0
  buffer_load_dwordx4 v148, s[12:15], m0 offen offset:0 nt lds
  buffer_load_dwordx4 v149, s[12:15], m0 offen offset:1024 nt lds
  buffer_load_dwordx4 v150, s[12:15], m0 offen offset:2048 nt lds
  buffer_load_dwordx4 v151, s[12:15], m0 offen offset:3072 nt lds
  s_cmp_eq_u32 s44, 3
  s_cbranch_scc1 PATH_5
PATH_6:
  s_add_u32 s20, s74, s63
  s_addc_u32 s21, s75, 0
  s_mov_b32 s22, 188416
  s_mov_b32 s23, 0x20000
  s_mov_b32 s24, s20
  s_mov_b32 s25, s21
  s_mov_b32 s26, 94208
  s_mov_b32 s27, 0x20000
  s_add_u32 s16, s12, 94208
  s_addc_u32 s17, s13, 0
  s_mov_b32 s18, 94208
  s_mov_b32 s19, 0x20000
  s_mov_b32 s48, 0xffff0000
  s_mov_b32 s46, 0x3e0293ee
  s_mov_b32 s47, 0x3e0293ee
  s_mov_b32 s49, 0x44800000
  v_lshl_add_u32 v8, v12, 8, v14
  v_add_u32 v8, s45, v8
  v_xor_b32 v9, 64, v8
  v_xor_b32 v10, 0x80, v8
  v_xor_b32 v11, 0xc0, v8
  v_and_b32 v15, 7, v0
  v_mul_u32_u24 v15, 1056, v15
  v_bfe_u32 v16, v0, 3, 1
  v_lshl_add_u32 v15, v16, 9, v15
  v_lshl_add_u32 v15, v13, 4, v15
  v_add_u32 v2, 94208, v15
  v_bfe_u32 v15, v0, 3, 2
  v_mul_u32_u24 v15, 2112, v15
  v_bfe_u32 v16, v0, 2, 1
  v_mul_u32_u24 v16, 1032, v16
  v_lshrrev_b32 v17, 5, v0
  v_lshl_add_u32 v15, v17, 9, v15
  v_and_b32 v18, 3, v0
  v_lshl_add_u32 v16, v18, 4, v16
  v_add_u32 v15, v15, v16
  v_add_u32 v3, 128000, v15
  v_bfe_u32 v16, v0, 1, 1
  v_mov_b32 v19, 0x3f803f80
  v_cmp_eq_u32 vcc, v16, v17
  s_nop 1
  v_cndmask_b32 v19, 0, v19, vcc
  v_and_b32 v16, 1, v0
  v_mul_u32_u24 v16, 0xaaaa, v16
  v_add_u32 v5, 0x4444, v16
  v_accvgpr_write_b32 a240, v19
  v_accvgpr_write_b32 a244, 0
  v_accvgpr_write_b32 a241, v19
  v_accvgpr_write_b32 a245, 0
  v_accvgpr_write_b32 a242, v19
  v_accvgpr_write_b32 a246, 0
  v_accvgpr_write_b32 a243, v19
  v_accvgpr_write_b32 a247, 0
  s_mov_b32 s81, 0xc1980000
  s_add_u32 s51, s45, 24576
  s_add_u32 s50, s45, 20480
  s_mov_b32 s65, 6
  s_mov_b32 s39, 1
  s_mov_b32 s61, 0
  v_lshl_add_u32 v4, v0, 2, s50
  v_mfma_f32_32x32x16_bf16 v[16:31], a[244:247], a[244:247], 0
  s_waitcnt vmcnt(12)
  v_max3_f16 v56, |v224|, |v228|, |v232| op_sel:[0,0,0,0]
  v_max3_f16 v57, |v224|, |v228|, |v232| op_sel:[1,1,1,0]
  v_max3_f16 v58, |v225|, |v229|, |v233| op_sel:[0,0,0,0]
  v_max3_f16 v59, |v225|, |v229|, |v233| op_sel:[1,1,1,0]
  v_max3_f16 v60, |v226|, |v230|, |v234| op_sel:[0,0,0,0]
  v_max3_f16 v61, |v226|, |v230|, |v234| op_sel:[1,1,1,0]
  v_max3_f16 v62, |v227|, |v231|, |v235| op_sel:[0,0,0,0]
  v_max3_f16 v63, |v227|, |v231|, |v235| op_sel:[1,1,1,0]
  s_waitcnt vmcnt(10)
  v_max3_f16 v56, v56, |v236|, |v240| op_sel:[0,0,0,0]
  v_max3_f16 v57, v57, |v236|, |v240| op_sel:[0,1,1,0]
  v_max3_f16 v58, v58, |v237|, |v241| op_sel:[0,0,0,0]
  v_max3_f16 v59, v59, |v237|, |v241| op_sel:[0,1,1,0]
  v_max3_f16 v60, v60, |v238|, |v242| op_sel:[0,0,0,0]
  v_max3_f16 v61, v61, |v238|, |v242| op_sel:[0,1,1,0]
  v_max3_f16 v62, v62, |v239|, |v243| op_sel:[0,0,0,0]
  v_max3_f16 v63, v63, |v239|, |v243| op_sel:[0,1,1,0]
  v_min3_f16 v56, v56, v57, v58
  v_min3_f16 v59, v59, v60, v61
  v_min3_f16 v56, v56, v62, v63
  s_nop 0
  v_min_f16 v56, v56, v59
  s_nop 0
  v_and_b32 v56, 0x7f80, v56
  s_nop 1
  v_min_u32_dpp v56, v56, v56 row_ror:8 row_mask:0xf bank_mask:0xf
  s_nop 1
  v_min_u32_dpp v56, v56, v56 row_ror:4 row_mask:0xf bank_mask:0xf
  s_nop 1
  v_min_u32_dpp v56, v56, v56 row_ror:2 row_mask:0xf bank_mask:0xf
  s_nop 1
  v_min_u32_dpp v56, v56, v56 row_ror:1 row_mask:0xf bank_mask:0xf
  s_nop 0
  v_readlane_b32 s82, v56, 0
  v_readlane_b32 s88, v56, 16
  v_readlane_b32 s83, v56, 32
  v_readlane_b32 s89, v56, 48
  s_min_u32 s88, s88, s82
  s_sub_u32 s88, s88, 1877
  s_lshl_b32 s82, s88, 16
  s_add_u32 s82, s82, 0x81800000
  s_cmp_ge_i32 s88, 0x80
  s_cselect_b32 s88, s88, 0
  s_cselect_b32 s82, s82, 0
  s_pack_ll_b32_b16 s88, s88, s88
  s_min_u32 s89, s89, s83
  s_sub_u32 s89, s89, 1877
  s_lshl_b32 s83, s89, 16
  s_add_u32 s83, s83, 0x81800000
  s_cmp_ge_i32 s89, 0x80
  s_cselect_b32 s89, s89, 0
  s_cselect_b32 s83, s83, 0
  s_pack_ll_b32_b16 s89, s89, s89
  v_accvgpr_write_b32 a248, s88
  v_accvgpr_write_b32 a249, s88
  v_accvgpr_write_b32 a250, s88
  v_accvgpr_write_b32 a251, s88
  s_waitcnt vmcnt(8)
  s_barrier
  ds_read_b128 a[192:195], v2 offset:0
  ds_read_b128 a[196:199], v2 offset:64
  ds_read_b128 a[200:203], v2 offset:128
  ds_read_b128 a[204:207], v2 offset:192
  ds_read_b128 a[208:211], v2 offset:256
  ds_read_b128 a[212:215], v2 offset:320
  ds_read_b128 a[216:219], v2 offset:384
  ds_read_b128 a[220:223], v2 offset:448
  s_waitcnt vmcnt(4)
  ds_read_b128 v[160:163], v8 offset:0
  ds_read_b128 v[164:167], v9 offset:0
  ds_read_b128 v[168:171], v10 offset:0
  ds_read_b128 v[172:175], v11 offset:0
  v_mfma_f32_32x32x16_bf16 v[208:223], a[240:243], a[248:251], 0
  s_add_u32 m0, s45, 8192
  s_nop 0
  buffer_load_dwordx4 v148, s[12:15], m0 offen offset:0 nt lds
  buffer_load_dwordx4 v149, s[12:15], m0 offen offset:1024 nt lds
  buffer_load_dwordx4 v150, s[12:15], m0 offen offset:2048 nt lds
  buffer_load_dwordx4 v151, s[12:15], m0 offen offset:3072 nt lds
  v_mfma_f32_32x32x16_bf16 v[224:239], a[240:243], a[248:251], 0
  s_add_u32 m0, s45, 12288
  s_nop 0
  buffer_load_dwordx4 v148, s[12:15], m0 offen offset:0 nt lds
  buffer_load_dwordx4 v149, s[12:15], m0 offen offset:1024 nt lds
  buffer_load_dwordx4 v150, s[12:15], m0 offen offset:2048 nt lds
  buffer_load_dwordx4 v151, s[12:15], m0 offen offset:3072 nt lds
  ds_read_b128 v[80:83], v2 offset:8448
  ds_read_b128 v[84:87], v2 offset:8512
  ds_read_b128 v[88:91], v2 offset:8576
  ds_read_b128 v[92:95], v2 offset:8640
  ds_read_b128 v[96:99], v2 offset:8704
  ds_read_b128 v[100:103], v2 offset:8768
  ds_read_b128 v[104:107], v2 offset:8832
  ds_read_b128 v[108:111], v2 offset:8896
  s_waitcnt lgkmcnt(11)
  v_lshlrev_b32 v192, 16, v160
  v_and_b32 v193, s48, v160
  v_lshlrev_b32 v194, 16, v161
  v_and_b32 v195, s48, v161
  v_lshlrev_b32 v196, 16, v162
  v_and_b32 v197, s48, v162
  v_lshlrev_b32 v198, 16, v163
  v_and_b32 v199, s48, v163
  v_pk_mul_f32 v[192:193], v[192:193], s[46:47]
  v_pk_mul_f32 v[194:195], v[194:195], s[46:47]
  v_pk_mul_f32 v[196:197], v[196:197], s[46:47]
  v_pk_mul_f32 v[198:199], v[198:199], s[46:47]
  v_cvt_pk_bf16_f32 v160, v192, v193
  v_cvt_pk_bf16_f32 v161, v194, v195
  v_cvt_pk_bf16_f32 v162, v196, v197
  v_cvt_pk_bf16_f32 v163, v198, v199
  v_accvgpr_write_b32 a96, v160
  v_accvgpr_write_b32 a97, v161
  v_accvgpr_write_b32 a98, v162
  v_accvgpr_write_b32 a99, v163
  s_waitcnt lgkmcnt(10)
  v_lshlrev_b32 v200, 16, v164
  v_and_b32 v201, s48, v164
  v_lshlrev_b32 v202, 16, v165
  v_and_b32 v203, s48, v165
  v_lshlrev_b32 v204, 16, v166
  v_and_b32 v205, s48, v166
  v_lshlrev_b32 v206, 16, v167
  v_and_b32 v207, s48, v167
  v_pk_mul_f32 v[200:201], v[200:201], s[46:47]
  v_pk_mul_f32 v[202:203], v[202:203], s[46:47]
  v_pk_mul_f32 v[204:205], v[204:205], s[46:47]
  v_pk_mul_f32 v[206:207], v[206:207], s[46:47]
  v_cvt_pk_bf16_f32 v164, v200, v201
  v_cvt_pk_bf16_f32 v165, v202, v203
  v_cvt_pk_bf16_f32 v166, v204, v205
  v_cvt_pk_bf16_f32 v167, v206, v207
  v_accvgpr_write_b32 a100, v164
  v_accvgpr_write_b32 a101, v165
  v_accvgpr_write_b32 a102, v166
  v_accvgpr_write_b32 a103, v167
  s_waitcnt lgkmcnt(9)
  v_lshlrev_b32 v192, 16, v168
  v_and_b32 v193, s48, v168
  v_lshlrev_b32 v194, 16, v169
  v_and_b32 v195, s48, v169
  v_lshlrev_b32 v196, 16, v170
  v_and_b32 v197, s48, v170
  v_lshlrev_b32 v198, 16, v171
  v_and_b32 v199, s48, v171
  v_pk_mul_f32 v[192:193], v[192:193], s[46:47]
  v_pk_mul_f32 v[194:195], v[194:195], s[46:47]
  v_pk_mul_f32 v[196:197], v[196:197], s[46:47]
  v_pk_mul_f32 v[198:199], v[198:199], s[46:47]
  v_cvt_pk_bf16_f32 v168, v192, v193
  v_cvt_pk_bf16_f32 v169, v194, v195
  v_cvt_pk_bf16_f32 v170, v196, v197
  v_cvt_pk_bf16_f32 v171, v198, v199
  v_accvgpr_write_b32 a104, v168
  v_accvgpr_write_b32 a105, v169
  v_accvgpr_write_b32 a106, v170
  v_accvgpr_write_b32 a107, v171
  s_waitcnt lgkmcnt(8)
  v_lshlrev_b32 v200, 16, v172
  v_and_b32 v201, s48, v172
  v_lshlrev_b32 v202, 16, v173
  v_and_b32 v203, s48, v173
  v_lshlrev_b32 v204, 16, v174
  v_and_b32 v205, s48, v174
  v_lshlrev_b32 v206, 16, v175
  v_and_b32 v207, s48, v175
  v_pk_mul_f32 v[200:201], v[200:201], s[46:47]
  v_pk_mul_f32 v[202:203], v[202:203], s[46:47]
  v_pk_mul_f32 v[204:205], v[204:205], s[46:47]
  v_pk_mul_f32 v[206:207], v[206:207], s[46:47]
  v_cvt_pk_bf16_f32 v172, v200, v201
  v_cvt_pk_bf16_f32 v173, v202, v203
  v_cvt_pk_bf16_f32 v174, v204, v205
  v_cvt_pk_bf16_f32 v175, v206, v207
  v_accvgpr_write_b32 a108, v172
  v_accvgpr_write_b32 a109, v173
  v_accvgpr_write_b32 a110, v174
  v_accvgpr_write_b32 a111, v175
  v_mfma_f32_16x16x32_bf16 v[112:115], a[192:195], a[96:99], 0
  s_waitcnt lgkmcnt(0)
  v_mfma_f32_16x16x32_bf16 v[112:115], a[196:199], a[100:103], v[112:115]
  v_mfma_f32_16x16x32_bf16 v[112:115], a[200:203], a[104:107], v[112:115]
  v_mfma_f32_16x16x32_bf16 v[112:115], a[204:207], a[108:111], v[112:115]
  s_nop 7
  v_max3_f32 v18, v112, v113, v114
  v_max_f32 v18, v18, v115
  v_mov_b32 v19, v18
  s_nop 1
  v_permlane32_swap_b32 v18, v19
  v_max_f32 v18, v18, v19
  v_mov_b32 v19, v18
  s_nop 1
  v_permlane16_swap_b32 v18, v19
  v_max_f32 v18, v18, v19
  v_sub_f32 v128, s81, v18
  v_sub_f32 v129, s81, v18
  v_sub_f32 v130, s81, v18
  v_sub_f32 v131, s81, v18
  v_add_f32 v112, v112, v128
  v_add_f32 v113, v113, v128
  v_mfma_f32_16x16x32_bf16 v[116:119], a[208:211], a[96:99], v[128:131]
  v_add_f32 v114, v114, v128
  v_add_f32 v115, v115, v128
  v_mfma_f32_16x16x32_bf16 v[116:119], a[212:215], a[100:103], v[116:119]
  v_exp_f32 v112, v112
  v_mfma_f32_16x16x32_bf16 v[116:119], a[216:219], a[104:107], v[116:119]
  v_exp_f32 v113, v113
  v_mfma_f32_16x16x32_bf16 v[116:119], a[220:223], a[108:111], v[116:119]
  v_exp_f32 v114, v114
  v_mfma_f32_16x16x32_bf16 v[120:123], v[80:83], a[96:99], v[128:131]
  v_exp_f32 v115, v115
  v_mfma_f32_16x16x32_bf16 v[120:123], v[84:87], a[100:103], v[120:123]
  v_cvt_pk_bf16_f32 v32, v112, v113
  v_cvt_pk_bf16_f32 v33, v114, v115
  v_mfma_f32_16x16x32_bf16 v[120:123], v[88:91], a[104:107], v[120:123]
  v_mfma_f32_16x16x32_bf16 v[120:123], v[92:95], a[108:111], v[120:123]
  v_exp_f32 v116, v116
  v_mfma_f32_16x16x32_bf16 v[124:127], v[96:99], a[96:99], v[128:131]
  v_exp_f32 v117, v117
  v_mfma_f32_16x16x32_bf16 v[124:127], v[100:103], a[100:103], v[124:127]
  v_exp_f32 v118, v118
  v_mfma_f32_16x16x32_bf16 v[124:127], v[104:107], a[104:107], v[124:127]
  v_exp_f32 v119, v119
  v_mfma_f32_16x16x32_bf16 v[124:127], v[108:111], a[108:111], v[124:127]
  v_cvt_pk_bf16_f32 v34, v116, v117
  v_cvt_pk_bf16_f32 v35, v118, v119
  s_waitcnt vmcnt(8)
  ds_read_b128 v[176:179], v8 offset:4096
  ds_read_b128 v[180:183], v9 offset:4096
  ds_read_b128 v[184:187], v10 offset:4096
  ds_read_b128 v[188:191], v11 offset:4096
  v_mfma_f32_32x32x16_bf16 v[240:255], a[240:243], a[248:251], 0
  s_add_u32 m0, s45, 16384
  s_nop 0
  buffer_load_dwordx4 v148, s[12:15], m0 offen offset:0 nt lds
  buffer_load_dwordx4 v149, s[12:15], m0 offen offset:1024 nt lds
  v_exp_f32 v120, v120
  v_mfma_f32_32x32x16_bf16 a[0:15], a[240:243], a[248:251], 0
  buffer_load_dwordx4 v150, s[12:15], m0 offen offset:2048 nt lds
  buffer_load_dwordx4 v151, s[12:15], m0 offen offset:3072 nt lds
  v_exp_f32 v121, v121
  v_exp_f32 v122, v122
  v_exp_f32 v123, v123
  v_cvt_pk_bf16_f32 v56, v120, v121
  v_cvt_pk_bf16_f32 v57, v122, v123
  v_exp_f32 v124, v124
  v_exp_f32 v125, v125
  v_exp_f32 v126, v126
  v_exp_f32 v127, v127
  v_cvt_pk_bf16_f32 v58, v124, v125
  v_cvt_pk_bf16_f32 v59, v126, v127
  s_waitcnt lgkmcnt(3)
  v_lshlrev_b32 v192, 16, v176
  v_and_b32 v193, s48, v176
  v_lshlrev_b32 v194, 16, v177
  v_and_b32 v195, s48, v177
  v_lshlrev_b32 v196, 16, v178
  v_and_b32 v197, s48, v178
  v_lshlrev_b32 v198, 16, v179
  v_and_b32 v199, s48, v179
  v_pk_mul_f32 v[192:193], v[192:193], s[46:47]
  v_pk_mul_f32 v[194:195], v[194:195], s[46:47]
  v_pk_mul_f32 v[196:197], v[196:197], s[46:47]
  v_pk_mul_f32 v[198:199], v[198:199], s[46:47]
  v_cvt_pk_bf16_f32 v176, v192, v193
  v_cvt_pk_bf16_f32 v177, v194, v195
  v_cvt_pk_bf16_f32 v178, v196, v197
  v_cvt_pk_bf16_f32 v179, v198, v199
  v_accvgpr_write_b32 a112, v176
  v_accvgpr_write_b32 a113, v177
  v_accvgpr_write_b32 a114, v178
  v_accvgpr_write_b32 a115, v179
  s_waitcnt lgkmcnt(2)
  v_lshlrev_b32 v200, 16, v180
  v_and_b32 v201, s48, v180
  v_lshlrev_b32 v202, 16, v181
  v_and_b32 v203, s48, v181
  v_lshlrev_b32 v204, 16, v182
  v_and_b32 v205, s48, v182
  v_lshlrev_b32 v206, 16, v183
  v_and_b32 v207, s48, v183
  v_pk_mul_f32 v[200:201], v[200:201], s[46:47]
  v_pk_mul_f32 v[202:203], v[202:203], s[46:47]
  v_pk_mul_f32 v[204:205], v[204:205], s[46:47]
  v_pk_mul_f32 v[206:207], v[206:207], s[46:47]
  v_cvt_pk_bf16_f32 v180, v200, v201
  v_cvt_pk_bf16_f32 v181, v202, v203
  v_cvt_pk_bf16_f32 v182, v204, v205
  v_cvt_pk_bf16_f32 v183, v206, v207
  v_accvgpr_write_b32 a116, v180
  v_accvgpr_write_b32 a117, v181
  v_accvgpr_write_b32 a118, v182
  v_accvgpr_write_b32 a119, v183
  s_waitcnt lgkmcnt(1)
  v_lshlrev_b32 v192, 16, v184
  v_and_b32 v193, s48, v184
  v_lshlrev_b32 v194, 16, v185
  v_and_b32 v195, s48, v185
  v_lshlrev_b32 v196, 16, v186
  v_and_b32 v197, s48, v186
  v_lshlrev_b32 v198, 16, v187
  v_and_b32 v199, s48, v187
  v_pk_mul_f32 v[192:193], v[192:193], s[46:47]
  v_pk_mul_f32 v[194:195], v[194:195], s[46:47]
  v_pk_mul_f32 v[196:197], v[196:197], s[46:47]
  v_pk_mul_f32 v[198:199], v[198:199], s[46:47]
  v_cvt_pk_bf16_f32 v184, v192, v193
  v_cvt_pk_bf16_f32 v185, v194, v195
  v_cvt_pk_bf16_f32 v186, v196, v197
  v_cvt_pk_bf16_f32 v187, v198, v199
  v_accvgpr_write_b32 a120, v184
  v_accvgpr_write_b32 a121, v185
  v_accvgpr_write_b32 a122, v186
  v_accvgpr_write_b32 a123, v187
  s_waitcnt lgkmcnt(0)
  v_lshlrev_b32 v200, 16, v188
  v_and_b32 v201, s48, v188
  v_lshlrev_b32 v202, 16, v189
  v_and_b32 v203, s48, v189
  v_lshlrev_b32 v204, 16, v190
  v_and_b32 v205, s48, v190
  v_lshlrev_b32 v206, 16, v191
  v_and_b32 v207, s48, v191
  v_pk_mul_f32 v[200:201], v[200:201], s[46:47]
  v_pk_mul_f32 v[202:203], v[202:203], s[46:47]
  v_pk_mul_f32 v[204:205], v[204:205], s[46:47]
  v_pk_mul_f32 v[206:207], v[206:207], s[46:47]
  v_cvt_pk_bf16_f32 v188, v200, v201
  v_cvt_pk_bf16_f32 v189, v202, v203
  v_cvt_pk_bf16_f32 v190, v204, v205
  v_cvt_pk_bf16_f32 v191, v206, v207
  v_accvgpr_write_b32 a124, v188
  v_accvgpr_write_b32 a125, v189
  v_accvgpr_write_b32 a126, v190
  v_accvgpr_write_b32 a127, v191
  v_mfma_f32_16x16x32_bf16 v[152:155], a[192:195], a[112:115], 0
  v_mfma_f32_16x16x32_bf16 v[152:155], a[196:199], a[116:119], v[152:155]
  v_mfma_f32_16x16x32_bf16 v[152:155], a[200:203], a[120:123], v[152:155]
  v_mfma_f32_16x16x32_bf16 v[152:155], a[204:207], a[124:127], v[152:155]
  s_nop 7
  v_max3_f32 v6, v152, v153, v154
  v_max_f32 v6, v6, v155
  v_mov_b32 v7, v6
  s_nop 1
  v_permlane32_swap_b32 v6, v7
  v_max_f32 v6, v6, v7
  v_mov_b32 v7, v6
  s_nop 1
  v_permlane16_swap_b32 v6, v7
  v_max_f32 v6, v6, v7
  v_sub_f32 v132, s81, v6
  v_sub_f32 v133, s81, v6
  v_sub_f32 v134, s81, v6
  v_sub_f32 v135, s81, v6
  v_add_f32 v152, v152, v132
  v_add_f32 v153, v153, v132
  v_mfma_f32_16x16x32_bf16 v[156:159], a[208:211], a[112:115], v[132:135]
  v_add_f32 v154, v154, v132
  v_add_f32 v155, v155, v132
  v_mfma_f32_16x16x32_bf16 v[156:159], a[212:215], a[116:119], v[156:159]
  v_exp_f32 v152, v152
  v_mfma_f32_16x16x32_bf16 v[156:159], a[216:219], a[120:123], v[156:159]
  v_exp_f32 v153, v153
  v_mfma_f32_16x16x32_bf16 v[156:159], a[220:223], a[124:127], v[156:159]
  v_exp_f32 v154, v154
  v_mfma_f32_16x16x32_bf16 v[112:115], v[80:83], a[112:115], v[132:135]
  v_exp_f32 v155, v155
  v_mfma_f32_16x16x32_bf16 v[112:115], v[84:87], a[116:119], v[112:115]
  v_cvt_pk_bf16_f32 v36, v152, v153
  v_cvt_pk_bf16_f32 v37, v154, v155
  v_mfma_f32_16x16x32_bf16 v[112:115], v[88:91], a[120:123], v[112:115]
  v_mfma_f32_16x16x32_bf16 v[112:115], v[92:95], a[124:127], v[112:115]
  v_exp_f32 v156, v156
  v_mfma_f32_16x16x32_bf16 v[116:119], v[96:99], a[112:115], v[132:135]
  v_exp_f32 v157, v157
  v_mfma_f32_16x16x32_bf16 v[116:119], v[100:103], a[116:119], v[116:119]
  v_exp_f32 v158, v158
  v_mfma_f32_16x16x32_bf16 v[116:119], v[104:107], a[120:123], v[116:119]
  v_exp_f32 v159, v159
  v_mfma_f32_16x16x32_bf16 v[116:119], v[108:111], a[124:127], v[116:119]
  v_cvt_pk_bf16_f32 v38, v156, v157
  v_cvt_pk_bf16_f32 v39, v158, v159
  s_waitcnt vmcnt(8)
  ds_read_b128 v[160:163], v8 offset:8192
  ds_read_b128 v[164:167], v9 offset:8192
  ds_read_b128 v[168:171], v10 offset:8192
  ds_read_b128 v[172:175], v11 offset:8192
  v_mfma_f32_32x32x16_bf16 a[16:31], a[240:243], a[248:251], 0
  s_add_u32 m0, s45, 20480
  s_nop 0
  buffer_load_dwordx4 v148, s[12:15], m0 offen offset:0 nt lds
  buffer_load_dwordx4 v149, s[12:15], m0 offen offset:1024 nt lds
  v_exp_f32 v112, v112
  v_mfma_f32_32x32x16_bf16 a[32:47], a[240:243], a[248:251], 0
  buffer_load_dwordx4 v150, s[12:15], m0 offen offset:2048 nt lds
  buffer_load_dwordx4 v151, s[12:15], m0 offen offset:3072 nt lds
  v_exp_f32 v113, v113
  v_exp_f32 v114, v114
  v_exp_f32 v115, v115
  v_cvt_pk_bf16_f32 v60, v112, v113
  v_cvt_pk_bf16_f32 v61, v114, v115
  v_exp_f32 v116, v116
  v_exp_f32 v117, v117
  v_exp_f32 v118, v118
  v_exp_f32 v119, v119
  v_cvt_pk_bf16_f32 v62, v116, v117
  v_cvt_pk_bf16_f32 v63, v118, v119
  s_waitcnt lgkmcnt(3)
  v_lshlrev_b32 v192, 16, v160
  v_and_b32 v193, s48, v160
  v_lshlrev_b32 v194, 16, v161
  v_and_b32 v195, s48, v161
  v_lshlrev_b32 v196, 16, v162
  v_and_b32 v197, s48, v162
  v_lshlrev_b32 v198, 16, v163
  v_and_b32 v199, s48, v163
  v_pk_mul_f32 v[192:193], v[192:193], s[46:47]
  v_pk_mul_f32 v[194:195], v[194:195], s[46:47]
  v_pk_mul_f32 v[196:197], v[196:197], s[46:47]
  v_pk_mul_f32 v[198:199], v[198:199], s[46:47]
  v_cvt_pk_bf16_f32 v160, v192, v193
  v_cvt_pk_bf16_f32 v161, v194, v195
  v_cvt_pk_bf16_f32 v162, v196, v197
  v_cvt_pk_bf16_f32 v163, v198, v199
  v_accvgpr_write_b32 a128, v160
  v_accvgpr_write_b32 a129, v161
  v_accvgpr_write_b32 a130, v162
  v_accvgpr_write_b32 a131, v163
  s_waitcnt lgkmcnt(2)
  v_lshlrev_b32 v200, 16, v164
  v_and_b32 v201, s48, v164
  v_lshlrev_b32 v202, 16, v165
  v_and_b32 v203, s48, v165
  v_lshlrev_b32 v204, 16, v166
  v_and_b32 v205, s48, v166
  v_lshlrev_b32 v206, 16, v167
  v_and_b32 v207, s48, v167
  v_pk_mul_f32 v[200:201], v[200:201], s[46:47]
  v_pk_mul_f32 v[202:203], v[202:203], s[46:47]
  v_pk_mul_f32 v[204:205], v[204:205], s[46:47]
  v_pk_mul_f32 v[206:207], v[206:207], s[46:47]
  v_cvt_pk_bf16_f32 v164, v200, v201
  v_cvt_pk_bf16_f32 v165, v202, v203
  v_cvt_pk_bf16_f32 v166, v204, v205
  v_cvt_pk_bf16_f32 v167, v206, v207
  v_accvgpr_write_b32 a132, v164
  v_accvgpr_write_b32 a133, v165
  v_accvgpr_write_b32 a134, v166
  v_accvgpr_write_b32 a135, v167
  s_waitcnt lgkmcnt(1)
  v_lshlrev_b32 v192, 16, v168
  v_and_b32 v193, s48, v168
  v_lshlrev_b32 v194, 16, v169
  v_and_b32 v195, s48, v169
  v_lshlrev_b32 v196, 16, v170
  v_and_b32 v197, s48, v170
  v_lshlrev_b32 v198, 16, v171
  v_and_b32 v199, s48, v171
  v_pk_mul_f32 v[192:193], v[192:193], s[46:47]
  v_pk_mul_f32 v[194:195], v[194:195], s[46:47]
  v_pk_mul_f32 v[196:197], v[196:197], s[46:47]
  v_pk_mul_f32 v[198:199], v[198:199], s[46:47]
  v_cvt_pk_bf16_f32 v168, v192, v193
  v_cvt_pk_bf16_f32 v169, v194, v195
  v_cvt_pk_bf16_f32 v170, v196, v197
  v_cvt_pk_bf16_f32 v171, v198, v199
  v_accvgpr_write_b32 a136, v168
  v_accvgpr_write_b32 a137, v169
  v_accvgpr_write_b32 a138, v170
  v_accvgpr_write_b32 a139, v171
  s_waitcnt lgkmcnt(0)
  v_lshlrev_b32 v200, 16, v172
  v_and_b32 v201, s48, v172
  v_lshlrev_b32 v202, 16, v173
  v_and_b32 v203, s48, v173
  v_lshlrev_b32 v204, 16, v174
  v_and_b32 v205, s48, v174
  v_lshlrev_b32 v206, 16, v175
  v_and_b32 v207, s48, v175
  v_pk_mul_f32 v[200:201], v[200:201], s[46:47]
  v_pk_mul_f32 v[202:203], v[202:203], s[46:47]
  v_pk_mul_f32 v[204:205], v[204:205], s[46:47]
  v_pk_mul_f32 v[206:207], v[206:207], s[46:47]
  v_cvt_pk_bf16_f32 v172, v200, v201
  v_cvt_pk_bf16_f32 v173, v202, v203
  v_cvt_pk_bf16_f32 v174, v204, v205
  v_cvt_pk_bf16_f32 v175, v206, v207
  v_accvgpr_write_b32 a140, v172
  v_accvgpr_write_b32 a141, v173
  v_accvgpr_write_b32 a142, v174
  v_accvgpr_write_b32 a143, v175
  v_mfma_f32_16x16x32_bf16 v[120:123], a[192:195], a[128:131], 0
  v_mfma_f32_16x16x32_bf16 v[120:123], a[196:199], a[132:135], v[120:123]
  v_mfma_f32_16x16x32_bf16 v[120:123], a[200:203], a[136:139], v[120:123]
  v_mfma_f32_16x16x32_bf16 v[120:123], a[204:207], a[140:143], v[120:123]
  s_nop 7
  v_max3_f32 v18, v120, v121, v122
  v_max_f32 v18, v18, v123
  v_mov_b32 v19, v18
  s_nop 1
  v_permlane32_swap_b32 v18, v19
  v_max_f32 v18, v18, v19
  v_mov_b32 v19, v18
  s_nop 1
  v_permlane16_swap_b32 v18, v19
  v_max_f32 v18, v18, v19
  v_sub_f32 v136, s81, v18
  v_sub_f32 v137, s81, v18
  v_sub_f32 v138, s81, v18
  v_sub_f32 v139, s81, v18
  v_add_f32 v120, v120, v136
  v_add_f32 v121, v121, v136
  v_mfma_f32_16x16x32_bf16 v[124:127], a[208:211], a[128:131], v[136:139]
  v_add_f32 v122, v122, v136
  v_add_f32 v123, v123, v136
  v_mfma_f32_16x16x32_bf16 v[124:127], a[212:215], a[132:135], v[124:127]
  v_exp_f32 v120, v120
  v_mfma_f32_16x16x32_bf16 v[124:127], a[216:219], a[136:139], v[124:127]
  v_exp_f32 v121, v121
  v_mfma_f32_16x16x32_bf16 v[124:127], a[220:223], a[140:143], v[124:127]
  v_exp_f32 v122, v122
  v_mfma_f32_16x16x32_bf16 v[152:155], v[80:83], a[128:131], v[136:139]
  v_exp_f32 v123, v123
  v_mfma_f32_16x16x32_bf16 v[152:155], v[84:87], a[132:135], v[152:155]
  v_cvt_pk_bf16_f32 v40, v120, v121
  v_cvt_pk_bf16_f32 v41, v122, v123
  v_mfma_f32_16x16x32_bf16 v[152:155], v[88:91], a[136:139], v[152:155]
  v_mfma_f32_16x16x32_bf16 v[152:155], v[92:95], a[140:143], v[152:155]
  v_exp_f32 v124, v124
  v_mfma_f32_16x16x32_bf16 v[156:159], v[96:99], a[128:131], v[136:139]
  v_exp_f32 v125, v125
  v_mfma_f32_16x16x32_bf16 v[156:159], v[100:103], a[132:135], v[156:159]
  v_exp_f32 v126, v126
  v_mfma_f32_16x16x32_bf16 v[156:159], v[104:107], a[136:139], v[156:159]
  v_exp_f32 v127, v127
  v_mfma_f32_16x16x32_bf16 v[156:159], v[108:111], a[140:143], v[156:159]
  v_cvt_pk_bf16_f32 v42, v124, v125
  v_cvt_pk_bf16_f32 v43, v126, v127
  s_waitcnt vmcnt(8)
  ds_read_b128 v[176:179], v8 offset:12288
  ds_read_b128 v[180:183], v9 offset:12288
  ds_read_b128 v[184:187], v10 offset:12288
  ds_read_b128 v[188:191], v11 offset:12288
  s_xor_b32 s28, s29, 0x4000
  s_add_u32 m0, s64, 111104
  s_nop 0
  buffer_load_dwordx4 v1, s[4:7], s28 offen offset:0 nt lds
  s_add_u32 m0, s64, 111136
  s_nop 0
  buffer_load_dwordx4 v1, s[4:7], s28 offen offset:1024 nt lds
  s_add_u32 m0, s64, 128000
  s_nop 0
  buffer_load_dwordx4 v1, s[8:11], s29 offen offset:0 nt lds
  s_add_u32 m0, s64, 128008
  s_nop 0
  buffer_load_dwordx4 v1, s[8:11], s29 offen offset:1024 nt lds
  v_exp_f32 v152, v152
  v_exp_f32 v153, v153
  v_exp_f32 v154, v154
  v_exp_f32 v155, v155
  v_cvt_pk_bf16_f32 v64, v152, v153
  v_cvt_pk_bf16_f32 v65, v154, v155
  v_exp_f32 v156, v156
  v_exp_f32 v157, v157
  v_exp_f32 v158, v158
  v_exp_f32 v159, v159
  v_cvt_pk_bf16_f32 v66, v156, v157
  v_cvt_pk_bf16_f32 v67, v158, v159
  s_waitcnt lgkmcnt(3)
  v_lshlrev_b32 v192, 16, v176
  v_and_b32 v193, s48, v176
  v_lshlrev_b32 v194, 16, v177
  v_and_b32 v195, s48, v177
  v_lshlrev_b32 v196, 16, v178
  v_and_b32 v197, s48, v178
  v_lshlrev_b32 v198, 16, v179
  v_and_b32 v199, s48, v179
  v_pk_mul_f32 v[192:193], v[192:193], s[46:47]
  v_pk_mul_f32 v[194:195], v[194:195], s[46:47]
  v_pk_mul_f32 v[196:197], v[196:197], s[46:47]
  v_pk_mul_f32 v[198:199], v[198:199], s[46:47]
  v_cvt_pk_bf16_f32 v176, v192, v193
  v_cvt_pk_bf16_f32 v177, v194, v195
  v_cvt_pk_bf16_f32 v178, v196, v197
  v_cvt_pk_bf16_f32 v179, v198, v199
  v_accvgpr_write_b32 a144, v176
  v_accvgpr_write_b32 a145, v177
  v_accvgpr_write_b32 a146, v178
  v_accvgpr_write_b32 a147, v179
  v_mfma_f32_32x32x16_bf16 a[48:63], a[240:243], a[248:251], 0
  s_waitcnt lgkmcnt(0)
  v_lshlrev_b32 v200, 16, v180
  v_and_b32 v201, s48, v180
  v_lshlrev_b32 v202, 16, v181
  v_and_b32 v203, s48, v181
  v_lshlrev_b32 v204, 16, v182
  v_and_b32 v205, s48, v182
  v_mfma_f32_16x16x32_bf16 v[112:115], a[192:195], a[144:147], 0
  v_lshlrev_b32 v206, 16, v183
  v_and_b32 v207, s48, v183
  v_lshlrev_b32 v192, 16, v184
  v_and_b32 v193, s48, v184
  v_lshlrev_b32 v194, 16, v185
  v_pk_mul_f32 v[200:201], v[200:201], s[46:47]
  v_pk_mul_f32 v[202:203], v[202:203], s[46:47]
  v_pk_mul_f32 v[204:205], v[204:205], s[46:47]
  v_pk_mul_f32 v[206:207], v[206:207], s[46:47]
  v_cvt_pk_bf16_f32 v180, v200, v201
  v_cvt_pk_bf16_f32 v181, v202, v203
  v_cvt_pk_bf16_f32 v182, v204, v205
  v_cvt_pk_bf16_f32 v183, v206, v207
  v_accvgpr_write_b32 a148, v180
  v_accvgpr_write_b32 a149, v181
  v_accvgpr_write_b32 a150, v182
  v_accvgpr_write_b32 a151, v183
  v_and_b32 v195, s48, v185
  v_lshlrev_b32 v196, 16, v186
  v_mfma_f32_16x16x32_bf16 v[112:115], a[196:199], a[148:151], v[112:115]
  v_and_b32 v197, s48, v186
  v_lshlrev_b32 v198, 16, v187
  v_and_b32 v199, s48, v187
  v_mfma_f32_32x32x16_bf16 a[64:79], a[240:243], a[248:251], 0
  v_lshlrev_b32 v200, 16, v188
  v_and_b32 v201, s48, v188
  v_lshlrev_b32 v202, 16, v189
  v_and_b32 v203, s48, v189
  v_lshlrev_b32 v204, 16, v190
  v_and_b32 v205, s48, v190
  v_lshlrev_b32 v206, 16, v191
  v_and_b32 v207, s48, v191
  v_pk_mul_f32 v[192:193], v[192:193], s[46:47]
  v_pk_mul_f32 v[194:195], v[194:195], s[46:47]
  v_pk_mul_f32 v[196:197], v[196:197], s[46:47]
  v_pk_mul_f32 v[198:199], v[198:199], s[46:47]
  v_cvt_pk_bf16_f32 v184, v192, v193
  v_cvt_pk_bf16_f32 v185, v194, v195
  v_cvt_pk_bf16_f32 v186, v196, v197
  v_cvt_pk_bf16_f32 v187, v198, v199
  v_accvgpr_write_b32 a152, v184
  v_accvgpr_write_b32 a153, v185
  v_accvgpr_write_b32 a154, v186
  v_accvgpr_write_b32 a155, v187
  v_pk_mul_f32 v[200:201], v[200:201], s[46:47]
  v_pk_mul_f32 v[202:203], v[202:203], s[46:47]
  v_pk_mul_f32 v[204:205], v[204:205], s[46:47]
  v_pk_mul_f32 v[206:207], v[206:207], s[46:47]
  v_cvt_pk_bf16_f32 v188, v200, v201
  v_cvt_pk_bf16_f32 v189, v202, v203
  v_mfma_f32_16x16x32_bf16 v[112:115], a[200:203], a[152:155], v[112:115]
  v_cvt_pk_bf16_f32 v190, v204, v205
  v_cvt_pk_bf16_f32 v191, v206, v207
  v_accvgpr_write_b32 a156, v188
  v_accvgpr_write_b32 a157, v189
  v_accvgpr_write_b32 a158, v190
  v_accvgpr_write_b32 a159, v191
  s_nop 1
  v_mfma_f32_16x16x32_bf16 v[112:115], a[204:207], a[156:159], v[112:115]
  s_nop 7
  v_max3_f32 v6, v112, v113, v114
  v_max_f32 v6, v6, v115
  v_mov_b32 v7, v6
  s_nop 1
  v_permlane32_swap_b32 v6, v7
  v_max_f32 v6, v6, v7
  v_mov_b32 v7, v6
  s_nop 1
  v_permlane16_swap_b32 v6, v7
  v_max_f32 v6, v6, v7
  v_sub_f32 v140, s81, v6
  v_sub_f32 v141, s81, v6
  v_sub_f32 v142, s81, v6
  v_sub_f32 v143, s81, v6
  v_add_f32 v112, v112, v140
  v_add_f32 v113, v113, v140
  v_mfma_f32_16x16x32_bf16 v[116:119], a[208:211], a[144:147], v[140:143]
  v_add_f32 v114, v114, v140
  v_add_f32 v115, v115, v140
  v_mfma_f32_16x16x32_bf16 v[116:119], a[212:215], a[148:151], v[116:119]
  v_exp_f32 v112, v112
  v_mfma_f32_16x16x32_bf16 v[116:119], a[216:219], a[152:155], v[116:119]
  v_exp_f32 v113, v113
  v_mfma_f32_16x16x32_bf16 v[116:119], a[220:223], a[156:159], v[116:119]
  v_exp_f32 v114, v114
  v_mfma_f32_16x16x32_bf16 v[120:123], v[80:83], a[144:147], v[140:143]
  v_exp_f32 v115, v115
  v_mfma_f32_16x16x32_bf16 v[120:123], v[84:87], a[148:151], v[120:123]
  v_cvt_pk_bf16_f32 v44, v112, v113
  v_cvt_pk_bf16_f32 v45, v114, v115
  v_mfma_f32_16x16x32_bf16 v[120:123], v[88:91], a[152:155], v[120:123]
  v_mfma_f32_16x16x32_bf16 v[120:123], v[92:95], a[156:159], v[120:123]
  v_exp_f32 v116, v116
  v_mfma_f32_16x16x32_bf16 v[124:127], v[96:99], a[144:147], v[140:143]
  v_exp_f32 v117, v117
  v_mfma_f32_16x16x32_bf16 v[124:127], v[100:103], a[148:151], v[124:127]
  v_exp_f32 v118, v118
  v_mfma_f32_16x16x32_bf16 v[124:127], v[104:107], a[152:155], v[124:127]
  v_exp_f32 v119, v119
  v_mfma_f32_16x16x32_bf16 v[124:127], v[108:111], a[156:159], v[124:127]
  v_cvt_pk_bf16_f32 v46, v116, v117
  v_cvt_pk_bf16_f32 v47, v118, v119
  s_waitcnt vmcnt(8)
  ds_read_b128 v[160:163], v8 offset:16384
  ds_read_b128 v[164:167], v9 offset:16384
  ds_read_b128 v[168:171], v10 offset:16384
  ds_read_b128 v[172:175], v11 offset:16384
  v_exp_f32 v120, v120
  v_exp_f32 v121, v121
  v_exp_f32 v122, v122
  v_exp_f32 v123, v123
  v_cvt_pk_bf16_f32 v68, v120, v121
  v_cvt_pk_bf16_f32 v69, v122, v123
  v_exp_f32 v124, v124
  v_exp_f32 v125, v125
  v_exp_f32 v126, v126
  v_exp_f32 v127, v127
  v_cvt_pk_bf16_f32 v70, v124, v125
  v_cvt_pk_bf16_f32 v71, v126, v127
  v_mfma_f32_32x32x16_bf16 a[80:95], a[240:243], a[248:251], 0
  s_waitcnt lgkmcnt(3)
  v_lshlrev_b32 v192, 16, v160
  v_and_b32 v193, s48, v160
  v_lshlrev_b32 v194, 16, v161
  v_and_b32 v195, s48, v161
  v_lshlrev_b32 v196, 16, v162
  v_and_b32 v197, s48, v162
  v_lshlrev_b32 v198, 16, v163
  v_and_b32 v199, s48, v163
  v_pk_mul_f32 v[192:193], v[192:193], s[46:47]
  v_pk_mul_f32 v[194:195], v[194:195], s[46:47]
  v_pk_mul_f32 v[196:197], v[196:197], s[46:47]
  v_pk_mul_f32 v[198:199], v[198:199], s[46:47]
  v_cvt_pk_bf16_f32 v160, v192, v193
  v_cvt_pk_bf16_f32 v161, v194, v195
  v_cvt_pk_bf16_f32 v162, v196, v197
  v_cvt_pk_bf16_f32 v163, v198, v199
  v_accvgpr_write_b32 a160, v160
  v_accvgpr_write_b32 a161, v161
  v_accvgpr_write_b32 a162, v162
  v_accvgpr_write_b32 a163, v163
  s_waitcnt lgkmcnt(2)
  v_lshlrev_b32 v200, 16, v164
  v_and_b32 v201, s48, v164
  v_mfma_f32_16x16x32_bf16 v[152:155], a[192:195], a[160:163], 0
  s_waitcnt lgkmcnt(0)
  v_lshlrev_b32 v202, 16, v165
  v_and_b32 v203, s48, v165
  v_lshlrev_b32 v204, 16, v166
  v_and_b32 v205, s48, v166
  v_lshlrev_b32 v206, 16, v167
  v_and_b32 v207, s48, v167
  v_pk_mul_f32 v[200:201], v[200:201], s[46:47]
  v_pk_mul_f32 v[202:203], v[202:203], s[46:47]
  v_pk_mul_f32 v[204:205], v[204:205], s[46:47]
  v_pk_mul_f32 v[206:207], v[206:207], s[46:47]
  v_cvt_pk_bf16_f32 v164, v200, v201
  v_cvt_pk_bf16_f32 v165, v202, v203
  v_cvt_pk_bf16_f32 v166, v204, v205
  v_cvt_pk_bf16_f32 v167, v206, v207
  v_accvgpr_write_b32 a164, v164
  v_accvgpr_write_b32 a165, v165
  v_accvgpr_write_b32 a166, v166
  v_accvgpr_write_b32 a167, v167
  v_lshlrev_b32 v192, 16, v168
  v_and_b32 v193, s48, v168
  v_mfma_f32_16x16x32_bf16 v[152:155], a[196:199], a[164:167], v[152:155]
  v_lshlrev_b32 v194, 16, v169
  v_and_b32 v195, s48, v169
  v_lshlrev_b32 v196, 16, v170
  v_and_b32 v197, s48, v170
  v_lshlrev_b32 v198, 16, v171
  v_and_b32 v199, s48, v171
  v_pk_mul_f32 v[192:193], v[192:193], s[46:47]
  v_pk_mul_f32 v[194:195], v[194:195], s[46:47]
  v_pk_mul_f32 v[196:197], v[196:197], s[46:47]
  v_pk_mul_f32 v[198:199], v[198:199], s[46:47]
  v_cvt_pk_bf16_f32 v168, v192, v193
  v_cvt_pk_bf16_f32 v169, v194, v195
  v_cvt_pk_bf16_f32 v170, v196, v197
  v_cvt_pk_bf16_f32 v171, v198, v199
  v_accvgpr_write_b32 a168, v168
  v_accvgpr_write_b32 a169, v169
  v_accvgpr_write_b32 a170, v170
  v_accvgpr_write_b32 a171, v171
  v_lshlrev_b32 v200, 16, v172
  v_and_b32 v201, s48, v172
  v_mfma_f32_16x16x32_bf16 v[152:155], a[200:203], a[168:171], v[152:155]
  v_lshlrev_b32 v202, 16, v173
  v_and_b32 v203, s48, v173
  v_lshlrev_b32 v204, 16, v174
  v_and_b32 v205, s48, v174
  v_lshlrev_b32 v206, 16, v175
  v_and_b32 v207, s48, v175
  v_pk_mul_f32 v[200:201], v[200:201], s[46:47]
  v_pk_mul_f32 v[202:203], v[202:203], s[46:47]
  v_pk_mul_f32 v[204:205], v[204:205], s[46:47]
  v_pk_mul_f32 v[206:207], v[206:207], s[46:47]
  v_cvt_pk_bf16_f32 v172, v200, v201
  v_cvt_pk_bf16_f32 v173, v202, v203
  v_cvt_pk_bf16_f32 v174, v204, v205
  v_cvt_pk_bf16_f32 v175, v206, v207
  v_accvgpr_write_b32 a172, v172
  v_accvgpr_write_b32 a173, v173
  v_accvgpr_write_b32 a174, v174
  v_accvgpr_write_b32 a175, v175
  s_nop 1
  v_mfma_f32_16x16x32_bf16 v[152:155], a[204:207], a[172:175], v[152:155]
  s_nop 7
  v_max3_f32 v18, v152, v153, v154
  v_max_f32 v18, v18, v155
  v_mov_b32 v19, v18
  s_nop 1
  v_permlane32_swap_b32 v18, v19
  v_max_f32 v18, v18, v19
  v_mov_b32 v19, v18
  s_nop 1
  v_permlane16_swap_b32 v18, v19
  v_max_f32 v18, v18, v19
  v_sub_f32 v144, s81, v18
  v_sub_f32 v145, s81, v18
  v_sub_f32 v146, s81, v18
  v_sub_f32 v147, s81, v18
  v_add_f32 v152, v152, v144
  v_add_f32 v153, v153, v144
  v_mfma_f32_16x16x32_bf16 v[156:159], a[208:211], a[160:163], v[144:147]
  v_add_f32 v154, v154, v144
  v_add_f32 v155, v155, v144
  v_mfma_f32_16x16x32_bf16 v[156:159], a[212:215], a[164:167], v[156:159]
  v_exp_f32 v152, v152
  v_mfma_f32_16x16x32_bf16 v[156:159], a[216:219], a[168:171], v[156:159]
  v_exp_f32 v153, v153
  v_mfma_f32_16x16x32_bf16 v[156:159], a[220:223], a[172:175], v[156:159]
  v_exp_f32 v154, v154
  v_mfma_f32_16x16x32_bf16 v[112:115], v[80:83], a[160:163], v[144:147]
  v_exp_f32 v155, v155
  v_mfma_f32_16x16x32_bf16 v[112:115], v[84:87], a[164:167], v[112:115]
  v_cvt_pk_bf16_f32 v48, v152, v153
  v_cvt_pk_bf16_f32 v49, v154, v155
  v_mfma_f32_16x16x32_bf16 v[112:115], v[88:91], a[168:171], v[112:115]
  v_mfma_f32_16x16x32_bf16 v[112:115], v[92:95], a[172:175], v[112:115]
  v_exp_f32 v156, v156
  v_mfma_f32_16x16x32_bf16 v[116:119], v[96:99], a[160:163], v[144:147]
  v_exp_f32 v157, v157
  v_mfma_f32_16x16x32_bf16 v[116:119], v[100:103], a[164:167], v[116:119]
  v_exp_f32 v158, v158
  v_mfma_f32_16x16x32_bf16 v[116:119], v[104:107], a[168:171], v[116:119]
  v_exp_f32 v159, v159
  v_mfma_f32_16x16x32_bf16 v[116:119], v[108:111], a[172:175], v[116:119]
  v_cvt_pk_bf16_f32 v50, v156, v157
  v_cvt_pk_bf16_f32 v51, v158, v159
  s_waitcnt vmcnt(4)
  ds_read_b128 v[176:179], v8 offset:20480
  ds_read_b128 v[180:183], v9 offset:20480
  ds_read_b128 v[184:187], v10 offset:20480
  ds_read_b128 v[188:191], v11 offset:20480
  v_exp_f32 v112, v112
  v_exp_f32 v113, v113
  v_exp_f32 v114, v114
  v_exp_f32 v115, v115
  v_cvt_pk_bf16_f32 v72, v112, v113
  v_cvt_pk_bf16_f32 v73, v114, v115
  v_exp_f32 v116, v116
  v_exp_f32 v117, v117
  v_exp_f32 v118, v118
  v_exp_f32 v119, v119
  v_cvt_pk_bf16_f32 v74, v116, v117
  v_cvt_pk_bf16_f32 v75, v118, v119
  v_mfma_f32_32x32x16_bf16 v[160:175], a[240:243], a[248:251], 0
  s_waitcnt lgkmcnt(3)
  v_lshlrev_b32 v192, 16, v176
  v_and_b32 v193, s48, v176
  v_lshlrev_b32 v194, 16, v177
  v_and_b32 v195, s48, v177
  v_lshlrev_b32 v196, 16, v178
  v_and_b32 v197, s48, v178
  v_lshlrev_b32 v198, 16, v179
  v_and_b32 v199, s48, v179
  v_pk_mul_f32 v[192:193], v[192:193], s[46:47]
  v_pk_mul_f32 v[194:195], v[194:195], s[46:47]
  v_pk_mul_f32 v[196:197], v[196:197], s[46:47]
  v_pk_mul_f32 v[198:199], v[198:199], s[46:47]
  v_cvt_pk_bf16_f32 v176, v192, v193
  v_cvt_pk_bf16_f32 v177, v194, v195
  v_cvt_pk_bf16_f32 v178, v196, v197
  v_cvt_pk_bf16_f32 v179, v198, v199
  v_accvgpr_write_b32 a176, v176
  v_accvgpr_write_b32 a177, v177
  v_accvgpr_write_b32 a178, v178
  v_accvgpr_write_b32 a179, v179
  s_waitcnt lgkmcnt(2)
  v_lshlrev_b32 v200, 16, v180
  v_and_b32 v201, s48, v180
  v_mfma_f32_16x16x32_bf16 v[120:123], a[192:195], a[176:179], 0
  s_waitcnt lgkmcnt(0)
  v_lshlrev_b32 v202, 16, v181
  v_and_b32 v203, s48, v181
  v_lshlrev_b32 v204, 16, v182
  v_and_b32 v205, s48, v182
  v_lshlrev_b32 v206, 16, v183
  v_and_b32 v207, s48, v183
  v_pk_mul_f32 v[200:201], v[200:201], s[46:47]
  v_pk_mul_f32 v[202:203], v[202:203], s[46:47]
  v_pk_mul_f32 v[204:205], v[204:205], s[46:47]
  v_pk_mul_f32 v[206:207], v[206:207], s[46:47]
  v_cvt_pk_bf16_f32 v180, v200, v201
  v_cvt_pk_bf16_f32 v181, v202, v203
  v_cvt_pk_bf16_f32 v182, v204, v205
  v_cvt_pk_bf16_f32 v183, v206, v207
  v_accvgpr_write_b32 a180, v180
  v_accvgpr_write_b32 a181, v181
  v_accvgpr_write_b32 a182, v182
  v_accvgpr_write_b32 a183, v183
  v_lshlrev_b32 v192, 16, v184
  v_and_b32 v193, s48, v184
  v_mfma_f32_16x16x32_bf16 v[120:123], a[196:199], a[180:183], v[120:123]
  v_lshlrev_b32 v194, 16, v185
  v_and_b32 v195, s48, v185
  v_lshlrev_b32 v196, 16, v186
  v_and_b32 v197, s48, v186
  v_lshlrev_b32 v198, 16, v187
  v_and_b32 v199, s48, v187
  v_pk_mul_f32 v[192:193], v[192:193], s[46:47]
  v_pk_mul_f32 v[194:195], v[194:195], s[46:47]
  v_pk_mul_f32 v[196:197], v[196:197], s[46:47]
  v_pk_mul_f32 v[198:199], v[198:199], s[46:47]
  v_cvt_pk_bf16_f32 v184, v192, v193
  v_cvt_pk_bf16_f32 v185, v194, v195
  v_cvt_pk_bf16_f32 v186, v196, v197
  v_cvt_pk_bf16_f32 v187, v198, v199
  v_accvgpr_write_b32 a184, v184
  v_accvgpr_write_b32 a185, v185
  v_accvgpr_write_b32 a186, v186
  v_accvgpr_write_b32 a187, v187
  v_lshlrev_b32 v200, 16, v188
  v_and_b32 v201, s48, v188
  v_mfma_f32_16x16x32_bf16 v[120:123], a[200:203], a[184:187], v[120:123]
  v_lshlrev_b32 v202, 16, v189
  v_and_b32 v203, s48, v189
  v_lshlrev_b32 v204, 16, v190
  v_and_b32 v205, s48, v190
  v_lshlrev_b32 v206, 16, v191
  v_and_b32 v207, s48, v191
  v_pk_mul_f32 v[200:201], v[200:201], s[46:47]
  v_pk_mul_f32 v[202:203], v[202:203], s[46:47]
  v_pk_mul_f32 v[204:205], v[204:205], s[46:47]
  v_pk_mul_f32 v[206:207], v[206:207], s[46:47]
  v_cvt_pk_bf16_f32 v188, v200, v201
  v_cvt_pk_bf16_f32 v189, v202, v203
  v_cvt_pk_bf16_f32 v190, v204, v205
  v_cvt_pk_bf16_f32 v191, v206, v207
  v_accvgpr_write_b32 a188, v188
  v_accvgpr_write_b32 a189, v189
  v_accvgpr_write_b32 a190, v190
  v_accvgpr_write_b32 a191, v191
  v_mfma_f32_32x32x16_bf16 v[176:191], a[240:243], a[248:251], 0
  v_mfma_f32_32x32x16_bf16 v[192:207], a[240:243], a[248:251], 0
  v_mfma_f32_16x16x32_bf16 v[120:123], a[204:207], a[188:191], v[120:123]
  s_waitcnt vmcnt(0)
  s_barrier
  ds_read_b128 a[192:195], v2 offset:16896
  ds_read_b128 a[196:199], v2 offset:16960
  ds_read_b128 a[200:203], v2 offset:17024
  ds_read_b128 a[204:207], v2 offset:17088
  ds_read_b64_tr_b16 a[224:225], v3 offset:0
  ds_read_b64_tr_b16 a[226:227], v3 offset:256
  ds_read_b64_tr_b16 a[228:229], v3 offset:8448
  v_max3_f32 v6, v120, v121, v122
  v_max_f32 v6, v6, v123
  v_mov_b32 v7, v6
  ds_read_b64_tr_b16 a[230:231], v3 offset:8704
  ds_read_b64_tr_b16 a[236:237], v3 offset:8456
  v_permlane32_swap_b32 v6, v7
  v_max_f32 v6, v6, v7
  v_mov_b32 v7, v6
  s_nop 1
  v_permlane16_swap_b32 v6, v7
  v_max_f32 v6, v6, v7
  v_sub_f32 v148, s81, v6
  v_sub_f32 v149, s81, v6
  v_sub_f32 v150, s81, v6
  v_sub_f32 v151, s81, v6
  v_add_f32 v120, v120, v148
  v_add_f32 v121, v121, v148
  v_mfma_f32_16x16x32_bf16 v[124:127], a[208:211], a[176:179], v[148:151]
  v_add_f32 v122, v122, v148
  v_add_f32 v123, v123, v148
  v_mfma_f32_16x16x32_bf16 v[124:127], a[212:215], a[180:183], v[124:127]
  v_exp_f32 v120, v120
  v_mfma_f32_16x16x32_bf16 v[124:127], a[216:219], a[184:187], v[124:127]
  v_exp_f32 v121, v121
  v_mfma_f32_16x16x32_bf16 v[124:127], a[220:223], a[188:191], v[124:127]
  v_exp_f32 v122, v122
  v_mfma_f32_16x16x32_bf16 v[152:155], v[80:83], a[176:179], v[148:151]
  s_waitcnt lgkmcnt(0)
  v_exp_f32 v123, v123
  v_mfma_f32_16x16x32_bf16 v[152:155], v[84:87], a[180:183], v[152:155]
  v_cvt_pk_bf16_f32 v52, v120, v121
  v_cvt_pk_bf16_f32 v53, v122, v123
  v_mfma_f32_16x16x32_bf16 v[152:155], v[88:91], a[184:187], v[152:155]
  v_exp_f32 v124, v124
  v_mfma_f32_16x16x32_bf16 v[152:155], v[92:95], a[188:191], v[152:155]
  v_exp_f32 v125, v125
  v_mfma_f32_16x16x32_bf16 v[156:159], v[96:99], a[176:179], v[148:151]
  v_exp_f32 v126, v126
  v_mfma_f32_16x16x32_bf16 v[156:159], v[100:103], a[180:183], v[156:159]
  v_exp_f32 v127, v127
  v_mfma_f32_16x16x32_bf16 v[156:159], v[104:107], a[184:187], v[156:159]
  v_cvt_pk_bf16_f32 v54, v124, v125
  v_cvt_pk_bf16_f32 v55, v126, v127
  v_mfma_f32_16x16x32_bf16 v[156:159], v[108:111], a[188:191], v[156:159]
  v_exp_f32 v152, v152
  v_exp_f32 v153, v153
  v_exp_f32 v154, v154
  v_exp_f32 v155, v155
  v_cvt_pk_bf16_f32 v76, v152, v153
  v_cvt_pk_bf16_f32 v77, v154, v155
  s_waitcnt lgkmcnt(0)
  s_branch ENTRY1_6
MID_6:
  s_mov_b32 s39, 6
  s_mov_b32 s61, 1
  s_waitcnt lgkmcnt(0)
  s_branch LAST0_6
.p2align 6
LOOP0_6:
  v_mfma_f32_16x16x32_bf16 v[152:155], a[192:195], a[96:99], v[128:131]
  s_waitcnt lgkmcnt(8)
  v_exp_f32 v156, v156
  v_mfma_f32_16x16x32_bf16 v[152:155], a[196:199], a[100:103], v[152:155]
  ds_read2st64_b32 v[12:13], v4 offset0:0 offset1:1
  ds_read2st64_b32 v[14:15], v4 offset0:2 offset1:3
  v_mfma_f32_16x16x32_bf16 v[152:155], a[200:203], a[104:107], v[152:155]
  s_waitcnt lgkmcnt(5)
  v_exp_f32 v157, v157
  v_mfma_f32_16x16x32_bf16 v[152:155], a[204:207], a[108:111], v[152:155]
  ds_read_b64_tr_b16 a[238:239], v3 offset:25608
  v_cvt_pk_bf16_f32 v126, v156, v157
  v_mfma_f32_16x16x32_bf16 v[160:163], a[224:227], v[80:83], v[160:163]
  s_waitcnt lgkmcnt(4)
  v_exp_f32 v158, v158
  v_mfma_f32_16x16x32_bf16 v[160:163], a[228:231], v[104:107], v[160:163]
  ds_read_b128 a[208:211], v2 offset:256
  v_mfma_f32_16x16x32_bf16 v[192:195], a[228:231], v[108:111], v[192:195]
  v_exp_f32 v159, v159
  v_mfma_f32_16x16x32_bf16 v[192:195], a[224:227], v[84:87], v[192:195]
  ds_read_b64_tr_b16 a[232:233], v3 offset:16904
  v_cvt_pk_bf16_f32 v127, v158, v159
  v_mfma_f32_16x16x32_bf16 v[156:159], a[192:195], a[112:115], v[132:135]
  v_exp_f32 v152, v152
  v_mfma_f32_16x16x32_bf16 v[156:159], a[196:199], a[116:119], v[156:159]
  ds_read_b128 a[212:215], v2 offset:320
  v_mfma_f32_16x16x32_bf16 v[156:159], a[200:203], a[120:123], v[156:159]
  v_exp_f32 v153, v153
  v_mfma_f32_16x16x32_bf16 v[156:159], a[204:207], a[124:127], v[156:159]
  ds_read_b64_tr_b16 a[234:235], v3 offset:17160
  v_cvt_pk_bf16_f32 v32, v152, v153
  v_mfma_f32_16x16x32_bf16 v[224:227], a[224:227], v[88:91], v[224:227]
  s_waitcnt lgkmcnt(6)
  v_exp_f32 v154, v154
  v_mfma_f32_16x16x32_bf16 v[224:227], a[228:231], v[112:115], v[224:227]
  v_lshlrev_b32 v16, 16, v12
  v_and_b32 v17, s48, v12
  v_mfma_f32_16x16x32_bf16 a[0:3], a[228:231], v[116:119], a[0:3]
  v_exp_f32 v155, v155
  v_mfma_f32_16x16x32_bf16 a[0:3], a[224:227], v[92:95], a[0:3]
  ds_read_b128 a[216:219], v2 offset:384
  v_cvt_pk_bf16_f32 v33, v154, v155
  v_mfma_f32_16x16x32_bf16 v[152:155], a[192:195], a[128:131], v[136:139]
  v_exp_f32 v156, v156
  v_mfma_f32_16x16x32_bf16 v[152:155], a[196:199], a[132:135], v[152:155]
  v_mul_f32 v16, s46, v16
  v_mul_f32 v17, s46, v17
  v_mfma_f32_16x16x32_bf16 v[152:155], a[200:203], a[136:139], v[152:155]
  v_exp_f32 v157, v157
  v_mfma_f32_16x16x32_bf16 v[152:155], a[204:207], a[140:143], v[152:155]
  ds_read_b128 a[220:223], v2 offset:448
  v_cvt_pk_bf16_f32 v36, v156, v157
  v_mfma_f32_16x16x32_bf16 a[32:35], a[224:227], v[96:99], a[32:35]
  v_exp_f32 v158, v158
  v_mfma_f32_16x16x32_bf16 a[32:35], a[228:231], v[120:123], a[32:35]
  v_cvt_pk_bf16_f32 v12, v16, v17
  v_lshlrev_b32 v18, 16, v13
  v_mfma_f32_16x16x32_bf16 a[64:67], a[228:231], v[124:127], a[64:67]
  v_exp_f32 v159, v159
  v_mfma_f32_16x16x32_bf16 a[64:67], a[224:227], v[100:103], a[64:67]
  ds_read_b64_tr_b16 a[224:225], v3 offset:16960
  v_cvt_pk_bf16_f32 v37, v158, v159
  v_smfmac_f32_16x16x64_bf16 v[20:23], a[240:243], v[80:87], v5
  v_mfma_f32_16x16x32_bf16 v[156:159], a[192:195], a[144:147], v[140:143]
  v_exp_f32 v152, v152
  v_mfma_f32_16x16x32_bf16 v[156:159], a[196:199], a[148:151], v[156:159]
  v_and_b32 v19, s48, v13
  v_mul_f32 v18, s46, v18
  v_mfma_f32_16x16x32_bf16 v[156:159], a[200:203], a[152:155], v[156:159]
  s_waitcnt lgkmcnt(3)
  v_exp_f32 v153, v153
  v_mfma_f32_16x16x32_bf16 v[156:159], a[204:207], a[156:159], v[156:159]
  ds_read_b64_tr_b16 a[226:227], v3 offset:17216
  v_cvt_pk_bf16_f32 v40, v152, v153
  v_mfma_f32_16x16x32_bf16 v[164:167], a[232:235], v[80:83], v[164:167]
  v_exp_f32 v154, v154
  v_mfma_f32_16x16x32_bf16 v[164:167], a[236:239], v[104:107], v[164:167]
  v_mul_f32 v19, s46, v19
  v_cvt_pk_bf16_f32 v13, v18, v19
  v_mfma_f32_16x16x32_bf16 v[196:199], a[236:239], v[108:111], v[196:199]
  v_exp_f32 v155, v155
  v_mfma_f32_16x16x32_bf16 v[196:199], a[232:235], v[84:87], v[196:199]
  ds_read_b64_tr_b16 a[228:229], v3 offset:25408
  v_cvt_pk_bf16_f32 v41, v154, v155
  v_mfma_f32_16x16x32_bf16 v[152:155], a[192:195], a[160:163], v[144:147]
  v_exp_f32 v156, v156
  v_mfma_f32_16x16x32_bf16 v[152:155], a[196:199], a[164:167], v[152:155]
  v_lshlrev_b32 v16, 16, v14
  v_and_b32 v17, s48, v14
  v_mfma_f32_16x16x32_bf16 v[152:155], a[200:203], a[168:171], v[152:155]
  v_exp_f32 v157, v157
  v_mfma_f32_16x16x32_bf16 v[152:155], a[204:207], a[172:175], v[152:155]
  ds_read_b64_tr_b16 a[230:231], v3 offset:25664
  v_cvt_pk_bf16_f32 v44, v156, v157
  v_mfma_f32_16x16x32_bf16 v[228:231], a[232:235], v[88:91], v[228:231]
  v_exp_f32 v158, v158
  v_mfma_f32_16x16x32_bf16 v[228:231], a[236:239], v[112:115], v[228:231]
  v_mul_f32 v16, s46, v16
  v_mul_f32 v17, s46, v17
  v_mfma_f32_16x16x32_bf16 a[4:7], a[236:239], v[116:119], a[4:7]
  v_exp_f32 v159, v159
  v_mfma_f32_16x16x32_bf16 a[4:7], a[232:235], v[92:95], a[4:7]
  v_cvt_pk_bf16_f32 v45, v158, v159
  v_mfma_f32_16x16x32_bf16 v[156:159], a[192:195], a[176:179], v[148:151]
  v_exp_f32 v152, v152
  v_mfma_f32_16x16x32_bf16 v[156:159], a[196:199], a[180:183], v[156:159]
  v_cvt_pk_bf16_f32 v14, v16, v17
  v_lshlrev_b32 v18, 16, v15
  v_mfma_f32_16x16x32_bf16 v[156:159], a[200:203], a[184:187], v[156:159]
  v_exp_f32 v153, v153
  v_mfma_f32_16x16x32_bf16 v[156:159], a[204:207], a[188:191], v[156:159]
  v_cvt_pk_bf16_f32 v48, v152, v153
  v_mfma_f32_16x16x32_bf16 a[36:39], a[232:235], v[96:99], a[36:39]
  v_exp_f32 v154, v154
  v_mfma_f32_16x16x32_bf16 a[36:39], a[236:239], v[120:123], a[36:39]
  v_and_b32 v19, s48, v15
  v_mul_f32 v18, s46, v18
  v_mfma_f32_16x16x32_bf16 a[68:71], a[236:239], v[124:127], a[68:71]
  v_exp_f32 v155, v155
  v_mfma_f32_16x16x32_bf16 a[68:71], a[232:235], v[100:103], a[68:71]
  ds_read_b64_tr_b16 a[236:237], v3 offset:25416
  v_cvt_pk_bf16_f32 v49, v154, v155
  v_mfma_f32_16x16x32_bf16 v[152:155], a[208:211], a[96:99], v[128:131]
  s_waitcnt lgkmcnt(6)
  v_exp_f32 v156, v156
  v_mfma_f32_16x16x32_bf16 v[152:155], a[212:215], a[100:103], v[152:155]
  ds_read_b64_tr_b16 a[238:239], v3 offset:25672
  ds_read_b64_tr_b16 a[232:233], v3 offset:16968
  v_mfma_f32_16x16x32_bf16 v[152:155], a[216:219], a[104:107], v[152:155]
  s_waitcnt lgkmcnt(5)
  v_exp_f32 v157, v157
  v_mfma_f32_16x16x32_bf16 v[152:155], a[220:223], a[108:111], v[152:155]
  ds_read_b64_tr_b16 a[234:235], v3 offset:17224
  v_cvt_pk_bf16_f32 v52, v156, v157
  v_mfma_f32_16x16x32_bf16 v[168:171], a[224:227], v[80:83], v[168:171]
  s_waitcnt lgkmcnt(4)
  v_exp_f32 v158, v158
  v_mfma_f32_16x16x32_bf16 v[168:171], a[228:231], v[104:107], v[168:171]
  v_mul_f32 v19, s46, v19
  v_cvt_pk_bf16_f32 v15, v18, v19
  v_mfma_f32_16x16x32_bf16 v[200:203], a[228:231], v[108:111], v[200:203]
  v_exp_f32 v159, v159
  v_mfma_f32_16x16x32_bf16 v[200:203], a[224:227], v[84:87], v[200:203]
  v_cvt_pk_bf16_f32 v53, v158, v159
  v_smfmac_f32_16x16x64_bf16 v[24:27], a[240:243], v[88:95], v5
  v_mfma_f32_16x16x32_bf16 v[156:159], a[208:211], a[112:115], v[132:135]
  v_exp_f32 v152, v152
  v_mfma_f32_16x16x32_bf16 v[156:159], a[212:215], a[116:119], v[156:159]
  v_mfma_f32_16x16x32_bf16 v[156:159], a[216:219], a[120:123], v[156:159]
  v_exp_f32 v153, v153
  v_mfma_f32_16x16x32_bf16 v[156:159], a[220:223], a[124:127], v[156:159]
  v_cvt_pk_bf16_f32 v34, v152, v153
  v_smfmac_f32_16x16x64_bf16 v[28:31], a[240:243], v[96:103], v5
  v_mfma_f32_16x16x32_bf16 v[232:235], a[224:227], v[88:91], v[232:235]
  v_exp_f32 v154, v154
  v_mfma_f32_16x16x32_bf16 v[232:235], a[228:231], v[112:115], v[232:235]
  s_waitcnt lgkmcnt(0)
  s_barrier
  v_mfma_f32_16x16x32_bf16 a[8:11], a[228:231], v[116:119], a[8:11]
  v_exp_f32 v155, v155
  v_mfma_f32_16x16x32_bf16 a[8:11], a[224:227], v[92:95], a[8:11]
  ds_read_b128 a[192:195], v2 offset:8448
  v_cvt_pk_bf16_f32 v35, v154, v155
  v_mfma_f32_16x16x32_bf16 v[152:155], a[208:211], a[128:131], v[136:139]
  v_exp_f32 v156, v156
  v_mfma_f32_16x16x32_bf16 v[152:155], a[212:215], a[132:135], v[152:155]
  ds_write_b32 v4, v12 offset:0
  v_mfma_f32_16x16x32_bf16 v[152:155], a[216:219], a[136:139], v[152:155]
  v_exp_f32 v157, v157
  v_mfma_f32_16x16x32_bf16 v[152:155], a[220:223], a[140:143], v[152:155]
  ds_read_b128 a[196:199], v2 offset:8512
  v_cvt_pk_bf16_f32 v38, v156, v157
  v_mfma_f32_16x16x32_bf16 a[40:43], a[224:227], v[96:99], a[40:43]
  v_exp_f32 v158, v158
  v_mfma_f32_16x16x32_bf16 a[40:43], a[228:231], v[120:123], a[40:43]
  ds_write_b32 v4, v13 offset:256
  v_mfma_f32_16x16x32_bf16 a[72:75], a[228:231], v[124:127], a[72:75]
  v_exp_f32 v159, v159
  v_mfma_f32_16x16x32_bf16 a[72:75], a[224:227], v[100:103], a[72:75]
  ds_read_b128 a[200:203], v2 offset:8576
  v_cvt_pk_bf16_f32 v39, v158, v159
  v_mfma_f32_16x16x32_bf16 v[156:159], a[208:211], a[144:147], v[140:143]
  v_exp_f32 v152, v152
  v_mfma_f32_16x16x32_bf16 v[156:159], a[212:215], a[148:151], v[156:159]
  ds_write_b32 v4, v14 offset:512
  v_mfma_f32_16x16x32_bf16 v[156:159], a[216:219], a[152:155], v[156:159]
  v_exp_f32 v153, v153
  v_mfma_f32_16x16x32_bf16 v[156:159], a[220:223], a[156:159], v[156:159]
  ds_read_b128 a[204:207], v2 offset:8640
  v_cvt_pk_bf16_f32 v42, v152, v153
  v_mfma_f32_16x16x32_bf16 v[172:175], a[232:235], v[80:83], v[172:175]
  v_exp_f32 v154, v154
  v_mfma_f32_16x16x32_bf16 v[172:175], a[236:239], v[104:107], v[172:175]
  ds_write_b32 v4, v15 offset:768
  v_mfma_f32_16x16x32_bf16 v[204:207], a[236:239], v[108:111], v[204:207]
  v_exp_f32 v155, v155
  v_mfma_f32_16x16x32_bf16 v[204:207], a[232:235], v[84:87], v[204:207]
  ds_read_b64_tr_b16 a[224:225], v3 offset:17024
  v_cvt_pk_bf16_f32 v43, v154, v155
  v_mfma_f32_16x16x32_bf16 v[152:155], a[208:211], a[160:163], v[144:147]
  v_exp_f32 v156, v156
  v_mfma_f32_16x16x32_bf16 v[152:155], a[212:215], a[164:167], v[152:155]
  ds_read_b64_tr_b16 a[226:227], v3 offset:17280
  v_mfma_f32_16x16x32_bf16 v[152:155], a[216:219], a[168:171], v[152:155]
  v_exp_f32 v157, v157
  v_mfma_f32_16x16x32_bf16 v[152:155], a[220:223], a[172:175], v[152:155]
  ds_read_b64_tr_b16 a[228:229], v3 offset:25472
  v_cvt_pk_bf16_f32 v46, v156, v157
  v_mfma_f32_16x16x32_bf16 v[236:239], a[232:235], v[88:91], v[236:239]
  v_exp_f32 v158, v158
  v_mfma_f32_16x16x32_bf16 v[236:239], a[236:239], v[112:115], v[236:239]
  ds_read_b64_tr_b16 a[230:231], v3 offset:25728
  v_mfma_f32_16x16x32_bf16 a[12:15], a[236:239], v[116:119], a[12:15]
  v_exp_f32 v159, v159
  v_mfma_f32_16x16x32_bf16 a[12:15], a[232:235], v[92:95], a[12:15]
  v_cvt_pk_bf16_f32 v47, v158, v159
  v_mfma_f32_16x16x32_bf16 v[156:159], a[208:211], a[176:179], v[148:151]
  v_exp_f32 v152, v152
  v_mfma_f32_16x16x32_bf16 v[156:159], a[212:215], a[180:183], v[156:159]
  v_mfma_f32_16x16x32_bf16 v[156:159], a[216:219], a[184:187], v[156:159]
  v_exp_f32 v153, v153
  v_mfma_f32_16x16x32_bf16 v[156:159], a[220:223], a[188:191], v[156:159]
  v_cvt_pk_bf16_f32 v50, v152, v153
  v_mfma_f32_16x16x32_bf16 a[44:47], a[232:235], v[96:99], a[44:47]
  v_exp_f32 v154, v154
  v_mfma_f32_16x16x32_bf16 a[44:47], a[236:239], v[120:123], a[44:47]
  v_mfma_f32_16x16x32_bf16 a[76:79], a[236:239], v[124:127], a[76:79]
  s_waitcnt lgkmcnt(11)
  v_exp_f32 v155, v155
  v_mfma_f32_16x16x32_bf16 a[76:79], a[232:235], v[100:103], a[76:79]
  ds_read_b64_tr_b16 a[236:237], v3 offset:25480
  v_cvt_pk_bf16_f32 v51, v154, v155
  v_mfma_f32_16x16x32_bf16 v[152:155], a[192:195], a[96:99], v[128:131]
  s_waitcnt lgkmcnt(8)
  v_exp_f32 v156, v156
  v_mfma_f32_16x16x32_bf16 v[152:155], a[196:199], a[100:103], v[152:155]
  ds_read2st64_b32 v[12:13], v4 offset0:4 offset1:5
  ds_read2st64_b32 v[14:15], v4 offset0:6 offset1:7
  v_mfma_f32_16x16x32_bf16 v[152:155], a[200:203], a[104:107], v[152:155]
  s_waitcnt lgkmcnt(5)
  v_exp_f32 v157, v157
  v_mfma_f32_16x16x32_bf16 v[152:155], a[204:207], a[108:111], v[152:155]
  ds_read_b64_tr_b16 a[238:239], v3 offset:25736
  v_cvt_pk_bf16_f32 v54, v156, v157
  v_mfma_f32_16x16x32_bf16 v[176:179], a[224:227], v[80:83], v[176:179]
  s_waitcnt lgkmcnt(4)
  v_exp_f32 v158, v158
  v_mfma_f32_16x16x32_bf16 v[176:179], a[228:231], v[104:107], v[176:179]
  ds_read_b128 a[208:211], v2 offset:8704
  v_mfma_f32_16x16x32_bf16 v[208:211], a[228:231], v[108:111], v[208:211]
  v_exp_f32 v159, v159
  v_mfma_f32_16x16x32_bf16 v[208:211], a[224:227], v[84:87], v[208:211]
  ds_read_b64_tr_b16 a[232:233], v3 offset:17032
  v_cvt_pk_bf16_f32 v55, v158, v159
  v_mfma_f32_16x16x32_bf16 v[156:159], a[192:195], a[112:115], v[132:135]
  v_exp_f32 v152, v152
  v_mfma_f32_16x16x32_bf16 v[156:159], a[196:199], a[116:119], v[156:159]
  ds_read_b128 a[212:215], v2 offset:8768
  v_mfma_f32_16x16x32_bf16 v[156:159], a[200:203], a[120:123], v[156:159]
  v_exp_f32 v153, v153
  v_mfma_f32_16x16x32_bf16 v[156:159], a[204:207], a[124:127], v[156:159]
  ds_read_b64_tr_b16 a[234:235], v3 offset:17288
  v_cvt_pk_bf16_f32 v56, v152, v153
  v_mfma_f32_16x16x32_bf16 v[240:243], a[224:227], v[88:91], v[240:243]
  s_waitcnt lgkmcnt(6)
  v_exp_f32 v154, v154
  v_mfma_f32_16x16x32_bf16 v[240:243], a[228:231], v[112:115], v[240:243]
  v_lshlrev_b32 v16, 16, v12
  v_and_b32 v17, s48, v12
  v_mfma_f32_16x16x32_bf16 a[16:19], a[228:231], v[116:119], a[16:19]
  v_exp_f32 v155, v155
  v_mfma_f32_16x16x32_bf16 a[16:19], a[224:227], v[92:95], a[16:19]
  ds_read_b128 a[216:219], v2 offset:8832
  v_cvt_pk_bf16_f32 v57, v154, v155
  v_mfma_f32_16x16x32_bf16 v[152:155], a[192:195], a[128:131], v[136:139]
  v_exp_f32 v156, v156
  v_mfma_f32_16x16x32_bf16 v[152:155], a[196:199], a[132:135], v[152:155]
  v_mul_f32 v16, s46, v16
  v_mul_f32 v17, s46, v17
  v_mfma_f32_16x16x32_bf16 v[152:155], a[200:203], a[136:139], v[152:155]
  v_exp_f32 v157, v157
  v_mfma_f32_16x16x32_bf16 v[152:155], a[204:207], a[140:143], v[152:155]
  ds_read_b128 a[220:223], v2 offset:8896
  v_cvt_pk_bf16_f32 v60, v156, v157
  v_mfma_f32_16x16x32_bf16 a[48:51], a[224:227], v[96:99], a[48:51]
  v_exp_f32 v158, v158
  v_mfma_f32_16x16x32_bf16 a[48:51], a[228:231], v[120:123], a[48:51]
  v_cvt_pk_bf16_f32 v12, v16, v17
  v_lshlrev_b32 v18, 16, v13
  v_mfma_f32_16x16x32_bf16 a[80:83], a[228:231], v[124:127], a[80:83]
  v_exp_f32 v159, v159
  v_mfma_f32_16x16x32_bf16 a[80:83], a[224:227], v[100:103], a[80:83]
  ds_read_b64_tr_b16 a[224:225], v3 offset:17088
  v_cvt_pk_bf16_f32 v61, v158, v159
  v_smfmac_f32_16x16x64_bf16 v[20:23], a[240:243], v[104:111], v5
  v_mfma_f32_16x16x32_bf16 v[156:159], a[192:195], a[144:147], v[140:143]
  v_exp_f32 v152, v152
  v_mfma_f32_16x16x32_bf16 v[156:159], a[196:199], a[148:151], v[156:159]
  v_and_b32 v19, s48, v13
  v_mul_f32 v18, s46, v18
  v_mfma_f32_16x16x32_bf16 v[156:159], a[200:203], a[152:155], v[156:159]
  s_waitcnt lgkmcnt(3)
  v_exp_f32 v153, v153
  v_mfma_f32_16x16x32_bf16 v[156:159], a[204:207], a[156:159], v[156:159]
  ds_read_b64_tr_b16 a[226:227], v3 offset:17344
  v_cvt_pk_bf16_f32 v64, v152, v153
  v_mfma_f32_16x16x32_bf16 v[180:183], a[232:235], v[80:83], v[180:183]
  v_exp_f32 v154, v154
  v_mfma_f32_16x16x32_bf16 v[180:183], a[236:239], v[104:107], v[180:183]
  v_mul_f32 v19, s46, v19
  v_cvt_pk_bf16_f32 v13, v18, v19
  v_mfma_f32_16x16x32_bf16 v[212:215], a[236:239], v[108:111], v[212:215]
  v_exp_f32 v155, v155
  v_mfma_f32_16x16x32_bf16 v[212:215], a[232:235], v[84:87], v[212:215]
  ds_read_b64_tr_b16 a[228:229], v3 offset:25536
  v_cvt_pk_bf16_f32 v65, v154, v155
  v_mfma_f32_16x16x32_bf16 v[152:155], a[192:195], a[160:163], v[144:147]
  v_exp_f32 v156, v156
  v_mfma_f32_16x16x32_bf16 v[152:155], a[196:199], a[164:167], v[152:155]
  v_lshlrev_b32 v16, 16, v14
  v_and_b32 v17, s48, v14
  v_mfma_f32_16x16x32_bf16 v[152:155], a[200:203], a[168:171], v[152:155]
  v_exp_f32 v157, v157
  v_mfma_f32_16x16x32_bf16 v[152:155], a[204:207], a[172:175], v[152:155]
  ds_read_b64_tr_b16 a[230:231], v3 offset:25792
  v_cvt_pk_bf16_f32 v68, v156, v157
  v_mfma_f32_16x16x32_bf16 v[244:247], a[232:235], v[88:91], v[244:247]
  v_exp_f32 v158, v158
  v_mfma_f32_16x16x32_bf16 v[244:247], a[236:239], v[112:115], v[244:247]
  v_mul_f32 v16, s46, v16
  v_mul_f32 v17, s46, v17
  v_mfma_f32_16x16x32_bf16 a[20:23], a[236:239], v[116:119], a[20:23]
  v_exp_f32 v159, v159
  v_mfma_f32_16x16x32_bf16 a[20:23], a[232:235], v[92:95], a[20:23]
  v_cvt_pk_bf16_f32 v69, v158, v159
  v_mfma_f32_16x16x32_bf16 v[156:159], a[192:195], a[176:179], v[148:151]
  v_exp_f32 v152, v152
  v_mfma_f32_16x16x32_bf16 v[156:159], a[196:199], a[180:183], v[156:159]
  v_cvt_pk_bf16_f32 v14, v16, v17
  v_lshlrev_b32 v18, 16, v15
  v_mfma_f32_16x16x32_bf16 v[156:159], a[200:203], a[184:187], v[156:159]
  v_exp_f32 v153, v153
  v_mfma_f32_16x16x32_bf16 v[156:159], a[204:207], a[188:191], v[156:159]
  v_cvt_pk_bf16_f32 v72, v152, v153
  v_mfma_f32_16x16x32_bf16 a[52:55], a[232:235], v[96:99], a[52:55]
  v_exp_f32 v154, v154
  v_mfma_f32_16x16x32_bf16 a[52:55], a[236:239], v[120:123], a[52:55]
  v_and_b32 v19, s48, v15
  v_mul_f32 v18, s46, v18
  v_mfma_f32_16x16x32_bf16 a[84:87], a[236:239], v[124:127], a[84:87]
  v_exp_f32 v155, v155
  v_mfma_f32_16x16x32_bf16 a[84:87], a[232:235], v[100:103], a[84:87]
  ds_read_b64_tr_b16 a[236:237], v3 offset:25544
  v_cvt_pk_bf16_f32 v73, v154, v155
  v_mfma_f32_16x16x32_bf16 v[152:155], a[208:211], a[96:99], v[128:131]
  s_waitcnt lgkmcnt(6)
  v_exp_f32 v156, v156
  v_mfma_f32_16x16x32_bf16 v[152:155], a[212:215], a[100:103], v[152:155]
  ds_read_b64_tr_b16 a[238:239], v3 offset:25800
  ds_read_b64_tr_b16 a[232:233], v3 offset:17096
  v_mfma_f32_16x16x32_bf16 v[152:155], a[216:219], a[104:107], v[152:155]
  s_waitcnt lgkmcnt(5)
  v_exp_f32 v157, v157
  v_mfma_f32_16x16x32_bf16 v[152:155], a[220:223], a[108:111], v[152:155]
  ds_read_b64_tr_b16 a[234:235], v3 offset:17352
  v_cvt_pk_bf16_f32 v76, v156, v157
  v_mfma_f32_16x16x32_bf16 v[184:187], a[224:227], v[80:83], v[184:187]
  s_waitcnt lgkmcnt(4)
  v_exp_f32 v158, v158
  v_mfma_f32_16x16x32_bf16 v[184:187], a[228:231], v[104:107], v[184:187]
  v_mul_f32 v19, s46, v19
  v_cvt_pk_bf16_f32 v15, v18, v19
  v_mfma_f32_16x16x32_bf16 v[216:219], a[228:231], v[108:111], v[216:219]
  v_exp_f32 v159, v159
  v_mfma_f32_16x16x32_bf16 v[216:219], a[224:227], v[84:87], v[216:219]
  v_cvt_pk_bf16_f32 v77, v158, v159
  v_smfmac_f32_16x16x64_bf16 v[24:27], a[240:243], v[112:119], v5
  v_mfma_f32_16x16x32_bf16 v[156:159], a[208:211], a[112:115], v[132:135]
  v_exp_f32 v152, v152
  v_mfma_f32_16x16x32_bf16 v[156:159], a[212:215], a[116:119], v[156:159]
  v_mfma_f32_16x16x32_bf16 v[156:159], a[216:219], a[120:123], v[156:159]
  v_exp_f32 v153, v153
  v_mfma_f32_16x16x32_bf16 v[156:159], a[220:223], a[124:127], v[156:159]
  v_cvt_pk_bf16_f32 v58, v152, v153
  v_smfmac_f32_16x16x64_bf16 v[28:31], a[240:243], v[120:127], v5
  v_mfma_f32_16x16x32_bf16 v[248:251], a[224:227], v[88:91], v[248:251]
  v_exp_f32 v154, v154
  v_mfma_f32_16x16x32_bf16 v[248:251], a[228:231], v[112:115], v[248:251]
  s_waitcnt lgkmcnt(0)
  s_barrier
  v_mfma_f32_16x16x32_bf16 a[24:27], a[228:231], v[116:119], a[24:27]
  v_exp_f32 v155, v155
  v_mfma_f32_16x16x32_bf16 a[24:27], a[224:227], v[92:95], a[24:27]
  ds_read_b128 a[192:195], v2 offset:16896
  v_cvt_pk_bf16_f32 v59, v154, v155
  v_mfma_f32_16x16x32_bf16 v[152:155], a[208:211], a[128:131], v[136:139]
  v_exp_f32 v156, v156
  v_mfma_f32_16x16x32_bf16 v[152:155], a[212:215], a[132:135], v[152:155]
  ds_write_b32 v4, v12 offset:1024
  v_mfma_f32_16x16x32_bf16 v[152:155], a[216:219], a[136:139], v[152:155]
  v_exp_f32 v157, v157
  v_mfma_f32_16x16x32_bf16 v[152:155], a[220:223], a[140:143], v[152:155]
  ds_read_b128 a[196:199], v2 offset:16960
  v_cvt_pk_bf16_f32 v62, v156, v157
  v_mfma_f32_16x16x32_bf16 a[56:59], a[224:227], v[96:99], a[56:59]
  v_exp_f32 v158, v158
  v_mfma_f32_16x16x32_bf16 a[56:59], a[228:231], v[120:123], a[56:59]
  ds_write_b32 v4, v13 offset:1280
  v_mfma_f32_16x16x32_bf16 a[88:91], a[228:231], v[124:127], a[88:91]
  v_exp_f32 v159, v159
  v_mfma_f32_16x16x32_bf16 a[88:91], a[224:227], v[100:103], a[88:91]
  ds_read_b128 a[200:203], v2 offset:17024
  v_cvt_pk_bf16_f32 v63, v158, v159
  v_mfma_f32_16x16x32_bf16 v[156:159], a[208:211], a[144:147], v[140:143]
  v_exp_f32 v152, v152
  v_mfma_f32_16x16x32_bf16 v[156:159], a[212:215], a[148:151], v[156:159]
  ds_write_b32 v4, v14 offset:1536
  v_mfma_f32_16x16x32_bf16 v[156:159], a[216:219], a[152:155], v[156:159]
  v_exp_f32 v153, v153
  v_mfma_f32_16x16x32_bf16 v[156:159], a[220:223], a[156:159], v[156:159]
  ds_read_b128 a[204:207], v2 offset:17088
  v_cvt_pk_bf16_f32 v66, v152, v153
  v_mfma_f32_16x16x32_bf16 v[188:191], a[232:235], v[80:83], v[188:191]
  v_exp_f32 v154, v154
  v_mfma_f32_16x16x32_bf16 v[188:191], a[236:239], v[104:107], v[188:191]
  ds_write_b32 v4, v15 offset:1792
  v_mfma_f32_16x16x32_bf16 v[220:223], a[236:239], v[108:111], v[220:223]
  v_exp_f32 v155, v155
  v_mfma_f32_16x16x32_bf16 v[220:223], a[232:235], v[84:87], v[220:223]
  ds_read_b64_tr_b16 a[224:225], v3 offset:0
  v_cvt_pk_bf16_f32 v67, v154, v155
  v_mfma_f32_16x16x32_bf16 v[152:155], a[208:211], a[160:163], v[144:147]
  v_exp_f32 v156, v156
  v_mfma_f32_16x16x32_bf16 v[152:155], a[212:215], a[164:167], v[152:155]
  ds_read_b64_tr_b16 a[226:227], v3 offset:256
  v_mfma_f32_16x16x32_bf16 v[152:155], a[216:219], a[168:171], v[152:155]
  v_exp_f32 v157, v157
  v_mfma_f32_16x16x32_bf16 v[152:155], a[220:223], a[172:175], v[152:155]
  ds_read_b64_tr_b16 a[228:229], v3 offset:8448
  v_cvt_pk_bf16_f32 v70, v156, v157
  v_mfma_f32_16x16x32_bf16 v[252:255], a[232:235], v[88:91], v[252:255]
  v_exp_f32 v158, v158
  v_mfma_f32_16x16x32_bf16 v[252:255], a[236:239], v[112:115], v[252:255]
  ds_read_b64_tr_b16 a[230:231], v3 offset:8704
  v_mfma_f32_16x16x32_bf16 a[28:31], a[236:239], v[116:119], a[28:31]
  v_exp_f32 v159, v159
  v_mfma_f32_16x16x32_bf16 a[28:31], a[232:235], v[92:95], a[28:31]
  v_cvt_pk_bf16_f32 v71, v158, v159
  v_mfma_f32_16x16x32_bf16 v[156:159], a[208:211], a[176:179], v[148:151]
  v_exp_f32 v152, v152
  v_mfma_f32_16x16x32_bf16 v[156:159], a[212:215], a[180:183], v[156:159]
  v_mfma_f32_16x16x32_bf16 v[156:159], a[216:219], a[184:187], v[156:159]
  v_exp_f32 v153, v153
  v_mfma_f32_16x16x32_bf16 v[156:159], a[220:223], a[188:191], v[156:159]
  v_cvt_pk_bf16_f32 v74, v152, v153
  v_mfma_f32_16x16x32_bf16 a[60:63], a[232:235], v[96:99], a[60:63]
  v_exp_f32 v154, v154
  v_mfma_f32_16x16x32_bf16 a[60:63], a[236:239], v[120:123], a[60:63]
  v_mfma_f32_16x16x32_bf16 a[92:95], a[236:239], v[124:127], a[92:95]
  s_waitcnt lgkmcnt(11)
  v_exp_f32 v155, v155
  v_mfma_f32_16x16x32_bf16 a[92:95], a[232:235], v[100:103], a[92:95]
  ds_read_b64_tr_b16 a[236:237], v3 offset:8456
  v_cvt_pk_bf16_f32 v75, v154, v155
ENTRY0_6:
  v_mfma_f32_16x16x32_bf16 v[152:155], a[192:195], a[96:99], v[128:131]
  s_waitcnt lgkmcnt(8)
  v_exp_f32 v156, v156
  v_mfma_f32_16x16x32_bf16 v[152:155], a[196:199], a[100:103], v[152:155]
  ds_read2st64_b32 v[12:13], v4 offset0:8 offset1:9
  ds_read2st64_b32 v[14:15], v4 offset0:10 offset1:11
  v_mfma_f32_16x16x32_bf16 v[152:155], a[200:203], a[104:107], v[152:155]
  s_waitcnt lgkmcnt(5)
  v_exp_f32 v157, v157
  v_mfma_f32_16x16x32_bf16 v[152:155], a[204:207], a[108:111], v[152:155]
  ds_read_b64_tr_b16 a[238:239], v3 offset:8712
  v_cvt_pk_bf16_f32 v78, v156, v157
  v_mfma_f32_16x16x32_bf16 v[160:163], a[224:227], v[32:35], v[160:163]
  s_waitcnt lgkmcnt(4)
  v_exp_f32 v158, v158
  v_mfma_f32_16x16x32_bf16 v[160:163], a[228:231], v[56:59], v[160:163]
  ds_read_b128 a[208:211], v2 offset:17152
  v_mfma_f32_16x16x32_bf16 v[192:195], a[228:231], v[60:63], v[192:195]
  v_exp_f32 v159, v159
  v_mfma_f32_16x16x32_bf16 v[192:195], a[224:227], v[36:39], v[192:195]
  ds_read_b64_tr_b16 a[232:233], v3 offset:8
  v_cvt_pk_bf16_f32 v79, v158, v159
  v_mfma_f32_16x16x32_bf16 v[156:159], a[192:195], a[112:115], v[132:135]
  v_exp_f32 v152, v152
  v_mfma_f32_16x16x32_bf16 v[156:159], a[196:199], a[116:119], v[156:159]
  ds_read_b128 a[212:215], v2 offset:17216
  v_mfma_f32_16x16x32_bf16 v[156:159], a[200:203], a[120:123], v[156:159]
  v_exp_f32 v153, v153
  v_mfma_f32_16x16x32_bf16 v[156:159], a[204:207], a[124:127], v[156:159]
  ds_read_b64_tr_b16 a[234:235], v3 offset:264
  v_cvt_pk_bf16_f32 v80, v152, v153
  v_mfma_f32_16x16x32_bf16 v[224:227], a[224:227], v[40:43], v[224:227]
  s_waitcnt lgkmcnt(6)
  v_exp_f32 v154, v154
  v_mfma_f32_16x16x32_bf16 v[224:227], a[228:231], v[64:67], v[224:227]
  v_lshlrev_b32 v16, 16, v12
  v_and_b32 v17, s48, v12
  v_mfma_f32_16x16x32_bf16 a[0:3], a[228:231], v[68:71], a[0:3]
  v_exp_f32 v155, v155
  v_mfma_f32_16x16x32_bf16 a[0:3], a[224:227], v[44:47], a[0:3]
  ds_read_b128 a[216:219], v2 offset:17280
  v_cvt_pk_bf16_f32 v81, v154, v155
  v_mfma_f32_16x16x32_bf16 v[152:155], a[192:195], a[128:131], v[136:139]
  v_exp_f32 v156, v156
  v_mfma_f32_16x16x32_bf16 v[152:155], a[196:199], a[132:135], v[152:155]
  v_mul_f32 v16, s46, v16
  v_mul_f32 v17, s46, v17
  v_mfma_f32_16x16x32_bf16 v[152:155], a[200:203], a[136:139], v[152:155]
  v_exp_f32 v157, v157
  v_mfma_f32_16x16x32_bf16 v[152:155], a[204:207], a[140:143], v[152:155]
  ds_read_b128 a[220:223], v2 offset:17344
  v_cvt_pk_bf16_f32 v84, v156, v157
  v_mfma_f32_16x16x32_bf16 a[32:35], a[224:227], v[48:51], a[32:35]
  v_exp_f32 v158, v158
  v_mfma_f32_16x16x32_bf16 a[32:35], a[228:231], v[72:75], a[32:35]
  v_cvt_pk_bf16_f32 v12, v16, v17
  v_lshlrev_b32 v18, 16, v13
  v_mfma_f32_16x16x32_bf16 a[64:67], a[228:231], v[76:79], a[64:67]
  v_exp_f32 v159, v159
  v_mfma_f32_16x16x32_bf16 a[64:67], a[224:227], v[52:55], a[64:67]
  ds_read_b64_tr_b16 a[224:225], v3 offset:64
  v_cvt_pk_bf16_f32 v85, v158, v159
  v_smfmac_f32_16x16x64_bf16 v[20:23], a[240:243], v[32:39], v5
  v_mfma_f32_16x16x32_bf16 v[156:159], a[192:195], a[144:147], v[140:143]
  v_exp_f32 v152, v152
  v_mfma_f32_16x16x32_bf16 v[156:159], a[196:199], a[148:151], v[156:159]
  v_and_b32 v19, s48, v13
  v_mul_f32 v18, s46, v18
  v_mfma_f32_16x16x32_bf16 v[156:159], a[200:203], a[152:155], v[156:159]
  s_waitcnt lgkmcnt(3)
  v_exp_f32 v153, v153
  v_mfma_f32_16x16x32_bf16 v[156:159], a[204:207], a[156:159], v[156:159]
  ds_read_b64_tr_b16 a[226:227], v3 offset:320
  v_cvt_pk_bf16_f32 v88, v152, v153
  v_mfma_f32_16x16x32_bf16 v[164:167], a[232:235], v[32:35], v[164:167]
  v_exp_f32 v154, v154
  v_mfma_f32_16x16x32_bf16 v[164:167], a[236:239], v[56:59], v[164:167]
  v_mul_f32 v19, s46, v19
  v_cvt_pk_bf16_f32 v13, v18, v19
  v_mfma_f32_16x16x32_bf16 v[196:199], a[236:239], v[60:63], v[196:199]
  v_exp_f32 v155, v155
  v_mfma_f32_16x16x32_bf16 v[196:199], a[232:235], v[36:39], v[196:199]
  ds_read_b64_tr_b16 a[228:229], v3 offset:8512
  v_cvt_pk_bf16_f32 v89, v154, v155
  v_mfma_f32_16x16x32_bf16 v[152:155], a[192:195], a[160:163], v[144:147]
  v_exp_f32 v156, v156
  v_mfma_f32_16x16x32_bf16 v[152:155], a[196:199], a[164:167], v[152:155]
  v_lshlrev_b32 v16, 16, v14
  v_and_b32 v17, s48, v14
  v_mfma_f32_16x16x32_bf16 v[152:155], a[200:203], a[168:171], v[152:155]
  v_exp_f32 v157, v157
  v_mfma_f32_16x16x32_bf16 v[152:155], a[204:207], a[172:175], v[152:155]
  ds_read_b64_tr_b16 a[230:231], v3 offset:8768
  v_cvt_pk_bf16_f32 v92, v156, v157
  v_mfma_f32_16x16x32_bf16 v[228:231], a[232:235], v[40:43], v[228:231]
  v_exp_f32 v158, v158
  v_mfma_f32_16x16x32_bf16 v[228:231], a[236:239], v[64:67], v[228:231]
  v_mul_f32 v16, s46, v16
  v_mul_f32 v17, s46, v17
  v_mfma_f32_16x16x32_bf16 a[4:7], a[236:239], v[68:71], a[4:7]
  v_exp_f32 v159, v159
  v_mfma_f32_16x16x32_bf16 a[4:7], a[232:235], v[44:47], a[4:7]
  v_cvt_pk_bf16_f32 v93, v158, v159
  v_mfma_f32_16x16x32_bf16 v[156:159], a[192:195], a[176:179], v[148:151]
  v_exp_f32 v152, v152
  v_mfma_f32_16x16x32_bf16 v[156:159], a[196:199], a[180:183], v[156:159]
  v_cvt_pk_bf16_f32 v14, v16, v17
  v_lshlrev_b32 v18, 16, v15
  v_mfma_f32_16x16x32_bf16 v[156:159], a[200:203], a[184:187], v[156:159]
  v_exp_f32 v153, v153
  v_mfma_f32_16x16x32_bf16 v[156:159], a[204:207], a[188:191], v[156:159]
  v_cvt_pk_bf16_f32 v96, v152, v153
  v_mfma_f32_16x16x32_bf16 a[36:39], a[232:235], v[48:51], a[36:39]
  v_exp_f32 v154, v154
  v_mfma_f32_16x16x32_bf16 a[36:39], a[236:239], v[72:75], a[36:39]
  v_and_b32 v19, s48, v15
  v_mul_f32 v18, s46, v18
  v_mfma_f32_16x16x32_bf16 a[68:71], a[236:239], v[76:79], a[68:71]
  v_exp_f32 v155, v155
  v_mfma_f32_16x16x32_bf16 a[68:71], a[232:235], v[52:55], a[68:71]
  ds_read_b64_tr_b16 a[236:237], v3 offset:8520
  v_cvt_pk_bf16_f32 v97, v154, v155
  v_mfma_f32_16x16x32_bf16 v[152:155], a[208:211], a[96:99], v[128:131]
  s_waitcnt lgkmcnt(6)
  v_exp_f32 v156, v156
  v_mfma_f32_16x16x32_bf16 v[152:155], a[212:215], a[100:103], v[152:155]
  ds_read_b64_tr_b16 a[238:239], v3 offset:8776
  ds_read_b64_tr_b16 a[232:233], v3 offset:72
  v_mfma_f32_16x16x32_bf16 v[152:155], a[216:219], a[104:107], v[152:155]
  s_waitcnt lgkmcnt(5)
  v_exp_f32 v157, v157
  v_mfma_f32_16x16x32_bf16 v[152:155], a[220:223], a[108:111], v[152:155]
  ds_read_b64_tr_b16 a[234:235], v3 offset:328
  v_cvt_pk_bf16_f32 v100, v156, v157
  v_mfma_f32_16x16x32_bf16 v[168:171], a[224:227], v[32:35], v[168:171]
  s_waitcnt lgkmcnt(4)
  v_exp_f32 v158, v158
  v_mfma_f32_16x16x32_bf16 v[168:171], a[228:231], v[56:59], v[168:171]
  v_mul_f32 v19, s46, v19
  v_cvt_pk_bf16_f32 v15, v18, v19
  v_mfma_f32_16x16x32_bf16 v[200:203], a[228:231], v[60:63], v[200:203]
  v_exp_f32 v159, v159
  v_mfma_f32_16x16x32_bf16 v[200:203], a[224:227], v[36:39], v[200:203]
  v_cvt_pk_bf16_f32 v101, v158, v159
  v_smfmac_f32_16x16x64_bf16 v[24:27], a[240:243], v[40:47], v5
  v_mfma_f32_16x16x32_bf16 v[156:159], a[208:211], a[112:115], v[132:135]
  v_exp_f32 v152, v152
  v_mfma_f32_16x16x32_bf16 v[156:159], a[212:215], a[116:119], v[156:159]
  v_mfma_f32_16x16x32_bf16 v[156:159], a[216:219], a[120:123], v[156:159]
  v_exp_f32 v153, v153
  v_mfma_f32_16x16x32_bf16 v[156:159], a[220:223], a[124:127], v[156:159]
  v_cvt_pk_bf16_f32 v82, v152, v153
  v_smfmac_f32_16x16x64_bf16 v[28:31], a[240:243], v[48:55], v5
  v_mfma_f32_16x16x32_bf16 v[232:235], a[224:227], v[40:43], v[232:235]
  v_exp_f32 v154, v154
  v_mfma_f32_16x16x32_bf16 v[232:235], a[228:231], v[64:67], v[232:235]
  s_waitcnt lgkmcnt(0)
  s_barrier
  v_mfma_f32_16x16x32_bf16 a[8:11], a[228:231], v[68:71], a[8:11]
  v_exp_f32 v155, v155
  v_mfma_f32_16x16x32_bf16 a[8:11], a[224:227], v[44:47], a[8:11]
  ds_read_b128 a[192:195], v2 offset:25344
  v_cvt_pk_bf16_f32 v83, v154, v155
  v_mfma_f32_16x16x32_bf16 v[152:155], a[208:211], a[128:131], v[136:139]
  v_exp_f32 v156, v156
  v_mfma_f32_16x16x32_bf16 v[152:155], a[212:215], a[132:135], v[152:155]
  ds_write_b32 v4, v12 offset:2048
  v_mfma_f32_16x16x32_bf16 v[152:155], a[216:219], a[136:139], v[152:155]
  v_exp_f32 v157, v157
  v_mfma_f32_16x16x32_bf16 v[152:155], a[220:223], a[140:143], v[152:155]
  ds_read_b128 a[196:199], v2 offset:25408
  v_cvt_pk_bf16_f32 v86, v156, v157
  v_mfma_f32_16x16x32_bf16 a[40:43], a[224:227], v[48:51], a[40:43]
  v_exp_f32 v158, v158
  v_mfma_f32_16x16x32_bf16 a[40:43], a[228:231], v[72:75], a[40:43]
  ds_write_b32 v4, v13 offset:2304
  v_mfma_f32_16x16x32_bf16 a[72:75], a[228:231], v[76:79], a[72:75]
  v_exp_f32 v159, v159
  v_mfma_f32_16x16x32_bf16 a[72:75], a[224:227], v[52:55], a[72:75]
  ds_read_b128 a[200:203], v2 offset:25472
  v_cvt_pk_bf16_f32 v87, v158, v159
  v_mfma_f32_16x16x32_bf16 v[156:159], a[208:211], a[144:147], v[140:143]
  v_exp_f32 v152, v152
  v_mfma_f32_16x16x32_bf16 v[156:159], a[212:215], a[148:151], v[156:159]
  ds_write_b32 v4, v14 offset:2560
  v_mfma_f32_16x16x32_bf16 v[156:159], a[216:219], a[152:155], v[156:159]
  v_exp_f32 v153, v153
  v_mfma_f32_16x16x32_bf16 v[156:159], a[220:223], a[156:159], v[156:159]
  ds_read_b128 a[204:207], v2 offset:25536
  v_cvt_pk_bf16_f32 v90, v152, v153
  v_mfma_f32_16x16x32_bf16 v[172:175], a[232:235], v[32:35], v[172:175]
  v_exp_f32 v154, v154
  v_mfma_f32_16x16x32_bf16 v[172:175], a[236:239], v[56:59], v[172:175]
  ds_write_b32 v4, v15 offset:2816
  v_mfma_f32_16x16x32_bf16 v[204:207], a[236:239], v[60:63], v[204:207]
  v_exp_f32 v155, v155
  v_mfma_f32_16x16x32_bf16 v[204:207], a[232:235], v[36:39], v[204:207]
  ds_read_b64_tr_b16 a[224:225], v3 offset:128
  v_cvt_pk_bf16_f32 v91, v154, v155
  v_mfma_f32_16x16x32_bf16 v[152:155], a[208:211], a[160:163], v[144:147]
  v_exp_f32 v156, v156
  v_mfma_f32_16x16x32_bf16 v[152:155], a[212:215], a[164:167], v[152:155]
  ds_read_b64_tr_b16 a[226:227], v3 offset:384
  v_mfma_f32_16x16x32_bf16 v[152:155], a[216:219], a[168:171], v[152:155]
  v_exp_f32 v157, v157
  v_mfma_f32_16x16x32_bf16 v[152:155], a[220:223], a[172:175], v[152:155]
  ds_read_b64_tr_b16 a[228:229], v3 offset:8576
  v_cvt_pk_bf16_f32 v94, v156, v157
  v_mfma_f32_16x16x32_bf16 v[236:239], a[232:235], v[40:43], v[236:239]
  v_exp_f32 v158, v158
  v_mfma_f32_16x16x32_bf16 v[236:239], a[236:239], v[64:67], v[236:239]
  ds_read_b64_tr_b16 a[230:231], v3 offset:8832
  v_mfma_f32_16x16x32_bf16 a[12:15], a[236:239], v[68:71], a[12:15]
  v_exp_f32 v159, v159
  v_mfma_f32_16x16x32_bf16 a[12:15], a[232:235], v[44:47], a[12:15]
  v_cvt_pk_bf16_f32 v95, v158, v159
  v_mfma_f32_16x16x32_bf16 v[156:159], a[208:211], a[176:179], v[148:151]
  v_exp_f32 v152, v152
  v_mfma_f32_16x16x32_bf16 v[156:159], a[212:215], a[180:183], v[156:159]
  v_mfma_f32_16x16x32_bf16 v[156:159], a[216:219], a[184:187], v[156:159]
  v_exp_f32 v153, v153
  v_mfma_f32_16x16x32_bf16 v[156:159], a[220:223], a[188:191], v[156:159]
  v_cvt_pk_bf16_f32 v98, v152, v153
  v_mfma_f32_16x16x32_bf16 a[44:47], a[232:235], v[48:51], a[44:47]
  v_exp_f32 v154, v154
  v_mfma_f32_16x16x32_bf16 a[44:47], a[236:239], v[72:75], a[44:47]
  v_mfma_f32_16x16x32_bf16 a[76:79], a[236:239], v[76:79], a[76:79]
  s_waitcnt lgkmcnt(11)
  v_exp_f32 v155, v155
  v_mfma_f32_16x16x32_bf16 a[76:79], a[232:235], v[52:55], a[76:79]
  ds_read_b64_tr_b16 a[236:237], v3 offset:8584
  v_cvt_pk_bf16_f32 v99, v154, v155
LAST0_6:
  v_mfma_f32_16x16x32_bf16 v[152:155], a[192:195], a[96:99], v[128:131]
  s_waitcnt lgkmcnt(8)
  v_exp_f32 v156, v156
  v_mfma_f32_16x16x32_bf16 v[152:155], a[196:199], a[100:103], v[152:155]
  ds_read2st64_b32 v[12:13], v4 offset0:12 offset1:13
  ds_read2st64_b32 v[14:15], v4 offset0:14 offset1:15
  v_mfma_f32_16x16x32_bf16 v[152:155], a[200:203], a[104:107], v[152:155]
  s_waitcnt lgkmcnt(5)
  v_exp_f32 v157, v157
  v_mfma_f32_16x16x32_bf16 v[152:155], a[204:207], a[108:111], v[152:155]
  ds_read_b64_tr_b16 a[238:239], v3 offset:8840
  v_cvt_pk_bf16_f32 v102, v156, v157
  v_mfma_f32_16x16x32_bf16 v[176:179], a[224:227], v[32:35], v[176:179]
  s_waitcnt lgkmcnt(4)
  v_exp_f32 v158, v158
  v_mfma_f32_16x16x32_bf16 v[176:179], a[228:231], v[56:59], v[176:179]
  ds_read_b128 a[208:211], v2 offset:25600
  v_mfma_f32_16x16x32_bf16 v[208:211], a[228:231], v[60:63], v[208:211]
  v_exp_f32 v159, v159
  v_mfma_f32_16x16x32_bf16 v[208:211], a[224:227], v[36:39], v[208:211]
  ds_read_b64_tr_b16 a[232:233], v3 offset:136
  v_cvt_pk_bf16_f32 v103, v158, v159
  v_mfma_f32_16x16x32_bf16 v[156:159], a[192:195], a[112:115], v[132:135]
  v_exp_f32 v152, v152
  v_mfma_f32_16x16x32_bf16 v[156:159], a[196:199], a[116:119], v[156:159]
  ds_read_b128 a[212:215], v2 offset:25664
  v_mfma_f32_16x16x32_bf16 v[156:159], a[200:203], a[120:123], v[156:159]
  v_exp_f32 v153, v153
  v_mfma_f32_16x16x32_bf16 v[156:159], a[204:207], a[124:127], v[156:159]
  ds_read_b64_tr_b16 a[234:235], v3 offset:392
  v_cvt_pk_bf16_f32 v104, v152, v153
  v_mfma_f32_16x16x32_bf16 v[240:243], a[224:227], v[40:43], v[240:243]
  s_waitcnt lgkmcnt(6)
  v_exp_f32 v154, v154
  v_mfma_f32_16x16x32_bf16 v[240:243], a[228:231], v[64:67], v[240:243]
  v_lshlrev_b32 v16, 16, v12
  v_and_b32 v17, s48, v12
  v_mfma_f32_16x16x32_bf16 a[16:19], a[228:231], v[68:71], a[16:19]
  v_exp_f32 v155, v155
  v_mfma_f32_16x16x32_bf16 a[16:19], a[224:227], v[44:47], a[16:19]
  ds_read_b128 a[216:219], v2 offset:25728
  v_cvt_pk_bf16_f32 v105, v154, v155
  v_mfma_f32_16x16x32_bf16 v[152:155], a[192:195], a[128:131], v[136:139]
  v_exp_f32 v156, v156
  v_mfma_f32_16x16x32_bf16 v[152:155], a[196:199], a[132:135], v[152:155]
  v_mul_f32 v16, s46, v16
  v_mul_f32 v17, s46, v17
  v_mfma_f32_16x16x32_bf16 v[152:155], a[200:203], a[136:139], v[152:155]
  v_exp_f32 v157, v157
  v_mfma_f32_16x16x32_bf16 v[152:155], a[204:207], a[140:143], v[152:155]
  ds_read_b128 a[220:223], v2 offset:25792
  v_cvt_pk_bf16_f32 v108, v156, v157
  v_mfma_f32_16x16x32_bf16 a[48:51], a[224:227], v[48:51], a[48:51]
  v_exp_f32 v158, v158
  v_mfma_f32_16x16x32_bf16 a[48:51], a[228:231], v[72:75], a[48:51]
  v_cvt_pk_bf16_f32 v12, v16, v17
  v_lshlrev_b32 v18, 16, v13
  v_mfma_f32_16x16x32_bf16 a[80:83], a[228:231], v[76:79], a[80:83]
  v_exp_f32 v159, v159
  v_mfma_f32_16x16x32_bf16 a[80:83], a[224:227], v[52:55], a[80:83]
  ds_read_b64_tr_b16 a[224:225], v3 offset:192
  v_cvt_pk_bf16_f32 v109, v158, v159
  v_smfmac_f32_16x16x64_bf16 v[20:23], a[240:243], v[56:63], v5
  v_mfma_f32_16x16x32_bf16 v[156:159], a[192:195], a[144:147], v[140:143]
  v_exp_f32 v152, v152
  v_mfma_f32_16x16x32_bf16 v[156:159], a[196:199], a[148:151], v[156:159]
  v_and_b32 v19, s48, v13
  v_mul_f32 v18, s46, v18
  v_mfma_f32_16x16x32_bf16 v[156:159], a[200:203], a[152:155], v[156:159]
  s_waitcnt lgkmcnt(3)
  v_exp_f32 v153, v153
  v_mfma_f32_16x16x32_bf16 v[156:159], a[204:207], a[156:159], v[156:159]
  ds_read_b64_tr_b16 a[226:227], v3 offset:448
  v_cvt_pk_bf16_f32 v112, v152, v153
  v_mfma_f32_16x16x32_bf16 v[180:183], a[232:235], v[32:35], v[180:183]
  v_exp_f32 v154, v154
  v_mfma_f32_16x16x32_bf16 v[180:183], a[236:239], v[56:59], v[180:183]
  v_mul_f32 v19, s46, v19
  v_cvt_pk_bf16_f32 v13, v18, v19
  v_mfma_f32_16x16x32_bf16 v[212:215], a[236:239], v[60:63], v[212:215]
  v_exp_f32 v155, v155
  v_mfma_f32_16x16x32_bf16 v[212:215], a[232:235], v[36:39], v[212:215]
  ds_read_b64_tr_b16 a[228:229], v3 offset:8640
  v_cvt_pk_bf16_f32 v113, v154, v155
  v_mfma_f32_16x16x32_bf16 v[152:155], a[192:195], a[160:163], v[144:147]
  v_exp_f32 v156, v156
  v_mfma_f32_16x16x32_bf16 v[152:155], a[196:199], a[164:167], v[152:155]
  v_lshlrev_b32 v16, 16, v14
  v_and_b32 v17, s48, v14
  v_mfma_f32_16x16x32_bf16 v[152:155], a[200:203], a[168:171], v[152:155]
  v_exp_f32 v157, v157
  v_mfma_f32_16x16x32_bf16 v[152:155], a[204:207], a[172:175], v[152:155]
  ds_read_b64_tr_b16 a[230:231], v3 offset:8896
  v_cvt_pk_bf16_f32 v116, v156, v157
  v_mfma_f32_16x16x32_bf16 v[244:247], a[232:235], v[40:43], v[244:247]
  v_exp_f32 v158, v158
  v_mfma_f32_16x16x32_bf16 v[244:247], a[236:239], v[64:67], v[244:247]
  v_mul_f32 v16, s46, v16
  v_mul_f32 v17, s46, v17
  v_mfma_f32_16x16x32_bf16 a[20:23], a[236:239], v[68:71], a[20:23]
  v_exp_f32 v159, v159
  v_mfma_f32_16x16x32_bf16 a[20:23], a[232:235], v[44:47], a[20:23]
  v_cvt_pk_bf16_f32 v117, v158, v159
  v_mfma_f32_16x16x32_bf16 v[156:159], a[192:195], a[176:179], v[148:151]
  v_exp_f32 v152, v152
  v_mfma_f32_16x16x32_bf16 v[156:159], a[196:199], a[180:183], v[156:159]
  v_cvt_pk_bf16_f32 v14, v16, v17
  v_lshlrev_b32 v18, 16, v15
  v_mfma_f32_16x16x32_bf16 v[156:159], a[200:203], a[184:187], v[156:159]
  v_exp_f32 v153, v153
  v_mfma_f32_16x16x32_bf16 v[156:159], a[204:207], a[188:191], v[156:159]
  v_cvt_pk_bf16_f32 v120, v152, v153
  v_mfma_f32_16x16x32_bf16 a[52:55], a[232:235], v[48:51], a[52:55]
  v_exp_f32 v154, v154
  v_mfma_f32_16x16x32_bf16 a[52:55], a[236:239], v[72:75], a[52:55]
  v_and_b32 v19, s48, v15
  v_mul_f32 v18, s46, v18
  v_mfma_f32_16x16x32_bf16 a[84:87], a[236:239], v[76:79], a[84:87]
  v_exp_f32 v155, v155
  v_mfma_f32_16x16x32_bf16 a[84:87], a[232:235], v[52:55], a[84:87]
  ds_read_b64_tr_b16 a[236:237], v3 offset:8648
  v_cvt_pk_bf16_f32 v121, v154, v155
  v_mfma_f32_16x16x32_bf16 v[152:155], a[208:211], a[96:99], v[128:131]
  s_waitcnt lgkmcnt(6)
  v_exp_f32 v156, v156
  v_mfma_f32_16x16x32_bf16 v[152:155], a[212:215], a[100:103], v[152:155]
  ds_read_b64_tr_b16 a[238:239], v3 offset:8904
  ds_read_b64_tr_b16 a[232:233], v3 offset:200
  v_mfma_f32_16x16x32_bf16 v[152:155], a[216:219], a[104:107], v[152:155]
  s_waitcnt lgkmcnt(5)
  v_exp_f32 v157, v157
  v_mfma_f32_16x16x32_bf16 v[152:155], a[220:223], a[108:111], v[152:155]
  ds_read_b64_tr_b16 a[234:235], v3 offset:456
  v_cvt_pk_bf16_f32 v124, v156, v157
  v_mfma_f32_16x16x32_bf16 v[184:187], a[224:227], v[32:35], v[184:187]
  s_waitcnt lgkmcnt(4)
  v_exp_f32 v158, v158
  v_mfma_f32_16x16x32_bf16 v[184:187], a[228:231], v[56:59], v[184:187]
  v_mul_f32 v19, s46, v19
  v_cvt_pk_bf16_f32 v15, v18, v19
  v_mfma_f32_16x16x32_bf16 v[216:219], a[228:231], v[60:63], v[216:219]
  v_exp_f32 v159, v159
  v_mfma_f32_16x16x32_bf16 v[216:219], a[224:227], v[36:39], v[216:219]
  v_cvt_pk_bf16_f32 v125, v158, v159
  v_smfmac_f32_16x16x64_bf16 v[24:27], a[240:243], v[64:71], v5
  v_mfma_f32_16x16x32_bf16 v[156:159], a[208:211], a[112:115], v[132:135]
  v_exp_f32 v152, v152
  v_mfma_f32_16x16x32_bf16 v[156:159], a[212:215], a[116:119], v[156:159]
  v_mfma_f32_16x16x32_bf16 v[156:159], a[216:219], a[120:123], v[156:159]
  v_exp_f32 v153, v153
  v_mfma_f32_16x16x32_bf16 v[156:159], a[220:223], a[124:127], v[156:159]
  v_cvt_pk_bf16_f32 v106, v152, v153
  v_smfmac_f32_16x16x64_bf16 v[28:31], a[240:243], v[72:79], v5
  v_mfma_f32_16x16x32_bf16 v[248:251], a[224:227], v[40:43], v[248:251]
  v_exp_f32 v154, v154
  v_mfma_f32_16x16x32_bf16 v[248:251], a[228:231], v[64:67], v[248:251]
  s_waitcnt lgkmcnt(0)
  s_barrier
  v_mfma_f32_16x16x32_bf16 a[24:27], a[228:231], v[68:71], a[24:27]
  v_exp_f32 v155, v155
  v_mfma_f32_16x16x32_bf16 a[24:27], a[224:227], v[44:47], a[24:27]
  ds_read_b128 a[192:195], v2 offset:0
  v_cvt_pk_bf16_f32 v107, v154, v155
  v_mfma_f32_16x16x32_bf16 v[152:155], a[208:211], a[128:131], v[136:139]
  v_exp_f32 v156, v156
  v_mfma_f32_16x16x32_bf16 v[152:155], a[212:215], a[132:135], v[152:155]
  ds_write_b32 v4, v12 offset:3072
  v_mfma_f32_16x16x32_bf16 v[152:155], a[216:219], a[136:139], v[152:155]
  s_addk_i32 s50, 0x1000
  v_exp_f32 v157, v157
  v_mfma_f32_16x16x32_bf16 v[152:155], a[220:223], a[140:143], v[152:155]
  ds_read_b128 a[196:199], v2 offset:64
  v_cvt_pk_bf16_f32 v110, v156, v157
  v_mfma_f32_16x16x32_bf16 a[56:59], a[224:227], v[48:51], a[56:59]
  v_exp_f32 v158, v158
  v_mfma_f32_16x16x32_bf16 a[56:59], a[228:231], v[72:75], a[56:59]
  ds_write_b32 v4, v13 offset:3328
  v_mfma_f32_16x16x32_bf16 a[88:91], a[228:231], v[76:79], a[88:91]
  s_cmp_eq_u32 s50, s51
  v_exp_f32 v159, v159
  v_mfma_f32_16x16x32_bf16 a[88:91], a[224:227], v[52:55], a[88:91]
  ds_read_b128 a[200:203], v2 offset:128
  v_cvt_pk_bf16_f32 v111, v158, v159
  v_mfma_f32_16x16x32_bf16 v[156:159], a[208:211], a[144:147], v[140:143]
  v_exp_f32 v152, v152
  v_mfma_f32_16x16x32_bf16 v[156:159], a[212:215], a[148:151], v[156:159]
  ds_write_b32 v4, v14 offset:3584
  v_mfma_f32_16x16x32_bf16 v[156:159], a[216:219], a[152:155], v[156:159]
  s_cselect_b32 s50, s45, s50
  v_exp_f32 v153, v153
  v_mfma_f32_16x16x32_bf16 v[156:159], a[220:223], a[156:159], v[156:159]
  ds_read_b128 a[204:207], v2 offset:192
  v_cvt_pk_bf16_f32 v114, v152, v153
  v_mfma_f32_16x16x32_bf16 v[188:191], a[232:235], v[32:35], v[188:191]
  v_exp_f32 v154, v154
  v_mfma_f32_16x16x32_bf16 v[188:191], a[236:239], v[56:59], v[188:191]
  ds_write_b32 v4, v15 offset:3840
  v_mfma_f32_16x16x32_bf16 v[220:223], a[236:239], v[60:63], v[220:223]
  v_exp_f32 v155, v155
  v_mfma_f32_16x16x32_bf16 v[220:223], a[232:235], v[36:39], v[220:223]
  ds_read_b64_tr_b16 a[224:225], v3 offset:16896
  v_cvt_pk_bf16_f32 v115, v154, v155
  v_mfma_f32_16x16x32_bf16 v[152:155], a[208:211], a[160:163], v[144:147]
  v_exp_f32 v156, v156
  v_mfma_f32_16x16x32_bf16 v[152:155], a[212:215], a[164:167], v[152:155]
  ds_read_b64_tr_b16 a[226:227], v3 offset:17152
  v_lshl_add_u32 v4, v0, 2, s50
  v_mfma_f32_16x16x32_bf16 v[152:155], a[216:219], a[168:171], v[152:155]
  v_exp_f32 v157, v157
  v_mfma_f32_16x16x32_bf16 v[152:155], a[220:223], a[172:175], v[152:155]
  ds_read_b64_tr_b16 a[228:229], v3 offset:25344
  v_cvt_pk_bf16_f32 v118, v156, v157
  v_mfma_f32_16x16x32_bf16 v[252:255], a[232:235], v[40:43], v[252:255]
  v_exp_f32 v158, v158
  v_mfma_f32_16x16x32_bf16 v[252:255], a[236:239], v[64:67], v[252:255]
  ds_read_b64_tr_b16 a[230:231], v3 offset:25600
  v_mfma_f32_16x16x32_bf16 a[28:31], a[236:239], v[68:71], a[28:31]
  v_exp_f32 v159, v159
  v_mfma_f32_16x16x32_bf16 a[28:31], a[232:235], v[44:47], a[28:31]
  v_cvt_pk_bf16_f32 v119, v158, v159
  v_mfma_f32_16x16x32_bf16 v[156:159], a[208:211], a[176:179], v[148:151]
  v_exp_f32 v152, v152
  v_mfma_f32_16x16x32_bf16 v[156:159], a[212:215], a[180:183], v[156:159]
  v_mfma_f32_16x16x32_bf16 v[156:159], a[216:219], a[184:187], v[156:159]
  s_sub_u32 s39, s39, 1
  v_exp_f32 v153, v153
  v_mfma_f32_16x16x32_bf16 v[156:159], a[220:223], a[188:191], v[156:159]
  v_cvt_pk_bf16_f32 v122, v152, v153
  v_mfma_f32_16x16x32_bf16 a[60:63], a[232:235], v[48:51], a[60:63]
  v_exp_f32 v154, v154
  v_mfma_f32_16x16x32_bf16 a[60:63], a[236:239], v[72:75], a[60:63]
  v_mfma_f32_16x16x32_bf16 a[92:95], a[236:239], v[76:79], a[92:95]
  s_waitcnt lgkmcnt(11)
  v_exp_f32 v155, v155
  v_mfma_f32_16x16x32_bf16 a[92:95], a[232:235], v[52:55], a[92:95]
  ds_read_b64_tr_b16 a[236:237], v3 offset:25352
  v_cvt_pk_bf16_f32 v123, v154, v155
  s_cbranch_scc0 LOOP0_6
  v_smfmac_f32_16x16x64_bf16 v[20:23], a[240:243], v[80:87], v5
  ds_read_b64_tr_b16 a[238:239], v3 offset:25608
  v_smfmac_f32_16x16x64_bf16 v[20:23], a[240:243], v[104:111], v5
  ds_read_b64_tr_b16 a[232:233], v3 offset:16904
  s_waitcnt lgkmcnt(5)
  v_mfma_f32_16x16x32_bf16 v[160:163], a[224:227], v[80:83], v[160:163]
  s_waitcnt lgkmcnt(2)
  ds_read_b64_tr_b16 a[234:235], v3 offset:17160
  ds_read_b64_tr_b16 a[148:149], v3 offset:25408
  v_mfma_f32_16x16x32_bf16 v[160:163], a[228:231], v[104:107], v[160:163]
  ds_read_b64_tr_b16 a[150:151], v3 offset:25664
  ds_read_b64_tr_b16 a[144:145], v3 offset:16960
  v_mfma_f32_16x16x32_bf16 v[192:195], a[224:227], v[84:87], v[192:195]
  ds_read_b64_tr_b16 a[146:147], v3 offset:17216
  ds_read_b64_tr_b16 a[156:157], v3 offset:25416
  v_mfma_f32_16x16x32_bf16 v[192:195], a[228:231], v[108:111], v[192:195]
  ds_read_b64_tr_b16 a[158:159], v3 offset:25672
  ds_read_b64_tr_b16 a[152:153], v3 offset:16968
  v_mfma_f32_16x16x32_bf16 v[224:227], a[224:227], v[88:91], v[224:227]
  ds_read_b64_tr_b16 a[154:155], v3 offset:17224
  ds_read_b64_tr_b16 a[164:165], v3 offset:25472
  v_mfma_f32_16x16x32_bf16 v[224:227], a[228:231], v[112:115], v[224:227]
  ds_read_b64_tr_b16 a[166:167], v3 offset:25728
  ds_read_b64_tr_b16 a[160:161], v3 offset:17024
  v_mfma_f32_16x16x32_bf16 a[0:3], a[224:227], v[92:95], a[0:3]
  ds_read_b64_tr_b16 a[162:163], v3 offset:17280
  ds_read_b64_tr_b16 a[172:173], v3 offset:25480
  v_mfma_f32_16x16x32_bf16 a[0:3], a[228:231], v[116:119], a[0:3]
  ds_read_b64_tr_b16 a[174:175], v3 offset:25736
  ds_read_b64_tr_b16 a[168:169], v3 offset:17032
  v_mfma_f32_16x16x32_bf16 a[32:35], a[224:227], v[96:99], a[32:35]
  ds_read_b64_tr_b16 a[170:171], v3 offset:17288
  ds_read_b64_tr_b16 a[180:181], v3 offset:25536
  v_mfma_f32_16x16x32_bf16 a[32:35], a[228:231], v[120:123], a[32:35]
  ds_read_b64_tr_b16 a[182:183], v3 offset:25792
  ds_read_b64_tr_b16 a[176:177], v3 offset:17088
  v_mfma_f32_16x16x32_bf16 a[64:67], a[224:227], v[100:103], a[64:67]
  ds_read_b64_tr_b16 a[178:179], v3 offset:17344
  ds_read_b64_tr_b16 a[188:189], v3 offset:25544
  v_smfmac_f32_16x16x64_bf16 v[24:27], a[240:243], v[88:95], v5
  ds_read_b64_tr_b16 a[190:191], v3 offset:25800
  v_smfmac_f32_16x16x64_bf16 v[24:27], a[240:243], v[112:119], v5
  s_waitcnt lgkmcnt(14)
  ds_read_b64_tr_b16 a[184:185], v3 offset:17096
  v_mfma_f32_16x16x32_bf16 v[164:167], a[236:239], v[104:107], v[164:167]
  ds_read_b64_tr_b16 a[186:187], v3 offset:17352
  v_exp_f32 v156, v156
  v_exp_f32 v157, v157
  v_exp_f32 v158, v158
  v_exp_f32 v159, v159
  v_cvt_pk_bf16_f32 v126, v156, v157
  v_cvt_pk_bf16_f32 v127, v158, v159
  v_mfma_f32_16x16x32_bf16 v[164:167], a[232:235], v[80:83], v[164:167]
  ds_read_b128 a[96:99], v8 offset:0
  ds_read_b128 a[100:103], v9 offset:0
  v_mfma_f32_16x16x32_bf16 a[64:67], a[228:231], v[124:127], a[64:67]
  ds_read_b128 a[104:107], v10 offset:0
  ds_read_b128 a[108:111], v11 offset:0
  v_mfma_f32_16x16x32_bf16 v[196:199], a[236:239], v[108:111], v[196:199]
  v_add_f32 v20, v20, v21
  v_rcp_f32 v12, v20
  v_mfma_f32_16x16x32_bf16 v[196:199], a[232:235], v[84:87], v[196:199]
  v_mul_f32 v21, s82, v12
  v_fma_f32 v160, v160, v12, v21
  v_mfma_f32_16x16x32_bf16 v[228:231], a[236:239], v[112:115], v[228:231]
  v_fma_f32 v161, v161, v12, v21
  v_fma_f32 v162, v162, v12, v21
  v_mfma_f32_16x16x32_bf16 v[228:231], a[232:235], v[88:91], v[228:231]
  v_fma_f32 v163, v163, v12, v21
  v_fma_f32 v164, v164, v12, v21
  v_mfma_f32_16x16x32_bf16 a[4:7], a[236:239], v[116:119], a[4:7]
  v_fma_f32 v165, v165, v12, v21
  v_fma_f32 v166, v166, v12, v21
  v_mfma_f32_16x16x32_bf16 a[4:7], a[232:235], v[92:95], a[4:7]
  v_fma_f32 v167, v167, v12, v21
  v_cvt_pk_bf16_f32 v160, v160, v161
  v_mfma_f32_16x16x32_bf16 a[36:39], a[236:239], v[120:123], a[36:39]
  v_cvt_pk_bf16_f32 v161, v162, v163
  v_cvt_pk_bf16_f32 v162, v164, v165
  v_mfma_f32_16x16x32_bf16 a[36:39], a[232:235], v[96:99], a[36:39]
  s_waitcnt lgkmcnt(0)
  v_cvt_pk_bf16_f32 v163, v166, v167
  v_add_f32 v22, v22, v23
  v_mfma_f32_16x16x32_bf16 a[68:71], a[236:239], v[124:127], a[68:71]
  v_rcp_f32 v13, v22
  v_mfma_f32_16x16x32_bf16 a[68:71], a[232:235], v[100:103], a[68:71]
  v_mul_f32 v23, s82, v13
  v_add_f32 v24, v24, v25
  v_smfmac_f32_16x16x64_bf16 v[28:31], a[240:243], v[96:103], v5
  v_rcp_f32 v14, v24
  v_smfmac_f32_16x16x64_bf16 v[28:31], a[240:243], v[120:127], v5
  ds_read_b128 a[112:115], v8 offset:4096
  v_mfma_f32_16x16x32_bf16 v[168:171], a[144:147], v[80:83], v[168:171]
  ds_read_b128 a[116:119], v9 offset:4096
  ds_read_b128 a[120:123], v10 offset:4096
  v_mfma_f32_16x16x32_bf16 v[168:171], a[148:151], v[104:107], v[168:171]
  ds_read_b128 a[124:127], v11 offset:4096
  ds_read_b128 a[208:211], v2 offset:256
  v_mfma_f32_16x16x32_bf16 v[172:175], a[156:159], v[104:107], v[172:175]
  ds_read_b128 a[212:215], v2 offset:320
  ds_read_b128 a[216:219], v2 offset:384
  v_mfma_f32_16x16x32_bf16 v[172:175], a[152:155], v[80:83], v[172:175]
  ds_read_b128 a[220:223], v2 offset:448
  ds_write_b128 v8, v[160:163] offset:0
  v_mfma_f32_16x16x32_bf16 v[176:179], a[160:163], v[80:83], v[176:179]
  v_fma_f32 v168, v168, v12, v21
  v_fma_f32 v169, v169, v12, v21
  v_mfma_f32_16x16x32_bf16 v[176:179], a[164:167], v[104:107], v[176:179]
  v_fma_f32 v170, v170, v12, v21
  v_fma_f32 v171, v171, v12, v21
  v_mfma_f32_16x16x32_bf16 v[180:183], a[172:175], v[104:107], v[180:183]
  v_fma_f32 v172, v172, v12, v21
  v_fma_f32 v173, v173, v12, v21
  v_mfma_f32_16x16x32_bf16 v[180:183], a[168:171], v[80:83], v[180:183]
  v_fma_f32 v174, v174, v12, v21
  v_fma_f32 v175, v175, v12, v21
  v_mfma_f32_16x16x32_bf16 v[184:187], a[176:179], v[80:83], v[184:187]
  v_cvt_pk_bf16_f32 v168, v168, v169
  v_cvt_pk_bf16_f32 v169, v170, v171
  v_mfma_f32_16x16x32_bf16 v[184:187], a[180:183], v[104:107], v[184:187]
  v_cvt_pk_bf16_f32 v170, v172, v173
  v_cvt_pk_bf16_f32 v171, v174, v175
  v_mfma_f32_16x16x32_bf16 v[188:191], a[188:191], v[104:107], v[188:191]
  s_waitcnt lgkmcnt(1)
  ds_write_b128 v9, v[168:171] offset:0
  v_mfma_f32_16x16x32_bf16 v[188:191], a[184:187], v[80:83], v[188:191]
  v_fma_f32 v176, v176, v12, v21
  v_fma_f32 v177, v177, v12, v21
  v_mfma_f32_16x16x32_bf16 v[200:203], a[144:147], v[84:87], v[200:203]
  v_fma_f32 v178, v178, v12, v21
  v_fma_f32 v179, v179, v12, v21
  v_mfma_f32_16x16x32_bf16 v[200:203], a[148:151], v[108:111], v[200:203]
  v_fma_f32 v180, v180, v12, v21
  v_fma_f32 v181, v181, v12, v21
  v_mfma_f32_16x16x32_bf16 v[204:207], a[156:159], v[108:111], v[204:207]
  v_fma_f32 v182, v182, v12, v21
  v_fma_f32 v183, v183, v12, v21
  v_mfma_f32_16x16x32_bf16 v[204:207], a[152:155], v[84:87], v[204:207]
  v_cvt_pk_bf16_f32 v176, v176, v177
  v_cvt_pk_bf16_f32 v177, v178, v179
  v_mfma_f32_16x16x32_bf16 v[208:211], a[160:163], v[84:87], v[208:211]
  v_cvt_pk_bf16_f32 v178, v180, v181
  v_cvt_pk_bf16_f32 v179, v182, v183
  v_mfma_f32_16x16x32_bf16 v[208:211], a[164:167], v[108:111], v[208:211]
  v_mul_f32 v25, s82, v14
  v_add_f32 v26, v26, v27
  v_mfma_f32_16x16x32_bf16 v[212:215], a[172:175], v[108:111], v[212:215]
  v_rcp_f32 v15, v26
  v_mfma_f32_16x16x32_bf16 v[212:215], a[168:171], v[84:87], v[212:215]
  v_mul_f32 v27, s82, v15
  v_add_f32 v28, v28, v29
  v_mfma_f32_16x16x32_bf16 v[216:219], a[176:179], v[84:87], v[216:219]
  v_rcp_f32 v16, v28
  v_mfma_f32_16x16x32_bf16 v[216:219], a[180:183], v[108:111], v[216:219]
  v_mul_f32 v29, s82, v16
  v_add_f32 v30, v30, v31
  v_mfma_f32_16x16x32_bf16 v[220:223], a[188:191], v[108:111], v[220:223]
  v_rcp_f32 v17, v30
  v_mfma_f32_16x16x32_bf16 v[220:223], a[184:187], v[84:87], v[220:223]
  ds_write_b128 v10, v[176:179] offset:0
  v_mfma_f32_16x16x32_bf16 v[232:235], a[144:147], v[88:91], v[232:235]
  v_mul_f32 v31, s82, v17
  v_add_f32 v6, v20, v22
  v_mfma_f32_16x16x32_bf16 v[232:235], a[148:151], v[112:115], v[232:235]
  v_add_f32 v6, v6, v24
  v_add_f32 v6, v6, v26
  v_mfma_f32_16x16x32_bf16 v[236:239], a[156:159], v[112:115], v[236:239]
  v_add_f32 v6, v6, v28
  v_add_f32 v6, v6, v30
  v_mfma_f32_16x16x32_bf16 v[236:239], a[152:155], v[88:91], v[236:239]
  v_cmp_nge_f32 s[40:41], s49, v6
  v_accvgpr_write_b32 a248, s89
  v_mfma_f32_16x16x32_bf16 v[240:243], a[160:163], v[88:91], v[240:243]
  v_accvgpr_write_b32 a249, s89
  v_accvgpr_write_b32 a250, s89
  v_mfma_f32_16x16x32_bf16 v[240:243], a[164:167], v[112:115], v[240:243]
  v_accvgpr_write_b32 a251, s89
  v_fma_f32 v184, v184, v12, v21
  v_mfma_f32_16x16x32_bf16 v[244:247], a[172:175], v[112:115], v[244:247]
  v_fma_f32 v185, v185, v12, v21
  v_fma_f32 v186, v186, v12, v21
  v_mfma_f32_16x16x32_bf16 v[244:247], a[168:171], v[88:91], v[244:247]
  v_fma_f32 v187, v187, v12, v21
  v_fma_f32 v188, v188, v12, v21
  v_mfma_f32_16x16x32_bf16 v[248:251], a[176:179], v[88:91], v[248:251]
  v_fma_f32 v189, v189, v12, v21
  v_fma_f32 v190, v190, v12, v21
  v_mfma_f32_16x16x32_bf16 v[248:251], a[180:183], v[112:115], v[248:251]
  v_fma_f32 v191, v191, v12, v21
  v_cvt_pk_bf16_f32 v184, v184, v185
  v_mfma_f32_16x16x32_bf16 v[252:255], a[188:191], v[112:115], v[252:255]
  v_cvt_pk_bf16_f32 v185, v186, v187
  v_cvt_pk_bf16_f32 v186, v188, v189
  v_mfma_f32_16x16x32_bf16 v[252:255], a[184:187], v[88:91], v[252:255]
  v_cvt_pk_bf16_f32 v187, v190, v191
  v_fma_f32 v192, v192, v13, v23
  v_mfma_f32_16x16x32_bf16 a[8:11], a[144:147], v[92:95], a[8:11]
  v_fma_f32 v193, v193, v13, v23
  v_fma_f32 v194, v194, v13, v23
  v_mfma_f32_16x16x32_bf16 a[8:11], a[148:151], v[116:119], a[8:11]
  v_fma_f32 v195, v195, v13, v23
  v_fma_f32 v196, v196, v13, v23
  v_mfma_f32_16x16x32_bf16 a[12:15], a[156:159], v[116:119], a[12:15]
  v_fma_f32 v197, v197, v13, v23
  v_fma_f32 v198, v198, v13, v23
  v_mfma_f32_16x16x32_bf16 a[12:15], a[152:155], v[92:95], a[12:15]
  v_fma_f32 v199, v199, v13, v23
  v_cvt_pk_bf16_f32 v192, v192, v193
  v_mfma_f32_16x16x32_bf16 a[16:19], a[160:163], v[92:95], a[16:19]
  v_cvt_pk_bf16_f32 v193, v194, v195
  v_cvt_pk_bf16_f32 v194, v196, v197
  v_mfma_f32_16x16x32_bf16 a[16:19], a[164:167], v[116:119], a[16:19]
  v_cvt_pk_bf16_f32 v195, v198, v199
  v_fma_f32 v200, v200, v13, v23
  v_mfma_f32_16x16x32_bf16 a[20:23], a[172:175], v[116:119], a[20:23]
  v_fma_f32 v201, v201, v13, v23
  v_fma_f32 v202, v202, v13, v23
  v_mfma_f32_16x16x32_bf16 a[20:23], a[168:171], v[92:95], a[20:23]
  v_fma_f32 v203, v203, v13, v23
  v_fma_f32 v204, v204, v13, v23
  v_mfma_f32_16x16x32_bf16 a[24:27], a[176:179], v[92:95], a[24:27]
  v_fma_f32 v205, v205, v13, v23
  v_fma_f32 v206, v206, v13, v23
  v_mfma_f32_16x16x32_bf16 a[24:27], a[180:183], v[116:119], a[24:27]
  v_fma_f32 v207, v207, v13, v23
  v_cvt_pk_bf16_f32 v200, v200, v201
  v_mfma_f32_16x16x32_bf16 a[28:31], a[188:191], v[116:119], a[28:31]
  v_cvt_pk_bf16_f32 v201, v202, v203
  v_cvt_pk_bf16_f32 v202, v204, v205
  v_mfma_f32_16x16x32_bf16 a[28:31], a[184:187], v[92:95], a[28:31]
  ds_write_b128 v11, v[184:187] offset:0
  v_mfma_f32_16x16x32_bf16 a[40:43], a[144:147], v[96:99], a[40:43]
  v_cvt_pk_bf16_f32 v203, v206, v207
  v_fma_f32 v208, v208, v13, v23
  v_mfma_f32_16x16x32_bf16 a[40:43], a[148:151], v[120:123], a[40:43]
  v_fma_f32 v209, v209, v13, v23
  v_fma_f32 v210, v210, v13, v23
  v_mfma_f32_16x16x32_bf16 a[44:47], a[156:159], v[120:123], a[44:47]
  v_fma_f32 v211, v211, v13, v23
  v_fma_f32 v212, v212, v13, v23
  v_mfma_f32_16x16x32_bf16 a[44:47], a[152:155], v[96:99], a[44:47]
  v_fma_f32 v213, v213, v13, v23
  v_fma_f32 v214, v214, v13, v23
  v_mfma_f32_16x16x32_bf16 a[48:51], a[160:163], v[96:99], a[48:51]
  v_fma_f32 v215, v215, v13, v23
  v_cvt_pk_bf16_f32 v208, v208, v209
  v_mfma_f32_16x16x32_bf16 a[48:51], a[164:167], v[120:123], a[48:51]
  v_cvt_pk_bf16_f32 v209, v210, v211
  v_cvt_pk_bf16_f32 v210, v212, v213
  v_mfma_f32_16x16x32_bf16 a[52:55], a[172:175], v[120:123], a[52:55]
  v_cvt_pk_bf16_f32 v211, v214, v215
  v_fma_f32 v216, v216, v13, v23
  v_mfma_f32_16x16x32_bf16 a[52:55], a[168:171], v[96:99], a[52:55]
  v_fma_f32 v217, v217, v13, v23
  v_fma_f32 v218, v218, v13, v23
  v_mfma_f32_16x16x32_bf16 a[56:59], a[176:179], v[96:99], a[56:59]
  v_fma_f32 v219, v219, v13, v23
  v_fma_f32 v220, v220, v13, v23
  v_mfma_f32_16x16x32_bf16 a[56:59], a[180:183], v[120:123], a[56:59]
  v_fma_f32 v221, v221, v13, v23
  v_fma_f32 v222, v222, v13, v23
  v_mfma_f32_16x16x32_bf16 a[60:63], a[188:191], v[120:123], a[60:63]
  v_fma_f32 v223, v223, v13, v23
  v_cvt_pk_bf16_f32 v216, v216, v217
  v_mfma_f32_16x16x32_bf16 a[60:63], a[184:187], v[96:99], a[60:63]
  v_cvt_pk_bf16_f32 v217, v218, v219
  v_cvt_pk_bf16_f32 v218, v220, v221
  v_mfma_f32_16x16x32_bf16 a[72:75], a[144:147], v[100:103], a[72:75]
  v_cvt_pk_bf16_f32 v219, v222, v223
  ds_write_b128 v8, v[192:195] offset:4096
  v_mfma_f32_16x16x32_bf16 a[72:75], a[148:151], v[124:127], a[72:75]
  ds_read_b128 a[128:131], v8 offset:8192
  ds_read_b128 a[132:135], v9 offset:8192
  v_mfma_f32_16x16x32_bf16 a[76:79], a[156:159], v[124:127], a[76:79]
  ds_read_b128 a[136:139], v10 offset:8192
  ds_read_b128 a[140:143], v11 offset:8192
  v_mfma_f32_16x16x32_bf16 a[76:79], a[152:155], v[100:103], a[76:79]
  s_barrier
  ds_read_b128 v[80:83], v2 offset:8448
  ds_read_b128 v[84:87], v2 offset:8512
  v_mfma_f32_16x16x32_bf16 a[80:83], a[160:163], v[100:103], a[80:83]
  ds_read_b128 v[88:91], v2 offset:8576
  ds_read_b128 v[92:95], v2 offset:8640
  v_mfma_f32_16x16x32_bf16 a[80:83], a[164:167], v[124:127], a[80:83]
  ds_read_b128 v[96:99], v2 offset:8704
  ds_read_b128 v[104:107], v2 offset:8832
  v_mfma_f32_16x16x32_bf16 a[84:87], a[172:175], v[124:127], a[84:87]
  ds_read_b128 v[108:111], v2 offset:8896
  ds_write_b128 v9, v[200:203] offset:4096
  v_mfma_f32_16x16x32_bf16 a[84:87], a[168:171], v[100:103], a[84:87]
  v_fma_f32 v224, v224, v14, v25
  v_fma_f32 v225, v225, v14, v25
  v_mfma_f32_16x16x32_bf16 a[88:91], a[176:179], v[100:103], a[88:91]
  v_fma_f32 v226, v226, v14, v25
  v_fma_f32 v227, v227, v14, v25
  v_mfma_f32_16x16x32_bf16 a[88:91], a[180:183], v[124:127], a[88:91]
  v_fma_f32 v228, v228, v14, v25
  v_fma_f32 v229, v229, v14, v25
  v_mfma_f32_16x16x32_bf16 a[92:95], a[188:191], v[124:127], a[92:95]
  v_fma_f32 v230, v230, v14, v25
  v_fma_f32 v231, v231, v14, v25
  v_mfma_f32_16x16x32_bf16 a[92:95], a[184:187], v[100:103], a[92:95]
  ds_read_b128 v[100:103], v2 offset:8768
  ds_write_b128 v10, v[208:211] offset:4096
  v_mfma_f32_16x16x32_bf16 v[176:179], a[192:195], a[96:99], 0
  ds_write_b128 v11, v[216:219] offset:4096
  v_mfma_f32_16x16x32_bf16 v[176:179], a[196:199], a[100:103], v[176:179]
  ds_read_b128 a[144:147], v8 offset:12288
  ds_read_b128 a[148:151], v9 offset:12288
  v_mfma_f32_16x16x32_bf16 v[176:179], a[200:203], a[104:107], v[176:179]
  ds_read_b128 a[152:155], v10 offset:12288
  ds_read_b128 a[156:159], v11 offset:12288
  v_mfma_f32_16x16x32_bf16 v[176:179], a[204:207], a[108:111], v[176:179]
  s_mov_b32 s39, 7
  v_cvt_pk_bf16_f32 v224, v224, v225
  v_cvt_pk_bf16_f32 v225, v226, v227
  v_mfma_f32_32x32x16_bf16 v[160:175], a[240:243], a[248:251], 0
  v_cvt_pk_bf16_f32 v226, v228, v229
  v_cvt_pk_bf16_f32 v227, v230, v231
  v_fma_f32 v232, v232, v14, v25
  v_fma_f32 v233, v233, v14, v25
  v_max3_f32 v18, v176, v177, v178
  v_max_f32 v18, v18, v179
  v_mfma_f32_32x32x16_bf16 v[192:207], a[240:243], a[248:251], 0
  ds_write_b128 v8, v[224:227] offset:8192
  v_mov_b32 v19, v18
  v_mfma_f32_32x32x16_bf16 v[208:223], a[240:243], a[248:251], 0
  v_fma_f32 v234, v234, v14, v25
  v_permlane32_swap_b32 v18, v19
  v_max_f32 v18, v18, v19
  v_mov_b32 v19, v18
  v_fma_f32 v235, v235, v14, v25
  v_fma_f32 v236, v236, v14, v25
  v_permlane16_swap_b32 v18, v19
  v_max_f32 v18, v18, v19
  v_sub_f32 v128, s81, v18
  v_sub_f32 v129, s81, v18
  v_sub_f32 v130, s81, v18
  v_sub_f32 v131, s81, v18
  v_add_f32 v176, v176, v128
  v_add_f32 v177, v177, v128
  v_mfma_f32_16x16x32_bf16 v[180:183], a[208:211], a[96:99], v[128:131]
  s_waitcnt lgkmcnt(1)
  v_add_f32 v178, v178, v128
  v_add_f32 v179, v179, v128
  v_mfma_f32_16x16x32_bf16 v[180:183], a[212:215], a[100:103], v[180:183]
  v_exp_f32 v176, v176
  v_mfma_f32_16x16x32_bf16 v[180:183], a[216:219], a[104:107], v[180:183]
  v_exp_f32 v177, v177
  v_mfma_f32_16x16x32_bf16 v[180:183], a[220:223], a[108:111], v[180:183]
  v_exp_f32 v178, v178
  v_exp_f32 v179, v179
  v_cvt_pk_bf16_f32 v32, v176, v177
  v_cvt_pk_bf16_f32 v33, v178, v179
  v_mfma_f32_16x16x32_bf16 v[184:187], v[80:83], a[96:99], v[128:131]
  v_fma_f32 v237, v237, v14, v25
  v_fma_f32 v238, v238, v14, v25
  v_mfma_f32_16x16x32_bf16 v[184:187], v[84:87], a[100:103], v[184:187]
  v_exp_f32 v180, v180
  v_mfma_f32_16x16x32_bf16 v[184:187], v[88:91], a[104:107], v[184:187]
  v_exp_f32 v181, v181
  v_mfma_f32_16x16x32_bf16 v[184:187], v[92:95], a[108:111], v[184:187]
  v_exp_f32 v182, v182
  v_exp_f32 v183, v183
  v_cvt_pk_bf16_f32 v34, v180, v181
  v_cvt_pk_bf16_f32 v35, v182, v183
  v_mfma_f32_16x16x32_bf16 v[188:191], v[96:99], a[96:99], v[128:131]
  v_fma_f32 v239, v239, v14, v25
  v_cvt_pk_bf16_f32 v232, v232, v233
  v_mfma_f32_16x16x32_bf16 v[188:191], v[100:103], a[100:103], v[188:191]
  v_exp_f32 v184, v184
  v_mfma_f32_16x16x32_bf16 v[188:191], v[104:107], a[104:107], v[188:191]
  v_exp_f32 v185, v185
  v_mfma_f32_16x16x32_bf16 v[188:191], v[108:111], a[108:111], v[188:191]
  v_exp_f32 v186, v186
  v_exp_f32 v187, v187
  v_cvt_pk_bf16_f32 v56, v184, v185
  v_cvt_pk_bf16_f32 v57, v186, v187
  v_cvt_pk_bf16_f32 v233, v234, v235
  v_cvt_pk_bf16_f32 v234, v236, v237
  v_cvt_pk_bf16_f32 v235, v238, v239
  v_mfma_f32_16x16x32_bf16 v[152:155], a[192:195], a[112:115], 0
  ds_write_b128 v9, v[232:235] offset:8192
  v_exp_f32 v188, v188
  v_exp_f32 v189, v189
  v_exp_f32 v190, v190
  v_exp_f32 v191, v191
  v_cvt_pk_bf16_f32 v58, v188, v189
  v_cvt_pk_bf16_f32 v59, v190, v191
  v_mfma_f32_16x16x32_bf16 v[152:155], a[196:199], a[116:119], v[152:155]
  v_fma_f32 v240, v240, v14, v25
  v_fma_f32 v241, v241, v14, v25
  v_mfma_f32_16x16x32_bf16 v[152:155], a[200:203], a[120:123], v[152:155]
  v_fma_f32 v242, v242, v14, v25
  v_fma_f32 v243, v243, v14, v25
  v_mfma_f32_16x16x32_bf16 v[152:155], a[204:207], a[124:127], v[152:155]
  ds_read_b128 a[160:163], v8 offset:16384
  ds_read_b128 a[164:167], v9 offset:16384
  v_mfma_f32_32x32x16_bf16 v[224:239], a[240:243], a[248:251], 0
  ds_read_b128 a[168:171], v10 offset:16384
  ds_read_b128 a[172:175], v11 offset:16384
  v_fma_f32 v244, v244, v14, v25
  v_fma_f32 v245, v245, v14, v25
  v_fma_f32 v246, v246, v14, v25
  v_max3_f32 v6, v152, v153, v154
  v_max_f32 v6, v6, v155
  v_mov_b32 v7, v6
  v_fma_f32 v247, v247, v14, v25
  v_cvt_pk_bf16_f32 v240, v240, v241
  v_permlane32_swap_b32 v6, v7
  v_max_f32 v6, v6, v7
  v_mov_b32 v7, v6
  v_cvt_pk_bf16_f32 v241, v242, v243
  v_cvt_pk_bf16_f32 v242, v244, v245
  v_permlane16_swap_b32 v6, v7
  v_max_f32 v6, v6, v7
  v_sub_f32 v132, s81, v6
  v_sub_f32 v133, s81, v6
  v_sub_f32 v134, s81, v6
  v_sub_f32 v135, s81, v6
  v_add_f32 v152, v152, v132
  v_add_f32 v153, v153, v132
  v_mfma_f32_16x16x32_bf16 v[156:159], a[208:211], a[112:115], v[132:135]
  v_add_f32 v154, v154, v132
  v_add_f32 v155, v155, v132
  v_mfma_f32_16x16x32_bf16 v[156:159], a[212:215], a[116:119], v[156:159]
  v_exp_f32 v152, v152
  v_mfma_f32_16x16x32_bf16 v[156:159], a[216:219], a[120:123], v[156:159]
  v_exp_f32 v153, v153
  v_mfma_f32_16x16x32_bf16 v[156:159], a[220:223], a[124:127], v[156:159]
  v_exp_f32 v154, v154
  v_exp_f32 v155, v155
  v_cvt_pk_bf16_f32 v36, v152, v153
  v_cvt_pk_bf16_f32 v37, v154, v155
  v_cvt_pk_bf16_f32 v243, v246, v247
  v_mfma_f32_16x16x32_bf16 v[176:179], v[80:83], a[112:115], v[132:135]
  ds_write_b128 v10, v[240:243] offset:8192
  v_mfma_f32_16x16x32_bf16 v[176:179], v[84:87], a[116:119], v[176:179]
  v_exp_f32 v156, v156
  v_mfma_f32_16x16x32_bf16 v[176:179], v[88:91], a[120:123], v[176:179]
  v_exp_f32 v157, v157
  v_mfma_f32_16x16x32_bf16 v[176:179], v[92:95], a[124:127], v[176:179]
  v_exp_f32 v158, v158
  v_exp_f32 v159, v159
  v_cvt_pk_bf16_f32 v38, v156, v157
  v_cvt_pk_bf16_f32 v39, v158, v159
  v_fma_f32 v248, v248, v14, v25
  v_fma_f32 v249, v249, v14, v25
  v_fma_f32 v250, v250, v14, v25
  v_fma_f32 v251, v251, v14, v25
  v_fma_f32 v252, v252, v14, v25
  v_fma_f32 v253, v253, v14, v25
  v_fma_f32 v254, v254, v14, v25
  v_fma_f32 v255, v255, v14, v25
  v_cvt_pk_bf16_f32 v248, v248, v249
  v_cvt_pk_bf16_f32 v249, v250, v251
  v_cvt_pk_bf16_f32 v250, v252, v253
  v_cvt_pk_bf16_f32 v251, v254, v255
  v_mfma_f32_16x16x32_bf16 v[180:183], v[96:99], a[112:115], v[132:135]
  ds_write_b128 v11, v[248:251] offset:8192
  v_mfma_f32_32x32x16_bf16 v[240:255], a[240:243], a[248:251], 0
  v_exp_f32 v176, v176
  v_exp_f32 v177, v177
  v_exp_f32 v178, v178
  v_mfma_f32_16x16x32_bf16 v[180:183], v[100:103], a[116:119], v[180:183]
  v_exp_f32 v179, v179
  v_mfma_f32_16x16x32_bf16 v[180:183], v[104:107], a[120:123], v[180:183]
  v_cvt_pk_bf16_f32 v60, v176, v177
  v_cvt_pk_bf16_f32 v61, v178, v179
  v_mfma_f32_16x16x32_bf16 v[180:183], v[108:111], a[124:127], v[180:183]
  v_accvgpr_read_b32 v112, a0
  v_accvgpr_read_b32 v113, a1
  v_accvgpr_read_b32 v114, a2
  v_accvgpr_read_b32 v115, a3
  v_accvgpr_read_b32 v116, a4
  v_accvgpr_read_b32 v117, a5
  v_accvgpr_read_b32 v118, a6
  v_accvgpr_read_b32 v119, a7
  v_exp_f32 v180, v180
  v_exp_f32 v181, v181
  v_exp_f32 v182, v182
  v_exp_f32 v183, v183
  v_cvt_pk_bf16_f32 v62, v180, v181
  v_cvt_pk_bf16_f32 v63, v182, v183
  v_fma_f32 v112, v112, v15, v27
  v_fma_f32 v113, v113, v15, v27
  v_fma_f32 v114, v114, v15, v27
  v_fma_f32 v115, v115, v15, v27
  v_fma_f32 v116, v116, v15, v27
  v_fma_f32 v117, v117, v15, v27
  v_fma_f32 v118, v118, v15, v27
  v_fma_f32 v119, v119, v15, v27
  v_cvt_pk_bf16_f32 v112, v112, v113
  v_cvt_pk_bf16_f32 v113, v114, v115
  v_cvt_pk_bf16_f32 v114, v116, v117
  v_cvt_pk_bf16_f32 v115, v118, v119
  v_mfma_f32_16x16x32_bf16 v[184:187], a[192:195], a[128:131], 0
  ds_write_b128 v8, v[112:115] offset:12288
  v_mfma_f32_16x16x32_bf16 v[184:187], a[196:199], a[132:135], v[184:187]
  v_accvgpr_read_b32 v120, a8
  v_accvgpr_read_b32 v121, a9
  v_mfma_f32_16x16x32_bf16 v[184:187], a[200:203], a[136:139], v[184:187]
  v_accvgpr_read_b32 v122, a10
  v_accvgpr_read_b32 v123, a11
  v_mfma_f32_16x16x32_bf16 v[184:187], a[204:207], a[140:143], v[184:187]
  v_accvgpr_read_b32 v124, a12
  v_accvgpr_read_b32 v125, a13
  v_accvgpr_read_b32 v126, a14
  v_accvgpr_read_b32 v127, a15
  v_fma_f32 v120, v120, v15, v27
  v_fma_f32 v121, v121, v15, v27
  v_fma_f32 v122, v122, v15, v27
  v_fma_f32 v123, v123, v15, v27
  v_max3_f32 v18, v184, v185, v186
  v_max_f32 v18, v18, v187
  v_mov_b32 v19, v18
  v_fma_f32 v124, v124, v15, v27
  v_fma_f32 v125, v125, v15, v27
  v_permlane32_swap_b32 v18, v19
  v_max_f32 v18, v18, v19
  v_mov_b32 v19, v18
  v_fma_f32 v126, v126, v15, v27
  v_fma_f32 v127, v127, v15, v27
  v_permlane16_swap_b32 v18, v19
  v_max_f32 v18, v18, v19
  v_sub_f32 v136, s81, v18
  v_sub_f32 v137, s81, v18
  v_sub_f32 v138, s81, v18
  v_sub_f32 v139, s81, v18
  v_add_f32 v184, v184, v136
  v_add_f32 v185, v185, v136
  v_mfma_f32_16x16x32_bf16 v[188:191], a[208:211], a[128:131], v[136:139]
  v_add_f32 v186, v186, v136
  v_add_f32 v187, v187, v136
  v_mfma_f32_16x16x32_bf16 v[188:191], a[212:215], a[132:135], v[188:191]
  v_exp_f32 v184, v184
  v_mfma_f32_16x16x32_bf16 v[188:191], a[216:219], a[136:139], v[188:191]
  v_exp_f32 v185, v185
  v_mfma_f32_16x16x32_bf16 v[188:191], a[220:223], a[140:143], v[188:191]
  v_exp_f32 v186, v186
  v_exp_f32 v187, v187
  v_cvt_pk_bf16_f32 v40, v184, v185
  v_cvt_pk_bf16_f32 v41, v186, v187
  v_cvt_pk_bf16_f32 v120, v120, v121
  v_cvt_pk_bf16_f32 v121, v122, v123
  v_cvt_pk_bf16_f32 v122, v124, v125
  v_cvt_pk_bf16_f32 v123, v126, v127
  v_mfma_f32_16x16x32_bf16 v[152:155], v[80:83], a[128:131], v[136:139]
  ds_write_b128 v9, v[120:123] offset:12288
  v_mfma_f32_16x16x32_bf16 v[152:155], v[84:87], a[132:135], v[152:155]
  v_exp_f32 v188, v188
  v_mfma_f32_16x16x32_bf16 v[152:155], v[88:91], a[136:139], v[152:155]
  v_exp_f32 v189, v189
  v_mfma_f32_16x16x32_bf16 v[152:155], v[92:95], a[140:143], v[152:155]
  v_exp_f32 v190, v190
  v_exp_f32 v191, v191
  v_cvt_pk_bf16_f32 v42, v188, v189
  v_cvt_pk_bf16_f32 v43, v190, v191
  v_mfma_f32_16x16x32_bf16 v[156:159], v[96:99], a[128:131], v[136:139]
  ds_read_b128 a[176:179], v8 offset:20480
  ds_read_b128 a[180:183], v9 offset:20480
  v_mfma_f32_16x16x32_bf16 v[156:159], v[100:103], a[132:135], v[156:159]
  ds_read_b128 a[184:187], v10 offset:20480
  ds_read_b128 a[188:191], v11 offset:20480
  v_mfma_f32_16x16x32_bf16 v[156:159], v[104:107], a[136:139], v[156:159]
  v_accvgpr_read_b32 v112, a16
  v_accvgpr_read_b32 v113, a17
  v_mfma_f32_16x16x32_bf16 v[156:159], v[108:111], a[140:143], v[156:159]
  v_accvgpr_read_b32 v114, a18
  v_accvgpr_read_b32 v115, a19
  v_accvgpr_read_b32 v116, a20
  v_accvgpr_read_b32 v117, a21
  v_accvgpr_read_b32 v118, a22
  v_accvgpr_read_b32 v119, a23
  v_fma_f32 v112, v112, v15, v27
  v_fma_f32 v113, v113, v15, v27
  v_fma_f32 v114, v114, v15, v27
  v_fma_f32 v115, v115, v15, v27
  v_fma_f32 v116, v116, v15, v27
  v_fma_f32 v117, v117, v15, v27
  v_fma_f32 v118, v118, v15, v27
  v_fma_f32 v119, v119, v15, v27
  v_cvt_pk_bf16_f32 v112, v112, v113
  v_cvt_pk_bf16_f32 v113, v114, v115
  v_cvt_pk_bf16_f32 v114, v116, v117
  v_cvt_pk_bf16_f32 v115, v118, v119
  v_mfma_f32_32x32x16_bf16 a[0:15], a[240:243], a[248:251], 0
  ds_write_b128 v10, v[112:115] offset:12288
  v_exp_f32 v152, v152
  v_exp_f32 v153, v153
  v_exp_f32 v154, v154
  v_exp_f32 v155, v155
  v_cvt_pk_bf16_f32 v64, v152, v153
  v_cvt_pk_bf16_f32 v65, v154, v155
  v_exp_f32 v156, v156
  v_exp_f32 v157, v157
  v_exp_f32 v158, v158
  v_exp_f32 v159, v159
  v_cvt_pk_bf16_f32 v66, v156, v157
  v_cvt_pk_bf16_f32 v67, v158, v159
  v_accvgpr_read_b32 v120, a24
  v_accvgpr_read_b32 v121, a25
  v_accvgpr_read_b32 v122, a26
  v_accvgpr_read_b32 v123, a27
  v_accvgpr_read_b32 v124, a28
  v_accvgpr_read_b32 v125, a29
  v_accvgpr_read_b32 v126, a30
  v_accvgpr_read_b32 v127, a31
  v_mfma_f32_32x32x16_bf16 a[16:31], a[240:243], a[248:251], 0
  s_waitcnt lgkmcnt(1)
  v_fma_f32 v120, v120, v15, v27
  v_fma_f32 v121, v121, v15, v27
  v_fma_f32 v122, v122, v15, v27
  v_fma_f32 v123, v123, v15, v27
  v_fma_f32 v124, v124, v15, v27
  v_fma_f32 v125, v125, v15, v27
  v_mfma_f32_16x16x32_bf16 v[176:179], a[192:195], a[144:147], 0
  v_fma_f32 v126, v126, v15, v27
  v_fma_f32 v127, v127, v15, v27
  v_mfma_f32_16x16x32_bf16 v[176:179], a[196:199], a[148:151], v[176:179]
  v_cvt_pk_bf16_f32 v120, v120, v121
  v_cvt_pk_bf16_f32 v121, v122, v123
  v_mfma_f32_16x16x32_bf16 v[176:179], a[200:203], a[152:155], v[176:179]
  v_cvt_pk_bf16_f32 v122, v124, v125
  v_cvt_pk_bf16_f32 v123, v126, v127
  v_mfma_f32_16x16x32_bf16 v[176:179], a[204:207], a[156:159], v[176:179]
  ds_write_b128 v11, v[120:123] offset:12288
  v_accvgpr_read_b32 v112, a32
  v_accvgpr_read_b32 v113, a33
  v_accvgpr_read_b32 v114, a34
  v_accvgpr_read_b32 v115, a35
  v_accvgpr_read_b32 v116, a36
  v_accvgpr_read_b32 v117, a37
  v_accvgpr_read_b32 v118, a38
  v_max3_f32 v6, v176, v177, v178
  v_max_f32 v6, v6, v179
  v_mov_b32 v7, v6
  v_accvgpr_read_b32 v119, a39
  v_fma_f32 v112, v112, v16, v29
  v_permlane32_swap_b32 v6, v7
  v_max_f32 v6, v6, v7
  v_mov_b32 v7, v6
  v_fma_f32 v113, v113, v16, v29
  v_fma_f32 v114, v114, v16, v29
  v_permlane16_swap_b32 v6, v7
  v_max_f32 v6, v6, v7
  v_sub_f32 v140, s81, v6
  v_sub_f32 v141, s81, v6
  v_sub_f32 v142, s81, v6
  v_sub_f32 v143, s81, v6
  v_add_f32 v176, v176, v140
  v_add_f32 v177, v177, v140
  v_mfma_f32_16x16x32_bf16 v[180:183], a[208:211], a[144:147], v[140:143]
  v_add_f32 v178, v178, v140
  v_add_f32 v179, v179, v140
  v_mfma_f32_16x16x32_bf16 v[180:183], a[212:215], a[148:151], v[180:183]
  v_exp_f32 v176, v176
  v_mfma_f32_16x16x32_bf16 v[180:183], a[216:219], a[152:155], v[180:183]
  v_exp_f32 v177, v177
  v_mfma_f32_16x16x32_bf16 v[180:183], a[220:223], a[156:159], v[180:183]
  v_exp_f32 v178, v178
  v_exp_f32 v179, v179
  v_cvt_pk_bf16_f32 v44, v176, v177
  v_cvt_pk_bf16_f32 v45, v178, v179
  v_mfma_f32_16x16x32_bf16 v[184:187], v[80:83], a[144:147], v[140:143]
  v_fma_f32 v115, v115, v16, v29
  v_fma_f32 v116, v116, v16, v29
  v_mfma_f32_16x16x32_bf16 v[184:187], v[84:87], a[148:151], v[184:187]
  v_fma_f32 v117, v117, v16, v29
  v_fma_f32 v118, v118, v16, v29
  v_mfma_f32_16x16x32_bf16 v[184:187], v[88:91], a[152:155], v[184:187]
  v_fma_f32 v119, v119, v16, v29
  v_cvt_pk_bf16_f32 v112, v112, v113
  v_mfma_f32_16x16x32_bf16 v[184:187], v[92:95], a[156:159], v[184:187]
  v_cvt_pk_bf16_f32 v113, v114, v115
  v_cvt_pk_bf16_f32 v114, v116, v117
  v_cvt_pk_bf16_f32 v115, v118, v119
  v_mfma_f32_16x16x32_bf16 v[188:191], v[96:99], a[144:147], v[140:143]
  ds_write_b128 v8, v[112:115] offset:16384
  v_exp_f32 v180, v180
  v_exp_f32 v181, v181
  v_exp_f32 v182, v182
  v_exp_f32 v183, v183
  v_cvt_pk_bf16_f32 v46, v180, v181
  v_cvt_pk_bf16_f32 v47, v182, v183
  v_mfma_f32_16x16x32_bf16 v[188:191], v[100:103], a[148:151], v[188:191]
  v_exp_f32 v184, v184
  v_mfma_f32_16x16x32_bf16 v[188:191], v[104:107], a[152:155], v[188:191]
  v_exp_f32 v185, v185
  v_mfma_f32_16x16x32_bf16 v[188:191], v[108:111], a[156:159], v[188:191]
  v_exp_f32 v186, v186
  v_exp_f32 v187, v187
  v_cvt_pk_bf16_f32 v68, v184, v185
  v_cvt_pk_bf16_f32 v69, v186, v187
  v_accvgpr_read_b32 v120, a40
  v_accvgpr_read_b32 v121, a41
  v_accvgpr_read_b32 v122, a42
  v_accvgpr_read_b32 v123, a43
  v_accvgpr_read_b32 v124, a44
  v_accvgpr_read_b32 v125, a45
  v_accvgpr_read_b32 v126, a46
  v_accvgpr_read_b32 v127, a47
  v_fma_f32 v120, v120, v16, v29
  v_fma_f32 v121, v121, v16, v29
  v_fma_f32 v122, v122, v16, v29
  v_fma_f32 v123, v123, v16, v29
  v_fma_f32 v124, v124, v16, v29
  v_fma_f32 v125, v125, v16, v29
  v_fma_f32 v126, v126, v16, v29
  v_fma_f32 v127, v127, v16, v29
  v_cvt_pk_bf16_f32 v120, v120, v121
  v_cvt_pk_bf16_f32 v121, v122, v123
  v_cvt_pk_bf16_f32 v122, v124, v125
  v_cvt_pk_bf16_f32 v123, v126, v127
  v_mfma_f32_16x16x32_bf16 v[152:155], a[192:195], a[160:163], 0
  ds_write_b128 v9, v[120:123] offset:16384
  v_exp_f32 v188, v188
  v_exp_f32 v189, v189
  v_exp_f32 v190, v190
  v_exp_f32 v191, v191
  v_cvt_pk_bf16_f32 v70, v188, v189
  v_cvt_pk_bf16_f32 v71, v190, v191
  v_mfma_f32_16x16x32_bf16 v[152:155], a[196:199], a[164:167], v[152:155]
  ds_read_b64_tr_b16 a[224:225], v3 offset:0
  ds_read_b64_tr_b16 a[226:227], v3 offset:256
  v_mfma_f32_16x16x32_bf16 v[152:155], a[200:203], a[168:171], v[152:155]
  ds_read_b64_tr_b16 a[228:229], v3 offset:8448
  ds_read_b64_tr_b16 a[230:231], v3 offset:8704
  v_mfma_f32_16x16x32_bf16 v[152:155], a[204:207], a[172:175], v[152:155]
  ds_read_b64_tr_b16 a[236:237], v3 offset:8456
  v_accvgpr_read_b32 v112, a48
  v_accvgpr_read_b32 v113, a49
  v_accvgpr_read_b32 v114, a50
  v_accvgpr_read_b32 v115, a51
  v_accvgpr_read_b32 v116, a52
  v_accvgpr_read_b32 v117, a53
  v_accvgpr_read_b32 v118, a54
  v_max3_f32 v18, v152, v153, v154
  v_max_f32 v18, v18, v155
  v_mov_b32 v19, v18
  v_accvgpr_read_b32 v119, a55
  v_fma_f32 v112, v112, v16, v29
  v_permlane32_swap_b32 v18, v19
  v_max_f32 v18, v18, v19
  v_mov_b32 v19, v18
  v_fma_f32 v113, v113, v16, v29
  v_fma_f32 v114, v114, v16, v29
  v_permlane16_swap_b32 v18, v19
  v_max_f32 v18, v18, v19
  v_sub_f32 v144, s81, v18
  v_sub_f32 v145, s81, v18
  v_sub_f32 v146, s81, v18
  v_sub_f32 v147, s81, v18
  v_fma_f32 v115, v115, v16, v29
  v_fma_f32 v116, v116, v16, v29
  v_fma_f32 v117, v117, v16, v29
  v_fma_f32 v118, v118, v16, v29
  v_fma_f32 v119, v119, v16, v29
  v_cvt_pk_bf16_f32 v112, v112, v113
  v_cvt_pk_bf16_f32 v113, v114, v115
  v_cvt_pk_bf16_f32 v114, v116, v117
  v_cvt_pk_bf16_f32 v115, v118, v119
  v_mfma_f32_16x16x32_bf16 v[156:159], a[208:211], a[160:163], v[144:147]
  ds_write_b128 v10, v[112:115] offset:16384
  v_mfma_f32_16x16x32_bf16 v[156:159], a[212:215], a[164:167], v[156:159]
  v_add_f32 v152, v152, v144
  v_add_f32 v153, v153, v144
  v_mfma_f32_16x16x32_bf16 v[156:159], a[216:219], a[168:171], v[156:159]
  v_add_f32 v154, v154, v144
  v_add_f32 v155, v155, v144
  v_mfma_f32_16x16x32_bf16 v[156:159], a[220:223], a[172:175], v[156:159]
  v_exp_f32 v152, v152
  v_exp_f32 v153, v153
  v_exp_f32 v154, v154
  v_exp_f32 v155, v155
  v_cvt_pk_bf16_f32 v48, v152, v153
  v_cvt_pk_bf16_f32 v49, v154, v155
  v_mfma_f32_16x16x32_bf16 v[176:179], v[80:83], a[160:163], v[144:147]
  v_accvgpr_read_b32 v120, a56
  v_accvgpr_read_b32 v121, a57
  v_mfma_f32_16x16x32_bf16 v[176:179], v[84:87], a[164:167], v[176:179]
  v_accvgpr_read_b32 v122, a58
  v_accvgpr_read_b32 v123, a59
  v_mfma_f32_16x16x32_bf16 v[176:179], v[88:91], a[168:171], v[176:179]
  v_accvgpr_read_b32 v124, a60
  v_accvgpr_read_b32 v125, a61
  v_mfma_f32_16x16x32_bf16 v[176:179], v[92:95], a[172:175], v[176:179]
  v_accvgpr_read_b32 v126, a62
  v_accvgpr_read_b32 v127, a63
  v_mfma_f32_32x32x16_bf16 a[32:47], a[240:243], a[248:251], 0
  v_fma_f32 v120, v120, v16, v29
  v_fma_f32 v121, v121, v16, v29
  v_fma_f32 v122, v122, v16, v29
  v_fma_f32 v123, v123, v16, v29
  v_fma_f32 v124, v124, v16, v29
  v_fma_f32 v125, v125, v16, v29
  v_mfma_f32_32x32x16_bf16 a[48:63], a[240:243], a[248:251], 0
  v_fma_f32 v126, v126, v16, v29
  v_fma_f32 v127, v127, v16, v29
  v_cvt_pk_bf16_f32 v120, v120, v121
  v_cvt_pk_bf16_f32 v121, v122, v123
  v_cvt_pk_bf16_f32 v122, v124, v125
  v_cvt_pk_bf16_f32 v123, v126, v127
  v_mfma_f32_16x16x32_bf16 v[180:183], v[96:99], a[160:163], v[144:147]
  ds_write_b128 v11, v[120:123] offset:16384
  v_exp_f32 v156, v156
  v_exp_f32 v157, v157
  v_exp_f32 v158, v158
  v_exp_f32 v159, v159
  v_cvt_pk_bf16_f32 v50, v156, v157
  v_cvt_pk_bf16_f32 v51, v158, v159
  v_mfma_f32_16x16x32_bf16 v[180:183], v[100:103], a[164:167], v[180:183]
  v_exp_f32 v176, v176
  v_mfma_f32_16x16x32_bf16 v[180:183], v[104:107], a[168:171], v[180:183]
  v_exp_f32 v177, v177
  v_mfma_f32_16x16x32_bf16 v[180:183], v[108:111], a[172:175], v[180:183]
  v_exp_f32 v178, v178
  v_exp_f32 v179, v179
  v_cvt_pk_bf16_f32 v72, v176, v177
  v_cvt_pk_bf16_f32 v73, v178, v179
  v_accvgpr_read_b32 v112, a64
  v_accvgpr_read_b32 v113, a65
  v_accvgpr_read_b32 v114, a66
  v_accvgpr_read_b32 v115, a67
  v_accvgpr_read_b32 v116, a68
  v_accvgpr_read_b32 v117, a69
  v_accvgpr_read_b32 v118, a70
  v_accvgpr_read_b32 v119, a71
  v_fma_f32 v112, v112, v17, v31
  v_fma_f32 v113, v113, v17, v31
  v_fma_f32 v114, v114, v17, v31
  v_fma_f32 v115, v115, v17, v31
  v_fma_f32 v116, v116, v17, v31
  v_fma_f32 v117, v117, v17, v31
  v_fma_f32 v118, v118, v17, v31
  v_fma_f32 v119, v119, v17, v31
  v_cvt_pk_bf16_f32 v112, v112, v113
  v_cvt_pk_bf16_f32 v113, v114, v115
  v_cvt_pk_bf16_f32 v114, v116, v117
  v_cvt_pk_bf16_f32 v115, v118, v119
  v_mfma_f32_16x16x32_bf16 v[184:187], a[192:195], a[176:179], 0
  ds_write_b128 v8, v[112:115] offset:20480
  v_mfma_f32_16x16x32_bf16 v[184:187], a[196:199], a[180:183], v[184:187]
  ds_read_b128 a[192:195], v2 offset:16896
  ds_read_b128 a[196:199], v2 offset:16960
  v_exp_f32 v180, v180
  v_exp_f32 v181, v181
  v_exp_f32 v182, v182
  v_exp_f32 v183, v183
  v_cvt_pk_bf16_f32 v74, v180, v181
  v_cvt_pk_bf16_f32 v75, v182, v183
  v_mfma_f32_16x16x32_bf16 v[184:187], a[200:203], a[184:187], v[184:187]
  ds_read_b128 a[200:203], v2 offset:17024
  v_accvgpr_read_b32 v120, a72
  v_mfma_f32_16x16x32_bf16 v[184:187], a[204:207], a[188:191], v[184:187]
  ds_read_b128 a[204:207], v2 offset:17088
  v_accvgpr_read_b32 v121, a73
  v_accvgpr_read_b32 v122, a74
  v_accvgpr_read_b32 v123, a75
  v_accvgpr_read_b32 v124, a76
  v_accvgpr_read_b32 v125, a77
  v_accvgpr_read_b32 v126, a78
  v_accvgpr_read_b32 v127, a79
  v_max3_f32 v6, v184, v185, v186
  v_max_f32 v6, v6, v187
  v_mov_b32 v7, v6
  v_fma_f32 v120, v120, v17, v31
  v_fma_f32 v121, v121, v17, v31
  v_permlane32_swap_b32 v6, v7
  v_max_f32 v6, v6, v7
  v_mov_b32 v7, v6
  v_fma_f32 v122, v122, v17, v31
  v_fma_f32 v123, v123, v17, v31
  v_permlane16_swap_b32 v6, v7
  v_max_f32 v6, v6, v7
  v_sub_f32 v148, s81, v6
  v_sub_f32 v149, s81, v6
  v_sub_f32 v150, s81, v6
  v_sub_f32 v151, s81, v6
  v_fma_f32 v124, v124, v17, v31
  v_fma_f32 v125, v125, v17, v31
  v_mfma_f32_16x16x32_bf16 v[188:191], a[208:211], a[176:179], v[148:151]
  v_fma_f32 v126, v126, v17, v31
  v_fma_f32 v127, v127, v17, v31
  v_mfma_f32_16x16x32_bf16 v[188:191], a[212:215], a[180:183], v[188:191]
  v_cvt_pk_bf16_f32 v120, v120, v121
  v_cvt_pk_bf16_f32 v121, v122, v123
  v_mfma_f32_16x16x32_bf16 v[188:191], a[216:219], a[184:187], v[188:191]
  v_cvt_pk_bf16_f32 v122, v124, v125
  v_cvt_pk_bf16_f32 v123, v126, v127
  v_mfma_f32_16x16x32_bf16 v[188:191], a[220:223], a[188:191], v[188:191]
  ds_write_b128 v9, v[120:123] offset:20480
  v_add_f32 v184, v184, v148
  v_add_f32 v185, v185, v148
  v_add_f32 v186, v186, v148
  v_add_f32 v187, v187, v148
  v_exp_f32 v184, v184
  v_exp_f32 v185, v185
  v_exp_f32 v186, v186
  v_exp_f32 v187, v187
  v_cvt_pk_bf16_f32 v52, v184, v185
  v_cvt_pk_bf16_f32 v53, v186, v187
  v_mfma_f32_16x16x32_bf16 v[152:155], v[80:83], a[176:179], v[148:151]
  v_exp_f32 v188, v188
  v_mfma_f32_16x16x32_bf16 v[152:155], v[84:87], a[180:183], v[152:155]
  v_exp_f32 v189, v189
  v_mfma_f32_16x16x32_bf16 v[152:155], v[88:91], a[184:187], v[152:155]
  v_exp_f32 v190, v190
  v_mfma_f32_16x16x32_bf16 v[152:155], v[92:95], a[188:191], v[152:155]
  v_exp_f32 v191, v191
  v_cvt_pk_bf16_f32 v54, v188, v189
  v_cvt_pk_bf16_f32 v55, v190, v191
  v_accvgpr_read_b32 v112, a80
  v_accvgpr_read_b32 v113, a81
  v_accvgpr_read_b32 v114, a82
  v_accvgpr_read_b32 v115, a83
  v_accvgpr_read_b32 v116, a84
  v_accvgpr_read_b32 v117, a85
  v_accvgpr_read_b32 v118, a86
  v_accvgpr_read_b32 v119, a87
  v_fma_f32 v112, v112, v17, v31
  v_fma_f32 v113, v113, v17, v31
  v_fma_f32 v114, v114, v17, v31
  v_fma_f32 v115, v115, v17, v31
  v_fma_f32 v116, v116, v17, v31
  v_fma_f32 v117, v117, v17, v31
  v_fma_f32 v118, v118, v17, v31
  v_fma_f32 v119, v119, v17, v31
  v_cvt_pk_bf16_f32 v112, v112, v113
  v_cvt_pk_bf16_f32 v113, v114, v115
  v_cvt_pk_bf16_f32 v114, v116, v117
  v_cvt_pk_bf16_f32 v115, v118, v119
  v_mfma_f32_16x16x32_bf16 v[156:159], v[96:99], a[176:179], v[148:151]
  ds_write_b128 v10, v[112:115] offset:20480
  v_mfma_f32_16x16x32_bf16 v[156:159], v[100:103], a[180:183], v[156:159]
  v_exp_f32 v152, v152
  v_mfma_f32_16x16x32_bf16 v[156:159], v[104:107], a[184:187], v[156:159]
  v_exp_f32 v153, v153
  v_mfma_f32_16x16x32_bf16 v[156:159], v[108:111], a[188:191], v[156:159]
  v_exp_f32 v154, v154
  v_exp_f32 v155, v155
  v_cvt_pk_bf16_f32 v76, v152, v153
  v_cvt_pk_bf16_f32 v77, v154, v155
  v_mfma_f32_32x32x16_bf16 a[64:79], a[240:243], a[248:251], 0
  v_accvgpr_read_b32 v120, a88
  v_accvgpr_read_b32 v121, a89
  v_accvgpr_read_b32 v122, a90
  v_accvgpr_read_b32 v123, a91
  v_accvgpr_read_b32 v124, a92
  v_accvgpr_read_b32 v125, a93
  v_accvgpr_read_b32 v126, a94
  v_accvgpr_read_b32 v127, a95
  v_mfma_f32_32x32x16_bf16 a[80:95], a[240:243], a[248:251], 0
  v_fma_f32 v120, v120, v17, v31
  v_fma_f32 v121, v121, v17, v31
  v_fma_f32 v122, v122, v17, v31
  v_fma_f32 v123, v123, v17, v31
  v_fma_f32 v124, v124, v17, v31
  v_fma_f32 v125, v125, v17, v31
  v_fma_f32 v126, v126, v17, v31
  v_fma_f32 v127, v127, v17, v31
  v_cvt_pk_bf16_f32 v120, v120, v121
  v_cvt_pk_bf16_f32 v121, v122, v123
  v_cvt_pk_bf16_f32 v122, v124, v125
  v_cvt_pk_bf16_f32 v123, v126, v127
  v_mfma_f32_32x32x16_bf16 v[16:31], a[244:247], a[244:247], 0
  ds_write_b128 v11, v[120:123] offset:20480
  v_mfma_f32_32x32x16_bf16 v[176:191], a[240:243], a[248:251], 0
  s_waitcnt lgkmcnt(0)
  s_branch ENTRY1_6
.p2align 6
LOOP1_6:
  v_mfma_f32_16x16x32_bf16 v[152:155], a[192:195], a[96:99], v[128:131]
  s_waitcnt lgkmcnt(6)
  v_exp_f32 v156, v156
  v_mfma_f32_16x16x32_bf16 v[152:155], a[196:199], a[100:103], v[152:155]
  v_mfma_f32_16x16x32_bf16 v[152:155], a[200:203], a[104:107], v[152:155]
  s_waitcnt lgkmcnt(3)
  v_exp_f32 v157, v157
  v_mfma_f32_16x16x32_bf16 v[152:155], a[204:207], a[108:111], v[152:155]
  ds_read_b64_tr_b16 a[238:239], v3 offset:8840
  v_cvt_pk_bf16_f32 v102, v156, v157
  v_mfma_f32_16x16x32_bf16 v[176:179], a[224:227], v[32:35], v[176:179]
  s_waitcnt lgkmcnt(2)
  v_exp_f32 v158, v158
  v_mfma_f32_16x16x32_bf16 v[176:179], a[228:231], v[56:59], v[176:179]
  ds_read_b128 a[208:211], v2 offset:25600
  v_mfma_f32_16x16x32_bf16 v[208:211], a[228:231], v[60:63], v[208:211]
  v_exp_f32 v159, v159
  v_mfma_f32_16x16x32_bf16 v[208:211], a[224:227], v[36:39], v[208:211]
  ds_read_b64_tr_b16 a[232:233], v3 offset:136
  v_cvt_pk_bf16_f32 v103, v158, v159
  v_mfma_f32_16x16x32_bf16 v[156:159], a[192:195], a[112:115], v[132:135]
  v_exp_f32 v152, v152
  v_mfma_f32_16x16x32_bf16 v[156:159], a[196:199], a[116:119], v[156:159]
  ds_read_b128 a[212:215], v2 offset:25664
  v_mfma_f32_16x16x32_bf16 v[156:159], a[200:203], a[120:123], v[156:159]
  v_exp_f32 v153, v153
  v_mfma_f32_16x16x32_bf16 v[156:159], a[204:207], a[124:127], v[156:159]
  ds_read_b64_tr_b16 a[234:235], v3 offset:392
  v_cvt_pk_bf16_f32 v104, v152, v153
  v_mfma_f32_16x16x32_bf16 v[240:243], a[224:227], v[40:43], v[240:243]
  v_exp_f32 v154, v154
  v_mfma_f32_16x16x32_bf16 v[240:243], a[228:231], v[64:67], v[240:243]
  v_mfma_f32_16x16x32_bf16 a[16:19], a[228:231], v[68:71], a[16:19]
  v_exp_f32 v155, v155
  v_mfma_f32_16x16x32_bf16 a[16:19], a[224:227], v[44:47], a[16:19]
  ds_read_b128 a[216:219], v2 offset:25728
  v_cvt_pk_bf16_f32 v105, v154, v155
  v_mfma_f32_16x16x32_bf16 v[152:155], a[192:195], a[128:131], v[136:139]
  v_exp_f32 v156, v156
  v_mfma_f32_16x16x32_bf16 v[152:155], a[196:199], a[132:135], v[152:155]
  v_mfma_f32_16x16x32_bf16 v[152:155], a[200:203], a[136:139], v[152:155]
  v_exp_f32 v157, v157
  v_mfma_f32_16x16x32_bf16 v[152:155], a[204:207], a[140:143], v[152:155]
  ds_read_b128 a[220:223], v2 offset:25792
  v_cvt_pk_bf16_f32 v108, v156, v157
  v_mfma_f32_16x16x32_bf16 a[48:51], a[224:227], v[48:51], a[48:51]
  v_exp_f32 v158, v158
  v_mfma_f32_16x16x32_bf16 a[48:51], a[228:231], v[72:75], a[48:51]
  v_mfma_f32_16x16x32_bf16 a[80:83], a[228:231], v[76:79], a[80:83]
  v_exp_f32 v159, v159
  v_mfma_f32_16x16x32_bf16 a[80:83], a[224:227], v[52:55], a[80:83]
  ds_read_b64_tr_b16 a[224:225], v3 offset:192
  v_cvt_pk_bf16_f32 v109, v158, v159
  v_smfmac_f32_16x16x64_bf16 v[20:23], a[240:243], v[56:63], v5
  v_mfma_f32_16x16x32_bf16 v[156:159], a[192:195], a[144:147], v[140:143]
  v_exp_f32 v152, v152
  v_mfma_f32_16x16x32_bf16 v[156:159], a[196:199], a[148:151], v[156:159]
  v_mfma_f32_16x16x32_bf16 v[156:159], a[200:203], a[152:155], v[156:159]
  s_waitcnt lgkmcnt(3)
  v_exp_f32 v153, v153
  v_mfma_f32_16x16x32_bf16 v[156:159], a[204:207], a[156:159], v[156:159]
  ds_read_b64_tr_b16 a[226:227], v3 offset:448
  v_cvt_pk_bf16_f32 v112, v152, v153
  v_mfma_f32_16x16x32_bf16 v[180:183], a[232:235], v[32:35], v[180:183]
  v_exp_f32 v154, v154
  v_mfma_f32_16x16x32_bf16 v[180:183], a[236:239], v[56:59], v[180:183]
  v_mfma_f32_16x16x32_bf16 v[212:215], a[236:239], v[60:63], v[212:215]
  v_exp_f32 v155, v155
  v_mfma_f32_16x16x32_bf16 v[212:215], a[232:235], v[36:39], v[212:215]
  ds_read_b64_tr_b16 a[228:229], v3 offset:8640
  v_cvt_pk_bf16_f32 v113, v154, v155
  v_mfma_f32_16x16x32_bf16 v[152:155], a[192:195], a[160:163], v[144:147]
  v_exp_f32 v156, v156
  v_mfma_f32_16x16x32_bf16 v[152:155], a[196:199], a[164:167], v[152:155]
  v_mfma_f32_16x16x32_bf16 v[152:155], a[200:203], a[168:171], v[152:155]
  v_exp_f32 v157, v157
  v_mfma_f32_16x16x32_bf16 v[152:155], a[204:207], a[172:175], v[152:155]
  ds_read_b64_tr_b16 a[230:231], v3 offset:8896
  v_cvt_pk_bf16_f32 v116, v156, v157
  v_mfma_f32_16x16x32_bf16 v[244:247], a[232:235], v[40:43], v[244:247]
  v_exp_f32 v158, v158
  v_mfma_f32_16x16x32_bf16 v[244:247], a[236:239], v[64:67], v[244:247]
  v_mfma_f32_16x16x32_bf16 a[20:23], a[236:239], v[68:71], a[20:23]
  v_exp_f32 v159, v159
  v_mfma_f32_16x16x32_bf16 a[20:23], a[232:235], v[44:47], a[20:23]
  v_cvt_pk_bf16_f32 v117, v158, v159
  v_mfma_f32_16x16x32_bf16 v[156:159], a[192:195], a[176:179], v[148:151]
  v_exp_f32 v152, v152
  v_mfma_f32_16x16x32_bf16 v[156:159], a[196:199], a[180:183], v[156:159]
  v_mfma_f32_16x16x32_bf16 v[156:159], a[200:203], a[184:187], v[156:159]
  v_exp_f32 v153, v153
  v_mfma_f32_16x16x32_bf16 v[156:159], a[204:207], a[188:191], v[156:159]
  v_cvt_pk_bf16_f32 v120, v152, v153
  v_mfma_f32_16x16x32_bf16 a[52:55], a[232:235], v[48:51], a[52:55]
  v_exp_f32 v154, v154
  v_mfma_f32_16x16x32_bf16 a[52:55], a[236:239], v[72:75], a[52:55]
  v_mfma_f32_16x16x32_bf16 a[84:87], a[236:239], v[76:79], a[84:87]
  v_exp_f32 v155, v155
  v_mfma_f32_16x16x32_bf16 a[84:87], a[232:235], v[52:55], a[84:87]
  ds_read_b64_tr_b16 a[236:237], v3 offset:8648
  v_cvt_pk_bf16_f32 v121, v154, v155
  v_mfma_f32_16x16x32_bf16 v[152:155], a[208:211], a[96:99], v[128:131]
  s_waitcnt lgkmcnt(6)
  v_exp_f32 v156, v156
  v_mfma_f32_16x16x32_bf16 v[152:155], a[212:215], a[100:103], v[152:155]
  ds_read_b64_tr_b16 a[238:239], v3 offset:8904
  ds_read_b64_tr_b16 a[232:233], v3 offset:200
  v_mfma_f32_16x16x32_bf16 v[152:155], a[216:219], a[104:107], v[152:155]
  s_waitcnt lgkmcnt(5)
  v_exp_f32 v157, v157
  v_mfma_f32_16x16x32_bf16 v[152:155], a[220:223], a[108:111], v[152:155]
  ds_read_b64_tr_b16 a[234:235], v3 offset:456
  v_cvt_pk_bf16_f32 v124, v156, v157
  v_mfma_f32_16x16x32_bf16 v[184:187], a[224:227], v[32:35], v[184:187]
  s_waitcnt lgkmcnt(4)
  v_exp_f32 v158, v158
  v_mfma_f32_16x16x32_bf16 v[184:187], a[228:231], v[56:59], v[184:187]
  v_mfma_f32_16x16x32_bf16 v[216:219], a[228:231], v[60:63], v[216:219]
  v_exp_f32 v159, v159
  v_mfma_f32_16x16x32_bf16 v[216:219], a[224:227], v[36:39], v[216:219]
  v_cvt_pk_bf16_f32 v125, v158, v159
  v_smfmac_f32_16x16x64_bf16 v[24:27], a[240:243], v[64:71], v5
  v_mfma_f32_16x16x32_bf16 v[156:159], a[208:211], a[112:115], v[132:135]
  v_exp_f32 v152, v152
  v_mfma_f32_16x16x32_bf16 v[156:159], a[212:215], a[116:119], v[156:159]
  v_mfma_f32_16x16x32_bf16 v[156:159], a[216:219], a[120:123], v[156:159]
  v_exp_f32 v153, v153
  v_mfma_f32_16x16x32_bf16 v[156:159], a[220:223], a[124:127], v[156:159]
  v_cvt_pk_bf16_f32 v106, v152, v153
  v_smfmac_f32_16x16x64_bf16 v[28:31], a[240:243], v[72:79], v5
  v_mfma_f32_16x16x32_bf16 v[248:251], a[224:227], v[40:43], v[248:251]
  v_exp_f32 v154, v154
  v_mfma_f32_16x16x32_bf16 v[248:251], a[228:231], v[64:67], v[248:251]
  s_waitcnt lgkmcnt(0)
  s_barrier
  v_mfma_f32_16x16x32_bf16 a[24:27], a[228:231], v[68:71], a[24:27]
  v_exp_f32 v155, v155
  v_mfma_f32_16x16x32_bf16 a[24:27], a[224:227], v[44:47], a[24:27]
  ds_read_b128 a[192:195], v2 offset:0
  v_cvt_pk_bf16_f32 v107, v154, v155
  v_mfma_f32_16x16x32_bf16 v[152:155], a[208:211], a[128:131], v[136:139]
  v_exp_f32 v156, v156
  v_mfma_f32_16x16x32_bf16 v[152:155], a[212:215], a[132:135], v[152:155]
  v_mfma_f32_16x16x32_bf16 v[152:155], a[216:219], a[136:139], v[152:155]
  v_exp_f32 v157, v157
  v_mfma_f32_16x16x32_bf16 v[152:155], a[220:223], a[140:143], v[152:155]
  ds_read_b128 a[196:199], v2 offset:64
  v_cvt_pk_bf16_f32 v110, v156, v157
  v_mfma_f32_16x16x32_bf16 a[56:59], a[224:227], v[48:51], a[56:59]
  v_exp_f32 v158, v158
  v_mfma_f32_16x16x32_bf16 a[56:59], a[228:231], v[72:75], a[56:59]
  v_mfma_f32_16x16x32_bf16 a[88:91], a[228:231], v[76:79], a[88:91]
  v_exp_f32 v159, v159
  v_mfma_f32_16x16x32_bf16 a[88:91], a[224:227], v[52:55], a[88:91]
  ds_read_b128 a[200:203], v2 offset:128
  v_cvt_pk_bf16_f32 v111, v158, v159
  v_mfma_f32_16x16x32_bf16 v[156:159], a[208:211], a[144:147], v[140:143]
  v_exp_f32 v152, v152
  v_mfma_f32_16x16x32_bf16 v[156:159], a[212:215], a[148:151], v[156:159]
  v_mfma_f32_16x16x32_bf16 v[156:159], a[216:219], a[152:155], v[156:159]
  v_exp_f32 v153, v153
  v_mfma_f32_16x16x32_bf16 v[156:159], a[220:223], a[156:159], v[156:159]
  ds_read_b128 a[204:207], v2 offset:192
  v_cvt_pk_bf16_f32 v114, v152, v153
  v_mfma_f32_16x16x32_bf16 v[188:191], a[232:235], v[32:35], v[188:191]
  v_exp_f32 v154, v154
  v_mfma_f32_16x16x32_bf16 v[188:191], a[236:239], v[56:59], v[188:191]
  v_mfma_f32_16x16x32_bf16 v[220:223], a[236:239], v[60:63], v[220:223]
  v_exp_f32 v155, v155
  v_mfma_f32_16x16x32_bf16 v[220:223], a[232:235], v[36:39], v[220:223]
  ds_read_b64_tr_b16 a[224:225], v3 offset:16896
  v_cvt_pk_bf16_f32 v115, v154, v155
  v_mfma_f32_16x16x32_bf16 v[152:155], a[208:211], a[160:163], v[144:147]
  v_exp_f32 v156, v156
  v_mfma_f32_16x16x32_bf16 v[152:155], a[212:215], a[164:167], v[152:155]
  ds_read_b64_tr_b16 a[226:227], v3 offset:17152
  v_mfma_f32_16x16x32_bf16 v[152:155], a[216:219], a[168:171], v[152:155]
  v_exp_f32 v157, v157
  v_mfma_f32_16x16x32_bf16 v[152:155], a[220:223], a[172:175], v[152:155]
  ds_read_b64_tr_b16 a[228:229], v3 offset:25344
  v_cvt_pk_bf16_f32 v118, v156, v157
  v_mfma_f32_16x16x32_bf16 v[252:255], a[232:235], v[40:43], v[252:255]
  v_exp_f32 v158, v158
  v_mfma_f32_16x16x32_bf16 v[252:255], a[236:239], v[64:67], v[252:255]
  ds_read_b64_tr_b16 a[230:231], v3 offset:25600
  v_mfma_f32_16x16x32_bf16 a[28:31], a[236:239], v[68:71], a[28:31]
  v_exp_f32 v159, v159
  v_mfma_f32_16x16x32_bf16 a[28:31], a[232:235], v[44:47], a[28:31]
  v_cvt_pk_bf16_f32 v119, v158, v159
  v_mfma_f32_16x16x32_bf16 v[156:159], a[208:211], a[176:179], v[148:151]
  v_exp_f32 v152, v152
  v_mfma_f32_16x16x32_bf16 v[156:159], a[212:215], a[180:183], v[156:159]
  v_mfma_f32_16x16x32_bf16 v[156:159], a[216:219], a[184:187], v[156:159]
  v_exp_f32 v153, v153
  v_mfma_f32_16x16x32_bf16 v[156:159], a[220:223], a[188:191], v[156:159]
  v_cvt_pk_bf16_f32 v122, v152, v153
  v_mfma_f32_16x16x32_bf16 a[60:63], a[232:235], v[48:51], a[60:63]
  v_exp_f32 v154, v154
  v_mfma_f32_16x16x32_bf16 a[60:63], a[236:239], v[72:75], a[60:63]
  v_mfma_f32_16x16x32_bf16 a[92:95], a[236:239], v[76:79], a[92:95]
  s_waitcnt lgkmcnt(7)
  v_exp_f32 v155, v155
  v_mfma_f32_16x16x32_bf16 a[92:95], a[232:235], v[52:55], a[92:95]
  ds_read_b64_tr_b16 a[236:237], v3 offset:25352
  v_cvt_pk_bf16_f32 v123, v154, v155
  v_mfma_f32_16x16x32_bf16 v[152:155], a[192:195], a[96:99], v[128:131]
  s_waitcnt lgkmcnt(6)
  v_exp_f32 v156, v156
  v_mfma_f32_16x16x32_bf16 v[152:155], a[196:199], a[100:103], v[152:155]
  v_mfma_f32_16x16x32_bf16 v[152:155], a[200:203], a[104:107], v[152:155]
  s_waitcnt lgkmcnt(3)
  v_exp_f32 v157, v157
  v_mfma_f32_16x16x32_bf16 v[152:155], a[204:207], a[108:111], v[152:155]
  ds_read_b64_tr_b16 a[238:239], v3 offset:25608
  v_cvt_pk_bf16_f32 v126, v156, v157
  v_mfma_f32_16x16x32_bf16 v[160:163], a[224:227], v[80:83], v[160:163]
  s_waitcnt lgkmcnt(2)
  v_exp_f32 v158, v158
  v_mfma_f32_16x16x32_bf16 v[160:163], a[228:231], v[104:107], v[160:163]
  ds_read_b128 a[208:211], v2 offset:256
  v_mfma_f32_16x16x32_bf16 v[192:195], a[228:231], v[108:111], v[192:195]
  v_exp_f32 v159, v159
  v_mfma_f32_16x16x32_bf16 v[192:195], a[224:227], v[84:87], v[192:195]
  ds_read_b64_tr_b16 a[232:233], v3 offset:16904
  v_cvt_pk_bf16_f32 v127, v158, v159
  v_mfma_f32_16x16x32_bf16 v[156:159], a[192:195], a[112:115], v[132:135]
  v_exp_f32 v152, v152
  v_mfma_f32_16x16x32_bf16 v[156:159], a[196:199], a[116:119], v[156:159]
  ds_read_b128 a[212:215], v2 offset:320
  v_mfma_f32_16x16x32_bf16 v[156:159], a[200:203], a[120:123], v[156:159]
  v_exp_f32 v153, v153
  v_mfma_f32_16x16x32_bf16 v[156:159], a[204:207], a[124:127], v[156:159]
  ds_read_b64_tr_b16 a[234:235], v3 offset:17160
  v_cvt_pk_bf16_f32 v32, v152, v153
  v_mfma_f32_16x16x32_bf16 v[224:227], a[224:227], v[88:91], v[224:227]
  v_exp_f32 v154, v154
  v_mfma_f32_16x16x32_bf16 v[224:227], a[228:231], v[112:115], v[224:227]
  v_mfma_f32_16x16x32_bf16 a[0:3], a[228:231], v[116:119], a[0:3]
  v_exp_f32 v155, v155
  v_mfma_f32_16x16x32_bf16 a[0:3], a[224:227], v[92:95], a[0:3]
  ds_read_b128 a[216:219], v2 offset:384
  v_cvt_pk_bf16_f32 v33, v154, v155
  v_mfma_f32_16x16x32_bf16 v[152:155], a[192:195], a[128:131], v[136:139]
  v_exp_f32 v156, v156
  v_mfma_f32_16x16x32_bf16 v[152:155], a[196:199], a[132:135], v[152:155]
  v_mfma_f32_16x16x32_bf16 v[152:155], a[200:203], a[136:139], v[152:155]
  v_exp_f32 v157, v157
  v_mfma_f32_16x16x32_bf16 v[152:155], a[204:207], a[140:143], v[152:155]
  ds_read_b128 a[220:223], v2 offset:448
  v_cvt_pk_bf16_f32 v36, v156, v157
  v_mfma_f32_16x16x32_bf16 a[32:35], a[224:227], v[96:99], a[32:35]
  v_exp_f32 v158, v158
  v_mfma_f32_16x16x32_bf16 a[32:35], a[228:231], v[120:123], a[32:35]
  v_mfma_f32_16x16x32_bf16 a[64:67], a[228:231], v[124:127], a[64:67]
  v_exp_f32 v159, v159
  v_mfma_f32_16x16x32_bf16 a[64:67], a[224:227], v[100:103], a[64:67]
  ds_read_b64_tr_b16 a[224:225], v3 offset:16960
  v_cvt_pk_bf16_f32 v37, v158, v159
  v_smfmac_f32_16x16x64_bf16 v[20:23], a[240:243], v[80:87], v5
  v_mfma_f32_16x16x32_bf16 v[156:159], a[192:195], a[144:147], v[140:143]
  v_exp_f32 v152, v152
  v_mfma_f32_16x16x32_bf16 v[156:159], a[196:199], a[148:151], v[156:159]
  v_mfma_f32_16x16x32_bf16 v[156:159], a[200:203], a[152:155], v[156:159]
  s_waitcnt lgkmcnt(3)
  v_exp_f32 v153, v153
  v_mfma_f32_16x16x32_bf16 v[156:159], a[204:207], a[156:159], v[156:159]
  ds_read_b64_tr_b16 a[226:227], v3 offset:17216
  v_cvt_pk_bf16_f32 v40, v152, v153
  v_mfma_f32_16x16x32_bf16 v[164:167], a[232:235], v[80:83], v[164:167]
  v_exp_f32 v154, v154
  v_mfma_f32_16x16x32_bf16 v[164:167], a[236:239], v[104:107], v[164:167]
  v_mfma_f32_16x16x32_bf16 v[196:199], a[236:239], v[108:111], v[196:199]
  v_exp_f32 v155, v155
  v_mfma_f32_16x16x32_bf16 v[196:199], a[232:235], v[84:87], v[196:199]
  ds_read_b64_tr_b16 a[228:229], v3 offset:25408
  v_cvt_pk_bf16_f32 v41, v154, v155
  v_mfma_f32_16x16x32_bf16 v[152:155], a[192:195], a[160:163], v[144:147]
  v_exp_f32 v156, v156
  v_mfma_f32_16x16x32_bf16 v[152:155], a[196:199], a[164:167], v[152:155]
  v_mfma_f32_16x16x32_bf16 v[152:155], a[200:203], a[168:171], v[152:155]
  v_exp_f32 v157, v157
  v_mfma_f32_16x16x32_bf16 v[152:155], a[204:207], a[172:175], v[152:155]
  ds_read_b64_tr_b16 a[230:231], v3 offset:25664
  v_cvt_pk_bf16_f32 v44, v156, v157
  v_mfma_f32_16x16x32_bf16 v[228:231], a[232:235], v[88:91], v[228:231]
  v_exp_f32 v158, v158
  v_mfma_f32_16x16x32_bf16 v[228:231], a[236:239], v[112:115], v[228:231]
  v_mfma_f32_16x16x32_bf16 a[4:7], a[236:239], v[116:119], a[4:7]
  v_exp_f32 v159, v159
  v_mfma_f32_16x16x32_bf16 a[4:7], a[232:235], v[92:95], a[4:7]
  v_cvt_pk_bf16_f32 v45, v158, v159
  v_mfma_f32_16x16x32_bf16 v[156:159], a[192:195], a[176:179], v[148:151]
  v_exp_f32 v152, v152
  v_mfma_f32_16x16x32_bf16 v[156:159], a[196:199], a[180:183], v[156:159]
  v_mfma_f32_16x16x32_bf16 v[156:159], a[200:203], a[184:187], v[156:159]
  v_exp_f32 v153, v153
  v_mfma_f32_16x16x32_bf16 v[156:159], a[204:207], a[188:191], v[156:159]
  v_cvt_pk_bf16_f32 v48, v152, v153
  v_mfma_f32_16x16x32_bf16 a[36:39], a[232:235], v[96:99], a[36:39]
  v_exp_f32 v154, v154
  v_mfma_f32_16x16x32_bf16 a[36:39], a[236:239], v[120:123], a[36:39]
  v_mfma_f32_16x16x32_bf16 a[68:71], a[236:239], v[124:127], a[68:71]
  v_exp_f32 v155, v155
  v_mfma_f32_16x16x32_bf16 a[68:71], a[232:235], v[100:103], a[68:71]
  ds_read_b64_tr_b16 a[236:237], v3 offset:25416
  v_cvt_pk_bf16_f32 v49, v154, v155
  v_mfma_f32_16x16x32_bf16 v[152:155], a[208:211], a[96:99], v[128:131]
  s_waitcnt lgkmcnt(6)
  v_exp_f32 v156, v156
  v_mfma_f32_16x16x32_bf16 v[152:155], a[212:215], a[100:103], v[152:155]
  ds_read_b64_tr_b16 a[238:239], v3 offset:25672
  ds_read_b64_tr_b16 a[232:233], v3 offset:16968
  v_mfma_f32_16x16x32_bf16 v[152:155], a[216:219], a[104:107], v[152:155]
  s_waitcnt lgkmcnt(5)
  v_exp_f32 v157, v157
  v_mfma_f32_16x16x32_bf16 v[152:155], a[220:223], a[108:111], v[152:155]
  ds_read_b64_tr_b16 a[234:235], v3 offset:17224
  v_cvt_pk_bf16_f32 v52, v156, v157
  v_mfma_f32_16x16x32_bf16 v[168:171], a[224:227], v[80:83], v[168:171]
  s_waitcnt lgkmcnt(4)
  v_exp_f32 v158, v158
  v_mfma_f32_16x16x32_bf16 v[168:171], a[228:231], v[104:107], v[168:171]
  v_mfma_f32_16x16x32_bf16 v[200:203], a[228:231], v[108:111], v[200:203]
  v_exp_f32 v159, v159
  v_mfma_f32_16x16x32_bf16 v[200:203], a[224:227], v[84:87], v[200:203]
  v_cvt_pk_bf16_f32 v53, v158, v159
  v_smfmac_f32_16x16x64_bf16 v[24:27], a[240:243], v[88:95], v5
  v_mfma_f32_16x16x32_bf16 v[156:159], a[208:211], a[112:115], v[132:135]
  v_exp_f32 v152, v152
  v_mfma_f32_16x16x32_bf16 v[156:159], a[212:215], a[116:119], v[156:159]
  v_mfma_f32_16x16x32_bf16 v[156:159], a[216:219], a[120:123], v[156:159]
  v_exp_f32 v153, v153
  v_mfma_f32_16x16x32_bf16 v[156:159], a[220:223], a[124:127], v[156:159]
  v_cvt_pk_bf16_f32 v34, v152, v153
  v_smfmac_f32_16x16x64_bf16 v[28:31], a[240:243], v[96:103], v5
  v_mfma_f32_16x16x32_bf16 v[232:235], a[224:227], v[88:91], v[232:235]
  v_exp_f32 v154, v154
  v_mfma_f32_16x16x32_bf16 v[232:235], a[228:231], v[112:115], v[232:235]
  s_waitcnt lgkmcnt(0)
  s_barrier
  v_mfma_f32_16x16x32_bf16 a[8:11], a[228:231], v[116:119], a[8:11]
  v_exp_f32 v155, v155
  v_mfma_f32_16x16x32_bf16 a[8:11], a[224:227], v[92:95], a[8:11]
  ds_read_b128 a[192:195], v2 offset:8448
  v_cvt_pk_bf16_f32 v35, v154, v155
  v_mfma_f32_16x16x32_bf16 v[152:155], a[208:211], a[128:131], v[136:139]
  v_exp_f32 v156, v156
  v_mfma_f32_16x16x32_bf16 v[152:155], a[212:215], a[132:135], v[152:155]
  v_mfma_f32_16x16x32_bf16 v[152:155], a[216:219], a[136:139], v[152:155]
  v_exp_f32 v157, v157
  v_mfma_f32_16x16x32_bf16 v[152:155], a[220:223], a[140:143], v[152:155]
  ds_read_b128 a[196:199], v2 offset:8512
  v_cvt_pk_bf16_f32 v38, v156, v157
  v_mfma_f32_16x16x32_bf16 a[40:43], a[224:227], v[96:99], a[40:43]
  v_exp_f32 v158, v158
  v_mfma_f32_16x16x32_bf16 a[40:43], a[228:231], v[120:123], a[40:43]
  v_mfma_f32_16x16x32_bf16 a[72:75], a[228:231], v[124:127], a[72:75]
  v_exp_f32 v159, v159
  v_mfma_f32_16x16x32_bf16 a[72:75], a[224:227], v[100:103], a[72:75]
  ds_read_b128 a[200:203], v2 offset:8576
  v_cvt_pk_bf16_f32 v39, v158, v159
  v_mfma_f32_16x16x32_bf16 v[156:159], a[208:211], a[144:147], v[140:143]
  v_exp_f32 v152, v152
  v_mfma_f32_16x16x32_bf16 v[156:159], a[212:215], a[148:151], v[156:159]
  v_mfma_f32_16x16x32_bf16 v[156:159], a[216:219], a[152:155], v[156:159]
  v_exp_f32 v153, v153
  v_mfma_f32_16x16x32_bf16 v[156:159], a[220:223], a[156:159], v[156:159]
  ds_read_b128 a[204:207], v2 offset:8640
  v_cvt_pk_bf16_f32 v42, v152, v153
  v_mfma_f32_16x16x32_bf16 v[172:175], a[232:235], v[80:83], v[172:175]
  v_exp_f32 v154, v154
  v_mfma_f32_16x16x32_bf16 v[172:175], a[236:239], v[104:107], v[172:175]
  v_mfma_f32_16x16x32_bf16 v[204:207], a[236:239], v[108:111], v[204:207]
  v_exp_f32 v155, v155
  v_mfma_f32_16x16x32_bf16 v[204:207], a[232:235], v[84:87], v[204:207]
  ds_read_b64_tr_b16 a[224:225], v3 offset:17024
  v_cvt_pk_bf16_f32 v43, v154, v155
  v_mfma_f32_16x16x32_bf16 v[152:155], a[208:211], a[160:163], v[144:147]
  v_exp_f32 v156, v156
  v_mfma_f32_16x16x32_bf16 v[152:155], a[212:215], a[164:167], v[152:155]
  ds_read_b64_tr_b16 a[226:227], v3 offset:17280
  v_mfma_f32_16x16x32_bf16 v[152:155], a[216:219], a[168:171], v[152:155]
  v_exp_f32 v157, v157
  v_mfma_f32_16x16x32_bf16 v[152:155], a[220:223], a[172:175], v[152:155]
  ds_read_b64_tr_b16 a[228:229], v3 offset:25472
  v_cvt_pk_bf16_f32 v46, v156, v157
  v_mfma_f32_16x16x32_bf16 v[236:239], a[232:235], v[88:91], v[236:239]
  v_exp_f32 v158, v158
  v_mfma_f32_16x16x32_bf16 v[236:239], a[236:239], v[112:115], v[236:239]
  ds_read_b64_tr_b16 a[230:231], v3 offset:25728
  v_mfma_f32_16x16x32_bf16 a[12:15], a[236:239], v[116:119], a[12:15]
  v_exp_f32 v159, v159
  v_mfma_f32_16x16x32_bf16 a[12:15], a[232:235], v[92:95], a[12:15]
  v_cvt_pk_bf16_f32 v47, v158, v159
  v_mfma_f32_16x16x32_bf16 v[156:159], a[208:211], a[176:179], v[148:151]
  v_exp_f32 v152, v152
  v_mfma_f32_16x16x32_bf16 v[156:159], a[212:215], a[180:183], v[156:159]
  v_mfma_f32_16x16x32_bf16 v[156:159], a[216:219], a[184:187], v[156:159]
  v_exp_f32 v153, v153
  v_mfma_f32_16x16x32_bf16 v[156:159], a[220:223], a[188:191], v[156:159]
  v_cvt_pk_bf16_f32 v50, v152, v153
  v_mfma_f32_16x16x32_bf16 a[44:47], a[232:235], v[96:99], a[44:47]
  v_exp_f32 v154, v154
  v_mfma_f32_16x16x32_bf16 a[44:47], a[236:239], v[120:123], a[44:47]
  v_mfma_f32_16x16x32_bf16 a[76:79], a[236:239], v[124:127], a[76:79]
  s_waitcnt lgkmcnt(7)
  v_exp_f32 v155, v155
  v_mfma_f32_16x16x32_bf16 a[76:79], a[232:235], v[100:103], a[76:79]
  ds_read_b64_tr_b16 a[236:237], v3 offset:25480
  v_cvt_pk_bf16_f32 v51, v154, v155
  v_mfma_f32_16x16x32_bf16 v[152:155], a[192:195], a[96:99], v[128:131]
  s_waitcnt lgkmcnt(6)
  v_exp_f32 v156, v156
  v_mfma_f32_16x16x32_bf16 v[152:155], a[196:199], a[100:103], v[152:155]
  v_mfma_f32_16x16x32_bf16 v[152:155], a[200:203], a[104:107], v[152:155]
  s_waitcnt lgkmcnt(3)
  v_exp_f32 v157, v157
  v_mfma_f32_16x16x32_bf16 v[152:155], a[204:207], a[108:111], v[152:155]
  ds_read_b64_tr_b16 a[238:239], v3 offset:25736
  v_cvt_pk_bf16_f32 v54, v156, v157
  v_mfma_f32_16x16x32_bf16 v[176:179], a[224:227], v[80:83], v[176:179]
  s_waitcnt lgkmcnt(2)
  v_exp_f32 v158, v158
  v_mfma_f32_16x16x32_bf16 v[176:179], a[228:231], v[104:107], v[176:179]
  ds_read_b128 a[208:211], v2 offset:8704
  v_mfma_f32_16x16x32_bf16 v[208:211], a[228:231], v[108:111], v[208:211]
  v_exp_f32 v159, v159
  v_mfma_f32_16x16x32_bf16 v[208:211], a[224:227], v[84:87], v[208:211]
  ds_read_b64_tr_b16 a[232:233], v3 offset:17032
  v_cvt_pk_bf16_f32 v55, v158, v159
  v_mfma_f32_16x16x32_bf16 v[156:159], a[192:195], a[112:115], v[132:135]
  v_exp_f32 v152, v152
  v_mfma_f32_16x16x32_bf16 v[156:159], a[196:199], a[116:119], v[156:159]
  ds_read_b128 a[212:215], v2 offset:8768
  v_mfma_f32_16x16x32_bf16 v[156:159], a[200:203], a[120:123], v[156:159]
  v_exp_f32 v153, v153
  v_mfma_f32_16x16x32_bf16 v[156:159], a[204:207], a[124:127], v[156:159]
  ds_read_b64_tr_b16 a[234:235], v3 offset:17288
  v_cvt_pk_bf16_f32 v56, v152, v153
  v_mfma_f32_16x16x32_bf16 v[240:243], a[224:227], v[88:91], v[240:243]
  v_exp_f32 v154, v154
  v_mfma_f32_16x16x32_bf16 v[240:243], a[228:231], v[112:115], v[240:243]
  v_mfma_f32_16x16x32_bf16 a[16:19], a[228:231], v[116:119], a[16:19]
  v_exp_f32 v155, v155
  v_mfma_f32_16x16x32_bf16 a[16:19], a[224:227], v[92:95], a[16:19]
  ds_read_b128 a[216:219], v2 offset:8832
  v_cvt_pk_bf16_f32 v57, v154, v155
  v_mfma_f32_16x16x32_bf16 v[152:155], a[192:195], a[128:131], v[136:139]
  v_exp_f32 v156, v156
  v_mfma_f32_16x16x32_bf16 v[152:155], a[196:199], a[132:135], v[152:155]
  v_mfma_f32_16x16x32_bf16 v[152:155], a[200:203], a[136:139], v[152:155]
  v_exp_f32 v157, v157
  v_mfma_f32_16x16x32_bf16 v[152:155], a[204:207], a[140:143], v[152:155]
  ds_read_b128 a[220:223], v2 offset:8896
  v_cvt_pk_bf16_f32 v60, v156, v157
  v_mfma_f32_16x16x32_bf16 a[48:51], a[224:227], v[96:99], a[48:51]
  v_exp_f32 v158, v158
  v_mfma_f32_16x16x32_bf16 a[48:51], a[228:231], v[120:123], a[48:51]
  v_mfma_f32_16x16x32_bf16 a[80:83], a[228:231], v[124:127], a[80:83]
  v_exp_f32 v159, v159
  v_mfma_f32_16x16x32_bf16 a[80:83], a[224:227], v[100:103], a[80:83]
  ds_read_b64_tr_b16 a[224:225], v3 offset:17088
  v_cvt_pk_bf16_f32 v61, v158, v159
  v_smfmac_f32_16x16x64_bf16 v[20:23], a[240:243], v[104:111], v5
  v_mfma_f32_16x16x32_bf16 v[156:159], a[192:195], a[144:147], v[140:143]
  v_exp_f32 v152, v152
  v_mfma_f32_16x16x32_bf16 v[156:159], a[196:199], a[148:151], v[156:159]
  v_mfma_f32_16x16x32_bf16 v[156:159], a[200:203], a[152:155], v[156:159]
  s_waitcnt lgkmcnt(3)
  v_exp_f32 v153, v153
  v_mfma_f32_16x16x32_bf16 v[156:159], a[204:207], a[156:159], v[156:159]
  ds_read_b64_tr_b16 a[226:227], v3 offset:17344
  v_cvt_pk_bf16_f32 v64, v152, v153
  v_mfma_f32_16x16x32_bf16 v[180:183], a[232:235], v[80:83], v[180:183]
  v_exp_f32 v154, v154
  v_mfma_f32_16x16x32_bf16 v[180:183], a[236:239], v[104:107], v[180:183]
  v_mfma_f32_16x16x32_bf16 v[212:215], a[236:239], v[108:111], v[212:215]
  v_exp_f32 v155, v155
  v_mfma_f32_16x16x32_bf16 v[212:215], a[232:235], v[84:87], v[212:215]
  ds_read_b64_tr_b16 a[228:229], v3 offset:25536
  v_cvt_pk_bf16_f32 v65, v154, v155
  v_mfma_f32_16x16x32_bf16 v[152:155], a[192:195], a[160:163], v[144:147]
  v_exp_f32 v156, v156
  v_mfma_f32_16x16x32_bf16 v[152:155], a[196:199], a[164:167], v[152:155]
  v_mfma_f32_16x16x32_bf16 v[152:155], a[200:203], a[168:171], v[152:155]
  v_exp_f32 v157, v157
  v_mfma_f32_16x16x32_bf16 v[152:155], a[204:207], a[172:175], v[152:155]
  ds_read_b64_tr_b16 a[230:231], v3 offset:25792
  v_cvt_pk_bf16_f32 v68, v156, v157
  v_mfma_f32_16x16x32_bf16 v[244:247], a[232:235], v[88:91], v[244:247]
  v_exp_f32 v158, v158
  v_mfma_f32_16x16x32_bf16 v[244:247], a[236:239], v[112:115], v[244:247]
  v_mfma_f32_16x16x32_bf16 a[20:23], a[236:239], v[116:119], a[20:23]
  v_exp_f32 v159, v159
  v_mfma_f32_16x16x32_bf16 a[20:23], a[232:235], v[92:95], a[20:23]
  v_cvt_pk_bf16_f32 v69, v158, v159
  v_mfma_f32_16x16x32_bf16 v[156:159], a[192:195], a[176:179], v[148:151]
  v_exp_f32 v152, v152
  v_mfma_f32_16x16x32_bf16 v[156:159], a[196:199], a[180:183], v[156:159]
  v_mfma_f32_16x16x32_bf16 v[156:159], a[200:203], a[184:187], v[156:159]
  v_exp_f32 v153, v153
  v_mfma_f32_16x16x32_bf16 v[156:159], a[204:207], a[188:191], v[156:159]
  v_cvt_pk_bf16_f32 v72, v152, v153
  v_mfma_f32_16x16x32_bf16 a[52:55], a[232:235], v[96:99], a[52:55]
  v_exp_f32 v154, v154
  v_mfma_f32_16x16x32_bf16 a[52:55], a[236:239], v[120:123], a[52:55]
  v_mfma_f32_16x16x32_bf16 a[84:87], a[236:239], v[124:127], a[84:87]
  v_exp_f32 v155, v155
  v_mfma_f32_16x16x32_bf16 a[84:87], a[232:235], v[100:103], a[84:87]
  ds_read_b64_tr_b16 a[236:237], v3 offset:25544
  v_cvt_pk_bf16_f32 v73, v154, v155
  v_mfma_f32_16x16x32_bf16 v[152:155], a[208:211], a[96:99], v[128:131]
  s_waitcnt lgkmcnt(6)
  v_exp_f32 v156, v156
  v_mfma_f32_16x16x32_bf16 v[152:155], a[212:215], a[100:103], v[152:155]
  ds_read_b64_tr_b16 a[238:239], v3 offset:25800
  ds_read_b64_tr_b16 a[232:233], v3 offset:17096
  v_mfma_f32_16x16x32_bf16 v[152:155], a[216:219], a[104:107], v[152:155]
  s_waitcnt lgkmcnt(5)
  v_exp_f32 v157, v157
  v_mfma_f32_16x16x32_bf16 v[152:155], a[220:223], a[108:111], v[152:155]
  ds_read_b64_tr_b16 a[234:235], v3 offset:17352
  v_cvt_pk_bf16_f32 v76, v156, v157
  v_mfma_f32_16x16x32_bf16 v[184:187], a[224:227], v[80:83], v[184:187]
  s_waitcnt lgkmcnt(4)
  v_exp_f32 v158, v158
  v_mfma_f32_16x16x32_bf16 v[184:187], a[228:231], v[104:107], v[184:187]
  v_mfma_f32_16x16x32_bf16 v[216:219], a[228:231], v[108:111], v[216:219]
  v_exp_f32 v159, v159
  v_mfma_f32_16x16x32_bf16 v[216:219], a[224:227], v[84:87], v[216:219]
  v_cvt_pk_bf16_f32 v77, v158, v159
  v_smfmac_f32_16x16x64_bf16 v[24:27], a[240:243], v[112:119], v5
  v_mfma_f32_16x16x32_bf16 v[156:159], a[208:211], a[112:115], v[132:135]
  v_exp_f32 v152, v152
  v_mfma_f32_16x16x32_bf16 v[156:159], a[212:215], a[116:119], v[156:159]
  v_mfma_f32_16x16x32_bf16 v[156:159], a[216:219], a[120:123], v[156:159]
  v_exp_f32 v153, v153
  v_mfma_f32_16x16x32_bf16 v[156:159], a[220:223], a[124:127], v[156:159]
  v_cvt_pk_bf16_f32 v58, v152, v153
  v_smfmac_f32_16x16x64_bf16 v[28:31], a[240:243], v[120:127], v5
  v_mfma_f32_16x16x32_bf16 v[248:251], a[224:227], v[88:91], v[248:251]
  v_exp_f32 v154, v154
  v_mfma_f32_16x16x32_bf16 v[248:251], a[228:231], v[112:115], v[248:251]
  s_waitcnt lgkmcnt(0)
  s_barrier
  v_mfma_f32_16x16x32_bf16 a[24:27], a[228:231], v[116:119], a[24:27]
  v_exp_f32 v155, v155
  v_mfma_f32_16x16x32_bf16 a[24:27], a[224:227], v[92:95], a[24:27]
  ds_read_b128 a[192:195], v2 offset:16896
  v_cvt_pk_bf16_f32 v59, v154, v155
  v_mfma_f32_16x16x32_bf16 v[152:155], a[208:211], a[128:131], v[136:139]
  v_exp_f32 v156, v156
  v_mfma_f32_16x16x32_bf16 v[152:155], a[212:215], a[132:135], v[152:155]
  v_mfma_f32_16x16x32_bf16 v[152:155], a[216:219], a[136:139], v[152:155]
  v_exp_f32 v157, v157
  v_mfma_f32_16x16x32_bf16 v[152:155], a[220:223], a[140:143], v[152:155]
  ds_read_b128 a[196:199], v2 offset:16960
  v_cvt_pk_bf16_f32 v62, v156, v157
  v_mfma_f32_16x16x32_bf16 a[56:59], a[224:227], v[96:99], a[56:59]
  v_exp_f32 v158, v158
  v_mfma_f32_16x16x32_bf16 a[56:59], a[228:231], v[120:123], a[56:59]
  v_mfma_f32_16x16x32_bf16 a[88:91], a[228:231], v[124:127], a[88:91]
  v_exp_f32 v159, v159
  v_mfma_f32_16x16x32_bf16 a[88:91], a[224:227], v[100:103], a[88:91]
  ds_read_b128 a[200:203], v2 offset:17024
  v_cvt_pk_bf16_f32 v63, v158, v159
  v_mfma_f32_16x16x32_bf16 v[156:159], a[208:211], a[144:147], v[140:143]
  v_exp_f32 v152, v152
  v_mfma_f32_16x16x32_bf16 v[156:159], a[212:215], a[148:151], v[156:159]
  v_mfma_f32_16x16x32_bf16 v[156:159], a[216:219], a[152:155], v[156:159]
  v_exp_f32 v153, v153
  v_mfma_f32_16x16x32_bf16 v[156:159], a[220:223], a[156:159], v[156:159]
  ds_read_b128 a[204:207], v2 offset:17088
  v_cvt_pk_bf16_f32 v66, v152, v153
  v_mfma_f32_16x16x32_bf16 v[188:191], a[232:235], v[80:83], v[188:191]
  v_exp_f32 v154, v154
  v_mfma_f32_16x16x32_bf16 v[188:191], a[236:239], v[104:107], v[188:191]
  v_mfma_f32_16x16x32_bf16 v[220:223], a[236:239], v[108:111], v[220:223]
  v_exp_f32 v155, v155
  v_mfma_f32_16x16x32_bf16 v[220:223], a[232:235], v[84:87], v[220:223]
  ds_read_b64_tr_b16 a[224:225], v3 offset:0
  v_cvt_pk_bf16_f32 v67, v154, v155
  v_mfma_f32_16x16x32_bf16 v[152:155], a[208:211], a[160:163], v[144:147]
  v_exp_f32 v156, v156
  v_mfma_f32_16x16x32_bf16 v[152:155], a[212:215], a[164:167], v[152:155]
  ds_read_b64_tr_b16 a[226:227], v3 offset:256
  v_mfma_f32_16x16x32_bf16 v[152:155], a[216:219], a[168:171], v[152:155]
  v_exp_f32 v157, v157
  v_mfma_f32_16x16x32_bf16 v[152:155], a[220:223], a[172:175], v[152:155]
  ds_read_b64_tr_b16 a[228:229], v3 offset:8448
  v_cvt_pk_bf16_f32 v70, v156, v157
  v_mfma_f32_16x16x32_bf16 v[252:255], a[232:235], v[88:91], v[252:255]
  v_exp_f32 v158, v158
  v_mfma_f32_16x16x32_bf16 v[252:255], a[236:239], v[112:115], v[252:255]
  ds_read_b64_tr_b16 a[230:231], v3 offset:8704
  v_mfma_f32_16x16x32_bf16 a[28:31], a[236:239], v[116:119], a[28:31]
  v_exp_f32 v159, v159
  v_mfma_f32_16x16x32_bf16 a[28:31], a[232:235], v[92:95], a[28:31]
  v_cvt_pk_bf16_f32 v71, v158, v159
  v_mfma_f32_16x16x32_bf16 v[156:159], a[208:211], a[176:179], v[148:151]
  v_exp_f32 v152, v152
  v_mfma_f32_16x16x32_bf16 v[156:159], a[212:215], a[180:183], v[156:159]
  v_mfma_f32_16x16x32_bf16 v[156:159], a[216:219], a[184:187], v[156:159]
  v_exp_f32 v153, v153
  v_mfma_f32_16x16x32_bf16 v[156:159], a[220:223], a[188:191], v[156:159]
  v_cvt_pk_bf16_f32 v74, v152, v153
  v_mfma_f32_16x16x32_bf16 a[60:63], a[232:235], v[96:99], a[60:63]
  v_exp_f32 v154, v154
  v_mfma_f32_16x16x32_bf16 a[60:63], a[236:239], v[120:123], a[60:63]
  v_mfma_f32_16x16x32_bf16 a[92:95], a[236:239], v[124:127], a[92:95]
  s_waitcnt lgkmcnt(7)
  v_exp_f32 v155, v155
  v_mfma_f32_16x16x32_bf16 a[92:95], a[232:235], v[100:103], a[92:95]
  ds_read_b64_tr_b16 a[236:237], v3 offset:8456
  v_cvt_pk_bf16_f32 v75, v154, v155
ENTRY1_6:
  v_mfma_f32_16x16x32_bf16 v[152:155], a[192:195], a[96:99], v[128:131]
  s_waitcnt lgkmcnt(6)
  v_exp_f32 v156, v156
  v_mfma_f32_16x16x32_bf16 v[152:155], a[196:199], a[100:103], v[152:155]
  v_mfma_f32_16x16x32_bf16 v[152:155], a[200:203], a[104:107], v[152:155]
  s_waitcnt lgkmcnt(3)
  v_exp_f32 v157, v157
  v_mfma_f32_16x16x32_bf16 v[152:155], a[204:207], a[108:111], v[152:155]
  ds_read_b64_tr_b16 a[238:239], v3 offset:8712
  v_cvt_pk_bf16_f32 v78, v156, v157
  v_mfma_f32_16x16x32_bf16 v[160:163], a[224:227], v[32:35], v[160:163]
  s_waitcnt lgkmcnt(2)
  v_exp_f32 v158, v158
  v_mfma_f32_16x16x32_bf16 v[160:163], a[228:231], v[56:59], v[160:163]
  ds_read_b128 a[208:211], v2 offset:17152
  v_mfma_f32_16x16x32_bf16 v[192:195], a[228:231], v[60:63], v[192:195]
  v_exp_f32 v159, v159
  v_mfma_f32_16x16x32_bf16 v[192:195], a[224:227], v[36:39], v[192:195]
  ds_read_b64_tr_b16 a[232:233], v3 offset:8
  v_cvt_pk_bf16_f32 v79, v158, v159
  v_mfma_f32_16x16x32_bf16 v[156:159], a[192:195], a[112:115], v[132:135]
  v_exp_f32 v152, v152
  v_mfma_f32_16x16x32_bf16 v[156:159], a[196:199], a[116:119], v[156:159]
  ds_read_b128 a[212:215], v2 offset:17216
  v_mfma_f32_16x16x32_bf16 v[156:159], a[200:203], a[120:123], v[156:159]
  v_exp_f32 v153, v153
  v_mfma_f32_16x16x32_bf16 v[156:159], a[204:207], a[124:127], v[156:159]
  ds_read_b64_tr_b16 a[234:235], v3 offset:264
  v_cvt_pk_bf16_f32 v80, v152, v153
  v_mfma_f32_16x16x32_bf16 v[224:227], a[224:227], v[40:43], v[224:227]
  v_exp_f32 v154, v154
  v_mfma_f32_16x16x32_bf16 v[224:227], a[228:231], v[64:67], v[224:227]
  v_mfma_f32_16x16x32_bf16 a[0:3], a[228:231], v[68:71], a[0:3]
  v_exp_f32 v155, v155
  v_mfma_f32_16x16x32_bf16 a[0:3], a[224:227], v[44:47], a[0:3]
  ds_read_b128 a[216:219], v2 offset:17280
  v_cvt_pk_bf16_f32 v81, v154, v155
  v_mfma_f32_16x16x32_bf16 v[152:155], a[192:195], a[128:131], v[136:139]
  v_exp_f32 v156, v156
  v_mfma_f32_16x16x32_bf16 v[152:155], a[196:199], a[132:135], v[152:155]
  v_mfma_f32_16x16x32_bf16 v[152:155], a[200:203], a[136:139], v[152:155]
  v_exp_f32 v157, v157
  v_mfma_f32_16x16x32_bf16 v[152:155], a[204:207], a[140:143], v[152:155]
  ds_read_b128 a[220:223], v2 offset:17344
  v_cvt_pk_bf16_f32 v84, v156, v157
  v_mfma_f32_16x16x32_bf16 a[32:35], a[224:227], v[48:51], a[32:35]
  v_exp_f32 v158, v158
  v_mfma_f32_16x16x32_bf16 a[32:35], a[228:231], v[72:75], a[32:35]
  v_mfma_f32_16x16x32_bf16 a[64:67], a[228:231], v[76:79], a[64:67]
  v_exp_f32 v159, v159
  v_mfma_f32_16x16x32_bf16 a[64:67], a[224:227], v[52:55], a[64:67]
  ds_read_b64_tr_b16 a[224:225], v3 offset:64
  v_cvt_pk_bf16_f32 v85, v158, v159
  v_smfmac_f32_16x16x64_bf16 v[20:23], a[240:243], v[32:39], v5
  v_mfma_f32_16x16x32_bf16 v[156:159], a[192:195], a[144:147], v[140:143]
  v_exp_f32 v152, v152
  v_mfma_f32_16x16x32_bf16 v[156:159], a[196:199], a[148:151], v[156:159]
  v_mfma_f32_16x16x32_bf16 v[156:159], a[200:203], a[152:155], v[156:159]
  s_waitcnt lgkmcnt(3)
  v_exp_f32 v153, v153
  v_mfma_f32_16x16x32_bf16 v[156:159], a[204:207], a[156:159], v[156:159]
  ds_read_b64_tr_b16 a[226:227], v3 offset:320
  v_cvt_pk_bf16_f32 v88, v152, v153
  v_mfma_f32_16x16x32_bf16 v[164:167], a[232:235], v[32:35], v[164:167]
  v_exp_f32 v154, v154
  v_mfma_f32_16x16x32_bf16 v[164:167], a[236:239], v[56:59], v[164:167]
  v_mfma_f32_16x16x32_bf16 v[196:199], a[236:239], v[60:63], v[196:199]
  v_exp_f32 v155, v155
  v_mfma_f32_16x16x32_bf16 v[196:199], a[232:235], v[36:39], v[196:199]
  ds_read_b64_tr_b16 a[228:229], v3 offset:8512
  v_cvt_pk_bf16_f32 v89, v154, v155
  v_mfma_f32_16x16x32_bf16 v[152:155], a[192:195], a[160:163], v[144:147]
  v_exp_f32 v156, v156
  v_mfma_f32_16x16x32_bf16 v[152:155], a[196:199], a[164:167], v[152:155]
  v_mfma_f32_16x16x32_bf16 v[152:155], a[200:203], a[168:171], v[152:155]
  v_exp_f32 v157, v157
  v_mfma_f32_16x16x32_bf16 v[152:155], a[204:207], a[172:175], v[152:155]
  ds_read_b64_tr_b16 a[230:231], v3 offset:8768
  v_cvt_pk_bf16_f32 v92, v156, v157
  v_mfma_f32_16x16x32_bf16 v[228:231], a[232:235], v[40:43], v[228:231]
  v_exp_f32 v158, v158
  v_mfma_f32_16x16x32_bf16 v[228:231], a[236:239], v[64:67], v[228:231]
  v_mfma_f32_16x16x32_bf16 a[4:7], a[236:239], v[68:71], a[4:7]
  v_exp_f32 v159, v159
  v_mfma_f32_16x16x32_bf16 a[4:7], a[232:235], v[44:47], a[4:7]
  v_cvt_pk_bf16_f32 v93, v158, v159
  v_mfma_f32_16x16x32_bf16 v[156:159], a[192:195], a[176:179], v[148:151]
  v_exp_f32 v152, v152
  v_mfma_f32_16x16x32_bf16 v[156:159], a[196:199], a[180:183], v[156:159]
  v_mfma_f32_16x16x32_bf16 v[156:159], a[200:203], a[184:187], v[156:159]
  v_exp_f32 v153, v153
  v_mfma_f32_16x16x32_bf16 v[156:159], a[204:207], a[188:191], v[156:159]
  v_cvt_pk_bf16_f32 v96, v152, v153
  v_mfma_f32_16x16x32_bf16 a[36:39], a[232:235], v[48:51], a[36:39]
  v_exp_f32 v154, v154
  v_mfma_f32_16x16x32_bf16 a[36:39], a[236:239], v[72:75], a[36:39]
  v_mfma_f32_16x16x32_bf16 a[68:71], a[236:239], v[76:79], a[68:71]
  v_exp_f32 v155, v155
  v_mfma_f32_16x16x32_bf16 a[68:71], a[232:235], v[52:55], a[68:71]
  ds_read_b64_tr_b16 a[236:237], v3 offset:8520
  v_cvt_pk_bf16_f32 v97, v154, v155
  v_mfma_f32_16x16x32_bf16 v[152:155], a[208:211], a[96:99], v[128:131]
  s_waitcnt lgkmcnt(6)
  v_exp_f32 v156, v156
  v_mfma_f32_16x16x32_bf16 v[152:155], a[212:215], a[100:103], v[152:155]
  ds_read_b64_tr_b16 a[238:239], v3 offset:8776
  ds_read_b64_tr_b16 a[232:233], v3 offset:72
  v_mfma_f32_16x16x32_bf16 v[152:155], a[216:219], a[104:107], v[152:155]
  s_waitcnt lgkmcnt(5)
  v_exp_f32 v157, v157
  v_mfma_f32_16x16x32_bf16 v[152:155], a[220:223], a[108:111], v[152:155]
  ds_read_b64_tr_b16 a[234:235], v3 offset:328
  v_cvt_pk_bf16_f32 v100, v156, v157
  v_mfma_f32_16x16x32_bf16 v[168:171], a[224:227], v[32:35], v[168:171]
  s_waitcnt lgkmcnt(4)
  v_exp_f32 v158, v158
  v_mfma_f32_16x16x32_bf16 v[168:171], a[228:231], v[56:59], v[168:171]
  v_mfma_f32_16x16x32_bf16 v[200:203], a[228:231], v[60:63], v[200:203]
  v_exp_f32 v159, v159
  v_mfma_f32_16x16x32_bf16 v[200:203], a[224:227], v[36:39], v[200:203]
  v_cvt_pk_bf16_f32 v101, v158, v159
  v_smfmac_f32_16x16x64_bf16 v[24:27], a[240:243], v[40:47], v5
  v_mfma_f32_16x16x32_bf16 v[156:159], a[208:211], a[112:115], v[132:135]
  v_exp_f32 v152, v152
  v_mfma_f32_16x16x32_bf16 v[156:159], a[212:215], a[116:119], v[156:159]
  v_mfma_f32_16x16x32_bf16 v[156:159], a[216:219], a[120:123], v[156:159]
  v_exp_f32 v153, v153
  v_mfma_f32_16x16x32_bf16 v[156:159], a[220:223], a[124:127], v[156:159]
  v_cvt_pk_bf16_f32 v82, v152, v153
  v_smfmac_f32_16x16x64_bf16 v[28:31], a[240:243], v[48:55], v5
  v_mfma_f32_16x16x32_bf16 v[232:235], a[224:227], v[40:43], v[232:235]
  v_exp_f32 v154, v154
  v_mfma_f32_16x16x32_bf16 v[232:235], a[228:231], v[64:67], v[232:235]
  s_waitcnt lgkmcnt(0)
  s_barrier
  v_mfma_f32_16x16x32_bf16 a[8:11], a[228:231], v[68:71], a[8:11]
  v_exp_f32 v155, v155
  v_mfma_f32_16x16x32_bf16 a[8:11], a[224:227], v[44:47], a[8:11]
  ds_read_b128 a[192:195], v2 offset:25344
  v_cvt_pk_bf16_f32 v83, v154, v155
  v_mfma_f32_16x16x32_bf16 v[152:155], a[208:211], a[128:131], v[136:139]
  v_exp_f32 v156, v156
  v_mfma_f32_16x16x32_bf16 v[152:155], a[212:215], a[132:135], v[152:155]
  v_mfma_f32_16x16x32_bf16 v[152:155], a[216:219], a[136:139], v[152:155]
  v_exp_f32 v157, v157
  v_mfma_f32_16x16x32_bf16 v[152:155], a[220:223], a[140:143], v[152:155]
  ds_read_b128 a[196:199], v2 offset:25408
  v_cvt_pk_bf16_f32 v86, v156, v157
  v_mfma_f32_16x16x32_bf16 a[40:43], a[224:227], v[48:51], a[40:43]
  v_exp_f32 v158, v158
  v_mfma_f32_16x16x32_bf16 a[40:43], a[228:231], v[72:75], a[40:43]
  v_mfma_f32_16x16x32_bf16 a[72:75], a[228:231], v[76:79], a[72:75]
  v_exp_f32 v159, v159
  v_mfma_f32_16x16x32_bf16 a[72:75], a[224:227], v[52:55], a[72:75]
  ds_read_b128 a[200:203], v2 offset:25472
  v_cvt_pk_bf16_f32 v87, v158, v159
  v_mfma_f32_16x16x32_bf16 v[156:159], a[208:211], a[144:147], v[140:143]
  v_exp_f32 v152, v152
  v_mfma_f32_16x16x32_bf16 v[156:159], a[212:215], a[148:151], v[156:159]
  v_mfma_f32_16x16x32_bf16 v[156:159], a[216:219], a[152:155], v[156:159]
  v_exp_f32 v153, v153
  v_mfma_f32_16x16x32_bf16 v[156:159], a[220:223], a[156:159], v[156:159]
  ds_read_b128 a[204:207], v2 offset:25536
  v_cvt_pk_bf16_f32 v90, v152, v153
  v_mfma_f32_16x16x32_bf16 v[172:175], a[232:235], v[32:35], v[172:175]
  v_exp_f32 v154, v154
  v_mfma_f32_16x16x32_bf16 v[172:175], a[236:239], v[56:59], v[172:175]
  v_mfma_f32_16x16x32_bf16 v[204:207], a[236:239], v[60:63], v[204:207]
  v_exp_f32 v155, v155
  v_mfma_f32_16x16x32_bf16 v[204:207], a[232:235], v[36:39], v[204:207]
  ds_read_b64_tr_b16 a[224:225], v3 offset:128
  v_cvt_pk_bf16_f32 v91, v154, v155
  v_mfma_f32_16x16x32_bf16 v[152:155], a[208:211], a[160:163], v[144:147]
  v_exp_f32 v156, v156
  v_mfma_f32_16x16x32_bf16 v[152:155], a[212:215], a[164:167], v[152:155]
  ds_read_b64_tr_b16 a[226:227], v3 offset:384
  v_mfma_f32_16x16x32_bf16 v[152:155], a[216:219], a[168:171], v[152:155]
  v_exp_f32 v157, v157
  v_mfma_f32_16x16x32_bf16 v[152:155], a[220:223], a[172:175], v[152:155]
  ds_read_b64_tr_b16 a[228:229], v3 offset:8576
  v_cvt_pk_bf16_f32 v94, v156, v157
  v_mfma_f32_16x16x32_bf16 v[236:239], a[232:235], v[40:43], v[236:239]
  v_exp_f32 v158, v158
  v_mfma_f32_16x16x32_bf16 v[236:239], a[236:239], v[64:67], v[236:239]
  ds_read_b64_tr_b16 a[230:231], v3 offset:8832
  v_mfma_f32_16x16x32_bf16 a[12:15], a[236:239], v[68:71], a[12:15]
  v_exp_f32 v159, v159
  v_mfma_f32_16x16x32_bf16 a[12:15], a[232:235], v[44:47], a[12:15]
  v_cvt_pk_bf16_f32 v95, v158, v159
  v_mfma_f32_16x16x32_bf16 v[156:159], a[208:211], a[176:179], v[148:151]
  v_exp_f32 v152, v152
  v_mfma_f32_16x16x32_bf16 v[156:159], a[212:215], a[180:183], v[156:159]
  v_mfma_f32_16x16x32_bf16 v[156:159], a[216:219], a[184:187], v[156:159]
  s_sub_u32 s39, s39, 1
  v_exp_f32 v153, v153
  v_mfma_f32_16x16x32_bf16 v[156:159], a[220:223], a[188:191], v[156:159]
  v_cvt_pk_bf16_f32 v98, v152, v153
  v_mfma_f32_16x16x32_bf16 a[44:47], a[232:235], v[48:51], a[44:47]
  v_exp_f32 v154, v154
  v_mfma_f32_16x16x32_bf16 a[44:47], a[236:239], v[72:75], a[44:47]
  v_mfma_f32_16x16x32_bf16 a[76:79], a[236:239], v[76:79], a[76:79]
  s_waitcnt lgkmcnt(7)
  v_exp_f32 v155, v155
  v_mfma_f32_16x16x32_bf16 a[76:79], a[232:235], v[52:55], a[76:79]
  ds_read_b64_tr_b16 a[236:237], v3 offset:8584
  v_cvt_pk_bf16_f32 v99, v154, v155
  s_cbranch_scc0 LOOP1_6
  s_cmp_eq_u32 s61, 0
  s_cbranch_scc1 MID_6
FIN_6:
  v_mfma_f32_16x16x32_bf16 v[152:155], a[192:195], a[96:99], v[128:131]
  ds_read_b128 a[208:211], v2 offset:25600
  ds_read_b128 a[212:215], v2 offset:25664
  s_waitcnt lgkmcnt(9)
  v_mfma_f32_16x16x32_bf16 v[152:155], a[196:199], a[100:103], v[152:155]
  ds_read_b128 a[216:219], v2 offset:25728
  ds_read_b128 a[220:223], v2 offset:25792
  s_waitcnt lgkmcnt(10)
  v_mfma_f32_16x16x32_bf16 v[152:155], a[200:203], a[104:107], v[152:155]
  s_waitcnt lgkmcnt(4)
  ds_read_b64_tr_b16 a[238:239], v3 offset:8840
  ds_read_b64_tr_b16 a[232:233], v3 offset:136
  v_mfma_f32_16x16x32_bf16 v[152:155], a[204:207], a[108:111], v[152:155]
  ds_read_b64_tr_b16 a[234:235], v3 offset:392
  ds_read_b64_tr_b16 a[244:245], v3 offset:192
  v_mfma_f32_16x16x32_bf16 v[176:179], a[224:227], v[32:35], v[176:179]
  ds_read_b64_tr_b16 a[246:247], v3 offset:448
  ds_read_b64_tr_b16 a[248:249], v3 offset:8640
  v_mfma_f32_16x16x32_bf16 v[176:179], a[228:231], v[56:59], v[176:179]
  ds_read_b64_tr_b16 a[250:251], v3 offset:8896
  v_exp_f32 v156, v156
  v_exp_f32 v157, v157
  v_exp_f32 v158, v158
  v_exp_f32 v159, v159
  v_cvt_pk_bf16_f32 v102, v156, v157
  v_cvt_pk_bf16_f32 v103, v158, v159
  v_mfma_f32_16x16x32_bf16 v[156:159], a[192:195], a[112:115], v[132:135]
  s_waitcnt lgkmcnt(9)
  v_exp_f32 v152, v152
  v_mfma_f32_16x16x32_bf16 v[16:19], a[208:211], a[96:99], v[128:131]
  ds_read_b64_tr_b16 a[96:97], v3 offset:200
  ds_read_b64_tr_b16 a[98:99], v3 offset:456
  v_mfma_f32_16x16x32_bf16 v[16:19], a[212:215], a[100:103], v[16:19]
  s_waitcnt lgkmcnt(7)
  ds_read_b64_tr_b16 a[100:101], v3 offset:8648
  ds_read_b64_tr_b16 a[102:103], v3 offset:8904
  v_mfma_f32_16x16x32_bf16 v[16:19], a[216:219], a[104:107], v[16:19]
  v_exp_f32 v153, v153
  v_mfma_f32_16x16x32_bf16 v[16:19], a[220:223], a[108:111], v[16:19]
  v_exp_f32 v154, v154
  v_mfma_f32_16x16x32_bf16 v[156:159], a[196:199], a[116:119], v[156:159]
  s_waitcnt lgkmcnt(4)
  v_exp_f32 v155, v155
  v_mfma_f32_16x16x32_bf16 v[156:159], a[200:203], a[120:123], v[156:159]
  v_cvt_pk_bf16_f32 v104, v152, v153
  v_cvt_pk_bf16_f32 v105, v154, v155
  v_mfma_f32_16x16x32_bf16 v[156:159], a[204:207], a[124:127], v[156:159]
  v_exp_f32 v16, v16
  v_mfma_f32_16x16x32_bf16 v[152:155], a[208:211], a[112:115], v[132:135]
  v_exp_f32 v17, v17
  v_mfma_f32_16x16x32_bf16 v[152:155], a[212:215], a[116:119], v[152:155]
  v_exp_f32 v18, v18
  v_mfma_f32_16x16x32_bf16 v[152:155], a[216:219], a[120:123], v[152:155]
  v_exp_f32 v19, v19
  v_mfma_f32_16x16x32_bf16 v[152:155], a[220:223], a[124:127], v[152:155]
  v_cvt_pk_bf16_f32 v106, v16, v17
  v_cvt_pk_bf16_f32 v107, v18, v19
  v_mfma_f32_16x16x32_bf16 v[16:19], a[192:195], a[176:179], v[148:151]
  s_barrier
  ds_read_b64_tr_b16 v[128:129], v3 offset:16968
  ds_read_b64_tr_b16 v[130:131], v3 offset:17224
  v_mfma_f32_16x16x32_bf16 v[16:19], a[196:199], a[180:183], v[16:19]
  ds_read_b64_tr_b16 v[132:133], v3 offset:25416
  ds_read_b64_tr_b16 v[134:135], v3 offset:25672
  v_mfma_f32_16x16x32_bf16 v[16:19], a[200:203], a[184:187], v[16:19]
  ds_read_b64_tr_b16 a[120:121], v3 offset:16960
  ds_read_b64_tr_b16 a[122:123], v3 offset:17216
  v_mfma_f32_16x16x32_bf16 v[16:19], a[204:207], a[188:191], v[16:19]
  ds_read_b64_tr_b16 a[124:125], v3 offset:25408
  ds_read_b64_tr_b16 a[126:127], v3 offset:25664
  v_mfma_f32_16x16x32_bf16 v[180:183], a[232:235], v[32:35], v[180:183]
  ds_read_b64_tr_b16 a[112:113], v3 offset:16904
  ds_read_b64_tr_b16 a[114:115], v3 offset:17160
  v_mfma_f32_16x16x32_bf16 v[180:183], a[236:239], v[56:59], v[180:183]
  ds_read_b64_tr_b16 a[116:117], v3 offset:25352
  ds_read_b64_tr_b16 a[118:119], v3 offset:25608
  v_mfma_f32_16x16x32_bf16 v[184:187], a[244:247], v[32:35], v[184:187]
  ds_read_b64_tr_b16 a[104:105], v3 offset:16896
  ds_read_b64_tr_b16 a[106:107], v3 offset:17152
  v_mfma_f32_16x16x32_bf16 v[184:187], a[248:251], v[56:59], v[184:187]
  ds_read_b64_tr_b16 a[108:109], v3 offset:25344
  ds_read_b64_tr_b16 a[110:111], v3 offset:25600
  v_exp_f32 v156, v156
  v_exp_f32 v157, v157
  v_exp_f32 v158, v158
  v_exp_f32 v159, v159
  v_cvt_pk_bf16_f32 v108, v156, v157
  v_cvt_pk_bf16_f32 v109, v158, v159
  v_mfma_f32_16x16x32_bf16 v[156:159], a[208:211], a[176:179], v[148:151]
  ds_read_b64_tr_b16 a[176:177], v3 offset:17024
  ds_read_b64_tr_b16 a[178:179], v3 offset:17280
  v_mfma_f32_16x16x32_bf16 v[156:159], a[212:215], a[180:183], v[156:159]
  ds_read_b64_tr_b16 a[180:181], v3 offset:25472
  ds_read_b64_tr_b16 a[182:183], v3 offset:25728
  v_mfma_f32_16x16x32_bf16 v[156:159], a[216:219], a[184:187], v[156:159]
  ds_read_b64_tr_b16 a[184:185], v3 offset:17032
  ds_read_b64_tr_b16 a[186:187], v3 offset:17288
  v_mfma_f32_16x16x32_bf16 v[156:159], a[220:223], a[188:191], v[156:159]
  ds_read_b64_tr_b16 a[188:189], v3 offset:25480
  ds_read_b64_tr_b16 a[190:191], v3 offset:25736
  v_exp_f32 v152, v152
  v_exp_f32 v153, v153
  v_exp_f32 v154, v154
  v_exp_f32 v155, v155
  v_cvt_pk_bf16_f32 v110, v152, v153
  v_cvt_pk_bf16_f32 v111, v154, v155
  v_mfma_f32_16x16x32_bf16 v[152:155], a[192:195], a[128:131], v[136:139]
  v_exp_f32 v16, v16
  v_mfma_f32_16x16x32_bf16 v[152:155], a[196:199], a[132:135], v[152:155]
  v_exp_f32 v17, v17
  v_mfma_f32_16x16x32_bf16 v[152:155], a[200:203], a[136:139], v[152:155]
  v_exp_f32 v18, v18
  v_mfma_f32_16x16x32_bf16 v[152:155], a[204:207], a[140:143], v[152:155]
  v_exp_f32 v19, v19
  v_cvt_pk_bf16_f32 v124, v16, v17
  v_cvt_pk_bf16_f32 v125, v18, v19
  v_mfma_f32_16x16x32_bf16 v[16:19], a[208:211], a[128:131], v[136:139]
  ds_read_b64_tr_b16 a[128:129], v3 offset:17088
  ds_read_b64_tr_b16 a[130:131], v3 offset:17344
  v_mfma_f32_16x16x32_bf16 v[16:19], a[212:215], a[132:135], v[16:19]
  s_waitcnt lgkmcnt(2)
  ds_read_b64_tr_b16 a[132:133], v3 offset:25536
  ds_read_b64_tr_b16 a[134:135], v3 offset:25792
  v_mfma_f32_16x16x32_bf16 v[16:19], a[216:219], a[136:139], v[16:19]
  ds_read_b64_tr_b16 a[136:137], v3 offset:17096
  ds_read_b64_tr_b16 a[138:139], v3 offset:17352
  v_mfma_f32_16x16x32_bf16 v[16:19], a[220:223], a[140:143], v[16:19]
  ds_read_b64_tr_b16 a[140:141], v3 offset:25544
  ds_read_b64_tr_b16 a[142:143], v3 offset:25800
  v_exp_f32 v156, v156
  v_exp_f32 v157, v157
  v_exp_f32 v158, v158
  v_exp_f32 v159, v159
  v_cvt_pk_bf16_f32 v126, v156, v157
  v_cvt_pk_bf16_f32 v127, v158, v159
  v_mfma_f32_16x16x32_bf16 v[188:191], a[96:99], v[32:35], v[188:191]
  v_exp_f32 v152, v152
  v_mfma_f32_16x16x32_bf16 v[188:191], a[100:103], v[56:59], v[188:191]
  v_exp_f32 v153, v153
  v_exp_f32 v154, v154
  v_exp_f32 v155, v155
  v_cvt_pk_bf16_f32 v112, v152, v153
  v_cvt_pk_bf16_f32 v113, v154, v155
  v_exp_f32 v16, v16
  v_exp_f32 v17, v17
  v_exp_f32 v18, v18
  v_exp_f32 v19, v19
  v_cvt_pk_bf16_f32 v114, v16, v17
  v_cvt_pk_bf16_f32 v115, v18, v19
  v_smfmac_f32_16x16x64_bf16 v[20:23], a[240:243], v[56:63], v5
  s_waitcnt lgkmcnt(0)
  v_add_u32 v4, s45, v1
  v_smfmac_f32_16x16x64_bf16 v[20:23], a[240:243], v[80:87], v5
  v_and_b32 v136, 15, v0
  v_smfmac_f32_16x16x64_bf16 v[20:23], a[240:243], v[104:111], v5
  v_lshrrev_b32 v137, 4, v0
  v_mfma_f32_16x16x32_bf16 v[160:163], a[104:107], v[80:83], v[160:163]
  v_xor_b32 v138, v136, v137
  v_lshlrev_b32 v138, 4, v138
  v_mfma_f32_16x16x32_bf16 v[160:163], a[108:111], v[104:107], v[160:163]
  v_lshl_add_u32 v148, v137, 8, v138
  v_xor_b32 v149, 64, v148
  v_mfma_f32_16x16x32_bf16 v[164:167], a[112:115], v[80:83], v[164:167]
  v_xor_b32 v150, 0x80, v148
  v_xor_b32 v151, 0xc0, v148
  v_mfma_f32_16x16x32_bf16 v[164:167], a[116:119], v[104:107], v[164:167]
  s_add_u32 s63, s45, 94208
  v_add_f32 v20, v20, v21
  v_rcp_f32 v12, v20
  v_mfma_f32_16x16x32_bf16 v[168:171], a[120:123], v[80:83], v[168:171]
  v_mul_f32 v21, s83, v12
  v_fma_f32 v160, v160, v12, v21
  v_mfma_f32_16x16x32_bf16 v[168:171], a[124:127], v[104:107], v[168:171]
  v_fma_f32 v161, v161, v12, v21
  v_fma_f32 v162, v162, v12, v21
  v_mfma_f32_16x16x32_bf16 v[172:175], v[128:131], v[80:83], v[172:175]
  v_fma_f32 v163, v163, v12, v21
  v_fma_f32 v164, v164, v12, v21
  v_mfma_f32_16x16x32_bf16 v[172:175], v[132:135], v[104:107], v[172:175]
  v_fma_f32 v165, v165, v12, v21
  v_fma_f32 v166, v166, v12, v21
  v_mfma_f32_16x16x32_bf16 v[176:179], a[176:179], v[80:83], v[176:179]
  v_fma_f32 v167, v167, v12, v21
  v_cvt_pk_bf16_f32 v160, v160, v161
  v_mfma_f32_16x16x32_bf16 v[176:179], a[180:183], v[104:107], v[176:179]
  v_cvt_pk_bf16_f32 v161, v162, v163
  v_cvt_pk_bf16_f32 v162, v164, v165
  v_mfma_f32_16x16x32_bf16 v[180:183], a[184:187], v[80:83], v[180:183]
  v_cvt_pk_bf16_f32 v163, v166, v167
  v_fma_f32 v168, v168, v12, v21
  v_mfma_f32_16x16x32_bf16 v[180:183], a[188:191], v[104:107], v[180:183]
  ds_write_b128 v8, v[160:163] offset:0
  v_mfma_f32_16x16x32_bf16 v[184:187], a[128:131], v[80:83], v[184:187]
  v_fma_f32 v169, v169, v12, v21
  v_fma_f32 v170, v170, v12, v21
  v_mfma_f32_16x16x32_bf16 v[184:187], a[132:135], v[104:107], v[184:187]
  v_fma_f32 v171, v171, v12, v21
  v_fma_f32 v172, v172, v12, v21
  v_mfma_f32_16x16x32_bf16 v[188:191], a[136:139], v[80:83], v[188:191]
  v_fma_f32 v173, v173, v12, v21
  v_fma_f32 v174, v174, v12, v21
  v_mfma_f32_16x16x32_bf16 v[188:191], a[140:143], v[104:107], v[188:191]
  v_fma_f32 v175, v175, v12, v21
  v_cvt_pk_bf16_f32 v168, v168, v169
  v_cvt_pk_bf16_f32 v169, v170, v171
  v_cvt_pk_bf16_f32 v170, v172, v173
  v_cvt_pk_bf16_f32 v171, v174, v175
  v_mfma_f32_16x16x32_bf16 v[192:195], a[104:107], v[84:87], v[192:195]
  ds_write_b128 v9, v[168:171] offset:0
  v_fma_f32 v176, v176, v12, v21
  v_fma_f32 v177, v177, v12, v21
  v_fma_f32 v178, v178, v12, v21
  v_fma_f32 v179, v179, v12, v21
  v_fma_f32 v180, v180, v12, v21
  v_fma_f32 v181, v181, v12, v21
  v_fma_f32 v182, v182, v12, v21
  v_fma_f32 v183, v183, v12, v21
  v_cvt_pk_bf16_f32 v176, v176, v177
  v_cvt_pk_bf16_f32 v177, v178, v179
  v_cvt_pk_bf16_f32 v178, v180, v181
  v_cvt_pk_bf16_f32 v179, v182, v183
  v_mfma_f32_16x16x32_bf16 v[192:195], a[108:111], v[108:111], v[192:195]
  ds_write_b128 v10, v[176:179] offset:0
  v_fma_f32 v184, v184, v12, v21
  v_fma_f32 v185, v185, v12, v21
  v_fma_f32 v186, v186, v12, v21
  v_fma_f32 v187, v187, v12, v21
  v_fma_f32 v188, v188, v12, v21
  v_fma_f32 v189, v189, v12, v21
  v_fma_f32 v190, v190, v12, v21
  v_fma_f32 v191, v191, v12, v21
  v_cvt_pk_bf16_f32 v184, v184, v185
  v_cvt_pk_bf16_f32 v185, v186, v187
  v_cvt_pk_bf16_f32 v186, v188, v189
  v_cvt_pk_bf16_f32 v187, v190, v191
  v_mfma_f32_16x16x32_bf16 v[196:199], a[112:115], v[84:87], v[196:199]
  ds_write_b128 v11, v[184:187] offset:0
  v_mfma_f32_16x16x32_bf16 v[196:199], a[116:119], v[108:111], v[196:199]
  ds_read_b128 v[32:35], v4 offset:0
  ds_read_b128 v[56:59], v4 offset:1024
  v_mfma_f32_16x16x32_bf16 v[200:203], a[120:123], v[84:87], v[200:203]
  ds_read_b128 v[80:83], v4 offset:2048
  ds_read_b128 v[104:107], v4 offset:3072
  v_mfma_f32_16x16x32_bf16 v[200:203], a[124:127], v[108:111], v[200:203]
  v_add_f32 v22, v22, v23
  v_rcp_f32 v13, v22
  v_mfma_f32_16x16x32_bf16 v[204:207], v[128:131], v[84:87], v[204:207]
  v_mul_f32 v23, s83, v13
  v_fma_f32 v192, v192, v13, v23
  v_mfma_f32_16x16x32_bf16 v[204:207], v[132:135], v[108:111], v[204:207]
  v_fma_f32 v193, v193, v13, v23
  v_fma_f32 v194, v194, v13, v23
  v_mfma_f32_16x16x32_bf16 v[208:211], a[224:227], v[36:39], v[208:211]
  v_fma_f32 v195, v195, v13, v23
  v_fma_f32 v196, v196, v13, v23
  v_mfma_f32_16x16x32_bf16 v[208:211], a[228:231], v[60:63], v[208:211]
  v_fma_f32 v197, v197, v13, v23
  v_fma_f32 v198, v198, v13, v23
  v_mfma_f32_16x16x32_bf16 v[208:211], a[176:179], v[84:87], v[208:211]
  v_fma_f32 v199, v199, v13, v23
  v_cvt_pk_bf16_f32 v192, v192, v193
  v_mfma_f32_16x16x32_bf16 v[208:211], a[180:183], v[108:111], v[208:211]
  v_cvt_pk_bf16_f32 v193, v194, v195
  v_cvt_pk_bf16_f32 v194, v196, v197
  v_mfma_f32_16x16x32_bf16 v[212:215], a[232:235], v[36:39], v[212:215]
  s_waitcnt lgkmcnt(0)
  buffer_store_dwordx4 v[32:35], v148, s[20:23], s63 offen offset:0 nt
  v_mfma_f32_16x16x32_bf16 v[212:215], a[236:239], v[60:63], v[212:215]
  v_cvt_pk_bf16_f32 v195, v198, v199
  v_fma_f32 v200, v200, v13, v23
  v_mfma_f32_16x16x32_bf16 v[212:215], a[184:187], v[84:87], v[212:215]
  v_fma_f32 v201, v201, v13, v23
  v_fma_f32 v202, v202, v13, v23
  v_mfma_f32_16x16x32_bf16 v[212:215], a[188:191], v[108:111], v[212:215]
  buffer_store_dwordx4 v[56:59], v149, s[20:23], s63 offen offset:1024 nt
  v_mfma_f32_16x16x32_bf16 v[216:219], a[244:247], v[36:39], v[216:219]
  v_fma_f32 v203, v203, v13, v23
  v_fma_f32 v204, v204, v13, v23
  v_mfma_f32_16x16x32_bf16 v[216:219], a[248:251], v[60:63], v[216:219]
  v_fma_f32 v205, v205, v13, v23
  v_fma_f32 v206, v206, v13, v23
  v_mfma_f32_16x16x32_bf16 v[216:219], a[128:131], v[84:87], v[216:219]
  buffer_store_dwordx4 v[80:83], v150, s[20:23], s63 offen offset:2048 nt
  v_mfma_f32_16x16x32_bf16 v[216:219], a[132:135], v[108:111], v[216:219]
  v_fma_f32 v207, v207, v13, v23
  v_cvt_pk_bf16_f32 v200, v200, v201
  v_mfma_f32_16x16x32_bf16 v[220:223], a[96:99], v[36:39], v[220:223]
  v_cvt_pk_bf16_f32 v201, v202, v203
  v_cvt_pk_bf16_f32 v202, v204, v205
  v_mfma_f32_16x16x32_bf16 v[220:223], a[100:103], v[60:63], v[220:223]
  buffer_store_dwordx4 v[104:107], v151, s[20:23], s63 offen offset:3072 nt
  v_mfma_f32_16x16x32_bf16 v[220:223], a[136:139], v[84:87], v[220:223]
  v_cvt_pk_bf16_f32 v203, v206, v207
  v_fma_f32 v208, v208, v13, v23
  v_mfma_f32_16x16x32_bf16 v[220:223], a[140:143], v[108:111], v[220:223]
  s_add_u32 s63, s45, 98304
  ds_write_b128 v8, v[192:195] offset:4096
  v_mfma_f32_16x16x32_bf16 v[156:159], a[192:195], a[144:147], v[140:143]
  ds_write_b128 v9, v[200:203] offset:4096
  v_mfma_f32_16x16x32_bf16 v[156:159], a[196:199], a[148:151], v[156:159]
  v_fma_f32 v209, v209, v13, v23
  v_fma_f32 v210, v210, v13, v23
  v_mfma_f32_16x16x32_bf16 v[156:159], a[200:203], a[152:155], v[156:159]
  v_fma_f32 v211, v211, v13, v23
  v_fma_f32 v212, v212, v13, v23
  v_mfma_f32_16x16x32_bf16 v[156:159], a[204:207], a[156:159], v[156:159]
  v_fma_f32 v213, v213, v13, v23
  v_fma_f32 v214, v214, v13, v23
  v_mfma_f32_16x16x32_bf16 v[152:155], a[208:211], a[144:147], v[140:143]
  v_fma_f32 v215, v215, v13, v23
  v_cvt_pk_bf16_f32 v208, v208, v209
  v_mfma_f32_16x16x32_bf16 v[152:155], a[212:215], a[148:151], v[152:155]
  v_cvt_pk_bf16_f32 v209, v210, v211
  v_cvt_pk_bf16_f32 v210, v212, v213
  v_mfma_f32_16x16x32_bf16 v[152:155], a[216:219], a[152:155], v[152:155]
  v_exp_f32 v156, v156
  v_mfma_f32_16x16x32_bf16 v[152:155], a[220:223], a[156:159], v[152:155]
  v_exp_f32 v157, v157
  v_exp_f32 v158, v158
  v_exp_f32 v159, v159
  v_cvt_pk_bf16_f32 v116, v156, v157
  v_cvt_pk_bf16_f32 v117, v158, v159
  v_smfmac_f32_16x16x64_bf16 v[24:27], a[240:243], v[64:71], v5
  v_cvt_pk_bf16_f32 v211, v214, v215
  v_smfmac_f32_16x16x64_bf16 v[24:27], a[240:243], v[88:95], v5
  ds_write_b128 v10, v[208:211] offset:4096
  v_exp_f32 v152, v152
  v_exp_f32 v153, v153
  v_exp_f32 v154, v154
  v_exp_f32 v155, v155
  v_cvt_pk_bf16_f32 v118, v152, v153
  v_cvt_pk_bf16_f32 v119, v154, v155
  v_fma_f32 v216, v216, v13, v23
  v_fma_f32 v217, v217, v13, v23
  v_smfmac_f32_16x16x64_bf16 v[24:27], a[240:243], v[112:119], v5
  v_fma_f32 v218, v218, v13, v23
  v_fma_f32 v219, v219, v13, v23
  v_fma_f32 v220, v220, v13, v23
  v_fma_f32 v221, v221, v13, v23
  v_fma_f32 v222, v222, v13, v23
  v_fma_f32 v223, v223, v13, v23
  v_cvt_pk_bf16_f32 v216, v216, v217
  v_cvt_pk_bf16_f32 v217, v218, v219
  v_cvt_pk_bf16_f32 v218, v220, v221
  v_cvt_pk_bf16_f32 v219, v222, v223
  v_mfma_f32_16x16x32_bf16 v[224:227], a[104:107], v[88:91], v[224:227]
  ds_write_b128 v11, v[216:219] offset:4096
  v_mfma_f32_16x16x32_bf16 v[224:227], a[108:111], v[112:115], v[224:227]
  ds_read_b128 v[36:39], v4 offset:4096
  ds_read_b128 v[60:63], v4 offset:5120
  v_mfma_f32_16x16x32_bf16 v[228:231], a[112:115], v[88:91], v[228:231]
  ds_read_b128 v[84:87], v4 offset:6144
  ds_read_b128 v[108:111], v4 offset:7168
  v_mfma_f32_16x16x32_bf16 v[228:231], a[116:119], v[112:115], v[228:231]
  v_add_f32 v24, v24, v25
  v_rcp_f32 v14, v24
  v_mfma_f32_16x16x32_bf16 v[232:235], a[120:123], v[88:91], v[232:235]
  v_mul_f32 v25, s83, v14
  v_fma_f32 v224, v224, v14, v25
  v_mfma_f32_16x16x32_bf16 v[232:235], a[124:127], v[112:115], v[232:235]
  v_fma_f32 v225, v225, v14, v25
  v_fma_f32 v226, v226, v14, v25
  v_mfma_f32_16x16x32_bf16 v[236:239], v[128:131], v[88:91], v[236:239]
  v_fma_f32 v227, v227, v14, v25
  v_fma_f32 v228, v228, v14, v25
  v_mfma_f32_16x16x32_bf16 v[236:239], v[132:135], v[112:115], v[236:239]
  v_fma_f32 v229, v229, v14, v25
  v_fma_f32 v230, v230, v14, v25
  v_fma_f32 v231, v231, v14, v25
  v_cvt_pk_bf16_f32 v224, v224, v225
  v_cvt_pk_bf16_f32 v225, v226, v227
  v_cvt_pk_bf16_f32 v226, v228, v229
  v_cvt_pk_bf16_f32 v227, v230, v231
  v_mfma_f32_16x16x32_bf16 v[240:243], a[224:227], v[40:43], v[240:243]
  ds_write_b128 v8, v[224:227] offset:8192
  v_mfma_f32_16x16x32_bf16 v[240:243], a[228:231], v[64:67], v[240:243]
  s_waitcnt lgkmcnt(1)
  buffer_store_dwordx4 v[36:39], v148, s[20:23], s63 offen offset:0 nt
  v_mfma_f32_16x16x32_bf16 v[240:243], a[176:179], v[88:91], v[240:243]
  v_fma_f32 v232, v232, v14, v25
  v_fma_f32 v233, v233, v14, v25
  v_mfma_f32_16x16x32_bf16 v[240:243], a[180:183], v[112:115], v[240:243]
  v_fma_f32 v234, v234, v14, v25
  v_fma_f32 v235, v235, v14, v25
  v_mfma_f32_16x16x32_bf16 v[244:247], a[232:235], v[40:43], v[244:247]
  buffer_store_dwordx4 v[60:63], v149, s[20:23], s63 offen offset:1024 nt
  v_mfma_f32_16x16x32_bf16 v[244:247], a[236:239], v[64:67], v[244:247]
  v_fma_f32 v236, v236, v14, v25
  v_fma_f32 v237, v237, v14, v25
  v_mfma_f32_16x16x32_bf16 v[244:247], a[184:187], v[88:91], v[244:247]
  v_fma_f32 v238, v238, v14, v25
  v_fma_f32 v239, v239, v14, v25
  v_mfma_f32_16x16x32_bf16 v[244:247], a[188:191], v[112:115], v[244:247]
  buffer_store_dwordx4 v[84:87], v150, s[20:23], s63 offen offset:2048 nt
  v_mfma_f32_16x16x32_bf16 v[248:251], a[244:247], v[40:43], v[248:251]
  v_cvt_pk_bf16_f32 v232, v232, v233
  v_cvt_pk_bf16_f32 v233, v234, v235
  v_mfma_f32_16x16x32_bf16 v[248:251], a[248:251], v[64:67], v[248:251]
  v_cvt_pk_bf16_f32 v234, v236, v237
  v_cvt_pk_bf16_f32 v235, v238, v239
  v_mfma_f32_16x16x32_bf16 v[248:251], a[128:131], v[88:91], v[248:251]
  buffer_store_dwordx4 v[108:111], v151, s[20:23], s63 offen offset:3072 nt
  v_mfma_f32_16x16x32_bf16 v[248:251], a[132:135], v[112:115], v[248:251]
  s_add_u32 s63, s45, 102400
  ds_write_b128 v9, v[232:235] offset:8192
  v_mfma_f32_16x16x32_bf16 v[252:255], a[96:99], v[40:43], v[252:255]
  v_fma_f32 v240, v240, v14, v25
  v_fma_f32 v241, v241, v14, v25
  v_mfma_f32_16x16x32_bf16 v[252:255], a[100:103], v[64:67], v[252:255]
  v_fma_f32 v242, v242, v14, v25
  v_fma_f32 v243, v243, v14, v25
  v_mfma_f32_16x16x32_bf16 v[252:255], a[136:139], v[88:91], v[252:255]
  v_fma_f32 v244, v244, v14, v25
  v_fma_f32 v245, v245, v14, v25
  v_mfma_f32_16x16x32_bf16 v[252:255], a[140:143], v[112:115], v[252:255]
  v_fma_f32 v246, v246, v14, v25
  v_fma_f32 v247, v247, v14, v25
  v_cvt_pk_bf16_f32 v240, v240, v241
  v_cvt_pk_bf16_f32 v241, v242, v243
  v_cvt_pk_bf16_f32 v242, v244, v245
  v_cvt_pk_bf16_f32 v243, v246, v247
  v_mfma_f32_16x16x32_bf16 v[16:19], a[192:195], a[160:163], v[144:147]
  ds_write_b128 v10, v[240:243] offset:8192
  v_fma_f32 v248, v248, v14, v25
  v_fma_f32 v249, v249, v14, v25
  v_fma_f32 v250, v250, v14, v25
  v_fma_f32 v251, v251, v14, v25
  v_fma_f32 v252, v252, v14, v25
  v_fma_f32 v253, v253, v14, v25
  v_fma_f32 v254, v254, v14, v25
  v_fma_f32 v255, v255, v14, v25
  v_cvt_pk_bf16_f32 v248, v248, v249
  v_cvt_pk_bf16_f32 v249, v250, v251
  v_cvt_pk_bf16_f32 v250, v252, v253
  v_cvt_pk_bf16_f32 v251, v254, v255
  v_mfma_f32_16x16x32_bf16 v[16:19], a[196:199], a[164:167], v[16:19]
  ds_write_b128 v11, v[248:251] offset:8192
  v_mfma_f32_16x16x32_bf16 v[16:19], a[200:203], a[168:171], v[16:19]
  ds_read_b128 v[40:43], v4 offset:8192
  ds_read_b128 v[64:67], v4 offset:9216
  v_mfma_f32_16x16x32_bf16 v[16:19], a[204:207], a[172:175], v[16:19]
  ds_read_b128 v[88:91], v4 offset:10240
  ds_read_b128 v[112:115], v4 offset:11264
  v_mfma_f32_16x16x32_bf16 v[156:159], a[208:211], a[160:163], v[144:147]
  v_add_f32 v26, v26, v27
  v_rcp_f32 v15, v26
  v_mfma_f32_16x16x32_bf16 v[156:159], a[212:215], a[164:167], v[156:159]
  v_mul_f32 v27, s83, v15
  v_add_f32 v6, v20, v22
  v_mfma_f32_16x16x32_bf16 v[156:159], a[216:219], a[168:171], v[156:159]
  v_exp_f32 v16, v16
  v_mfma_f32_16x16x32_bf16 v[156:159], a[220:223], a[172:175], v[156:159]
  v_exp_f32 v17, v17
  v_exp_f32 v18, v18
  v_exp_f32 v19, v19
  v_cvt_pk_bf16_f32 v120, v16, v17
  v_cvt_pk_bf16_f32 v121, v18, v19
  v_mfma_f32_16x16x32_bf16 a[0:3], a[104:107], v[92:95], a[0:3]
  v_add_f32 v6, v6, v24
  v_add_f32 v6, v6, v26
  v_exp_f32 v156, v156
  v_mfma_f32_16x16x32_bf16 a[0:3], a[108:111], v[116:119], a[0:3]
  s_waitcnt lgkmcnt(0)
  buffer_store_dwordx4 v[40:43], v148, s[20:23], s63 offen offset:0 nt
  v_exp_f32 v157, v157
  v_exp_f32 v158, v158
  v_exp_f32 v159, v159
  v_cvt_pk_bf16_f32 v122, v156, v157
  v_cvt_pk_bf16_f32 v123, v158, v159
  v_mfma_f32_16x16x32_bf16 a[4:7], a[112:115], v[92:95], a[4:7]
  buffer_store_dwordx4 v[64:67], v149, s[20:23], s63 offen offset:1024 nt
  v_mfma_f32_16x16x32_bf16 a[4:7], a[116:119], v[116:119], a[4:7]
  v_accvgpr_read_b32 v32, a0
  v_accvgpr_read_b32 v33, a1
  v_mfma_f32_16x16x32_bf16 a[8:11], a[120:123], v[92:95], a[8:11]
  v_accvgpr_read_b32 v34, a2
  v_accvgpr_read_b32 v35, a3
  v_mfma_f32_16x16x32_bf16 a[8:11], a[124:127], v[116:119], a[8:11]
  buffer_store_dwordx4 v[88:91], v150, s[20:23], s63 offen offset:2048 nt
  v_mfma_f32_16x16x32_bf16 a[12:15], v[128:131], v[92:95], a[12:15]
  v_accvgpr_read_b32 v36, a4
  v_accvgpr_read_b32 v37, a5
  v_mfma_f32_16x16x32_bf16 a[12:15], v[132:135], v[116:119], a[12:15]
  v_accvgpr_read_b32 v38, a6
  v_accvgpr_read_b32 v39, a7
  v_fma_f32 v32, v32, v15, v27
  v_fma_f32 v33, v33, v15, v27
  v_mfma_f32_16x16x32_bf16 a[16:19], a[224:227], v[44:47], a[16:19]
  buffer_store_dwordx4 v[112:115], v151, s[20:23], s63 offen offset:3072 nt
  v_fma_f32 v34, v34, v15, v27
  v_fma_f32 v35, v35, v15, v27
  v_fma_f32 v36, v36, v15, v27
  v_fma_f32 v37, v37, v15, v27
  v_fma_f32 v38, v38, v15, v27
  v_fma_f32 v39, v39, v15, v27
  v_cvt_pk_bf16_f32 v32, v32, v33
  v_cvt_pk_bf16_f32 v33, v34, v35
  v_cvt_pk_bf16_f32 v34, v36, v37
  v_cvt_pk_bf16_f32 v35, v38, v39
  v_mfma_f32_16x16x32_bf16 a[16:19], a[228:231], v[68:71], a[16:19]
  s_add_u32 s63, s45, 106496
  ds_write_b128 v8, v[32:35] offset:12288
  v_mfma_f32_16x16x32_bf16 a[16:19], a[176:179], v[92:95], a[16:19]
  v_accvgpr_read_b32 v40, a8
  v_accvgpr_read_b32 v41, a9
  v_mfma_f32_16x16x32_bf16 a[16:19], a[180:183], v[116:119], a[16:19]
  v_accvgpr_read_b32 v42, a10
  v_accvgpr_read_b32 v43, a11
  v_mfma_f32_16x16x32_bf16 a[20:23], a[232:235], v[44:47], a[20:23]
  v_fma_f32 v40, v40, v15, v27
  v_fma_f32 v41, v41, v15, v27
  v_mfma_f32_16x16x32_bf16 a[20:23], a[236:239], v[68:71], a[20:23]
  v_fma_f32 v42, v42, v15, v27
  v_fma_f32 v43, v43, v15, v27
  v_mfma_f32_16x16x32_bf16 a[20:23], a[184:187], v[92:95], a[20:23]
  v_cvt_pk_bf16_f32 v40, v40, v41
  v_cvt_pk_bf16_f32 v41, v42, v43
  v_mfma_f32_16x16x32_bf16 a[20:23], a[188:191], v[116:119], a[20:23]
  v_accvgpr_read_b32 v32, a16
  v_accvgpr_read_b32 v33, a17
  v_mfma_f32_16x16x32_bf16 a[24:27], a[244:247], v[44:47], a[24:27]
  v_accvgpr_read_b32 v34, a18
  v_accvgpr_read_b32 v35, a19
  v_mfma_f32_16x16x32_bf16 a[24:27], a[248:251], v[68:71], a[24:27]
  v_fma_f32 v32, v32, v15, v27
  v_fma_f32 v33, v33, v15, v27
  v_mfma_f32_16x16x32_bf16 a[24:27], a[128:131], v[92:95], a[24:27]
  v_accvgpr_read_b32 v36, a20
  v_accvgpr_read_b32 v37, a21
  v_mfma_f32_16x16x32_bf16 a[24:27], a[132:135], v[116:119], a[24:27]
  v_accvgpr_read_b32 v38, a22
  v_accvgpr_read_b32 v39, a23
  v_mfma_f32_16x16x32_bf16 a[28:31], a[96:99], v[44:47], a[28:31]
  v_accvgpr_read_b32 v44, a12
  v_accvgpr_read_b32 v45, a13
  v_mfma_f32_16x16x32_bf16 a[28:31], a[100:103], v[68:71], a[28:31]
  v_accvgpr_read_b32 v46, a14
  v_accvgpr_read_b32 v47, a15
  v_mfma_f32_16x16x32_bf16 a[28:31], a[136:139], v[92:95], a[28:31]
  v_fma_f32 v44, v44, v15, v27
  v_fma_f32 v45, v45, v15, v27
  v_mfma_f32_16x16x32_bf16 a[28:31], a[140:143], v[116:119], a[28:31]
  v_fma_f32 v46, v46, v15, v27
  v_fma_f32 v47, v47, v15, v27
  v_cvt_pk_bf16_f32 v42, v44, v45
  v_cvt_pk_bf16_f32 v43, v46, v47
  v_smfmac_f32_16x16x64_bf16 v[28:31], a[240:243], v[72:79], v5
  ds_write_b128 v9, v[40:43] offset:12288
  v_smfmac_f32_16x16x64_bf16 v[28:31], a[240:243], v[96:103], v5
  v_fma_f32 v34, v34, v15, v27
  v_smfmac_f32_16x16x64_bf16 v[28:31], a[240:243], v[120:127], v5
  v_fma_f32 v35, v35, v15, v27
  v_fma_f32 v36, v36, v15, v27
  v_fma_f32 v37, v37, v15, v27
  v_fma_f32 v38, v38, v15, v27
  v_fma_f32 v39, v39, v15, v27
  v_cvt_pk_bf16_f32 v32, v32, v33
  v_cvt_pk_bf16_f32 v33, v34, v35
  v_cvt_pk_bf16_f32 v34, v36, v37
  v_cvt_pk_bf16_f32 v35, v38, v39
  v_mfma_f32_16x16x32_bf16 a[32:35], a[104:107], v[96:99], a[32:35]
  ds_write_b128 v10, v[32:35] offset:12288
  v_accvgpr_read_b32 v40, a24
  v_add_f32 v28, v28, v29
  v_rcp_f32 v16, v28
  v_add_f32 v30, v30, v31
  v_mul_f32 v29, s83, v16
  v_rcp_f32 v17, v30
  v_add_f32 v6, v6, v28
  v_mul_f32 v31, s83, v17
  v_add_f32 v6, v6, v30
  v_cmp_nge_f32 s[42:43], s49, v6
  v_accvgpr_read_b32 v41, a25
  v_accvgpr_read_b32 v42, a26
  v_accvgpr_read_b32 v43, a27
  v_accvgpr_read_b32 v44, a28
  v_accvgpr_read_b32 v45, a29
  v_accvgpr_read_b32 v46, a30
  v_accvgpr_read_b32 v47, a31
  v_fma_f32 v40, v40, v15, v27
  v_fma_f32 v41, v41, v15, v27
  v_fma_f32 v42, v42, v15, v27
  v_fma_f32 v43, v43, v15, v27
  v_fma_f32 v44, v44, v15, v27
  v_fma_f32 v45, v45, v15, v27
  v_fma_f32 v46, v46, v15, v27
  v_fma_f32 v47, v47, v15, v27
  v_cvt_pk_bf16_f32 v40, v40, v41
  v_cvt_pk_bf16_f32 v41, v42, v43
  v_cvt_pk_bf16_f32 v42, v44, v45
  v_cvt_pk_bf16_f32 v43, v46, v47
  v_mfma_f32_16x16x32_bf16 a[32:35], a[108:111], v[120:123], a[32:35]
  ds_write_b128 v11, v[40:43] offset:12288
  v_mfma_f32_16x16x32_bf16 a[36:39], a[112:115], v[96:99], a[36:39]
  ds_read_b128 v[44:47], v4 offset:12288
  ds_read_b128 v[68:71], v4 offset:13312
  v_mfma_f32_16x16x32_bf16 a[36:39], a[116:119], v[120:123], a[36:39]
  ds_read_b128 v[92:95], v4 offset:14336
  ds_read_b128 v[116:119], v4 offset:15360
  v_mfma_f32_16x16x32_bf16 a[40:43], a[120:123], v[96:99], a[40:43]
  v_accvgpr_read_b32 v32, a32
  v_accvgpr_read_b32 v33, a33
  v_mfma_f32_16x16x32_bf16 a[40:43], a[124:127], v[120:123], a[40:43]
  v_accvgpr_read_b32 v34, a34
  v_accvgpr_read_b32 v35, a35
  v_mfma_f32_16x16x32_bf16 a[44:47], v[128:131], v[96:99], a[44:47]
  v_accvgpr_read_b32 v36, a36
  v_accvgpr_read_b32 v37, a37
  v_mfma_f32_16x16x32_bf16 a[44:47], v[132:135], v[120:123], a[44:47]
  v_accvgpr_read_b32 v38, a38
  v_accvgpr_read_b32 v39, a39
  v_fma_f32 v32, v32, v16, v29
  v_fma_f32 v33, v33, v16, v29
  v_fma_f32 v34, v34, v16, v29
  v_fma_f32 v35, v35, v16, v29
  v_fma_f32 v36, v36, v16, v29
  v_fma_f32 v37, v37, v16, v29
  v_fma_f32 v38, v38, v16, v29
  v_fma_f32 v39, v39, v16, v29
  v_cvt_pk_bf16_f32 v32, v32, v33
  v_cvt_pk_bf16_f32 v33, v34, v35
  v_cvt_pk_bf16_f32 v34, v36, v37
  v_cvt_pk_bf16_f32 v35, v38, v39
  v_mfma_f32_16x16x32_bf16 a[48:51], a[224:227], v[48:51], a[48:51]
  s_waitcnt lgkmcnt(1)
  buffer_store_dwordx4 v[44:47], v148, s[20:23], s63 offen offset:0 nt
  v_mfma_f32_16x16x32_bf16 a[48:51], a[228:231], v[72:75], a[48:51]
  s_waitcnt lgkmcnt(0)
  ds_write_b128 v8, v[32:35] offset:16384
  v_mfma_f32_16x16x32_bf16 a[48:51], a[176:179], v[96:99], a[48:51]
  buffer_store_dwordx4 v[68:71], v149, s[20:23], s63 offen offset:1024 nt
  v_mfma_f32_16x16x32_bf16 a[48:51], a[180:183], v[120:123], a[48:51]
  v_accvgpr_read_b32 v40, a40
  v_accvgpr_read_b32 v41, a41
  v_mfma_f32_16x16x32_bf16 a[52:55], a[232:235], v[48:51], a[52:55]
  v_accvgpr_read_b32 v42, a42
  v_accvgpr_read_b32 v43, a43
  v_mfma_f32_16x16x32_bf16 a[52:55], a[236:239], v[72:75], a[52:55]
  buffer_store_dwordx4 v[92:95], v150, s[20:23], s63 offen offset:2048 nt
  v_mfma_f32_16x16x32_bf16 a[52:55], a[184:187], v[96:99], a[52:55]
  v_accvgpr_read_b32 v44, a44
  v_accvgpr_read_b32 v45, a45
  v_mfma_f32_16x16x32_bf16 a[52:55], a[188:191], v[120:123], a[52:55]
  v_accvgpr_read_b32 v46, a46
  v_accvgpr_read_b32 v47, a47
  v_mfma_f32_16x16x32_bf16 a[56:59], a[244:247], v[48:51], a[56:59]
  buffer_store_dwordx4 v[116:119], v151, s[20:23], s63 offen offset:3072 nt
  v_mfma_f32_16x16x32_bf16 a[56:59], a[248:251], v[72:75], a[56:59]
  s_add_u32 s63, s45, 110592
  v_fma_f32 v40, v40, v16, v29
  v_fma_f32 v41, v41, v16, v29
  v_mfma_f32_16x16x32_bf16 a[56:59], a[128:131], v[96:99], a[56:59]
  v_fma_f32 v42, v42, v16, v29
  v_fma_f32 v43, v43, v16, v29
  v_mfma_f32_16x16x32_bf16 a[56:59], a[132:135], v[120:123], a[56:59]
  v_fma_f32 v44, v44, v16, v29
  v_fma_f32 v45, v45, v16, v29
  v_mfma_f32_16x16x32_bf16 a[60:63], a[96:99], v[48:51], a[60:63]
  v_fma_f32 v46, v46, v16, v29
  v_fma_f32 v47, v47, v16, v29
  v_mfma_f32_16x16x32_bf16 a[60:63], a[100:103], v[72:75], a[60:63]
  v_cvt_pk_bf16_f32 v40, v40, v41
  v_cvt_pk_bf16_f32 v41, v42, v43
  v_mfma_f32_16x16x32_bf16 a[60:63], a[136:139], v[96:99], a[60:63]
  v_cvt_pk_bf16_f32 v42, v44, v45
  v_cvt_pk_bf16_f32 v43, v46, v47
  v_mfma_f32_16x16x32_bf16 a[60:63], a[140:143], v[120:123], a[60:63]
  ds_write_b128 v9, v[40:43] offset:16384
  v_accvgpr_read_b32 v32, a48
  v_accvgpr_read_b32 v33, a49
  v_accvgpr_read_b32 v34, a50
  v_accvgpr_read_b32 v35, a51
  v_accvgpr_read_b32 v36, a52
  v_accvgpr_read_b32 v37, a53
  v_accvgpr_read_b32 v38, a54
  v_accvgpr_read_b32 v39, a55
  v_fma_f32 v32, v32, v16, v29
  v_fma_f32 v33, v33, v16, v29
  v_fma_f32 v34, v34, v16, v29
  v_fma_f32 v35, v35, v16, v29
  v_fma_f32 v36, v36, v16, v29
  v_fma_f32 v37, v37, v16, v29
  v_fma_f32 v38, v38, v16, v29
  v_fma_f32 v39, v39, v16, v29
  v_cvt_pk_bf16_f32 v32, v32, v33
  v_cvt_pk_bf16_f32 v33, v34, v35
  v_cvt_pk_bf16_f32 v34, v36, v37
  v_cvt_pk_bf16_f32 v35, v38, v39
  v_mfma_f32_16x16x32_bf16 a[64:67], a[104:107], v[100:103], a[64:67]
  ds_write_b128 v10, v[32:35] offset:16384
  v_accvgpr_read_b32 v40, a56
  v_accvgpr_read_b32 v41, a57
  v_accvgpr_read_b32 v42, a58
  v_accvgpr_read_b32 v43, a59
  v_accvgpr_read_b32 v44, a60
  v_accvgpr_read_b32 v45, a61
  v_accvgpr_read_b32 v46, a62
  v_accvgpr_read_b32 v47, a63
  v_fma_f32 v40, v40, v16, v29
  v_fma_f32 v41, v41, v16, v29
  v_fma_f32 v42, v42, v16, v29
  v_fma_f32 v43, v43, v16, v29
  v_fma_f32 v44, v44, v16, v29
  v_fma_f32 v45, v45, v16, v29
  v_fma_f32 v46, v46, v16, v29
  v_fma_f32 v47, v47, v16, v29
  v_cvt_pk_bf16_f32 v40, v40, v41
  v_cvt_pk_bf16_f32 v41, v42, v43
  v_cvt_pk_bf16_f32 v42, v44, v45
  v_cvt_pk_bf16_f32 v43, v46, v47
  v_mfma_f32_16x16x32_bf16 a[64:67], a[108:111], v[124:127], a[64:67]
  ds_write_b128 v11, v[40:43] offset:16384
  v_mfma_f32_16x16x32_bf16 a[68:71], a[112:115], v[100:103], a[68:71]
  ds_read_b128 v[48:51], v4 offset:16384
  ds_read_b128 v[72:75], v4 offset:17408
  v_mfma_f32_16x16x32_bf16 a[68:71], a[116:119], v[124:127], a[68:71]
  ds_read_b128 v[96:99], v4 offset:18432
  ds_read_b128 v[120:123], v4 offset:19456
  v_mfma_f32_16x16x32_bf16 a[72:75], a[120:123], v[100:103], a[72:75]
  v_accvgpr_read_b32 v32, a64
  v_accvgpr_read_b32 v33, a65
  v_mfma_f32_16x16x32_bf16 a[72:75], a[124:127], v[124:127], a[72:75]
  v_accvgpr_read_b32 v34, a66
  v_accvgpr_read_b32 v35, a67
  v_mfma_f32_16x16x32_bf16 a[76:79], v[128:131], v[100:103], a[76:79]
  v_accvgpr_read_b32 v36, a68
  v_accvgpr_read_b32 v37, a69
  v_mfma_f32_16x16x32_bf16 a[76:79], v[132:135], v[124:127], a[76:79]
  v_accvgpr_read_b32 v38, a70
  v_accvgpr_read_b32 v39, a71
  v_fma_f32 v32, v32, v17, v31
  v_fma_f32 v33, v33, v17, v31
  v_fma_f32 v34, v34, v17, v31
  v_fma_f32 v35, v35, v17, v31
  v_fma_f32 v36, v36, v17, v31
  v_fma_f32 v37, v37, v17, v31
  v_fma_f32 v38, v38, v17, v31
  v_fma_f32 v39, v39, v17, v31
  v_cvt_pk_bf16_f32 v32, v32, v33
  v_cvt_pk_bf16_f32 v33, v34, v35
  v_cvt_pk_bf16_f32 v34, v36, v37
  v_cvt_pk_bf16_f32 v35, v38, v39
  v_mfma_f32_16x16x32_bf16 a[80:83], a[224:227], v[52:55], a[80:83]
  s_waitcnt lgkmcnt(1)
  buffer_store_dwordx4 v[48:51], v148, s[20:23], s63 offen offset:0 nt
  v_mfma_f32_16x16x32_bf16 a[80:83], a[228:231], v[76:79], a[80:83]
  s_waitcnt lgkmcnt(0)
  ds_write_b128 v8, v[32:35] offset:20480
  v_mfma_f32_16x16x32_bf16 a[80:83], a[176:179], v[100:103], a[80:83]
  buffer_store_dwordx4 v[72:75], v149, s[20:23], s63 offen offset:1024 nt
  v_mfma_f32_16x16x32_bf16 a[80:83], a[180:183], v[124:127], a[80:83]
  v_accvgpr_read_b32 v40, a72
  v_accvgpr_read_b32 v41, a73
  v_mfma_f32_16x16x32_bf16 a[84:87], a[232:235], v[52:55], a[84:87]
  v_accvgpr_read_b32 v42, a74
  v_accvgpr_read_b32 v43, a75
  v_mfma_f32_16x16x32_bf16 a[84:87], a[236:239], v[76:79], a[84:87]
  buffer_store_dwordx4 v[96:99], v150, s[20:23], s63 offen offset:2048 nt
  v_mfma_f32_16x16x32_bf16 a[84:87], a[184:187], v[100:103], a[84:87]
  v_accvgpr_read_b32 v44, a76
  v_accvgpr_read_b32 v45, a77
  v_mfma_f32_16x16x32_bf16 a[84:87], a[188:191], v[124:127], a[84:87]
  v_accvgpr_read_b32 v46, a78
  v_accvgpr_read_b32 v47, a79
  v_mfma_f32_16x16x32_bf16 a[88:91], a[244:247], v[52:55], a[88:91]
  buffer_store_dwordx4 v[120:123], v151, s[20:23], s63 offen offset:3072 nt
  v_mfma_f32_16x16x32_bf16 a[88:91], a[248:251], v[76:79], a[88:91]
  s_add_u32 s63, s45, 114688
  v_fma_f32 v40, v40, v17, v31
  v_fma_f32 v41, v41, v17, v31
  v_mfma_f32_16x16x32_bf16 a[88:91], a[128:131], v[100:103], a[88:91]
  v_fma_f32 v42, v42, v17, v31
  v_fma_f32 v43, v43, v17, v31
  v_mfma_f32_16x16x32_bf16 a[88:91], a[132:135], v[124:127], a[88:91]
  v_fma_f32 v44, v44, v17, v31
  v_fma_f32 v45, v45, v17, v31
  v_mfma_f32_16x16x32_bf16 a[92:95], a[96:99], v[52:55], a[92:95]
  v_fma_f32 v46, v46, v17, v31
  v_fma_f32 v47, v47, v17, v31
  v_mfma_f32_16x16x32_bf16 a[92:95], a[100:103], v[76:79], a[92:95]
  v_cvt_pk_bf16_f32 v40, v40, v41
  v_cvt_pk_bf16_f32 v41, v42, v43
  v_mfma_f32_16x16x32_bf16 a[92:95], a[136:139], v[100:103], a[92:95]
  v_cvt_pk_bf16_f32 v42, v44, v45
  v_cvt_pk_bf16_f32 v43, v46, v47
  v_mfma_f32_16x16x32_bf16 a[92:95], a[140:143], v[124:127], a[92:95]
  ds_write_b128 v9, v[40:43] offset:20480
  v_accvgpr_read_b32 v32, a80
  v_accvgpr_read_b32 v33, a81
  v_accvgpr_read_b32 v34, a82
  v_accvgpr_read_b32 v35, a83
  v_accvgpr_read_b32 v36, a84
  v_accvgpr_read_b32 v37, a85
  v_accvgpr_read_b32 v38, a86
  v_accvgpr_read_b32 v39, a87
  v_fma_f32 v32, v32, v17, v31
  v_fma_f32 v33, v33, v17, v31
  v_fma_f32 v34, v34, v17, v31
  v_fma_f32 v35, v35, v17, v31
  v_fma_f32 v36, v36, v17, v31
  v_fma_f32 v37, v37, v17, v31
  v_fma_f32 v38, v38, v17, v31
  v_fma_f32 v39, v39, v17, v31
  v_cvt_pk_bf16_f32 v32, v32, v33
  v_cvt_pk_bf16_f32 v33, v34, v35
  v_cvt_pk_bf16_f32 v34, v36, v37
  v_cvt_pk_bf16_f32 v35, v38, v39
  v_accvgpr_read_b32 v40, a88
  v_accvgpr_read_b32 v41, a89
  v_accvgpr_read_b32 v42, a90
  v_accvgpr_read_b32 v43, a91
  v_accvgpr_read_b32 v44, a92
  v_accvgpr_read_b32 v45, a93
  v_accvgpr_read_b32 v46, a94
  v_accvgpr_read_b32 v47, a95
  v_fma_f32 v40, v40, v17, v31
  v_fma_f32 v41, v41, v17, v31
  v_fma_f32 v42, v42, v17, v31
  v_fma_f32 v43, v43, v17, v31
  v_fma_f32 v44, v44, v17, v31
  v_fma_f32 v45, v45, v17, v31
  v_fma_f32 v46, v46, v17, v31
  v_fma_f32 v47, v47, v17, v31
  v_cvt_pk_bf16_f32 v40, v40, v41
  v_cvt_pk_bf16_f32 v41, v42, v43
  v_cvt_pk_bf16_f32 v42, v44, v45
  v_cvt_pk_bf16_f32 v43, v46, v47
  ds_write_b128 v10, v[32:35] offset:20480
  ds_write_b128 v11, v[40:43] offset:20480
  ds_read_b128 v[52:55], v4 offset:20480
  ds_read_b128 v[76:79], v4 offset:21504
  ds_read_b128 v[100:103], v4 offset:22528
  ds_read_b128 v[124:127], v4 offset:23552
  s_waitcnt lgkmcnt(3)
  buffer_store_dwordx4 v[52:55], v148, s[20:23], s63 offen offset:0 nt
  s_waitcnt lgkmcnt(2)
  buffer_store_dwordx4 v[76:79], v149, s[20:23], s63 offen offset:1024 nt
  s_waitcnt lgkmcnt(1)
  buffer_store_dwordx4 v[100:103], v150, s[20:23], s63 offen offset:2048 nt
  s_waitcnt lgkmcnt(0)
  buffer_store_dwordx4 v[124:127], v151, s[20:23], s63 offen offset:3072 nt
  s_branch DONE
PATH_5:
  s_add_u32 s20, s74, s63
  s_addc_u32 s21, s75, 0
  s_mov_b32 s22, 188416
  s_mov_b32 s23, 0x20000
  s_mov_b32 s24, s20
  s_mov_b32 s25, s21
  s_mov_b32 s26, 94208
  s_mov_b32 s27, 0x20000
  s_add_u32 s16, s12, 94208
  s_addc_u32 s17, s13, 0
  s_mov_b32 s18, 94208
  s_mov_b32 s19, 0x20000
  s_mov_b32 s48, 0xffff0000
  s_mov_b32 s46, 0x3e0293ee
  s_mov_b32 s47, 0x3e0293ee
  s_mov_b32 s49, 0x44800000
  v_lshl_add_u32 v8, v12, 8, v14
  v_add_u32 v8, s45, v8
  v_xor_b32 v9, 64, v8
  v_xor_b32 v10, 0x80, v8
  v_xor_b32 v11, 0xc0, v8
  v_and_b32 v15, 7, v0
  v_mul_u32_u24 v15, 1056, v15
  v_bfe_u32 v16, v0, 3, 1
  v_lshl_add_u32 v15, v16, 9, v15
  v_lshl_add_u32 v15, v13, 4, v15
  v_add_u32 v2, 94208, v15
  v_bfe_u32 v15, v0, 3, 2
  v_mul_u32_u24 v15, 2112, v15
  v_bfe_u32 v16, v0, 2, 1
  v_mul_u32_u24 v16, 1032, v16
  v_lshrrev_b32 v17, 5, v0
  v_lshl_add_u32 v15, v17, 9, v15
  v_and_b32 v18, 3, v0
  v_lshl_add_u32 v16, v18, 4, v16
  v_add_u32 v15, v15, v16
  v_add_u32 v3, 128000, v15
  v_bfe_u32 v16, v0, 1, 1
  v_mov_b32 v19, 0x3f803f80
  v_cmp_eq_u32 vcc, v16, v17
  s_nop 1
  v_cndmask_b32 v19, 0, v19, vcc
  v_and_b32 v16, 1, v0
  v_mul_u32_u24 v16, 0xaaaa, v16
  v_add_u32 v5, 0x4444, v16
  v_accvgpr_write_b32 a240, v19
  v_accvgpr_write_b32 a244, 0
  v_accvgpr_write_b32 a241, v19
  v_accvgpr_write_b32 a245, 0
  v_accvgpr_write_b32 a242, v19
  v_accvgpr_write_b32 a246, 0
  v_accvgpr_write_b32 a243, v19
  v_accvgpr_write_b32 a247, 0
  s_mov_b32 s81, 0xc1980000
  s_add_u32 s51, s45, 20480
  s_add_u32 s50, s45, 8192
  s_mov_b32 s65, 5
  s_mov_b32 s39, 7
  s_mov_b32 s61, 0
  v_lshl_add_u32 v4, v0, 2, s50
  s_mov_b32 s34, -8192
  s_mov_b32 s33, 65536
  v_add_u32 v72, 0x1000, v1
  s_mov_b32 s30, -4096
  s_mov_b32 s31, 20480
  s_mov_b32 s32, 45056
  s_mov_b32 s67, 0x8000
  s_xor_b32 s90, s67, s66
  v_mfma_f32_32x32x16_bf16 v[16:31], a[244:247], a[244:247], 0
  s_waitcnt vmcnt(12)
  v_max3_f16 v56, |v224|, |v228|, |v232| op_sel:[0,0,0,0]
  v_max3_f16 v57, |v224|, |v228|, |v232| op_sel:[1,1,1,0]
  v_max3_f16 v58, |v225|, |v229|, |v233| op_sel:[0,0,0,0]
  v_max3_f16 v59, |v225|, |v229|, |v233| op_sel:[1,1,1,0]
  v_max3_f16 v60, |v226|, |v230|, |v234| op_sel:[0,0,0,0]
  v_max3_f16 v61, |v226|, |v230|, |v234| op_sel:[1,1,1,0]
  v_max3_f16 v62, |v227|, |v231|, |v235| op_sel:[0,0,0,0]
  v_max3_f16 v63, |v227|, |v231|, |v235| op_sel:[1,1,1,0]
  s_waitcnt vmcnt(10)
  v_max3_f16 v56, v56, |v236|, |v240| op_sel:[0,0,0,0]
  v_max3_f16 v57, v57, |v236|, |v240| op_sel:[0,1,1,0]
  v_max3_f16 v58, v58, |v237|, |v241| op_sel:[0,0,0,0]
  v_max3_f16 v59, v59, |v237|, |v241| op_sel:[0,1,1,0]
  v_max3_f16 v60, v60, |v238|, |v242| op_sel:[0,0,0,0]
  v_max3_f16 v61, v61, |v238|, |v242| op_sel:[0,1,1,0]
  v_max3_f16 v62, v62, |v239|, |v243| op_sel:[0,0,0,0]
  v_max3_f16 v63, v63, |v239|, |v243| op_sel:[0,1,1,0]
  v_min3_f16 v56, v56, v57, v58
  v_min3_f16 v59, v59, v60, v61
  v_min3_f16 v56, v56, v62, v63
  s_nop 0
  v_min_f16 v56, v56, v59
  s_nop 0
  v_and_b32 v56, 0x7f80, v56
  s_nop 1
  v_min_u32_dpp v56, v56, v56 row_ror:8 row_mask:0xf bank_mask:0xf
  s_nop 1
  v_min_u32_dpp v56, v56, v56 row_ror:4 row_mask:0xf bank_mask:0xf
  s_nop 1
  v_min_u32_dpp v56, v56, v56 row_ror:2 row_mask:0xf bank_mask:0xf
  s_nop 1
  v_min_u32_dpp v56, v56, v56 row_ror:1 row_mask:0xf bank_mask:0xf
  s_nop 0
  v_readlane_b32 s82, v56, 0
  v_readlane_b32 s88, v56, 16
  v_readlane_b32 s83, v56, 32
  v_readlane_b32 s89, v56, 48
  s_min_u32 s88, s88, s82
  s_sub_u32 s88, s88, 1877
  s_lshl_b32 s82, s88, 16
  s_add_u32 s82, s82, 0x81800000
  s_cmp_ge_i32 s88, 0x80
  s_cselect_b32 s88, s88, 0
  s_cselect_b32 s82, s82, 0
  s_pack_ll_b32_b16 s88, s88, s88
  s_min_u32 s89, s89, s83
  s_sub_u32 s89, s89, 1877
  s_lshl_b32 s83, s89, 16
  s_add_u32 s83, s83, 0x81800000
  s_cmp_ge_i32 s89, 0x80
  s_cselect_b32 s89, s89, 0
  s_cselect_b32 s83, s83, 0
  s_pack_ll_b32_b16 s89, s89, s89
  v_accvgpr_write_b32 a248, s88
  v_accvgpr_write_b32 a249, s88
  v_accvgpr_write_b32 a250, s88
  v_accvgpr_write_b32 a251, s88
  s_waitcnt vmcnt(8)
  s_barrier
  ds_read_b128 a[192:195], v2 offset:0
  ds_read_b128 a[196:199], v2 offset:64
  ds_read_b128 a[200:203], v2 offset:128
  ds_read_b128 a[204:207], v2 offset:192
  ds_read_b128 a[208:211], v2 offset:256
  ds_read_b128 a[212:215], v2 offset:320
  ds_read_b128 a[216:219], v2 offset:384
  ds_read_b128 a[220:223], v2 offset:448
  s_waitcnt vmcnt(4)
  ds_read_b128 v[160:163], v8 offset:0
  ds_read_b128 v[164:167], v9 offset:0
  ds_read_b128 v[168:171], v10 offset:0
  ds_read_b128 v[172:175], v11 offset:0
  v_mfma_f32_32x32x16_bf16 v[208:223], a[240:243], a[248:251], 0
  s_add_u32 m0, s45, 8192
  s_nop 0
  buffer_load_dwordx4 v148, s[12:15], m0 offen offset:0 nt lds
  buffer_load_dwordx4 v149, s[12:15], m0 offen offset:1024 nt lds
  buffer_load_dwordx4 v150, s[12:15], m0 offen offset:2048 nt lds
  buffer_load_dwordx4 v151, s[12:15], m0 offen offset:3072 nt lds
  v_mfma_f32_32x32x16_bf16 v[224:239], a[240:243], a[248:251], 0
  s_add_u32 m0, s45, 12288
  s_nop 0
  buffer_load_dwordx4 v148, s[12:15], m0 offen offset:0 nt lds
  buffer_load_dwordx4 v149, s[12:15], m0 offen offset:1024 nt lds
  buffer_load_dwordx4 v150, s[12:15], m0 offen offset:2048 nt lds
  buffer_load_dwordx4 v151, s[12:15], m0 offen offset:3072 nt lds
  ds_read_b128 v[80:83], v2 offset:8448
  ds_read_b128 v[84:87], v2 offset:8512
  ds_read_b128 v[88:91], v2 offset:8576
  ds_read_b128 v[92:95], v2 offset:8640
  ds_read_b128 v[96:99], v2 offset:8704
  ds_read_b128 v[100:103], v2 offset:8768
  ds_read_b128 v[104:107], v2 offset:8832
  ds_read_b128 v[108:111], v2 offset:8896
  s_waitcnt lgkmcnt(11)
  v_lshlrev_b32 v192, 16, v160
  v_and_b32 v193, s48, v160
  v_lshlrev_b32 v194, 16, v161
  v_and_b32 v195, s48, v161
  v_lshlrev_b32 v196, 16, v162
  v_and_b32 v197, s48, v162
  v_lshlrev_b32 v198, 16, v163
  v_and_b32 v199, s48, v163
  v_pk_mul_f32 v[192:193], v[192:193], s[46:47]
  v_pk_mul_f32 v[194:195], v[194:195], s[46:47]
  v_pk_mul_f32 v[196:197], v[196:197], s[46:47]
  v_pk_mul_f32 v[198:199], v[198:199], s[46:47]
  v_cvt_pk_bf16_f32 v160, v192, v193
  v_cvt_pk_bf16_f32 v161, v194, v195
  v_cvt_pk_bf16_f32 v162, v196, v197
  v_cvt_pk_bf16_f32 v163, v198, v199
  v_accvgpr_write_b32 a96, v160
  v_accvgpr_write_b32 a97, v161
  v_accvgpr_write_b32 a98, v162
  v_accvgpr_write_b32 a99, v163
  s_waitcnt lgkmcnt(10)
  v_lshlrev_b32 v200, 16, v164
  v_and_b32 v201, s48, v164
  v_lshlrev_b32 v202, 16, v165
  v_and_b32 v203, s48, v165
  v_lshlrev_b32 v204, 16, v166
  v_and_b32 v205, s48, v166
  v_lshlrev_b32 v206, 16, v167
  v_and_b32 v207, s48, v167
  v_pk_mul_f32 v[200:201], v[200:201], s[46:47]
  v_pk_mul_f32 v[202:203], v[202:203], s[46:47]
  v_pk_mul_f32 v[204:205], v[204:205], s[46:47]
  v_pk_mul_f32 v[206:207], v[206:207], s[46:47]
  v_cvt_pk_bf16_f32 v164, v200, v201
  v_cvt_pk_bf16_f32 v165, v202, v203
  v_cvt_pk_bf16_f32 v166, v204, v205
  v_cvt_pk_bf16_f32 v167, v206, v207
  v_accvgpr_write_b32 a100, v164
  v_accvgpr_write_b32 a101, v165
  v_accvgpr_write_b32 a102, v166
  v_accvgpr_write_b32 a103, v167
  s_waitcnt lgkmcnt(9)
  v_lshlrev_b32 v192, 16, v168
  v_and_b32 v193, s48, v168
  v_lshlrev_b32 v194, 16, v169
  v_and_b32 v195, s48, v169
  v_lshlrev_b32 v196, 16, v170
  v_and_b32 v197, s48, v170
  v_lshlrev_b32 v198, 16, v171
  v_and_b32 v199, s48, v171
  v_pk_mul_f32 v[192:193], v[192:193], s[46:47]
  v_pk_mul_f32 v[194:195], v[194:195], s[46:47]
  v_pk_mul_f32 v[196:197], v[196:197], s[46:47]
  v_pk_mul_f32 v[198:199], v[198:199], s[46:47]
  v_cvt_pk_bf16_f32 v168, v192, v193
  v_cvt_pk_bf16_f32 v169, v194, v195
  v_cvt_pk_bf16_f32 v170, v196, v197
  v_cvt_pk_bf16_f32 v171, v198, v199
  v_accvgpr_write_b32 a104, v168
  v_accvgpr_write_b32 a105, v169
  v_accvgpr_write_b32 a106, v170
  v_accvgpr_write_b32 a107, v171
  s_waitcnt lgkmcnt(8)
  v_lshlrev_b32 v200, 16, v172
  v_and_b32 v201, s48, v172
  v_lshlrev_b32 v202, 16, v173
  v_and_b32 v203, s48, v173
  v_lshlrev_b32 v204, 16, v174
  v_and_b32 v205, s48, v174
  v_lshlrev_b32 v206, 16, v175
  v_and_b32 v207, s48, v175
  v_pk_mul_f32 v[200:201], v[200:201], s[46:47]
  v_pk_mul_f32 v[202:203], v[202:203], s[46:47]
  v_pk_mul_f32 v[204:205], v[204:205], s[46:47]
  v_pk_mul_f32 v[206:207], v[206:207], s[46:47]
  v_cvt_pk_bf16_f32 v172, v200, v201
  v_cvt_pk_bf16_f32 v173, v202, v203
  v_cvt_pk_bf16_f32 v174, v204, v205
  v_cvt_pk_bf16_f32 v175, v206, v207
  v_accvgpr_write_b32 a108, v172
  v_accvgpr_write_b32 a109, v173
  v_accvgpr_write_b32 a110, v174
  v_accvgpr_write_b32 a111, v175
  v_mfma_f32_16x16x32_bf16 v[152:155], a[192:195], a[96:99], 0
  s_waitcnt lgkmcnt(0)
  v_mfma_f32_16x16x32_bf16 v[152:155], a[196:199], a[100:103], v[152:155]
  v_mfma_f32_16x16x32_bf16 v[152:155], a[200:203], a[104:107], v[152:155]
  v_mfma_f32_16x16x32_bf16 v[152:155], a[204:207], a[108:111], v[152:155]
  s_nop 7
  v_max3_f32 v18, v152, v153, v154
  v_max_f32 v18, v18, v155
  v_mov_b32 v19, v18
  s_nop 1
  v_permlane32_swap_b32 v18, v19
  v_max_f32 v18, v18, v19
  v_mov_b32 v19, v18
  s_nop 1
  v_permlane16_swap_b32 v18, v19
  v_max_f32 v18, v18, v19
  v_sub_f32 v128, s81, v18
  v_sub_f32 v129, s81, v18
  v_sub_f32 v130, s81, v18
  v_sub_f32 v131, s81, v18
  v_add_f32 v152, v152, v128
  v_add_f32 v153, v153, v128
  v_mfma_f32_16x16x32_bf16 v[156:159], a[208:211], a[96:99], v[128:131]
  v_add_f32 v154, v154, v128
  v_add_f32 v155, v155, v128
  v_mfma_f32_16x16x32_bf16 v[156:159], a[212:215], a[100:103], v[156:159]
  v_exp_f32 v152, v152
  v_mfma_f32_16x16x32_bf16 v[156:159], a[216:219], a[104:107], v[156:159]
  v_exp_f32 v153, v153
  v_mfma_f32_16x16x32_bf16 v[156:159], a[220:223], a[108:111], v[156:159]
  v_exp_f32 v154, v154
  v_mfma_f32_16x16x32_bf16 v[112:115], v[80:83], a[96:99], v[128:131]
  v_exp_f32 v155, v155
  v_mfma_f32_16x16x32_bf16 v[112:115], v[84:87], a[100:103], v[112:115]
  v_cvt_pk_bf16_f32 v32, v152, v153
  v_cvt_pk_bf16_f32 v33, v154, v155
  v_mfma_f32_16x16x32_bf16 v[112:115], v[88:91], a[104:107], v[112:115]
  v_mfma_f32_16x16x32_bf16 v[112:115], v[92:95], a[108:111], v[112:115]
  v_exp_f32 v156, v156
  v_mfma_f32_16x16x32_bf16 v[116:119], v[96:99], a[96:99], v[128:131]
  v_exp_f32 v157, v157
  v_mfma_f32_16x16x32_bf16 v[116:119], v[100:103], a[100:103], v[116:119]
  v_exp_f32 v158, v158
  v_mfma_f32_16x16x32_bf16 v[116:119], v[104:107], a[104:107], v[116:119]
  v_exp_f32 v159, v159
  v_mfma_f32_16x16x32_bf16 v[116:119], v[108:111], a[108:111], v[116:119]
  v_cvt_pk_bf16_f32 v34, v156, v157
  v_cvt_pk_bf16_f32 v35, v158, v159
  s_waitcnt vmcnt(8)
  ds_read_b128 v[176:179], v8 offset:4096
  ds_read_b128 v[180:183], v9 offset:4096
  ds_read_b128 v[184:187], v10 offset:4096
  ds_read_b128 v[188:191], v11 offset:4096
  v_mfma_f32_32x32x16_bf16 v[240:255], a[240:243], a[248:251], 0
  s_add_u32 m0, s45, 16384
  s_nop 0
  buffer_load_dwordx4 v148, s[12:15], m0 offen offset:0 nt lds
  buffer_load_dwordx4 v149, s[12:15], m0 offen offset:1024 nt lds
  v_exp_f32 v112, v112
  v_mfma_f32_32x32x16_bf16 a[0:15], a[240:243], a[248:251], 0
  buffer_load_dwordx4 v150, s[12:15], m0 offen offset:2048 nt lds
  buffer_load_dwordx4 v151, s[12:15], m0 offen offset:3072 nt lds
  v_exp_f32 v113, v113
  v_exp_f32 v114, v114
  v_exp_f32 v115, v115
  v_cvt_pk_bf16_f32 v56, v112, v113
  v_cvt_pk_bf16_f32 v57, v114, v115
  v_exp_f32 v116, v116
  v_exp_f32 v117, v117
  v_exp_f32 v118, v118
  v_exp_f32 v119, v119
  v_cvt_pk_bf16_f32 v58, v116, v117
  v_cvt_pk_bf16_f32 v59, v118, v119
  s_waitcnt lgkmcnt(3)
  v_lshlrev_b32 v192, 16, v176
  v_and_b32 v193, s48, v176
  v_lshlrev_b32 v194, 16, v177
  v_and_b32 v195, s48, v177
  v_lshlrev_b32 v196, 16, v178
  v_and_b32 v197, s48, v178
  v_lshlrev_b32 v198, 16, v179
  v_and_b32 v199, s48, v179
  v_pk_mul_f32 v[192:193], v[192:193], s[46:47]
  v_pk_mul_f32 v[194:195], v[194:195], s[46:47]
  v_pk_mul_f32 v[196:197], v[196:197], s[46:47]
  v_pk_mul_f32 v[198:199], v[198:199], s[46:47]
  v_cvt_pk_bf16_f32 v176, v192, v193
  v_cvt_pk_bf16_f32 v177, v194, v195
  v_cvt_pk_bf16_f32 v178, v196, v197
  v_cvt_pk_bf16_f32 v179, v198, v199
  v_accvgpr_write_b32 a112, v176
  v_accvgpr_write_b32 a113, v177
  v_accvgpr_write_b32 a114, v178
  v_accvgpr_write_b32 a115, v179
  s_waitcnt lgkmcnt(2)
  v_lshlrev_b32 v200, 16, v180
  v_and_b32 v201, s48, v180
  v_lshlrev_b32 v202, 16, v181
  v_and_b32 v203, s48, v181
  v_lshlrev_b32 v204, 16, v182
  v_and_b32 v205, s48, v182
  v_lshlrev_b32 v206, 16, v183
  v_and_b32 v207, s48, v183
  v_pk_mul_f32 v[200:201], v[200:201], s[46:47]
  v_pk_mul_f32 v[202:203], v[202:203], s[46:47]
  v_pk_mul_f32 v[204:205], v[204:205], s[46:47]
  v_pk_mul_f32 v[206:207], v[206:207], s[46:47]
  v_cvt_pk_bf16_f32 v180, v200, v201
  v_cvt_pk_bf16_f32 v181, v202, v203
  v_cvt_pk_bf16_f32 v182, v204, v205
  v_cvt_pk_bf16_f32 v183, v206, v207
  v_accvgpr_write_b32 a116, v180
  v_accvgpr_write_b32 a117, v181
  v_accvgpr_write_b32 a118, v182
  v_accvgpr_write_b32 a119, v183
  s_waitcnt lgkmcnt(1)
  v_lshlrev_b32 v192, 16, v184
  v_and_b32 v193, s48, v184
  v_lshlrev_b32 v194, 16, v185
  v_and_b32 v195, s48, v185
  v_lshlrev_b32 v196, 16, v186
  v_and_b32 v197, s48, v186
  v_lshlrev_b32 v198, 16, v187
  v_and_b32 v199, s48, v187
  v_pk_mul_f32 v[192:193], v[192:193], s[46:47]
  v_pk_mul_f32 v[194:195], v[194:195], s[46:47]
  v_pk_mul_f32 v[196:197], v[196:197], s[46:47]
  v_pk_mul_f32 v[198:199], v[198:199], s[46:47]
  v_cvt_pk_bf16_f32 v184, v192, v193
  v_cvt_pk_bf16_f32 v185, v194, v195
  v_cvt_pk_bf16_f32 v186, v196, v197
  v_cvt_pk_bf16_f32 v187, v198, v199
  v_accvgpr_write_b32 a120, v184
  v_accvgpr_write_b32 a121, v185
  v_accvgpr_write_b32 a122, v186
  v_accvgpr_write_b32 a123, v187
  s_waitcnt lgkmcnt(0)
  v_lshlrev_b32 v200, 16, v188
  v_and_b32 v201, s48, v188
  v_lshlrev_b32 v202, 16, v189
  v_and_b32 v203, s48, v189
  v_lshlrev_b32 v204, 16, v190
  v_and_b32 v205, s48, v190
  v_lshlrev_b32 v206, 16, v191
  v_and_b32 v207, s48, v191
  v_pk_mul_f32 v[200:201], v[200:201], s[46:47]
  v_pk_mul_f32 v[202:203], v[202:203], s[46:47]
  v_pk_mul_f32 v[204:205], v[204:205], s[46:47]
  v_pk_mul_f32 v[206:207], v[206:207], s[46:47]
  v_cvt_pk_bf16_f32 v188, v200, v201
  v_cvt_pk_bf16_f32 v189, v202, v203
  v_cvt_pk_bf16_f32 v190, v204, v205
  v_cvt_pk_bf16_f32 v191, v206, v207
  v_accvgpr_write_b32 a124, v188
  v_accvgpr_write_b32 a125, v189
  v_accvgpr_write_b32 a126, v190
  v_accvgpr_write_b32 a127, v191
  v_mfma_f32_16x16x32_bf16 v[120:123], a[192:195], a[112:115], 0
  v_mfma_f32_16x16x32_bf16 v[120:123], a[196:199], a[116:119], v[120:123]
  v_mfma_f32_16x16x32_bf16 v[120:123], a[200:203], a[120:123], v[120:123]
  v_mfma_f32_16x16x32_bf16 v[120:123], a[204:207], a[124:127], v[120:123]
  s_nop 7
  v_max3_f32 v6, v120, v121, v122
  v_max_f32 v6, v6, v123
  v_mov_b32 v7, v6
  s_nop 1
  v_permlane32_swap_b32 v6, v7
  v_max_f32 v6, v6, v7
  v_mov_b32 v7, v6
  s_nop 1
  v_permlane16_swap_b32 v6, v7
  v_max_f32 v6, v6, v7
  v_sub_f32 v132, s81, v6
  v_sub_f32 v133, s81, v6
  v_sub_f32 v134, s81, v6
  v_sub_f32 v135, s81, v6
  v_add_f32 v120, v120, v132
  v_add_f32 v121, v121, v132
  v_mfma_f32_16x16x32_bf16 v[124:127], a[208:211], a[112:115], v[132:135]
  v_add_f32 v122, v122, v132
  v_add_f32 v123, v123, v132
  v_mfma_f32_16x16x32_bf16 v[124:127], a[212:215], a[116:119], v[124:127]
  v_exp_f32 v120, v120
  v_mfma_f32_16x16x32_bf16 v[124:127], a[216:219], a[120:123], v[124:127]
  v_exp_f32 v121, v121
  v_mfma_f32_16x16x32_bf16 v[124:127], a[220:223], a[124:127], v[124:127]
  v_exp_f32 v122, v122
  v_mfma_f32_16x16x32_bf16 v[152:155], v[80:83], a[112:115], v[132:135]
  v_exp_f32 v123, v123
  v_mfma_f32_16x16x32_bf16 v[152:155], v[84:87], a[116:119], v[152:155]
  v_cvt_pk_bf16_f32 v36, v120, v121
  v_cvt_pk_bf16_f32 v37, v122, v123
  v_mfma_f32_16x16x32_bf16 v[152:155], v[88:91], a[120:123], v[152:155]
  v_mfma_f32_16x16x32_bf16 v[152:155], v[92:95], a[124:127], v[152:155]
  v_exp_f32 v124, v124
  v_mfma_f32_16x16x32_bf16 v[156:159], v[96:99], a[112:115], v[132:135]
  v_exp_f32 v125, v125
  v_mfma_f32_16x16x32_bf16 v[156:159], v[100:103], a[116:119], v[156:159]
  v_exp_f32 v126, v126
  v_mfma_f32_16x16x32_bf16 v[156:159], v[104:107], a[120:123], v[156:159]
  v_exp_f32 v127, v127
  v_mfma_f32_16x16x32_bf16 v[156:159], v[108:111], a[124:127], v[156:159]
  v_cvt_pk_bf16_f32 v38, v124, v125
  v_cvt_pk_bf16_f32 v39, v126, v127
  s_waitcnt vmcnt(8)
  ds_read_b128 v[160:163], v8 offset:8192
  ds_read_b128 v[164:167], v9 offset:8192
  ds_read_b128 v[168:171], v10 offset:8192
  ds_read_b128 v[172:175], v11 offset:8192
  v_exp_f32 v152, v152
  v_exp_f32 v153, v153
  v_exp_f32 v154, v154
  v_exp_f32 v155, v155
  v_cvt_pk_bf16_f32 v60, v152, v153
  v_cvt_pk_bf16_f32 v61, v154, v155
  v_exp_f32 v156, v156
  v_exp_f32 v157, v157
  v_exp_f32 v158, v158
  v_exp_f32 v159, v159
  v_cvt_pk_bf16_f32 v62, v156, v157
  v_cvt_pk_bf16_f32 v63, v158, v159
  v_mfma_f32_32x32x16_bf16 a[16:31], a[240:243], a[248:251], 0
  s_xor_b32 s28, s29, 0x4000
  s_add_u32 m0, s64, 111104
  s_nop 0
  buffer_load_dwordx4 v1, s[4:7], s28 offen offset:0 nt lds
  s_add_u32 m0, s64, 111136
  s_nop 0
  buffer_load_dwordx4 v1, s[4:7], s28 offen offset:1024 nt lds
  v_mfma_f32_32x32x16_bf16 a[32:47], a[240:243], a[248:251], 0
  s_waitcnt lgkmcnt(1)
  s_add_u32 m0, s64, 128000
  s_nop 0
  buffer_load_dwordx4 v1, s[8:11], s29 offen offset:0 nt lds
  s_add_u32 m0, s64, 128008
  s_nop 0
  buffer_load_dwordx4 v1, s[8:11], s29 offen offset:1024 nt lds
  v_lshlrev_b32 v192, 16, v160
  v_and_b32 v193, s48, v160
  v_lshlrev_b32 v194, 16, v161
  v_and_b32 v195, s48, v161
  v_lshlrev_b32 v196, 16, v162
  v_and_b32 v197, s48, v162
  v_lshlrev_b32 v198, 16, v163
  v_and_b32 v199, s48, v163
  v_pk_mul_f32 v[192:193], v[192:193], s[46:47]
  v_pk_mul_f32 v[194:195], v[194:195], s[46:47]
  v_pk_mul_f32 v[196:197], v[196:197], s[46:47]
  v_pk_mul_f32 v[198:199], v[198:199], s[46:47]
  v_cvt_pk_bf16_f32 v160, v192, v193
  v_cvt_pk_bf16_f32 v161, v194, v195
  v_cvt_pk_bf16_f32 v162, v196, v197
  v_cvt_pk_bf16_f32 v163, v198, v199
  v_accvgpr_write_b32 a128, v160
  v_accvgpr_write_b32 a129, v161
  v_accvgpr_write_b32 a130, v162
  v_accvgpr_write_b32 a131, v163
  v_lshlrev_b32 v200, 16, v164
  v_and_b32 v201, s48, v164
  v_lshlrev_b32 v202, 16, v165
  v_and_b32 v203, s48, v165
  v_lshlrev_b32 v204, 16, v166
  v_and_b32 v205, s48, v166
  v_lshlrev_b32 v206, 16, v167
  v_and_b32 v207, s48, v167
  v_pk_mul_f32 v[200:201], v[200:201], s[46:47]
  v_pk_mul_f32 v[202:203], v[202:203], s[46:47]
  v_pk_mul_f32 v[204:205], v[204:205], s[46:47]
  v_pk_mul_f32 v[206:207], v[206:207], s[46:47]
  v_cvt_pk_bf16_f32 v164, v200, v201
  v_cvt_pk_bf16_f32 v165, v202, v203
  v_cvt_pk_bf16_f32 v166, v204, v205
  v_cvt_pk_bf16_f32 v167, v206, v207
  v_accvgpr_write_b32 a132, v164
  v_accvgpr_write_b32 a133, v165
  v_accvgpr_write_b32 a134, v166
  v_accvgpr_write_b32 a135, v167
  v_lshlrev_b32 v192, 16, v168
  v_and_b32 v193, s48, v168
  v_lshlrev_b32 v194, 16, v169
  v_and_b32 v195, s48, v169
  v_lshlrev_b32 v196, 16, v170
  v_and_b32 v197, s48, v170
  v_lshlrev_b32 v198, 16, v171
  v_and_b32 v199, s48, v171
  v_pk_mul_f32 v[192:193], v[192:193], s[46:47]
  v_pk_mul_f32 v[194:195], v[194:195], s[46:47]
  v_pk_mul_f32 v[196:197], v[196:197], s[46:47]
  v_pk_mul_f32 v[198:199], v[198:199], s[46:47]
  v_cvt_pk_bf16_f32 v168, v192, v193
  v_cvt_pk_bf16_f32 v169, v194, v195
  v_cvt_pk_bf16_f32 v170, v196, v197
  v_cvt_pk_bf16_f32 v171, v198, v199
  v_accvgpr_write_b32 a136, v168
  v_accvgpr_write_b32 a137, v169
  v_accvgpr_write_b32 a138, v170
  v_accvgpr_write_b32 a139, v171
  s_waitcnt lgkmcnt(0)
  v_lshlrev_b32 v200, 16, v172
  v_and_b32 v201, s48, v172
  v_lshlrev_b32 v202, 16, v173
  v_and_b32 v203, s48, v173
  v_lshlrev_b32 v204, 16, v174
  v_and_b32 v205, s48, v174
  v_lshlrev_b32 v206, 16, v175
  v_and_b32 v207, s48, v175
  v_pk_mul_f32 v[200:201], v[200:201], s[46:47]
  v_pk_mul_f32 v[202:203], v[202:203], s[46:47]
  v_pk_mul_f32 v[204:205], v[204:205], s[46:47]
  v_pk_mul_f32 v[206:207], v[206:207], s[46:47]
  v_cvt_pk_bf16_f32 v172, v200, v201
  v_cvt_pk_bf16_f32 v173, v202, v203
  v_cvt_pk_bf16_f32 v174, v204, v205
  v_cvt_pk_bf16_f32 v175, v206, v207
  v_accvgpr_write_b32 a140, v172
  v_accvgpr_write_b32 a141, v173
  v_accvgpr_write_b32 a142, v174
  v_accvgpr_write_b32 a143, v175
  v_mfma_f32_16x16x32_bf16 v[112:115], a[192:195], a[128:131], 0
  v_mfma_f32_16x16x32_bf16 v[112:115], a[196:199], a[132:135], v[112:115]
  v_mfma_f32_16x16x32_bf16 v[112:115], a[200:203], a[136:139], v[112:115]
  v_mfma_f32_16x16x32_bf16 v[112:115], a[204:207], a[140:143], v[112:115]
  s_nop 7
  v_max3_f32 v18, v112, v113, v114
  v_max_f32 v18, v18, v115
  v_mov_b32 v19, v18
  s_nop 1
  v_permlane32_swap_b32 v18, v19
  v_max_f32 v18, v18, v19
  v_mov_b32 v19, v18
  s_nop 1
  v_permlane16_swap_b32 v18, v19
  v_max_f32 v18, v18, v19
  v_sub_f32 v136, s81, v18
  v_sub_f32 v137, s81, v18
  v_sub_f32 v138, s81, v18
  v_sub_f32 v139, s81, v18
  v_add_f32 v112, v112, v136
  v_add_f32 v113, v113, v136
  v_mfma_f32_16x16x32_bf16 v[116:119], a[208:211], a[128:131], v[136:139]
  v_add_f32 v114, v114, v136
  v_add_f32 v115, v115, v136
  v_mfma_f32_16x16x32_bf16 v[116:119], a[212:215], a[132:135], v[116:119]
  v_exp_f32 v112, v112
  v_mfma_f32_16x16x32_bf16 v[116:119], a[216:219], a[136:139], v[116:119]
  v_exp_f32 v113, v113
  v_mfma_f32_16x16x32_bf16 v[116:119], a[220:223], a[140:143], v[116:119]
  v_exp_f32 v114, v114
  v_mfma_f32_16x16x32_bf16 v[120:123], v[80:83], a[128:131], v[136:139]
  v_exp_f32 v115, v115
  v_mfma_f32_16x16x32_bf16 v[120:123], v[84:87], a[132:135], v[120:123]
  v_cvt_pk_bf16_f32 v40, v112, v113
  v_cvt_pk_bf16_f32 v41, v114, v115
  v_mfma_f32_16x16x32_bf16 v[120:123], v[88:91], a[136:139], v[120:123]
  v_mfma_f32_16x16x32_bf16 v[120:123], v[92:95], a[140:143], v[120:123]
  v_exp_f32 v116, v116
  v_mfma_f32_16x16x32_bf16 v[124:127], v[96:99], a[128:131], v[136:139]
  v_exp_f32 v117, v117
  v_mfma_f32_16x16x32_bf16 v[124:127], v[100:103], a[132:135], v[124:127]
  v_exp_f32 v118, v118
  v_mfma_f32_16x16x32_bf16 v[124:127], v[104:107], a[136:139], v[124:127]
  v_exp_f32 v119, v119
  v_mfma_f32_16x16x32_bf16 v[124:127], v[108:111], a[140:143], v[124:127]
  v_cvt_pk_bf16_f32 v42, v116, v117
  v_cvt_pk_bf16_f32 v43, v118, v119
  s_waitcnt vmcnt(8)
  ds_read_b128 v[176:179], v8 offset:12288
  ds_read_b128 v[180:183], v9 offset:12288
  ds_read_b128 v[184:187], v10 offset:12288
  ds_read_b128 v[188:191], v11 offset:12288
  s_xor_b32 s28, s66, 8192
  s_mov_b32 m0, 136448
  s_nop 0
  buffer_load_dwordx4 v1, s[8:11], s28 offen offset:0 nt lds
  s_mov_b32 m0, 136456
  s_nop 0
  buffer_load_dwordx4 v1, s[8:11], s28 offen offset:1024 nt lds
  s_mov_b32 m0, 136512
  s_nop 0
  buffer_load_dwordx4 v1, s[8:11], s28 offen offset:2048 nt lds
  s_mov_b32 m0, 136520
  s_nop 0
  buffer_load_dwordx4 v1, s[8:11], s28 offen offset:3072 nt lds
  s_mov_b32 m0, 140672
  s_nop 0
  buffer_load_dwordx4 v72, s[8:11], s28 offen offset:0 nt lds
  s_mov_b32 m0, 140680
  s_nop 0
  buffer_load_dwordx4 v72, s[8:11], s28 offen offset:1024 nt lds
  s_mov_b32 m0, 140736
  s_nop 0
  buffer_load_dwordx4 v72, s[8:11], s28 offen offset:2048 nt lds
  s_mov_b32 m0, 140744
  s_nop 0
  buffer_load_dwordx4 v72, s[8:11], s28 offen offset:3072 nt lds
  v_exp_f32 v120, v120
  v_exp_f32 v121, v121
  v_exp_f32 v122, v122
  v_exp_f32 v123, v123
  v_cvt_pk_bf16_f32 v64, v120, v121
  v_cvt_pk_bf16_f32 v65, v122, v123
  v_exp_f32 v124, v124
  v_exp_f32 v125, v125
  v_exp_f32 v126, v126
  v_exp_f32 v127, v127
  v_cvt_pk_bf16_f32 v66, v124, v125
  v_cvt_pk_bf16_f32 v67, v126, v127
  s_waitcnt lgkmcnt(3)
  v_lshlrev_b32 v192, 16, v176
  v_and_b32 v193, s48, v176
  v_lshlrev_b32 v194, 16, v177
  v_and_b32 v195, s48, v177
  v_lshlrev_b32 v196, 16, v178
  v_and_b32 v197, s48, v178
  v_lshlrev_b32 v198, 16, v179
  v_and_b32 v199, s48, v179
  v_pk_mul_f32 v[192:193], v[192:193], s[46:47]
  v_pk_mul_f32 v[194:195], v[194:195], s[46:47]
  v_pk_mul_f32 v[196:197], v[196:197], s[46:47]
  v_pk_mul_f32 v[198:199], v[198:199], s[46:47]
  v_cvt_pk_bf16_f32 v176, v192, v193
  v_cvt_pk_bf16_f32 v177, v194, v195
  v_cvt_pk_bf16_f32 v178, v196, v197
  v_cvt_pk_bf16_f32 v179, v198, v199
  v_accvgpr_write_b32 a144, v176
  v_accvgpr_write_b32 a145, v177
  v_accvgpr_write_b32 a146, v178
  v_accvgpr_write_b32 a147, v179
  v_mfma_f32_32x32x16_bf16 a[48:63], a[240:243], a[248:251], 0
  s_waitcnt lgkmcnt(0)
  v_lshlrev_b32 v200, 16, v180
  v_and_b32 v201, s48, v180
  v_lshlrev_b32 v202, 16, v181
  v_and_b32 v203, s48, v181
  v_lshlrev_b32 v204, 16, v182
  v_and_b32 v205, s48, v182
  v_mfma_f32_16x16x32_bf16 v[152:155], a[192:195], a[144:147], 0
  v_lshlrev_b32 v206, 16, v183
  v_and_b32 v207, s48, v183
  v_lshlrev_b32 v192, 16, v184
  v_and_b32 v193, s48, v184
  v_lshlrev_b32 v194, 16, v185
  v_pk_mul_f32 v[200:201], v[200:201], s[46:47]
  v_pk_mul_f32 v[202:203], v[202:203], s[46:47]
  v_pk_mul_f32 v[204:205], v[204:205], s[46:47]
  v_pk_mul_f32 v[206:207], v[206:207], s[46:47]
  v_cvt_pk_bf16_f32 v180, v200, v201
  v_cvt_pk_bf16_f32 v181, v202, v203
  v_cvt_pk_bf16_f32 v182, v204, v205
  v_cvt_pk_bf16_f32 v183, v206, v207
  v_accvgpr_write_b32 a148, v180
  v_accvgpr_write_b32 a149, v181
  v_accvgpr_write_b32 a150, v182
  v_accvgpr_write_b32 a151, v183
  v_and_b32 v195, s48, v185
  v_lshlrev_b32 v196, 16, v186
  v_mfma_f32_16x16x32_bf16 v[152:155], a[196:199], a[148:151], v[152:155]
  v_and_b32 v197, s48, v186
  v_lshlrev_b32 v198, 16, v187
  v_and_b32 v199, s48, v187
  v_lshlrev_b32 v200, 16, v188
  v_and_b32 v201, s48, v188
  v_pk_mul_f32 v[192:193], v[192:193], s[46:47]
  v_pk_mul_f32 v[194:195], v[194:195], s[46:47]
  v_pk_mul_f32 v[196:197], v[196:197], s[46:47]
  v_pk_mul_f32 v[198:199], v[198:199], s[46:47]
  v_cvt_pk_bf16_f32 v184, v192, v193
  v_cvt_pk_bf16_f32 v185, v194, v195
  v_cvt_pk_bf16_f32 v186, v196, v197
  v_cvt_pk_bf16_f32 v187, v198, v199
  v_accvgpr_write_b32 a152, v184
  v_accvgpr_write_b32 a153, v185
  v_accvgpr_write_b32 a154, v186
  v_accvgpr_write_b32 a155, v187
  v_lshlrev_b32 v202, 16, v189
  v_and_b32 v203, s48, v189
  v_mfma_f32_16x16x32_bf16 v[152:155], a[200:203], a[152:155], v[152:155]
  v_lshlrev_b32 v204, 16, v190
  v_and_b32 v205, s48, v190
  v_lshlrev_b32 v206, 16, v191
  v_and_b32 v207, s48, v191
  v_pk_mul_f32 v[200:201], v[200:201], s[46:47]
  v_pk_mul_f32 v[202:203], v[202:203], s[46:47]
  v_pk_mul_f32 v[204:205], v[204:205], s[46:47]
  v_pk_mul_f32 v[206:207], v[206:207], s[46:47]
  v_cvt_pk_bf16_f32 v188, v200, v201
  v_cvt_pk_bf16_f32 v189, v202, v203
  v_cvt_pk_bf16_f32 v190, v204, v205
  v_cvt_pk_bf16_f32 v191, v206, v207
  v_accvgpr_write_b32 a156, v188
  v_accvgpr_write_b32 a157, v189
  v_accvgpr_write_b32 a158, v190
  v_accvgpr_write_b32 a159, v191
  s_nop 1
  v_mfma_f32_16x16x32_bf16 v[152:155], a[204:207], a[156:159], v[152:155]
  s_nop 7
  v_max3_f32 v6, v152, v153, v154
  v_max_f32 v6, v6, v155
  v_mov_b32 v7, v6
  s_nop 1
  v_permlane32_swap_b32 v6, v7
  v_max_f32 v6, v6, v7
  v_mov_b32 v7, v6
  s_nop 1
  v_permlane16_swap_b32 v6, v7
  v_max_f32 v6, v6, v7
  v_sub_f32 v140, s81, v6
  v_sub_f32 v141, s81, v6
  v_sub_f32 v142, s81, v6
  v_sub_f32 v143, s81, v6
  v_add_f32 v152, v152, v140
  v_add_f32 v153, v153, v140
  v_mfma_f32_16x16x32_bf16 v[156:159], a[208:211], a[144:147], v[140:143]
  v_add_f32 v154, v154, v140
  v_add_f32 v155, v155, v140
  v_mfma_f32_16x16x32_bf16 v[156:159], a[212:215], a[148:151], v[156:159]
  v_exp_f32 v152, v152
  v_mfma_f32_16x16x32_bf16 v[156:159], a[216:219], a[152:155], v[156:159]
  v_exp_f32 v153, v153
  v_mfma_f32_16x16x32_bf16 v[156:159], a[220:223], a[156:159], v[156:159]
  v_exp_f32 v154, v154
  v_mfma_f32_16x16x32_bf16 v[112:115], v[80:83], a[144:147], v[140:143]
  v_exp_f32 v155, v155
  v_mfma_f32_16x16x32_bf16 v[112:115], v[84:87], a[148:151], v[112:115]
  v_cvt_pk_bf16_f32 v44, v152, v153
  v_cvt_pk_bf16_f32 v45, v154, v155
  v_mfma_f32_16x16x32_bf16 v[112:115], v[88:91], a[152:155], v[112:115]
  v_mfma_f32_16x16x32_bf16 v[112:115], v[92:95], a[156:159], v[112:115]
  v_exp_f32 v156, v156
  v_mfma_f32_16x16x32_bf16 v[116:119], v[96:99], a[144:147], v[140:143]
  v_exp_f32 v157, v157
  v_mfma_f32_16x16x32_bf16 v[116:119], v[100:103], a[148:151], v[116:119]
  v_exp_f32 v158, v158
  v_mfma_f32_16x16x32_bf16 v[116:119], v[104:107], a[152:155], v[116:119]
  v_exp_f32 v159, v159
  v_mfma_f32_16x16x32_bf16 v[116:119], v[108:111], a[156:159], v[116:119]
  v_cvt_pk_bf16_f32 v46, v156, v157
  v_cvt_pk_bf16_f32 v47, v158, v159
  s_waitcnt vmcnt(12)
  ds_read_b128 v[160:163], v8 offset:16384
  ds_read_b128 v[164:167], v9 offset:16384
  ds_read_b128 v[168:171], v10 offset:16384
  ds_read_b128 v[172:175], v11 offset:16384
  v_exp_f32 v112, v112
  v_exp_f32 v113, v113
  v_exp_f32 v114, v114
  v_exp_f32 v115, v115
  v_cvt_pk_bf16_f32 v68, v112, v113
  v_cvt_pk_bf16_f32 v69, v114, v115
  v_exp_f32 v116, v116
  v_exp_f32 v117, v117
  v_exp_f32 v118, v118
  v_exp_f32 v119, v119
  v_cvt_pk_bf16_f32 v70, v116, v117
  v_cvt_pk_bf16_f32 v71, v118, v119
  v_mfma_f32_32x32x16_bf16 v[176:191], a[240:243], a[248:251], 0
  s_xor_b32 s28, s66, 24576
  s_waitcnt lgkmcnt(3)
  v_lshlrev_b32 v192, 16, v160
  v_and_b32 v193, s48, v160
  v_lshlrev_b32 v194, 16, v161
  v_and_b32 v195, s48, v161
  v_lshlrev_b32 v196, 16, v162
  v_and_b32 v197, s48, v162
  v_lshlrev_b32 v198, 16, v163
  v_and_b32 v199, s48, v163
  v_pk_mul_f32 v[192:193], v[192:193], s[46:47]
  v_pk_mul_f32 v[194:195], v[194:195], s[46:47]
  v_pk_mul_f32 v[196:197], v[196:197], s[46:47]
  v_pk_mul_f32 v[198:199], v[198:199], s[46:47]
  v_cvt_pk_bf16_f32 v160, v192, v193
  v_cvt_pk_bf16_f32 v161, v194, v195
  v_cvt_pk_bf16_f32 v162, v196, v197
  v_cvt_pk_bf16_f32 v163, v198, v199
  v_accvgpr_write_b32 a160, v160
  v_accvgpr_write_b32 a161, v161
  v_accvgpr_write_b32 a162, v162
  v_accvgpr_write_b32 a163, v163
  s_waitcnt lgkmcnt(2)
  v_lshlrev_b32 v200, 16, v164
  v_and_b32 v201, s48, v164
  v_mfma_f32_16x16x32_bf16 v[120:123], a[192:195], a[160:163], 0
  s_waitcnt lgkmcnt(0)
  v_lshlrev_b32 v202, 16, v165
  v_and_b32 v203, s48, v165
  v_lshlrev_b32 v204, 16, v166
  v_and_b32 v205, s48, v166
  v_lshlrev_b32 v206, 16, v167
  v_and_b32 v207, s48, v167
  v_pk_mul_f32 v[200:201], v[200:201], s[46:47]
  v_pk_mul_f32 v[202:203], v[202:203], s[46:47]
  v_pk_mul_f32 v[204:205], v[204:205], s[46:47]
  v_pk_mul_f32 v[206:207], v[206:207], s[46:47]
  v_cvt_pk_bf16_f32 v164, v200, v201
  v_cvt_pk_bf16_f32 v165, v202, v203
  v_cvt_pk_bf16_f32 v166, v204, v205
  v_cvt_pk_bf16_f32 v167, v206, v207
  v_accvgpr_write_b32 a164, v164
  v_accvgpr_write_b32 a165, v165
  v_accvgpr_write_b32 a166, v166
  v_accvgpr_write_b32 a167, v167
  v_lshlrev_b32 v192, 16, v168
  v_and_b32 v193, s48, v168
  v_mfma_f32_16x16x32_bf16 v[120:123], a[196:199], a[164:167], v[120:123]
  v_lshlrev_b32 v194, 16, v169
  v_and_b32 v195, s48, v169
  v_lshlrev_b32 v196, 16, v170
  v_and_b32 v197, s48, v170
  v_lshlrev_b32 v198, 16, v171
  v_and_b32 v199, s48, v171
  v_pk_mul_f32 v[192:193], v[192:193], s[46:47]
  v_pk_mul_f32 v[194:195], v[194:195], s[46:47]
  v_pk_mul_f32 v[196:197], v[196:197], s[46:47]
  v_pk_mul_f32 v[198:199], v[198:199], s[46:47]
  v_cvt_pk_bf16_f32 v168, v192, v193
  v_cvt_pk_bf16_f32 v169, v194, v195
  v_cvt_pk_bf16_f32 v170, v196, v197
  v_cvt_pk_bf16_f32 v171, v198, v199
  v_accvgpr_write_b32 a168, v168
  v_accvgpr_write_b32 a169, v169
  v_accvgpr_write_b32 a170, v170
  v_accvgpr_write_b32 a171, v171
  v_lshlrev_b32 v200, 16, v172
  v_and_b32 v201, s48, v172
  v_mfma_f32_16x16x32_bf16 v[120:123], a[200:203], a[168:171], v[120:123]
  v_lshlrev_b32 v202, 16, v173
  v_and_b32 v203, s48, v173
  v_lshlrev_b32 v204, 16, v174
  v_and_b32 v205, s48, v174
  v_lshlrev_b32 v206, 16, v175
  v_and_b32 v207, s48, v175
  v_pk_mul_f32 v[200:201], v[200:201], s[46:47]
  v_pk_mul_f32 v[202:203], v[202:203], s[46:47]
  v_pk_mul_f32 v[204:205], v[204:205], s[46:47]
  v_pk_mul_f32 v[206:207], v[206:207], s[46:47]
  v_cvt_pk_bf16_f32 v172, v200, v201
  v_cvt_pk_bf16_f32 v173, v202, v203
  v_cvt_pk_bf16_f32 v174, v204, v205
  v_cvt_pk_bf16_f32 v175, v206, v207
  v_accvgpr_write_b32 a172, v172
  v_accvgpr_write_b32 a173, v173
  v_accvgpr_write_b32 a174, v174
  v_accvgpr_write_b32 a175, v175
  v_mfma_f32_32x32x16_bf16 v[160:175], a[240:243], a[248:251], 0
  v_mfma_f32_32x32x16_bf16 v[192:207], a[240:243], a[248:251], 0
  v_mfma_f32_16x16x32_bf16 v[120:123], a[204:207], a[172:175], v[120:123]
  s_waitcnt vmcnt(0)
  s_barrier
  ds_read_b128 a[192:195], v2 offset:16896
  ds_read_b128 a[196:199], v2 offset:16960
  ds_read_b128 a[200:203], v2 offset:17024
  ds_read_b128 a[204:207], v2 offset:17088
  ds_read_b64_tr_b16 a[224:225], v3 offset:0
  ds_read_b64_tr_b16 a[226:227], v3 offset:256
  ds_read_b64_tr_b16 a[228:229], v3 offset:8448
  v_max3_f32 v18, v120, v121, v122
  v_max_f32 v18, v18, v123
  v_mov_b32 v19, v18
  ds_read_b64_tr_b16 a[230:231], v3 offset:8704
  ds_read_b64_tr_b16 a[236:237], v3 offset:8456
  v_permlane32_swap_b32 v18, v19
  v_max_f32 v18, v18, v19
  v_mov_b32 v19, v18
  s_mov_b32 m0, 119552
  s_nop 0
  buffer_load_dwordx4 v1, s[4:7], s28 offen offset:0 nt lds
  v_permlane16_swap_b32 v18, v19
  v_max_f32 v18, v18, v19
  v_sub_f32 v144, s81, v18
  v_sub_f32 v145, s81, v18
  v_sub_f32 v146, s81, v18
  v_sub_f32 v147, s81, v18
  v_add_f32 v120, v120, v144
  v_add_f32 v121, v121, v144
  v_mfma_f32_16x16x32_bf16 v[124:127], a[208:211], a[160:163], v[144:147]
  s_mov_b32 m0, 119584
  s_nop 0
  buffer_load_dwordx4 v1, s[4:7], s28 offen offset:1024 nt lds
  s_mov_b32 m0, 119616
  s_nop 0
  buffer_load_dwordx4 v1, s[4:7], s28 offen offset:2048 nt lds
  v_mfma_f32_16x16x32_bf16 v[124:127], a[212:215], a[164:167], v[124:127]
  s_mov_b32 m0, 119648
  s_nop 0
  buffer_load_dwordx4 v1, s[4:7], s28 offen offset:3072 nt lds
  s_mov_b32 m0, 123776
  s_nop 0
  buffer_load_dwordx4 v72, s[4:7], s28 offen offset:0 nt lds
  v_mfma_f32_16x16x32_bf16 v[124:127], a[216:219], a[168:171], v[124:127]
  s_mov_b32 m0, 123808
  s_nop 0
  buffer_load_dwordx4 v72, s[4:7], s28 offen offset:1024 nt lds
  s_mov_b32 m0, 123840
  s_nop 0
  buffer_load_dwordx4 v72, s[4:7], s28 offen offset:2048 nt lds
  v_mfma_f32_16x16x32_bf16 v[124:127], a[220:223], a[172:175], v[124:127]
  s_mov_b32 m0, 123872
  s_nop 0
  buffer_load_dwordx4 v72, s[4:7], s28 offen offset:3072 nt lds
  v_mfma_f32_16x16x32_bf16 v[152:155], v[80:83], a[160:163], v[144:147]
  s_xor_b32 s28, s66, 16384
  s_mov_b32 m0, 144896
  s_nop 0
  buffer_load_dwordx4 v1, s[8:11], s28 offen offset:0 nt lds
  s_mov_b32 m0, 144904
  s_nop 0
  buffer_load_dwordx4 v1, s[8:11], s28 offen offset:1024 nt lds
  v_mfma_f32_16x16x32_bf16 v[152:155], v[84:87], a[164:167], v[152:155]
  s_mov_b32 m0, 144960
  s_nop 0
  buffer_load_dwordx4 v1, s[8:11], s28 offen offset:2048 nt lds
  s_mov_b32 m0, 144968
  s_nop 0
  buffer_load_dwordx4 v1, s[8:11], s28 offen offset:3072 nt lds
  v_mfma_f32_16x16x32_bf16 v[152:155], v[88:91], a[168:171], v[152:155]
  s_mov_b32 m0, 149120
  s_nop 0
  buffer_load_dwordx4 v72, s[8:11], s28 offen offset:0 nt lds
  s_mov_b32 m0, 149128
  s_nop 0
  buffer_load_dwordx4 v72, s[8:11], s28 offen offset:1024 nt lds
  v_mfma_f32_16x16x32_bf16 v[152:155], v[92:95], a[172:175], v[152:155]
  s_mov_b32 m0, 149184
  s_nop 0
  buffer_load_dwordx4 v72, s[8:11], s28 offen offset:2048 nt lds
  s_mov_b32 m0, 149192
  s_nop 0
  buffer_load_dwordx4 v72, s[8:11], s28 offen offset:3072 nt lds
  v_mfma_f32_16x16x32_bf16 v[156:159], v[96:99], a[160:163], v[144:147]
  s_xor_b32 s28, s66, 32768
  s_mov_b32 m0, 161792
  s_nop 0
  buffer_load_dwordx4 v1, s[12:15], s62 offen lds
  buffer_load_dwordx4 v1, s[12:15], s62 offen lds
  v_mfma_f32_16x16x32_bf16 v[156:159], v[100:103], a[164:167], v[156:159]
  buffer_load_dwordx4 v1, s[12:15], s62 offen lds
  buffer_load_dwordx4 v1, s[12:15], s62 offen lds
  v_mfma_f32_16x16x32_bf16 v[156:159], v[104:107], a[168:171], v[156:159]
  s_mov_b32 m0, 94208
  s_nop 0
  buffer_load_dwordx4 v1, s[4:7], s28 offen offset:0 nt lds
  s_mov_b32 m0, 94240
  s_nop 0
  buffer_load_dwordx4 v1, s[4:7], s28 offen offset:1024 nt lds
  v_mfma_f32_16x16x32_bf16 v[156:159], v[108:111], a[172:175], v[156:159]
  s_mov_b32 m0, 94272
  s_nop 0
  buffer_load_dwordx4 v1, s[4:7], s28 offen offset:2048 nt lds
  s_mov_b32 m0, 94304
  s_nop 0
  buffer_load_dwordx4 v1, s[4:7], s28 offen offset:3072 nt lds
  v_add_f32 v122, v122, v144
  v_add_f32 v123, v123, v144
  v_exp_f32 v120, v120
  v_exp_f32 v121, v121
  v_exp_f32 v122, v122
  v_exp_f32 v123, v123
  v_cvt_pk_bf16_f32 v48, v120, v121
  v_cvt_pk_bf16_f32 v49, v122, v123
  v_exp_f32 v124, v124
  v_exp_f32 v125, v125
  v_exp_f32 v126, v126
  v_exp_f32 v127, v127
  v_cvt_pk_bf16_f32 v50, v124, v125
  v_cvt_pk_bf16_f32 v51, v126, v127
  v_exp_f32 v152, v152
  v_exp_f32 v153, v153
  v_exp_f32 v154, v154
  v_exp_f32 v155, v155
  v_cvt_pk_bf16_f32 v52, v152, v153
  v_cvt_pk_bf16_f32 v53, v154, v155
  s_mov_b32 m0, 98432
  s_nop 0
  buffer_load_dwordx4 v72, s[4:7], s28 offen offset:0 nt lds
  s_mov_b32 m0, 98464
  s_nop 0
  buffer_load_dwordx4 v72, s[4:7], s28 offen offset:1024 nt lds
  s_mov_b32 m0, 98496
  s_nop 0
  buffer_load_dwordx4 v72, s[4:7], s28 offen offset:2048 nt lds
  s_mov_b32 m0, 98528
  s_nop 0
  buffer_load_dwordx4 v72, s[4:7], s28 offen offset:3072 nt lds
  s_xor_b32 s28, s66, 24576
  s_mov_b32 m0, 153344
  s_nop 0
  buffer_load_dwordx4 v1, s[8:11], s28 offen offset:0 nt lds
  s_mov_b32 m0, 153352
  s_nop 0
  buffer_load_dwordx4 v1, s[8:11], s28 offen offset:1024 nt lds
  s_mov_b32 m0, 153408
  s_nop 0
  buffer_load_dwordx4 v1, s[8:11], s28 offen offset:2048 nt lds
  s_mov_b32 m0, 153416
  s_nop 0
  buffer_load_dwordx4 v1, s[8:11], s28 offen offset:3072 nt lds
  s_mov_b32 m0, 157568
  s_nop 0
  buffer_load_dwordx4 v72, s[8:11], s28 offen offset:0 nt lds
  s_mov_b32 m0, 157576
  s_nop 0
  buffer_load_dwordx4 v72, s[8:11], s28 offen offset:1024 nt lds
  s_mov_b32 m0, 157632
  s_nop 0
  buffer_load_dwordx4 v72, s[8:11], s28 offen offset:2048 nt lds
  s_mov_b32 m0, 157640
  s_nop 0
  buffer_load_dwordx4 v72, s[8:11], s28 offen offset:3072 nt lds
  s_mov_b32 m0, 161792
  s_nop 0
  buffer_load_dwordx4 v1, s[12:15], s62 offen lds
  buffer_load_dwordx4 v1, s[12:15], s62 offen lds
  buffer_load_dwordx4 v1, s[12:15], s62 offen lds
  buffer_load_dwordx4 v1, s[12:15], s62 offen lds
  s_waitcnt lgkmcnt(0)
  s_branch ENTRY0_5
.p2align 6
LOOP0_5:
  v_mfma_f32_16x16x32_bf16 v[152:155], a[192:195], a[96:99], v[128:131]
  s_waitcnt lgkmcnt(1)
  v_exp_f32 v156, v156
  v_mfma_f32_16x16x32_bf16 v[152:155], a[196:199], a[100:103], v[152:155]
  ds_read_b64_tr_b16 a[238:239], v3 offset:25608
  ds_read_b64_tr_b16 a[232:233], v3 offset:16904
  v_mfma_f32_16x16x32_bf16 v[152:155], a[200:203], a[104:107], v[152:155]
  s_addk_i32 s30, 0x1000
  v_exp_f32 v157, v157
  v_mfma_f32_16x16x32_bf16 v[152:155], a[204:207], a[108:111], v[152:155]
  ds_read_b64_tr_b16 a[234:235], v3 offset:17160
  v_cvt_pk_bf16_f32 v102, v156, v157
  v_mfma_f32_16x16x32_bf16 v[160:163], a[224:227], v[80:83], v[160:163]
  s_addk_i32 s31, 0x1000
  v_exp_f32 v158, v158
  v_mfma_f32_16x16x32_bf16 v[160:163], a[228:231], v[104:107], v[160:163]
  ds_read2st64_b32 v[12:13], v4 offset0:0 offset1:1
  ds_read2st64_b32 v[14:15], v4 offset0:2 offset1:3
  v_mfma_f32_16x16x32_bf16 v[192:195], a[228:231], v[108:111], v[192:195]
  s_addk_i32 s32, 0x1000
  v_exp_f32 v159, v159
  v_mfma_f32_16x16x32_bf16 v[192:195], a[224:227], v[84:87], v[192:195]
  ds_read_b128 a[208:211], v2 offset:256
  v_cvt_pk_bf16_f32 v103, v158, v159
  v_mfma_f32_16x16x32_bf16 v[156:159], a[192:195], a[112:115], v[132:135]
  s_addk_i32 s33, 0x1000
  v_exp_f32 v152, v152
  v_mfma_f32_16x16x32_bf16 v[156:159], a[196:199], a[116:119], v[156:159]
  ds_read_b128 a[212:215], v2 offset:320
  v_mfma_f32_16x16x32_bf16 v[156:159], a[200:203], a[120:123], v[156:159]
  s_addk_i32 s34, 0x1000
  v_exp_f32 v153, v153
  v_mfma_f32_16x16x32_bf16 v[156:159], a[204:207], a[124:127], v[156:159]
  ds_read_b128 a[216:219], v2 offset:384
  v_cvt_pk_bf16_f32 v32, v152, v153
  v_mfma_f32_16x16x32_bf16 v[224:227], a[224:227], v[88:91], v[224:227]
  v_exp_f32 v154, v154
  v_mfma_f32_16x16x32_bf16 v[224:227], a[228:231], v[112:115], v[224:227]
  s_waitcnt lgkmcnt(4)
  v_lshlrev_b32 v16, 16, v12
  v_and_b32 v17, s48, v12
  v_mfma_f32_16x16x32_bf16 a[0:3], a[228:231], v[116:119], a[0:3]
  s_mov_b32 s29, s90
  v_exp_f32 v155, v155
  v_mfma_f32_16x16x32_bf16 a[0:3], a[224:227], v[92:95], a[0:3]
  ds_read_b128 a[220:223], v2 offset:448
  v_cvt_pk_bf16_f32 v33, v154, v155
  v_smfmac_f32_16x16x64_bf16 v[20:23], a[240:243], v[80:87], v5
  v_mfma_f32_16x16x32_bf16 v[152:155], a[192:195], a[128:131], v[136:139]
  s_xor_b32 s28, s90, 0x2000
  v_exp_f32 v156, v156
  v_mfma_f32_16x16x32_bf16 v[152:155], a[196:199], a[132:135], v[152:155]
  v_mul_f32 v16, s46, v16
  v_mul_f32 v17, s46, v17
  v_cvt_pk_bf16_f32 v12, v16, v17
  v_lshlrev_b32 v18, 16, v13
  v_mfma_f32_16x16x32_bf16 v[152:155], a[200:203], a[136:139], v[152:155]
  s_addk_i32 s67, 0x4000
  v_exp_f32 v157, v157
  v_mfma_f32_16x16x32_bf16 v[152:155], a[204:207], a[140:143], v[152:155]
  v_cvt_pk_bf16_f32 v36, v156, v157
  v_mfma_f32_16x16x32_bf16 a[32:35], a[224:227], v[96:99], a[32:35]
  s_xor_b32 s90, s67, s66
  v_exp_f32 v158, v158
  v_mfma_f32_16x16x32_bf16 a[32:35], a[228:231], v[100:103], a[32:35]
  v_and_b32 v19, s48, v13
  v_mul_f32 v18, s46, v18
  v_mul_f32 v19, s46, v19
  v_cvt_pk_bf16_f32 v13, v18, v19
  v_mfma_f32_16x16x32_bf16 v[164:167], a[236:239], v[104:107], v[164:167]
  v_exp_f32 v159, v159
  v_mfma_f32_16x16x32_bf16 v[164:167], a[232:235], v[80:83], v[164:167]
  ds_read_b64_tr_b16 a[224:225], v3 offset:16960
  v_cvt_pk_bf16_f32 v37, v158, v159
  v_smfmac_f32_16x16x64_bf16 v[24:27], a[240:243], v[88:95], v5
  v_mfma_f32_16x16x32_bf16 v[156:159], a[192:195], a[144:147], v[140:143]
  s_waitcnt lgkmcnt(5)
  v_exp_f32 v152, v152
  v_mfma_f32_16x16x32_bf16 v[156:159], a[196:199], a[148:151], v[156:159]
  v_lshlrev_b32 v16, 16, v14
  v_and_b32 v17, s48, v14
  v_mul_f32 v16, s46, v16
  v_mul_f32 v17, s46, v17
  v_mfma_f32_16x16x32_bf16 v[156:159], a[200:203], a[152:155], v[156:159]
  v_exp_f32 v153, v153
  v_mfma_f32_16x16x32_bf16 v[156:159], a[204:207], a[156:159], v[156:159]
  ds_read_b64_tr_b16 a[226:227], v3 offset:17216
  ds_read_b64_tr_b16 a[228:229], v3 offset:25408
  v_cvt_pk_bf16_f32 v40, v152, v153
  v_mfma_f32_16x16x32_bf16 v[196:199], a[232:235], v[84:87], v[196:199]
  v_exp_f32 v154, v154
  v_mfma_f32_16x16x32_bf16 v[196:199], a[236:239], v[108:111], v[196:199]
  v_cvt_pk_bf16_f32 v14, v16, v17
  v_lshlrev_b32 v18, 16, v15
  v_and_b32 v19, s48, v15
  v_mul_f32 v18, s46, v18
  v_mfma_f32_16x16x32_bf16 v[228:231], a[236:239], v[112:115], v[228:231]
  v_exp_f32 v155, v155
  v_mfma_f32_16x16x32_bf16 v[228:231], a[232:235], v[88:91], v[228:231]
  ds_read_b64_tr_b16 a[230:231], v3 offset:25664
  v_cvt_pk_bf16_f32 v41, v154, v155
  v_mfma_f32_16x16x32_bf16 v[152:155], a[192:195], a[160:163], v[144:147]
  v_exp_f32 v156, v156
  v_mfma_f32_16x16x32_bf16 v[152:155], a[196:199], a[164:167], v[152:155]
  ds_write_b32 v4, v12 offset:0
  v_mul_f32 v19, s46, v19
  v_cvt_pk_bf16_f32 v15, v18, v19
  v_mfma_f32_16x16x32_bf16 v[152:155], a[200:203], a[168:171], v[152:155]
  v_exp_f32 v157, v157
  v_mfma_f32_16x16x32_bf16 v[152:155], a[204:207], a[172:175], v[152:155]
  v_cvt_pk_bf16_f32 v44, v156, v157
  v_mfma_f32_16x16x32_bf16 a[4:7], a[232:235], v[92:95], a[4:7]
  v_exp_f32 v158, v158
  v_mfma_f32_16x16x32_bf16 a[4:7], a[236:239], v[116:119], a[4:7]
  ds_write_b32 v4, v13 offset:256
  v_mfma_f32_16x16x32_bf16 a[36:39], a[236:239], v[100:103], a[36:39]
  s_waitcnt lgkmcnt(9)
  v_exp_f32 v159, v159
  v_mfma_f32_16x16x32_bf16 a[36:39], a[232:235], v[96:99], a[36:39]
  ds_read_b64_tr_b16 a[236:237], v3 offset:25416
  v_cvt_pk_bf16_f32 v45, v158, v159
  v_mfma_f32_16x16x32_bf16 v[156:159], a[208:211], a[96:99], v[128:131]
  s_waitcnt lgkmcnt(8)
  v_exp_f32 v152, v152
  v_mfma_f32_16x16x32_bf16 v[156:159], a[212:215], a[100:103], v[156:159]
  ds_read_b64_tr_b16 a[238:239], v3 offset:25672
  ds_read_b64_tr_b16 a[232:233], v3 offset:16968
  v_mfma_f32_16x16x32_bf16 v[156:159], a[216:219], a[104:107], v[156:159]
  s_waitcnt lgkmcnt(7)
  v_exp_f32 v153, v153
  v_mfma_f32_16x16x32_bf16 v[156:159], a[220:223], a[108:111], v[156:159]
  ds_read_b64_tr_b16 a[234:235], v3 offset:17224
  ds_write_b32 v4, v14 offset:512
  v_cvt_pk_bf16_f32 v48, v152, v153
  v_mfma_f32_16x16x32_bf16 v[168:171], a[224:227], v[80:83], v[168:171]
  s_waitcnt lgkmcnt(7)
  v_exp_f32 v154, v154
  v_mfma_f32_16x16x32_bf16 v[168:171], a[228:231], v[104:107], v[168:171]
  ds_write_b32 v4, v15 offset:768
  v_mfma_f32_16x16x32_bf16 v[200:203], a[228:231], v[108:111], v[200:203]
  v_exp_f32 v155, v155
  v_mfma_f32_16x16x32_bf16 v[200:203], a[224:227], v[84:87], v[200:203]
  v_cvt_pk_bf16_f32 v49, v154, v155
  v_smfmac_f32_16x16x64_bf16 v[28:31], a[240:243], v[96:103], v5
  v_mfma_f32_16x16x32_bf16 v[152:155], a[208:211], a[112:115], v[132:135]
  s_mov_b32 m0, 119552
  v_exp_f32 v156, v156
  v_mfma_f32_16x16x32_bf16 v[152:155], a[212:215], a[116:119], v[152:155]
  s_waitcnt vmcnt(32) lgkmcnt(0)
  s_barrier
  v_mfma_f32_16x16x32_bf16 v[152:155], a[216:219], a[120:123], v[152:155]
  buffer_load_dwordx4 v1, s[4:7], s28 offen offset:0 nt lds
  s_mov_b32 m0, 119584
  v_exp_f32 v157, v157
  v_mfma_f32_16x16x32_bf16 v[152:155], a[220:223], a[124:127], v[152:155]
  buffer_load_dwordx4 v1, s[4:7], s28 offen offset:1024 nt lds
  s_mov_b32 m0, 119616
  v_cvt_pk_bf16_f32 v34, v156, v157
  v_mfma_f32_16x16x32_bf16 v[232:235], a[224:227], v[88:91], v[232:235]
  buffer_load_dwordx4 v1, s[4:7], s28 offen offset:2048 nt lds
  s_mov_b32 m0, 119648
  v_exp_f32 v158, v158
  v_mfma_f32_16x16x32_bf16 v[232:235], a[228:231], v[112:115], v[232:235]
  buffer_load_dwordx4 v1, s[4:7], s28 offen offset:3072 nt lds
  ds_read_b128 a[192:195], v2 offset:8448
  s_mov_b32 m0, 123776
  v_mfma_f32_16x16x32_bf16 a[8:11], a[228:231], v[116:119], a[8:11]
  buffer_load_dwordx4 v72, s[4:7], s28 offen offset:0 nt lds
  s_mov_b32 m0, 123808
  v_exp_f32 v159, v159
  v_mfma_f32_16x16x32_bf16 a[8:11], a[224:227], v[92:95], a[8:11]
  buffer_load_dwordx4 v72, s[4:7], s28 offen offset:1024 nt lds
  ds_read_b128 a[196:199], v2 offset:8512
  v_cvt_pk_bf16_f32 v35, v158, v159
  v_mfma_f32_16x16x32_bf16 v[156:159], a[208:211], a[128:131], v[136:139]
  s_mov_b32 m0, 123840
  v_exp_f32 v152, v152
  v_mfma_f32_16x16x32_bf16 v[156:159], a[212:215], a[132:135], v[156:159]
  buffer_load_dwordx4 v72, s[4:7], s28 offen offset:2048 nt lds
  ds_read_b128 a[200:203], v2 offset:8576
  v_mfma_f32_16x16x32_bf16 v[156:159], a[216:219], a[136:139], v[156:159]
  s_mov_b32 m0, 123872
  v_exp_f32 v153, v153
  v_mfma_f32_16x16x32_bf16 v[156:159], a[220:223], a[140:143], v[156:159]
  buffer_load_dwordx4 v72, s[4:7], s28 offen offset:3072 nt lds
  ds_read_b128 a[204:207], v2 offset:8640
  v_cvt_pk_bf16_f32 v38, v152, v153
  v_mfma_f32_16x16x32_bf16 a[40:43], a[224:227], v[96:99], a[40:43]
  s_mov_b32 m0, 94208
  v_exp_f32 v154, v154
  v_mfma_f32_16x16x32_bf16 a[40:43], a[228:231], v[100:103], a[40:43]
  buffer_load_dwordx4 v1, s[4:7], s90 offen offset:0 nt lds
  ds_read_b64_tr_b16 a[224:225], v3 offset:17024
  v_mfma_f32_16x16x32_bf16 v[172:175], a[236:239], v[104:107], v[172:175]
  s_mov_b32 m0, 94240
  v_exp_f32 v155, v155
  v_mfma_f32_16x16x32_bf16 v[172:175], a[232:235], v[80:83], v[172:175]
  buffer_load_dwordx4 v1, s[4:7], s90 offen offset:1024 nt lds
  ds_read_b64_tr_b16 a[226:227], v3 offset:17280
  v_cvt_pk_bf16_f32 v39, v154, v155
  v_mfma_f32_16x16x32_bf16 v[152:155], a[208:211], a[144:147], v[140:143]
  s_mov_b32 m0, 94272
  v_exp_f32 v156, v156
  v_mfma_f32_16x16x32_bf16 v[152:155], a[212:215], a[148:151], v[152:155]
  buffer_load_dwordx4 v1, s[4:7], s90 offen offset:2048 nt lds
  ds_read_b64_tr_b16 a[228:229], v3 offset:25472
  v_mfma_f32_16x16x32_bf16 v[152:155], a[216:219], a[152:155], v[152:155]
  s_mov_b32 m0, 94304
  v_exp_f32 v157, v157
  v_mfma_f32_16x16x32_bf16 v[152:155], a[220:223], a[156:159], v[152:155]
  buffer_load_dwordx4 v1, s[4:7], s90 offen offset:3072 nt lds
  v_cvt_pk_bf16_f32 v42, v156, v157
  v_mfma_f32_16x16x32_bf16 v[204:207], a[232:235], v[84:87], v[204:207]
  s_mov_b32 m0, 98432
  v_exp_f32 v158, v158
  v_mfma_f32_16x16x32_bf16 v[204:207], a[236:239], v[108:111], v[204:207]
  buffer_load_dwordx4 v72, s[4:7], s90 offen offset:0 nt lds
  ds_read_b64_tr_b16 a[230:231], v3 offset:25728
  v_mfma_f32_16x16x32_bf16 v[236:239], a[236:239], v[112:115], v[236:239]
  s_mov_b32 m0, 98464
  v_exp_f32 v159, v159
  v_mfma_f32_16x16x32_bf16 v[236:239], a[232:235], v[88:91], v[236:239]
  buffer_load_dwordx4 v72, s[4:7], s90 offen offset:1024 nt lds
  v_cvt_pk_bf16_f32 v43, v158, v159
  v_mfma_f32_16x16x32_bf16 v[156:159], a[208:211], a[160:163], v[144:147]
  s_mov_b32 m0, 98496
  v_exp_f32 v152, v152
  v_mfma_f32_16x16x32_bf16 v[156:159], a[212:215], a[164:167], v[156:159]
  buffer_load_dwordx4 v72, s[4:7], s90 offen offset:2048 nt lds
  s_mov_b32 m0, 98528
  v_mfma_f32_16x16x32_bf16 v[156:159], a[216:219], a[168:171], v[156:159]
  buffer_load_dwordx4 v72, s[4:7], s90 offen offset:3072 nt lds
  s_cmp_lt_u32 s30, 24576
  s_cselect_b32 m0, s30, 161792
  v_exp_f32 v153, v153
  v_mfma_f32_16x16x32_bf16 v[156:159], a[220:223], a[172:175], v[156:159]
  buffer_load_dwordx4 v148, s[16:19], m0 offen offset:0 nt lds
  s_cselect_b32 m0, s31, 161792
  v_cvt_pk_bf16_f32 v46, v152, v153
  v_mfma_f32_16x16x32_bf16 a[12:15], a[232:235], v[92:95], a[12:15]
  buffer_load_dwordx4 v148, s[16:19], m0 offen offset:0 nt lds
  s_cselect_b32 m0, s32, 161792
  v_exp_f32 v154, v154
  v_mfma_f32_16x16x32_bf16 a[12:15], a[236:239], v[116:119], a[12:15]
  buffer_load_dwordx4 v148, s[16:19], m0 offen offset:0 nt lds
  s_cmp_lt_u32 s34, 20480
  s_cselect_b32 m0, s33, 161792
  v_mfma_f32_16x16x32_bf16 a[44:47], a[236:239], v[100:103], a[44:47]
  buffer_load_dwordx4 v148, s[16:19], m0 offen offset:0 nt lds
  v_exp_f32 v155, v155
  v_mfma_f32_16x16x32_bf16 a[44:47], a[232:235], v[96:99], a[44:47]
  s_waitcnt lgkmcnt(7)
  ds_read_b64_tr_b16 a[236:237], v3 offset:25480
  v_cvt_pk_bf16_f32 v47, v154, v155
  v_mfma_f32_16x16x32_bf16 v[152:155], a[192:195], a[96:99], v[128:131]
  s_waitcnt lgkmcnt(6)
  v_exp_f32 v156, v156
  v_mfma_f32_16x16x32_bf16 v[152:155], a[196:199], a[100:103], v[152:155]
  ds_read_b64_tr_b16 a[238:239], v3 offset:25736
  ds_read_b64_tr_b16 a[232:233], v3 offset:17032
  v_mfma_f32_16x16x32_bf16 v[152:155], a[200:203], a[104:107], v[152:155]
  s_waitcnt lgkmcnt(5)
  v_exp_f32 v157, v157
  v_mfma_f32_16x16x32_bf16 v[152:155], a[204:207], a[108:111], v[152:155]
  ds_read_b64_tr_b16 a[234:235], v3 offset:17288
  v_cvt_pk_bf16_f32 v50, v156, v157
  v_mfma_f32_16x16x32_bf16 v[176:179], a[224:227], v[80:83], v[176:179]
  s_waitcnt lgkmcnt(4)
  v_exp_f32 v158, v158
  v_mfma_f32_16x16x32_bf16 v[176:179], a[228:231], v[104:107], v[176:179]
  ds_read2st64_b32 v[12:13], v4 offset0:4 offset1:5
  ds_read2st64_b32 v[14:15], v4 offset0:6 offset1:7
  v_mfma_f32_16x16x32_bf16 v[208:211], a[228:231], v[108:111], v[208:211]
  v_exp_f32 v159, v159
  v_mfma_f32_16x16x32_bf16 v[208:211], a[224:227], v[84:87], v[208:211]
  ds_read_b128 a[208:211], v2 offset:8704
  v_cvt_pk_bf16_f32 v51, v158, v159
  v_mfma_f32_16x16x32_bf16 v[156:159], a[192:195], a[112:115], v[132:135]
  v_exp_f32 v152, v152
  v_mfma_f32_16x16x32_bf16 v[156:159], a[196:199], a[116:119], v[156:159]
  ds_read_b128 a[212:215], v2 offset:8768
  v_mfma_f32_16x16x32_bf16 v[156:159], a[200:203], a[120:123], v[156:159]
  v_exp_f32 v153, v153
  v_mfma_f32_16x16x32_bf16 v[156:159], a[204:207], a[124:127], v[156:159]
  ds_read_b128 a[216:219], v2 offset:8832
  v_cvt_pk_bf16_f32 v56, v152, v153
  v_mfma_f32_16x16x32_bf16 v[240:243], a[224:227], v[88:91], v[240:243]
  v_exp_f32 v154, v154
  v_mfma_f32_16x16x32_bf16 v[240:243], a[228:231], v[112:115], v[240:243]
  s_waitcnt lgkmcnt(4)
  v_lshlrev_b32 v16, 16, v12
  v_and_b32 v17, s48, v12
  v_mfma_f32_16x16x32_bf16 a[16:19], a[228:231], v[116:119], a[16:19]
  v_exp_f32 v155, v155
  v_mfma_f32_16x16x32_bf16 a[16:19], a[224:227], v[92:95], a[16:19]
  ds_read_b128 a[220:223], v2 offset:8896
  v_cvt_pk_bf16_f32 v57, v154, v155
  v_smfmac_f32_16x16x64_bf16 v[20:23], a[240:243], v[104:111], v5
  v_mfma_f32_16x16x32_bf16 v[152:155], a[192:195], a[128:131], v[136:139]
  v_exp_f32 v156, v156
  v_mfma_f32_16x16x32_bf16 v[152:155], a[196:199], a[132:135], v[152:155]
  v_mul_f32 v16, s46, v16
  v_mul_f32 v17, s46, v17
  v_cvt_pk_bf16_f32 v12, v16, v17
  v_lshlrev_b32 v18, 16, v13
  v_mfma_f32_16x16x32_bf16 v[152:155], a[200:203], a[136:139], v[152:155]
  v_exp_f32 v157, v157
  v_mfma_f32_16x16x32_bf16 v[152:155], a[204:207], a[140:143], v[152:155]
  v_cvt_pk_bf16_f32 v60, v156, v157
  v_mfma_f32_16x16x32_bf16 a[48:51], a[224:227], v[96:99], a[48:51]
  v_exp_f32 v158, v158
  v_mfma_f32_16x16x32_bf16 a[48:51], a[228:231], v[100:103], a[48:51]
  v_and_b32 v19, s48, v13
  v_mul_f32 v18, s46, v18
  v_mul_f32 v19, s46, v19
  v_cvt_pk_bf16_f32 v13, v18, v19
  v_mfma_f32_16x16x32_bf16 v[180:183], a[236:239], v[104:107], v[180:183]
  v_exp_f32 v159, v159
  v_mfma_f32_16x16x32_bf16 v[180:183], a[232:235], v[80:83], v[180:183]
  ds_read_b64_tr_b16 a[224:225], v3 offset:17088
  v_cvt_pk_bf16_f32 v61, v158, v159
  v_smfmac_f32_16x16x64_bf16 v[24:27], a[240:243], v[112:119], v5
  v_mfma_f32_16x16x32_bf16 v[156:159], a[192:195], a[144:147], v[140:143]
  s_waitcnt lgkmcnt(5)
  v_exp_f32 v152, v152
  v_mfma_f32_16x16x32_bf16 v[156:159], a[196:199], a[148:151], v[156:159]
  v_lshlrev_b32 v16, 16, v14
  v_and_b32 v17, s48, v14
  v_mul_f32 v16, s46, v16
  v_mul_f32 v17, s46, v17
  v_mfma_f32_16x16x32_bf16 v[156:159], a[200:203], a[152:155], v[156:159]
  v_exp_f32 v153, v153
  v_mfma_f32_16x16x32_bf16 v[156:159], a[204:207], a[156:159], v[156:159]
  ds_read_b64_tr_b16 a[226:227], v3 offset:17344
  ds_read_b64_tr_b16 a[228:229], v3 offset:25536
  v_cvt_pk_bf16_f32 v64, v152, v153
  v_mfma_f32_16x16x32_bf16 v[212:215], a[232:235], v[84:87], v[212:215]
  v_exp_f32 v154, v154
  v_mfma_f32_16x16x32_bf16 v[212:215], a[236:239], v[108:111], v[212:215]
  v_cvt_pk_bf16_f32 v14, v16, v17
  v_lshlrev_b32 v18, 16, v15
  v_and_b32 v19, s48, v15
  v_mul_f32 v18, s46, v18
  v_mfma_f32_16x16x32_bf16 v[244:247], a[236:239], v[112:115], v[244:247]
  v_exp_f32 v155, v155
  v_mfma_f32_16x16x32_bf16 v[244:247], a[232:235], v[88:91], v[244:247]
  ds_read_b64_tr_b16 a[230:231], v3 offset:25792
  v_cvt_pk_bf16_f32 v65, v154, v155
  v_mfma_f32_16x16x32_bf16 v[152:155], a[192:195], a[160:163], v[144:147]
  v_exp_f32 v156, v156
  v_mfma_f32_16x16x32_bf16 v[152:155], a[196:199], a[164:167], v[152:155]
  ds_write_b32 v4, v12 offset:1024
  v_mul_f32 v19, s46, v19
  v_cvt_pk_bf16_f32 v15, v18, v19
  v_mfma_f32_16x16x32_bf16 v[152:155], a[200:203], a[168:171], v[152:155]
  v_exp_f32 v157, v157
  v_mfma_f32_16x16x32_bf16 v[152:155], a[204:207], a[172:175], v[152:155]
  v_cvt_pk_bf16_f32 v68, v156, v157
  v_mfma_f32_16x16x32_bf16 a[20:23], a[232:235], v[92:95], a[20:23]
  v_exp_f32 v158, v158
  v_mfma_f32_16x16x32_bf16 a[20:23], a[236:239], v[116:119], a[20:23]
  ds_write_b32 v4, v13 offset:1280
  v_mfma_f32_16x16x32_bf16 a[52:55], a[236:239], v[100:103], a[52:55]
  s_waitcnt lgkmcnt(9)
  v_exp_f32 v159, v159
  v_mfma_f32_16x16x32_bf16 a[52:55], a[232:235], v[96:99], a[52:55]
  ds_read_b64_tr_b16 a[236:237], v3 offset:25544
  v_cvt_pk_bf16_f32 v69, v158, v159
  v_mfma_f32_16x16x32_bf16 v[156:159], a[208:211], a[96:99], v[128:131]
  s_waitcnt lgkmcnt(8)
  v_exp_f32 v152, v152
  v_mfma_f32_16x16x32_bf16 v[156:159], a[212:215], a[100:103], v[156:159]
  ds_read_b64_tr_b16 a[238:239], v3 offset:25800
  ds_read_b64_tr_b16 a[232:233], v3 offset:17096
  v_mfma_f32_16x16x32_bf16 v[156:159], a[216:219], a[104:107], v[156:159]
  s_waitcnt lgkmcnt(7)
  v_exp_f32 v153, v153
  v_mfma_f32_16x16x32_bf16 v[156:159], a[220:223], a[108:111], v[156:159]
  ds_read_b64_tr_b16 a[234:235], v3 offset:17352
  ds_write_b32 v4, v14 offset:1536
  v_cvt_pk_bf16_f32 v52, v152, v153
  v_mfma_f32_16x16x32_bf16 v[184:187], a[224:227], v[80:83], v[184:187]
  s_waitcnt lgkmcnt(7)
  v_exp_f32 v154, v154
  v_mfma_f32_16x16x32_bf16 v[184:187], a[228:231], v[104:107], v[184:187]
  ds_write_b32 v4, v15 offset:1792
  v_mfma_f32_16x16x32_bf16 v[216:219], a[228:231], v[108:111], v[216:219]
  v_exp_f32 v155, v155
  v_mfma_f32_16x16x32_bf16 v[216:219], a[224:227], v[84:87], v[216:219]
  v_cvt_pk_bf16_f32 v53, v154, v155
  v_mfma_f32_16x16x32_bf16 v[152:155], a[208:211], a[112:115], v[132:135]
  s_mov_b32 m0, 144896
  v_exp_f32 v156, v156
  v_mfma_f32_16x16x32_bf16 v[152:155], a[212:215], a[116:119], v[152:155]
  s_waitcnt vmcnt(24) lgkmcnt(0)
  s_barrier
  v_mfma_f32_16x16x32_bf16 v[152:155], a[216:219], a[120:123], v[152:155]
  buffer_load_dwordx4 v1, s[8:11], s29 offen offset:0 nt lds
  s_mov_b32 m0, 144904
  v_exp_f32 v157, v157
  v_mfma_f32_16x16x32_bf16 v[152:155], a[220:223], a[124:127], v[152:155]
  buffer_load_dwordx4 v1, s[8:11], s29 offen offset:1024 nt lds
  s_mov_b32 m0, 144960
  v_cvt_pk_bf16_f32 v58, v156, v157
  v_mfma_f32_16x16x32_bf16 v[248:251], a[224:227], v[88:91], v[248:251]
  buffer_load_dwordx4 v1, s[8:11], s29 offen offset:2048 nt lds
  s_mov_b32 m0, 144968
  v_exp_f32 v158, v158
  v_mfma_f32_16x16x32_bf16 v[248:251], a[228:231], v[112:115], v[248:251]
  buffer_load_dwordx4 v1, s[8:11], s29 offen offset:3072 nt lds
  ds_read_b128 a[192:195], v2 offset:16896
  s_mov_b32 m0, 149120
  v_mfma_f32_16x16x32_bf16 a[24:27], a[228:231], v[116:119], a[24:27]
  buffer_load_dwordx4 v72, s[8:11], s29 offen offset:0 nt lds
  s_mov_b32 m0, 149128
  v_exp_f32 v159, v159
  v_mfma_f32_16x16x32_bf16 a[24:27], a[224:227], v[92:95], a[24:27]
  buffer_load_dwordx4 v72, s[8:11], s29 offen offset:1024 nt lds
  ds_read_b128 a[196:199], v2 offset:16960
  v_cvt_pk_bf16_f32 v59, v158, v159
  v_mfma_f32_16x16x32_bf16 v[156:159], a[208:211], a[128:131], v[136:139]
  s_mov_b32 m0, 149184
  v_exp_f32 v152, v152
  v_mfma_f32_16x16x32_bf16 v[156:159], a[212:215], a[132:135], v[156:159]
  buffer_load_dwordx4 v72, s[8:11], s29 offen offset:2048 nt lds
  ds_read_b128 a[200:203], v2 offset:17024
  v_mfma_f32_16x16x32_bf16 v[156:159], a[216:219], a[136:139], v[156:159]
  s_mov_b32 m0, 149192
  v_exp_f32 v153, v153
  v_mfma_f32_16x16x32_bf16 v[156:159], a[220:223], a[140:143], v[156:159]
  buffer_load_dwordx4 v72, s[8:11], s29 offen offset:3072 nt lds
  ds_read_b128 a[204:207], v2 offset:17088
  v_cvt_pk_bf16_f32 v62, v152, v153
  v_mfma_f32_16x16x32_bf16 a[56:59], a[224:227], v[96:99], a[56:59]
  s_mov_b32 m0, 153344
  v_exp_f32 v154, v154
  v_mfma_f32_16x16x32_bf16 a[56:59], a[228:231], v[100:103], a[56:59]
  buffer_load_dwordx4 v1, s[8:11], s28 offen offset:0 nt lds
  ds_read_b64_tr_b16 a[224:225], v3 offset:0
  v_mfma_f32_16x16x32_bf16 v[188:191], a[236:239], v[104:107], v[188:191]
  s_mov_b32 m0, 153352
  v_exp_f32 v155, v155
  v_mfma_f32_16x16x32_bf16 v[188:191], a[232:235], v[80:83], v[188:191]
  buffer_load_dwordx4 v1, s[8:11], s28 offen offset:1024 nt lds
  ds_read_b64_tr_b16 a[226:227], v3 offset:256
  v_cvt_pk_bf16_f32 v63, v154, v155
  v_mfma_f32_16x16x32_bf16 v[152:155], a[208:211], a[144:147], v[140:143]
  s_mov_b32 m0, 153408
  v_exp_f32 v156, v156
  v_mfma_f32_16x16x32_bf16 v[152:155], a[212:215], a[148:151], v[152:155]
  buffer_load_dwordx4 v1, s[8:11], s28 offen offset:2048 nt lds
  ds_read_b64_tr_b16 a[228:229], v3 offset:8448
  v_mfma_f32_16x16x32_bf16 v[152:155], a[216:219], a[152:155], v[152:155]
  s_mov_b32 m0, 153416
  v_exp_f32 v157, v157
  v_mfma_f32_16x16x32_bf16 v[152:155], a[220:223], a[156:159], v[152:155]
  buffer_load_dwordx4 v1, s[8:11], s28 offen offset:3072 nt lds
  v_cvt_pk_bf16_f32 v66, v156, v157
  v_mfma_f32_16x16x32_bf16 v[220:223], a[232:235], v[84:87], v[220:223]
  s_mov_b32 m0, 157568
  v_exp_f32 v158, v158
  v_mfma_f32_16x16x32_bf16 v[220:223], a[236:239], v[108:111], v[220:223]
  buffer_load_dwordx4 v72, s[8:11], s28 offen offset:0 nt lds
  ds_read_b64_tr_b16 a[230:231], v3 offset:8704
  v_mfma_f32_16x16x32_bf16 v[252:255], a[236:239], v[112:115], v[252:255]
  s_mov_b32 m0, 157576
  v_exp_f32 v159, v159
  v_mfma_f32_16x16x32_bf16 v[252:255], a[232:235], v[88:91], v[252:255]
  buffer_load_dwordx4 v72, s[8:11], s28 offen offset:1024 nt lds
  v_cvt_pk_bf16_f32 v67, v158, v159
  v_mfma_f32_16x16x32_bf16 v[156:159], a[208:211], a[160:163], v[144:147]
  s_mov_b32 m0, 157632
  v_exp_f32 v152, v152
  v_mfma_f32_16x16x32_bf16 v[156:159], a[212:215], a[164:167], v[156:159]
  buffer_load_dwordx4 v72, s[8:11], s28 offen offset:2048 nt lds
  s_mov_b32 m0, 157640
  v_mfma_f32_16x16x32_bf16 v[156:159], a[216:219], a[168:171], v[156:159]
  buffer_load_dwordx4 v72, s[8:11], s28 offen offset:3072 nt lds
  s_cmp_lt_u32 s30, 24576
  s_cselect_b32 m0, s30, 160768
  v_exp_f32 v153, v153
  v_mfma_f32_16x16x32_bf16 v[156:159], a[220:223], a[172:175], v[156:159]
  buffer_load_dwordx4 v149, s[16:19], m0 offen offset:1024 nt lds
  s_cselect_b32 m0, s31, 160768
  v_cvt_pk_bf16_f32 v70, v152, v153
  v_mfma_f32_16x16x32_bf16 a[28:31], a[232:235], v[92:95], a[28:31]
  buffer_load_dwordx4 v149, s[16:19], m0 offen offset:1024 nt lds
  s_cselect_b32 m0, s32, 160768
  v_exp_f32 v154, v154
  v_mfma_f32_16x16x32_bf16 a[28:31], a[236:239], v[116:119], a[28:31]
  buffer_load_dwordx4 v149, s[16:19], m0 offen offset:1024 nt lds
  s_cmp_lt_u32 s34, 20480
  s_cselect_b32 m0, s33, 160768
  v_mfma_f32_16x16x32_bf16 a[60:63], a[236:239], v[100:103], a[60:63]
  buffer_load_dwordx4 v149, s[16:19], m0 offen offset:1024 nt lds
  v_exp_f32 v155, v155
  v_mfma_f32_16x16x32_bf16 a[60:63], a[232:235], v[96:99], a[60:63]
  s_waitcnt lgkmcnt(7)
  ds_read_b64_tr_b16 a[236:237], v3 offset:8456
  v_cvt_pk_bf16_f32 v71, v154, v155
ENTRY0_5:
  v_mfma_f32_16x16x32_bf16 v[152:155], a[192:195], a[96:99], v[128:131]
  s_waitcnt lgkmcnt(6)
  v_exp_f32 v156, v156
  v_mfma_f32_16x16x32_bf16 v[152:155], a[196:199], a[100:103], v[152:155]
  ds_read_b64_tr_b16 a[238:239], v3 offset:8712
  ds_read_b64_tr_b16 a[232:233], v3 offset:8
  v_mfma_f32_16x16x32_bf16 v[152:155], a[200:203], a[104:107], v[152:155]
  s_waitcnt lgkmcnt(5)
  v_exp_f32 v157, v157
  v_mfma_f32_16x16x32_bf16 v[152:155], a[204:207], a[108:111], v[152:155]
  ds_read_b64_tr_b16 a[234:235], v3 offset:264
  v_cvt_pk_bf16_f32 v54, v156, v157
  v_mfma_f32_16x16x32_bf16 v[160:163], a[224:227], v[32:35], v[160:163]
  s_waitcnt lgkmcnt(4)
  v_exp_f32 v158, v158
  v_mfma_f32_16x16x32_bf16 v[160:163], a[228:231], v[56:59], v[160:163]
  ds_read2st64_b32 v[12:13], v4 offset0:8 offset1:9
  ds_read2st64_b32 v[14:15], v4 offset0:10 offset1:11
  v_mfma_f32_16x16x32_bf16 v[192:195], a[228:231], v[60:63], v[192:195]
  v_exp_f32 v159, v159
  v_mfma_f32_16x16x32_bf16 v[192:195], a[224:227], v[36:39], v[192:195]
  ds_read_b128 a[208:211], v2 offset:17152
  v_cvt_pk_bf16_f32 v55, v158, v159
  v_mfma_f32_16x16x32_bf16 v[156:159], a[192:195], a[112:115], v[132:135]
  v_exp_f32 v152, v152
  v_mfma_f32_16x16x32_bf16 v[156:159], a[196:199], a[116:119], v[156:159]
  ds_read_b128 a[212:215], v2 offset:17216
  v_mfma_f32_16x16x32_bf16 v[156:159], a[200:203], a[120:123], v[156:159]
  v_exp_f32 v153, v153
  v_mfma_f32_16x16x32_bf16 v[156:159], a[204:207], a[124:127], v[156:159]
  ds_read_b128 a[216:219], v2 offset:17280
  v_cvt_pk_bf16_f32 v80, v152, v153
  v_mfma_f32_16x16x32_bf16 v[224:227], a[224:227], v[40:43], v[224:227]
  v_exp_f32 v154, v154
  v_mfma_f32_16x16x32_bf16 v[224:227], a[228:231], v[64:67], v[224:227]
  s_waitcnt lgkmcnt(4)
  v_lshlrev_b32 v16, 16, v12
  v_and_b32 v17, s48, v12
  v_mfma_f32_16x16x32_bf16 a[0:3], a[228:231], v[68:71], a[0:3]
  s_mov_b32 s29, s90
  v_exp_f32 v155, v155
  v_mfma_f32_16x16x32_bf16 a[0:3], a[224:227], v[44:47], a[0:3]
  ds_read_b128 a[220:223], v2 offset:17344
  v_cvt_pk_bf16_f32 v81, v154, v155
  v_smfmac_f32_16x16x64_bf16 v[20:23], a[240:243], v[32:39], v5
  v_mfma_f32_16x16x32_bf16 v[152:155], a[192:195], a[128:131], v[136:139]
  s_xor_b32 s28, s90, 0x2000
  v_exp_f32 v156, v156
  v_mfma_f32_16x16x32_bf16 v[152:155], a[196:199], a[132:135], v[152:155]
  v_mul_f32 v16, s46, v16
  v_mul_f32 v17, s46, v17
  v_cvt_pk_bf16_f32 v12, v16, v17
  v_lshlrev_b32 v18, 16, v13
  v_mfma_f32_16x16x32_bf16 v[152:155], a[200:203], a[136:139], v[152:155]
  s_addk_i32 s67, 0x4000
  v_exp_f32 v157, v157
  v_mfma_f32_16x16x32_bf16 v[152:155], a[204:207], a[140:143], v[152:155]
  v_cvt_pk_bf16_f32 v84, v156, v157
  v_mfma_f32_16x16x32_bf16 a[32:35], a[224:227], v[48:51], a[32:35]
  s_xor_b32 s90, s67, s66
  v_exp_f32 v158, v158
  v_mfma_f32_16x16x32_bf16 a[32:35], a[228:231], v[52:55], a[32:35]
  v_and_b32 v19, s48, v13
  v_mul_f32 v18, s46, v18
  v_mul_f32 v19, s46, v19
  v_cvt_pk_bf16_f32 v13, v18, v19
  v_mfma_f32_16x16x32_bf16 v[164:167], a[236:239], v[56:59], v[164:167]
  v_exp_f32 v159, v159
  v_mfma_f32_16x16x32_bf16 v[164:167], a[232:235], v[32:35], v[164:167]
  ds_read_b64_tr_b16 a[224:225], v3 offset:64
  v_cvt_pk_bf16_f32 v85, v158, v159
  v_smfmac_f32_16x16x64_bf16 v[24:27], a[240:243], v[40:47], v5
  v_mfma_f32_16x16x32_bf16 v[156:159], a[192:195], a[144:147], v[140:143]
  s_waitcnt lgkmcnt(5)
  v_exp_f32 v152, v152
  v_mfma_f32_16x16x32_bf16 v[156:159], a[196:199], a[148:151], v[156:159]
  v_lshlrev_b32 v16, 16, v14
  v_and_b32 v17, s48, v14
  v_mul_f32 v16, s46, v16
  v_mul_f32 v17, s46, v17
  v_mfma_f32_16x16x32_bf16 v[156:159], a[200:203], a[152:155], v[156:159]
  v_exp_f32 v153, v153
  v_mfma_f32_16x16x32_bf16 v[156:159], a[204:207], a[156:159], v[156:159]
  ds_read_b64_tr_b16 a[226:227], v3 offset:320
  ds_read_b64_tr_b16 a[228:229], v3 offset:8512
  v_cvt_pk_bf16_f32 v88, v152, v153
  v_mfma_f32_16x16x32_bf16 v[196:199], a[232:235], v[36:39], v[196:199]
  v_exp_f32 v154, v154
  v_mfma_f32_16x16x32_bf16 v[196:199], a[236:239], v[60:63], v[196:199]
  v_cvt_pk_bf16_f32 v14, v16, v17
  v_lshlrev_b32 v18, 16, v15
  v_and_b32 v19, s48, v15
  v_mul_f32 v18, s46, v18
  v_mfma_f32_16x16x32_bf16 v[228:231], a[236:239], v[64:67], v[228:231]
  v_exp_f32 v155, v155
  v_mfma_f32_16x16x32_bf16 v[228:231], a[232:235], v[40:43], v[228:231]
  ds_read_b64_tr_b16 a[230:231], v3 offset:8768
  v_cvt_pk_bf16_f32 v89, v154, v155
  v_mfma_f32_16x16x32_bf16 v[152:155], a[192:195], a[160:163], v[144:147]
  v_exp_f32 v156, v156
  v_mfma_f32_16x16x32_bf16 v[152:155], a[196:199], a[164:167], v[152:155]
  ds_write_b32 v4, v12 offset:2048
  v_mul_f32 v19, s46, v19
  v_cvt_pk_bf16_f32 v15, v18, v19
  v_mfma_f32_16x16x32_bf16 v[152:155], a[200:203], a[168:171], v[152:155]
  v_exp_f32 v157, v157
  v_mfma_f32_16x16x32_bf16 v[152:155], a[204:207], a[172:175], v[152:155]
  v_cvt_pk_bf16_f32 v92, v156, v157
  v_mfma_f32_16x16x32_bf16 a[4:7], a[232:235], v[44:47], a[4:7]
  v_exp_f32 v158, v158
  v_mfma_f32_16x16x32_bf16 a[4:7], a[236:239], v[68:71], a[4:7]
  ds_write_b32 v4, v13 offset:2304
  v_mfma_f32_16x16x32_bf16 a[36:39], a[236:239], v[52:55], a[36:39]
  s_waitcnt lgkmcnt(9)
  v_exp_f32 v159, v159
  v_mfma_f32_16x16x32_bf16 a[36:39], a[232:235], v[48:51], a[36:39]
  ds_read_b64_tr_b16 a[236:237], v3 offset:8520
  v_cvt_pk_bf16_f32 v93, v158, v159
  v_mfma_f32_16x16x32_bf16 v[156:159], a[208:211], a[96:99], v[128:131]
  s_waitcnt lgkmcnt(8)
  v_exp_f32 v152, v152
  v_mfma_f32_16x16x32_bf16 v[156:159], a[212:215], a[100:103], v[156:159]
  ds_read_b64_tr_b16 a[238:239], v3 offset:8776
  ds_read_b64_tr_b16 a[232:233], v3 offset:72
  v_mfma_f32_16x16x32_bf16 v[156:159], a[216:219], a[104:107], v[156:159]
  s_waitcnt lgkmcnt(7)
  v_exp_f32 v153, v153
  v_mfma_f32_16x16x32_bf16 v[156:159], a[220:223], a[108:111], v[156:159]
  ds_read_b64_tr_b16 a[234:235], v3 offset:328
  ds_write_b32 v4, v14 offset:2560
  v_cvt_pk_bf16_f32 v96, v152, v153
  v_mfma_f32_16x16x32_bf16 v[168:171], a[224:227], v[32:35], v[168:171]
  s_waitcnt lgkmcnt(7)
  v_exp_f32 v154, v154
  v_mfma_f32_16x16x32_bf16 v[168:171], a[228:231], v[56:59], v[168:171]
  ds_write_b32 v4, v15 offset:2816
  v_mfma_f32_16x16x32_bf16 v[200:203], a[228:231], v[60:63], v[200:203]
  v_exp_f32 v155, v155
  v_mfma_f32_16x16x32_bf16 v[200:203], a[224:227], v[36:39], v[200:203]
  v_cvt_pk_bf16_f32 v97, v154, v155
  v_smfmac_f32_16x16x64_bf16 v[28:31], a[240:243], v[48:55], v5
  v_mfma_f32_16x16x32_bf16 v[152:155], a[208:211], a[112:115], v[132:135]
  s_mov_b32 m0, 102656
  v_exp_f32 v156, v156
  v_mfma_f32_16x16x32_bf16 v[152:155], a[212:215], a[116:119], v[152:155]
  s_waitcnt vmcnt(32) lgkmcnt(0)
  s_barrier
  v_mfma_f32_16x16x32_bf16 v[152:155], a[216:219], a[120:123], v[152:155]
  buffer_load_dwordx4 v1, s[4:7], s28 offen offset:0 nt lds
  s_mov_b32 m0, 102688
  v_exp_f32 v157, v157
  v_mfma_f32_16x16x32_bf16 v[152:155], a[220:223], a[124:127], v[152:155]
  buffer_load_dwordx4 v1, s[4:7], s28 offen offset:1024 nt lds
  s_mov_b32 m0, 102720
  v_cvt_pk_bf16_f32 v82, v156, v157
  v_mfma_f32_16x16x32_bf16 v[232:235], a[224:227], v[40:43], v[232:235]
  buffer_load_dwordx4 v1, s[4:7], s28 offen offset:2048 nt lds
  s_mov_b32 m0, 102752
  v_exp_f32 v158, v158
  v_mfma_f32_16x16x32_bf16 v[232:235], a[228:231], v[64:67], v[232:235]
  buffer_load_dwordx4 v1, s[4:7], s28 offen offset:3072 nt lds
  ds_read_b128 a[192:195], v2 offset:25344
  s_mov_b32 m0, 106880
  v_mfma_f32_16x16x32_bf16 a[8:11], a[228:231], v[68:71], a[8:11]
  buffer_load_dwordx4 v72, s[4:7], s28 offen offset:0 nt lds
  s_mov_b32 m0, 106912
  v_exp_f32 v159, v159
  v_mfma_f32_16x16x32_bf16 a[8:11], a[224:227], v[44:47], a[8:11]
  buffer_load_dwordx4 v72, s[4:7], s28 offen offset:1024 nt lds
  ds_read_b128 a[196:199], v2 offset:25408
  v_cvt_pk_bf16_f32 v83, v158, v159
  v_mfma_f32_16x16x32_bf16 v[156:159], a[208:211], a[128:131], v[136:139]
  s_mov_b32 m0, 106944
  v_exp_f32 v152, v152
  v_mfma_f32_16x16x32_bf16 v[156:159], a[212:215], a[132:135], v[156:159]
  buffer_load_dwordx4 v72, s[4:7], s28 offen offset:2048 nt lds
  ds_read_b128 a[200:203], v2 offset:25472
  v_mfma_f32_16x16x32_bf16 v[156:159], a[216:219], a[136:139], v[156:159]
  s_mov_b32 m0, 106976
  v_exp_f32 v153, v153
  v_mfma_f32_16x16x32_bf16 v[156:159], a[220:223], a[140:143], v[156:159]
  buffer_load_dwordx4 v72, s[4:7], s28 offen offset:3072 nt lds
  ds_read_b128 a[204:207], v2 offset:25536
  v_cvt_pk_bf16_f32 v86, v152, v153
  v_mfma_f32_16x16x32_bf16 a[40:43], a[224:227], v[48:51], a[40:43]
  s_mov_b32 m0, 111104
  v_exp_f32 v154, v154
  v_mfma_f32_16x16x32_bf16 a[40:43], a[228:231], v[52:55], a[40:43]
  buffer_load_dwordx4 v1, s[4:7], s90 offen offset:0 nt lds
  ds_read_b64_tr_b16 a[224:225], v3 offset:128
  v_mfma_f32_16x16x32_bf16 v[172:175], a[236:239], v[56:59], v[172:175]
  s_mov_b32 m0, 111136
  v_exp_f32 v155, v155
  v_mfma_f32_16x16x32_bf16 v[172:175], a[232:235], v[32:35], v[172:175]
  buffer_load_dwordx4 v1, s[4:7], s90 offen offset:1024 nt lds
  ds_read_b64_tr_b16 a[226:227], v3 offset:384
  v_cvt_pk_bf16_f32 v87, v154, v155
  v_mfma_f32_16x16x32_bf16 v[152:155], a[208:211], a[144:147], v[140:143]
  s_mov_b32 m0, 111168
  v_exp_f32 v156, v156
  v_mfma_f32_16x16x32_bf16 v[152:155], a[212:215], a[148:151], v[152:155]
  buffer_load_dwordx4 v1, s[4:7], s90 offen offset:2048 nt lds
  ds_read_b64_tr_b16 a[228:229], v3 offset:8576
  v_mfma_f32_16x16x32_bf16 v[152:155], a[216:219], a[152:155], v[152:155]
  s_mov_b32 m0, 111200
  v_exp_f32 v157, v157
  v_mfma_f32_16x16x32_bf16 v[152:155], a[220:223], a[156:159], v[152:155]
  buffer_load_dwordx4 v1, s[4:7], s90 offen offset:3072 nt lds
  v_cvt_pk_bf16_f32 v90, v156, v157
  v_mfma_f32_16x16x32_bf16 v[204:207], a[232:235], v[36:39], v[204:207]
  s_mov_b32 m0, 115328
  v_exp_f32 v158, v158
  v_mfma_f32_16x16x32_bf16 v[204:207], a[236:239], v[60:63], v[204:207]
  buffer_load_dwordx4 v72, s[4:7], s90 offen offset:0 nt lds
  ds_read_b64_tr_b16 a[230:231], v3 offset:8832
  v_mfma_f32_16x16x32_bf16 v[236:239], a[236:239], v[64:67], v[236:239]
  s_mov_b32 m0, 115360
  v_exp_f32 v159, v159
  v_mfma_f32_16x16x32_bf16 v[236:239], a[232:235], v[40:43], v[236:239]
  buffer_load_dwordx4 v72, s[4:7], s90 offen offset:1024 nt lds
  v_cvt_pk_bf16_f32 v91, v158, v159
  v_mfma_f32_16x16x32_bf16 v[156:159], a[208:211], a[160:163], v[144:147]
  s_mov_b32 m0, 115392
  v_exp_f32 v152, v152
  v_mfma_f32_16x16x32_bf16 v[156:159], a[212:215], a[164:167], v[156:159]
  buffer_load_dwordx4 v72, s[4:7], s90 offen offset:2048 nt lds
  s_mov_b32 m0, 115424
  v_mfma_f32_16x16x32_bf16 v[156:159], a[216:219], a[168:171], v[156:159]
  buffer_load_dwordx4 v72, s[4:7], s90 offen offset:3072 nt lds
  s_cmp_lt_u32 s30, 24576
  s_cselect_b32 m0, s30, 159744
  v_exp_f32 v153, v153
  v_mfma_f32_16x16x32_bf16 v[156:159], a[220:223], a[172:175], v[156:159]
  buffer_load_dwordx4 v150, s[16:19], m0 offen offset:2048 nt lds
  s_cselect_b32 m0, s31, 159744
  v_cvt_pk_bf16_f32 v94, v152, v153
  v_mfma_f32_16x16x32_bf16 a[12:15], a[232:235], v[44:47], a[12:15]
  buffer_load_dwordx4 v150, s[16:19], m0 offen offset:2048 nt lds
  s_cselect_b32 m0, s32, 159744
  v_exp_f32 v154, v154
  v_mfma_f32_16x16x32_bf16 a[12:15], a[236:239], v[68:71], a[12:15]
  buffer_load_dwordx4 v150, s[16:19], m0 offen offset:2048 nt lds
  s_cmp_lt_u32 s34, 20480
  s_cselect_b32 m0, s33, 159744
  v_mfma_f32_16x16x32_bf16 a[44:47], a[236:239], v[52:55], a[44:47]
  buffer_load_dwordx4 v150, s[16:19], m0 offen offset:2048 nt lds
  v_exp_f32 v155, v155
  v_mfma_f32_16x16x32_bf16 a[44:47], a[232:235], v[48:51], a[44:47]
  s_waitcnt lgkmcnt(7)
  ds_read_b64_tr_b16 a[236:237], v3 offset:8584
  v_cvt_pk_bf16_f32 v95, v154, v155
LAST0_5:
  v_mfma_f32_16x16x32_bf16 v[152:155], a[192:195], a[96:99], v[128:131]
  s_waitcnt lgkmcnt(6)
  v_exp_f32 v156, v156
  v_mfma_f32_16x16x32_bf16 v[152:155], a[196:199], a[100:103], v[152:155]
  ds_read_b64_tr_b16 a[238:239], v3 offset:8840
  ds_read_b64_tr_b16 a[232:233], v3 offset:136
  v_mfma_f32_16x16x32_bf16 v[152:155], a[200:203], a[104:107], v[152:155]
  s_waitcnt lgkmcnt(5)
  v_exp_f32 v157, v157
  v_mfma_f32_16x16x32_bf16 v[152:155], a[204:207], a[108:111], v[152:155]
  ds_read_b64_tr_b16 a[234:235], v3 offset:392
  v_cvt_pk_bf16_f32 v98, v156, v157
  v_mfma_f32_16x16x32_bf16 v[176:179], a[224:227], v[32:35], v[176:179]
  s_waitcnt lgkmcnt(4)
  v_exp_f32 v158, v158
  v_mfma_f32_16x16x32_bf16 v[176:179], a[228:231], v[56:59], v[176:179]
  ds_read2st64_b32 v[12:13], v4 offset0:12 offset1:13
  ds_read2st64_b32 v[14:15], v4 offset0:14 offset1:15
  v_mfma_f32_16x16x32_bf16 v[208:211], a[228:231], v[60:63], v[208:211]
  v_exp_f32 v159, v159
  v_mfma_f32_16x16x32_bf16 v[208:211], a[224:227], v[36:39], v[208:211]
  ds_read_b128 a[208:211], v2 offset:25600
  v_cvt_pk_bf16_f32 v99, v158, v159
  v_mfma_f32_16x16x32_bf16 v[156:159], a[192:195], a[112:115], v[132:135]
  v_exp_f32 v152, v152
  v_mfma_f32_16x16x32_bf16 v[156:159], a[196:199], a[116:119], v[156:159]
  ds_read_b128 a[212:215], v2 offset:25664
  v_mfma_f32_16x16x32_bf16 v[156:159], a[200:203], a[120:123], v[156:159]
  v_exp_f32 v153, v153
  v_mfma_f32_16x16x32_bf16 v[156:159], a[204:207], a[124:127], v[156:159]
  ds_read_b128 a[216:219], v2 offset:25728
  v_cvt_pk_bf16_f32 v104, v152, v153
  v_mfma_f32_16x16x32_bf16 v[240:243], a[224:227], v[40:43], v[240:243]
  v_exp_f32 v154, v154
  v_mfma_f32_16x16x32_bf16 v[240:243], a[228:231], v[64:67], v[240:243]
  s_waitcnt lgkmcnt(4)
  v_lshlrev_b32 v16, 16, v12
  v_and_b32 v17, s48, v12
  v_mfma_f32_16x16x32_bf16 a[16:19], a[228:231], v[68:71], a[16:19]
  v_exp_f32 v155, v155
  v_mfma_f32_16x16x32_bf16 a[16:19], a[224:227], v[44:47], a[16:19]
  ds_read_b128 a[220:223], v2 offset:25792
  v_cvt_pk_bf16_f32 v105, v154, v155
  v_smfmac_f32_16x16x64_bf16 v[20:23], a[240:243], v[56:63], v5
  v_mfma_f32_16x16x32_bf16 v[152:155], a[192:195], a[128:131], v[136:139]
  v_exp_f32 v156, v156
  v_mfma_f32_16x16x32_bf16 v[152:155], a[196:199], a[132:135], v[152:155]
  v_mul_f32 v16, s46, v16
  v_mul_f32 v17, s46, v17
  v_cvt_pk_bf16_f32 v12, v16, v17
  v_lshlrev_b32 v18, 16, v13
  v_mfma_f32_16x16x32_bf16 v[152:155], a[200:203], a[136:139], v[152:155]
  v_exp_f32 v157, v157
  v_mfma_f32_16x16x32_bf16 v[152:155], a[204:207], a[140:143], v[152:155]
  v_cvt_pk_bf16_f32 v108, v156, v157
  v_mfma_f32_16x16x32_bf16 a[48:51], a[224:227], v[48:51], a[48:51]
  v_exp_f32 v158, v158
  v_mfma_f32_16x16x32_bf16 a[48:51], a[228:231], v[52:55], a[48:51]
  v_and_b32 v19, s48, v13
  v_mul_f32 v18, s46, v18
  v_mul_f32 v19, s46, v19
  v_cvt_pk_bf16_f32 v13, v18, v19
  v_mfma_f32_16x16x32_bf16 v[180:183], a[236:239], v[56:59], v[180:183]
  v_exp_f32 v159, v159
  v_mfma_f32_16x16x32_bf16 v[180:183], a[232:235], v[32:35], v[180:183]
  ds_read_b64_tr_b16 a[224:225], v3 offset:192
  v_cvt_pk_bf16_f32 v109, v158, v159
  v_smfmac_f32_16x16x64_bf16 v[24:27], a[240:243], v[64:71], v5
  v_mfma_f32_16x16x32_bf16 v[156:159], a[192:195], a[144:147], v[140:143]
  s_waitcnt lgkmcnt(5)
  v_exp_f32 v152, v152
  v_mfma_f32_16x16x32_bf16 v[156:159], a[196:199], a[148:151], v[156:159]
  v_lshlrev_b32 v16, 16, v14
  v_and_b32 v17, s48, v14
  v_mul_f32 v16, s46, v16
  v_mul_f32 v17, s46, v17
  v_mfma_f32_16x16x32_bf16 v[156:159], a[200:203], a[152:155], v[156:159]
  v_exp_f32 v153, v153
  v_mfma_f32_16x16x32_bf16 v[156:159], a[204:207], a[156:159], v[156:159]
  ds_read_b64_tr_b16 a[226:227], v3 offset:448
  ds_read_b64_tr_b16 a[228:229], v3 offset:8640
  v_cvt_pk_bf16_f32 v112, v152, v153
  v_mfma_f32_16x16x32_bf16 v[212:215], a[232:235], v[36:39], v[212:215]
  v_exp_f32 v154, v154
  v_mfma_f32_16x16x32_bf16 v[212:215], a[236:239], v[60:63], v[212:215]
  v_cvt_pk_bf16_f32 v14, v16, v17
  v_lshlrev_b32 v18, 16, v15
  v_and_b32 v19, s48, v15
  v_mul_f32 v18, s46, v18
  v_mfma_f32_16x16x32_bf16 v[244:247], a[236:239], v[64:67], v[244:247]
  v_exp_f32 v155, v155
  v_mfma_f32_16x16x32_bf16 v[244:247], a[232:235], v[40:43], v[244:247]
  ds_read_b64_tr_b16 a[230:231], v3 offset:8896
  v_cvt_pk_bf16_f32 v113, v154, v155
  v_mfma_f32_16x16x32_bf16 v[152:155], a[192:195], a[160:163], v[144:147]
  s_addk_i32 s50, 0x1000
  v_exp_f32 v156, v156
  v_mfma_f32_16x16x32_bf16 v[152:155], a[196:199], a[164:167], v[152:155]
  ds_write_b32 v4, v12 offset:3072
  v_mul_f32 v19, s46, v19
  v_cvt_pk_bf16_f32 v15, v18, v19
  v_mfma_f32_16x16x32_bf16 v[152:155], a[200:203], a[168:171], v[152:155]
  v_exp_f32 v157, v157
  v_mfma_f32_16x16x32_bf16 v[152:155], a[204:207], a[172:175], v[152:155]
  v_cvt_pk_bf16_f32 v116, v156, v157
  v_mfma_f32_16x16x32_bf16 a[20:23], a[232:235], v[44:47], a[20:23]
  s_cmp_eq_u32 s50, s51
  v_exp_f32 v158, v158
  v_mfma_f32_16x16x32_bf16 a[20:23], a[236:239], v[68:71], a[20:23]
  ds_write_b32 v4, v13 offset:3328
  v_mfma_f32_16x16x32_bf16 a[52:55], a[236:239], v[52:55], a[52:55]
  s_waitcnt lgkmcnt(7)
  v_exp_f32 v159, v159
  v_mfma_f32_16x16x32_bf16 a[52:55], a[232:235], v[48:51], a[52:55]
  ds_read_b64_tr_b16 a[236:237], v3 offset:8648
  v_cvt_pk_bf16_f32 v117, v158, v159
  v_mfma_f32_16x16x32_bf16 v[156:159], a[208:211], a[96:99], v[128:131]
  s_cselect_b32 s50, s45, s50
  v_exp_f32 v152, v152
  v_mfma_f32_16x16x32_bf16 v[156:159], a[212:215], a[100:103], v[156:159]
  ds_read_b64_tr_b16 a[238:239], v3 offset:8904
  ds_read_b64_tr_b16 a[232:233], v3 offset:200
  v_mfma_f32_16x16x32_bf16 v[156:159], a[216:219], a[104:107], v[156:159]
  s_waitcnt lgkmcnt(7)
  v_exp_f32 v153, v153
  v_mfma_f32_16x16x32_bf16 v[156:159], a[220:223], a[108:111], v[156:159]
  ds_read_b64_tr_b16 a[234:235], v3 offset:456
  ds_write_b32 v4, v14 offset:3584
  v_cvt_pk_bf16_f32 v100, v152, v153
  v_mfma_f32_16x16x32_bf16 v[184:187], a[224:227], v[32:35], v[184:187]
  s_waitcnt lgkmcnt(7)
  v_exp_f32 v154, v154
  v_mfma_f32_16x16x32_bf16 v[184:187], a[228:231], v[56:59], v[184:187]
  ds_write_b32 v4, v15 offset:3840
  v_mfma_f32_16x16x32_bf16 v[216:219], a[228:231], v[60:63], v[216:219]
  v_exp_f32 v155, v155
  v_mfma_f32_16x16x32_bf16 v[216:219], a[224:227], v[36:39], v[216:219]
  v_cvt_pk_bf16_f32 v101, v154, v155
  v_lshl_add_u32 v4, v0, 2, s50
  v_mfma_f32_16x16x32_bf16 v[152:155], a[208:211], a[112:115], v[132:135]
  s_mov_b32 m0, 128000
  v_exp_f32 v156, v156
  v_mfma_f32_16x16x32_bf16 v[152:155], a[212:215], a[116:119], v[152:155]
  s_waitcnt vmcnt(24) lgkmcnt(0)
  s_barrier
  v_mfma_f32_16x16x32_bf16 v[152:155], a[216:219], a[120:123], v[152:155]
  buffer_load_dwordx4 v1, s[8:11], s29 offen offset:0 nt lds
  s_mov_b32 m0, 128008
  v_exp_f32 v157, v157
  v_mfma_f32_16x16x32_bf16 v[152:155], a[220:223], a[124:127], v[152:155]
  buffer_load_dwordx4 v1, s[8:11], s29 offen offset:1024 nt lds
  s_mov_b32 m0, 128064
  v_cvt_pk_bf16_f32 v106, v156, v157
  v_mfma_f32_16x16x32_bf16 v[248:251], a[224:227], v[40:43], v[248:251]
  buffer_load_dwordx4 v1, s[8:11], s29 offen offset:2048 nt lds
  s_mov_b32 m0, 128072
  v_exp_f32 v158, v158
  v_mfma_f32_16x16x32_bf16 v[248:251], a[228:231], v[64:67], v[248:251]
  buffer_load_dwordx4 v1, s[8:11], s29 offen offset:3072 nt lds
  ds_read_b128 a[192:195], v2 offset:0
  s_mov_b32 m0, 132224
  v_mfma_f32_16x16x32_bf16 a[24:27], a[228:231], v[68:71], a[24:27]
  buffer_load_dwordx4 v72, s[8:11], s29 offen offset:0 nt lds
  s_mov_b32 m0, 132232
  v_exp_f32 v159, v159
  v_mfma_f32_16x16x32_bf16 a[24:27], a[224:227], v[44:47], a[24:27]
  buffer_load_dwordx4 v72, s[8:11], s29 offen offset:1024 nt lds
  ds_read_b128 a[196:199], v2 offset:64
  v_cvt_pk_bf16_f32 v107, v158, v159
  v_mfma_f32_16x16x32_bf16 v[156:159], a[208:211], a[128:131], v[136:139]
  s_mov_b32 m0, 132288
  v_exp_f32 v152, v152
  v_mfma_f32_16x16x32_bf16 v[156:159], a[212:215], a[132:135], v[156:159]
  buffer_load_dwordx4 v72, s[8:11], s29 offen offset:2048 nt lds
  ds_read_b128 a[200:203], v2 offset:128
  v_mfma_f32_16x16x32_bf16 v[156:159], a[216:219], a[136:139], v[156:159]
  s_mov_b32 m0, 132296
  v_exp_f32 v153, v153
  v_mfma_f32_16x16x32_bf16 v[156:159], a[220:223], a[140:143], v[156:159]
  buffer_load_dwordx4 v72, s[8:11], s29 offen offset:3072 nt lds
  ds_read_b128 a[204:207], v2 offset:192
  v_cvt_pk_bf16_f32 v110, v152, v153
  v_mfma_f32_16x16x32_bf16 a[56:59], a[224:227], v[48:51], a[56:59]
  s_mov_b32 m0, 136448
  v_exp_f32 v154, v154
  v_mfma_f32_16x16x32_bf16 a[56:59], a[228:231], v[52:55], a[56:59]
  buffer_load_dwordx4 v1, s[8:11], s28 offen offset:0 nt lds
  ds_read_b64_tr_b16 a[224:225], v3 offset:16896
  v_mfma_f32_16x16x32_bf16 v[188:191], a[236:239], v[56:59], v[188:191]
  s_mov_b32 m0, 136456
  v_exp_f32 v155, v155
  v_mfma_f32_16x16x32_bf16 v[188:191], a[232:235], v[32:35], v[188:191]
  buffer_load_dwordx4 v1, s[8:11], s28 offen offset:1024 nt lds
  ds_read_b64_tr_b16 a[226:227], v3 offset:17152
  v_cvt_pk_bf16_f32 v111, v154, v155
  v_mfma_f32_16x16x32_bf16 v[152:155], a[208:211], a[144:147], v[140:143]
  s_mov_b32 m0, 136512
  v_exp_f32 v156, v156
  v_mfma_f32_16x16x32_bf16 v[152:155], a[212:215], a[148:151], v[152:155]
  buffer_load_dwordx4 v1, s[8:11], s28 offen offset:2048 nt lds
  ds_read_b64_tr_b16 a[228:229], v3 offset:25344
  v_mfma_f32_16x16x32_bf16 v[152:155], a[216:219], a[152:155], v[152:155]
  s_mov_b32 m0, 136520
  v_exp_f32 v157, v157
  v_mfma_f32_16x16x32_bf16 v[152:155], a[220:223], a[156:159], v[152:155]
  buffer_load_dwordx4 v1, s[8:11], s28 offen offset:3072 nt lds
  v_cvt_pk_bf16_f32 v114, v156, v157
  v_mfma_f32_16x16x32_bf16 v[220:223], a[232:235], v[36:39], v[220:223]
  s_mov_b32 m0, 140672
  v_exp_f32 v158, v158
  v_mfma_f32_16x16x32_bf16 v[220:223], a[236:239], v[60:63], v[220:223]
  buffer_load_dwordx4 v72, s[8:11], s28 offen offset:0 nt lds
  ds_read_b64_tr_b16 a[230:231], v3 offset:25600
  v_mfma_f32_16x16x32_bf16 v[252:255], a[236:239], v[64:67], v[252:255]
  s_mov_b32 m0, 140680
  v_exp_f32 v159, v159
  v_mfma_f32_16x16x32_bf16 v[252:255], a[232:235], v[40:43], v[252:255]
  buffer_load_dwordx4 v72, s[8:11], s28 offen offset:1024 nt lds
  v_cvt_pk_bf16_f32 v115, v158, v159
  v_mfma_f32_16x16x32_bf16 v[156:159], a[208:211], a[160:163], v[144:147]
  s_mov_b32 m0, 140736
  v_exp_f32 v152, v152
  v_mfma_f32_16x16x32_bf16 v[156:159], a[212:215], a[164:167], v[156:159]
  buffer_load_dwordx4 v72, s[8:11], s28 offen offset:2048 nt lds
  s_mov_b32 m0, 140744
  v_mfma_f32_16x16x32_bf16 v[156:159], a[216:219], a[168:171], v[156:159]
  buffer_load_dwordx4 v72, s[8:11], s28 offen offset:3072 nt lds
  s_cmp_lt_u32 s30, 24576
  s_cselect_b32 m0, s30, 158720
  v_exp_f32 v153, v153
  v_mfma_f32_16x16x32_bf16 v[156:159], a[220:223], a[172:175], v[156:159]
  buffer_load_dwordx4 v151, s[16:19], m0 offen offset:3072 nt lds
  s_cselect_b32 m0, s31, 158720
  v_cvt_pk_bf16_f32 v118, v152, v153
  v_mfma_f32_16x16x32_bf16 a[28:31], a[232:235], v[44:47], a[28:31]
  buffer_load_dwordx4 v151, s[16:19], m0 offen offset:3072 nt lds
  s_cselect_b32 m0, s32, 158720
  v_exp_f32 v154, v154
  v_mfma_f32_16x16x32_bf16 a[28:31], a[236:239], v[68:71], a[28:31]
  buffer_load_dwordx4 v151, s[16:19], m0 offen offset:3072 nt lds
  s_cmp_lt_u32 s34, 20480
  s_cselect_b32 m0, s33, 158720
  v_mfma_f32_16x16x32_bf16 a[60:63], a[236:239], v[52:55], a[60:63]
  buffer_load_dwordx4 v151, s[16:19], m0 offen offset:3072 nt lds
  v_exp_f32 v155, v155
  v_mfma_f32_16x16x32_bf16 a[60:63], a[232:235], v[48:51], a[60:63]
  s_waitcnt lgkmcnt(7)
  s_sub_u32 s39, s39, 1
  ds_read_b64_tr_b16 a[236:237], v3 offset:25352
  v_cvt_pk_bf16_f32 v119, v154, v155
  s_cbranch_scc0 LOOP0_5
  v_smfmac_f32_16x16x64_bf16 v[20:23], a[240:243], v[80:87], v5
  ds_read_b64_tr_b16 a[238:239], v3 offset:25608
  v_smfmac_f32_16x16x64_bf16 v[20:23], a[240:243], v[104:111], v5
  ds_read_b64_tr_b16 a[232:233], v3 offset:16904
  s_waitcnt lgkmcnt(5)
  v_mfma_f32_16x16x32_bf16 v[160:163], a[224:227], v[80:83], v[160:163]
  s_waitcnt lgkmcnt(2)
  ds_read_b64_tr_b16 a[234:235], v3 offset:17160
  ds_read_b64_tr_b16 a[148:149], v3 offset:25408
  v_mfma_f32_16x16x32_bf16 v[160:163], a[228:231], v[104:107], v[160:163]
  ds_read_b64_tr_b16 a[150:151], v3 offset:25664
  ds_read_b64_tr_b16 a[144:145], v3 offset:16960
  v_mfma_f32_16x16x32_bf16 v[192:195], a[224:227], v[84:87], v[192:195]
  ds_read_b64_tr_b16 a[146:147], v3 offset:17216
  ds_read_b64_tr_b16 a[156:157], v3 offset:25416
  v_mfma_f32_16x16x32_bf16 v[192:195], a[228:231], v[108:111], v[192:195]
  ds_read_b64_tr_b16 a[158:159], v3 offset:25672
  ds_read_b64_tr_b16 a[152:153], v3 offset:16968
  v_mfma_f32_16x16x32_bf16 v[224:227], a[224:227], v[88:91], v[224:227]
  ds_read_b64_tr_b16 a[154:155], v3 offset:17224
  ds_read_b64_tr_b16 a[164:165], v3 offset:25472
  v_mfma_f32_16x16x32_bf16 v[224:227], a[228:231], v[112:115], v[224:227]
  ds_read_b64_tr_b16 a[166:167], v3 offset:25728
  ds_read_b64_tr_b16 a[160:161], v3 offset:17024
  v_mfma_f32_16x16x32_bf16 a[0:3], a[224:227], v[92:95], a[0:3]
  ds_read_b64_tr_b16 a[162:163], v3 offset:17280
  ds_read_b64_tr_b16 a[172:173], v3 offset:25480
  v_mfma_f32_16x16x32_bf16 a[0:3], a[228:231], v[116:119], a[0:3]
  ds_read_b64_tr_b16 a[174:175], v3 offset:25736
  ds_read_b64_tr_b16 a[168:169], v3 offset:17032
  v_mfma_f32_16x16x32_bf16 a[32:35], a[224:227], v[96:99], a[32:35]
  ds_read_b64_tr_b16 a[170:171], v3 offset:17288
  ds_read_b64_tr_b16 a[180:181], v3 offset:25536
  v_smfmac_f32_16x16x64_bf16 v[24:27], a[240:243], v[88:95], v5
  ds_read_b64_tr_b16 a[182:183], v3 offset:25792
  v_smfmac_f32_16x16x64_bf16 v[24:27], a[240:243], v[112:119], v5
  s_waitcnt lgkmcnt(14)
  ds_read_b64_tr_b16 a[176:177], v3 offset:17088
  v_mfma_f32_16x16x32_bf16 v[164:167], a[236:239], v[104:107], v[164:167]
  ds_read_b64_tr_b16 a[178:179], v3 offset:17344
  ds_read_b64_tr_b16 a[188:189], v3 offset:25544
  v_mfma_f32_16x16x32_bf16 v[164:167], a[232:235], v[80:83], v[164:167]
  ds_read_b64_tr_b16 a[190:191], v3 offset:25800
  ds_read_b64_tr_b16 a[184:185], v3 offset:17096
  v_mfma_f32_16x16x32_bf16 v[196:199], a[236:239], v[108:111], v[196:199]
  ds_read_b64_tr_b16 a[186:187], v3 offset:17352
  v_exp_f32 v156, v156
  v_exp_f32 v157, v157
  v_exp_f32 v158, v158
  v_exp_f32 v159, v159
  v_cvt_pk_bf16_f32 v102, v156, v157
  v_cvt_pk_bf16_f32 v103, v158, v159
  v_mfma_f32_16x16x32_bf16 v[196:199], a[232:235], v[84:87], v[196:199]
  ds_read_b128 a[96:99], v8 offset:0
  ds_read_b128 a[100:103], v9 offset:0
  v_mfma_f32_16x16x32_bf16 a[32:35], a[228:231], v[100:103], a[32:35]
  ds_read_b128 a[104:107], v10 offset:0
  ds_read_b128 a[108:111], v11 offset:0
  v_mfma_f32_16x16x32_bf16 v[228:231], a[236:239], v[112:115], v[228:231]
  v_add_f32 v20, v20, v21
  v_rcp_f32 v12, v20
  v_mfma_f32_16x16x32_bf16 v[228:231], a[232:235], v[88:91], v[228:231]
  v_mul_f32 v21, s82, v12
  v_fma_f32 v160, v160, v12, v21
  v_mfma_f32_16x16x32_bf16 a[4:7], a[236:239], v[116:119], a[4:7]
  v_fma_f32 v161, v161, v12, v21
  v_fma_f32 v162, v162, v12, v21
  v_mfma_f32_16x16x32_bf16 a[4:7], a[232:235], v[92:95], a[4:7]
  v_fma_f32 v163, v163, v12, v21
  v_fma_f32 v164, v164, v12, v21
  v_mfma_f32_16x16x32_bf16 a[36:39], a[236:239], v[100:103], a[36:39]
  v_fma_f32 v165, v165, v12, v21
  v_fma_f32 v166, v166, v12, v21
  v_mfma_f32_16x16x32_bf16 a[36:39], a[232:235], v[96:99], a[36:39]
  v_fma_f32 v167, v167, v12, v21
  v_cvt_pk_bf16_f32 v160, v160, v161
  v_smfmac_f32_16x16x64_bf16 v[28:31], a[240:243], v[96:103], v5
  ds_read_b128 a[112:115], v8 offset:4096
  v_mfma_f32_16x16x32_bf16 v[168:171], a[144:147], v[80:83], v[168:171]
  s_waitcnt lgkmcnt(1)
  ds_read_b128 a[116:119], v9 offset:4096
  ds_read_b128 a[120:123], v10 offset:4096
  v_mfma_f32_16x16x32_bf16 v[168:171], a[148:151], v[104:107], v[168:171]
  ds_read_b128 a[124:127], v11 offset:4096
  ds_read_b128 a[208:211], v2 offset:256
  v_mfma_f32_16x16x32_bf16 v[172:175], a[156:159], v[104:107], v[172:175]
  ds_read_b128 a[212:215], v2 offset:320
  ds_read_b128 a[216:219], v2 offset:384
  v_mfma_f32_16x16x32_bf16 v[172:175], a[152:155], v[80:83], v[172:175]
  ds_read_b128 a[220:223], v2 offset:448
  v_cvt_pk_bf16_f32 v161, v162, v163
  v_mfma_f32_16x16x32_bf16 v[176:179], a[160:163], v[80:83], v[176:179]
  v_cvt_pk_bf16_f32 v162, v164, v165
  v_cvt_pk_bf16_f32 v163, v166, v167
  v_mfma_f32_16x16x32_bf16 v[176:179], a[164:167], v[104:107], v[176:179]
  ds_write_b128 v8, v[160:163] offset:0
  v_mfma_f32_16x16x32_bf16 v[180:183], a[172:175], v[104:107], v[180:183]
  v_fma_f32 v168, v168, v12, v21
  v_fma_f32 v169, v169, v12, v21
  v_mfma_f32_16x16x32_bf16 v[180:183], a[168:171], v[80:83], v[180:183]
  v_fma_f32 v170, v170, v12, v21
  v_fma_f32 v171, v171, v12, v21
  v_mfma_f32_16x16x32_bf16 v[184:187], a[176:179], v[80:83], v[184:187]
  v_fma_f32 v172, v172, v12, v21
  v_fma_f32 v173, v173, v12, v21
  v_mfma_f32_16x16x32_bf16 v[184:187], a[180:183], v[104:107], v[184:187]
  v_fma_f32 v174, v174, v12, v21
  v_fma_f32 v175, v175, v12, v21
  v_mfma_f32_16x16x32_bf16 v[188:191], a[188:191], v[104:107], v[188:191]
  s_waitcnt lgkmcnt(1)
  v_cvt_pk_bf16_f32 v168, v168, v169
  v_cvt_pk_bf16_f32 v169, v170, v171
  v_mfma_f32_16x16x32_bf16 v[188:191], a[184:187], v[80:83], v[188:191]
  v_cvt_pk_bf16_f32 v170, v172, v173
  v_cvt_pk_bf16_f32 v171, v174, v175
  v_mfma_f32_16x16x32_bf16 v[200:203], a[144:147], v[84:87], v[200:203]
  ds_write_b128 v9, v[168:171] offset:0
  v_mfma_f32_16x16x32_bf16 v[200:203], a[148:151], v[108:111], v[200:203]
  v_fma_f32 v176, v176, v12, v21
  v_fma_f32 v177, v177, v12, v21
  v_mfma_f32_16x16x32_bf16 v[204:207], a[156:159], v[108:111], v[204:207]
  v_fma_f32 v178, v178, v12, v21
  v_fma_f32 v179, v179, v12, v21
  v_mfma_f32_16x16x32_bf16 v[204:207], a[152:155], v[84:87], v[204:207]
  v_fma_f32 v180, v180, v12, v21
  v_fma_f32 v181, v181, v12, v21
  v_mfma_f32_16x16x32_bf16 v[208:211], a[160:163], v[84:87], v[208:211]
  v_fma_f32 v182, v182, v12, v21
  v_fma_f32 v183, v183, v12, v21
  v_mfma_f32_16x16x32_bf16 v[208:211], a[164:167], v[108:111], v[208:211]
  v_cvt_pk_bf16_f32 v176, v176, v177
  v_cvt_pk_bf16_f32 v177, v178, v179
  v_mfma_f32_16x16x32_bf16 v[212:215], a[172:175], v[108:111], v[212:215]
  v_cvt_pk_bf16_f32 v178, v180, v181
  v_cvt_pk_bf16_f32 v179, v182, v183
  v_mfma_f32_16x16x32_bf16 v[212:215], a[168:171], v[84:87], v[212:215]
  v_add_f32 v28, v28, v30
  v_add_f32 v29, v29, v31
  v_mfma_f32_16x16x32_bf16 v[216:219], a[176:179], v[84:87], v[216:219]
  v_add_f32 v22, v22, v23
  v_rcp_f32 v13, v22
  v_mfma_f32_16x16x32_bf16 v[216:219], a[180:183], v[108:111], v[216:219]
  v_mul_f32 v23, s82, v13
  v_add_f32 v24, v24, v25
  v_mfma_f32_16x16x32_bf16 v[220:223], a[188:191], v[108:111], v[220:223]
  v_rcp_f32 v14, v24
  v_mfma_f32_16x16x32_bf16 v[220:223], a[184:187], v[84:87], v[220:223]
  ds_write_b128 v10, v[176:179] offset:0
  v_mfma_f32_16x16x32_bf16 v[232:235], a[144:147], v[88:91], v[232:235]
  v_mul_f32 v25, s82, v14
  v_add_f32 v26, v26, v27
  v_mfma_f32_16x16x32_bf16 v[232:235], a[148:151], v[112:115], v[232:235]
  v_rcp_f32 v15, v26
  v_mfma_f32_16x16x32_bf16 v[236:239], a[156:159], v[112:115], v[236:239]
  v_mul_f32 v27, s82, v15
  v_add_f32 v28, v28, v29
  v_mfma_f32_16x16x32_bf16 v[236:239], a[152:155], v[88:91], v[236:239]
  v_rcp_f32 v16, v28
  v_mfma_f32_16x16x32_bf16 v[240:243], a[160:163], v[88:91], v[240:243]
  v_mul_f32 v29, s82, v16
  v_add_f32 v6, v20, v22
  v_mfma_f32_16x16x32_bf16 v[240:243], a[164:167], v[112:115], v[240:243]
  v_add_f32 v6, v6, v24
  v_add_f32 v6, v6, v26
  v_mfma_f32_16x16x32_bf16 v[244:247], a[172:175], v[112:115], v[244:247]
  v_add_f32 v6, v6, v28
  v_cmp_nge_f32 s[40:41], s49, v6
  v_mfma_f32_16x16x32_bf16 v[244:247], a[168:171], v[88:91], v[244:247]
  v_accvgpr_write_b32 a248, s89
  v_accvgpr_write_b32 a249, s89
  v_mfma_f32_16x16x32_bf16 v[248:251], a[176:179], v[88:91], v[248:251]
  v_accvgpr_write_b32 a250, s89
  v_accvgpr_write_b32 a251, s89
  v_mfma_f32_16x16x32_bf16 v[248:251], a[180:183], v[112:115], v[248:251]
  v_fma_f32 v184, v184, v12, v21
  v_fma_f32 v185, v185, v12, v21
  v_mfma_f32_16x16x32_bf16 v[252:255], a[188:191], v[112:115], v[252:255]
  v_fma_f32 v186, v186, v12, v21
  v_fma_f32 v187, v187, v12, v21
  v_mfma_f32_16x16x32_bf16 v[252:255], a[184:187], v[88:91], v[252:255]
  v_fma_f32 v188, v188, v12, v21
  v_fma_f32 v189, v189, v12, v21
  v_mfma_f32_16x16x32_bf16 a[8:11], a[144:147], v[92:95], a[8:11]
  v_fma_f32 v190, v190, v12, v21
  v_fma_f32 v191, v191, v12, v21
  v_mfma_f32_16x16x32_bf16 a[8:11], a[148:151], v[116:119], a[8:11]
  v_cvt_pk_bf16_f32 v184, v184, v185
  v_cvt_pk_bf16_f32 v185, v186, v187
  v_mfma_f32_16x16x32_bf16 a[12:15], a[156:159], v[116:119], a[12:15]
  v_cvt_pk_bf16_f32 v186, v188, v189
  v_cvt_pk_bf16_f32 v187, v190, v191
  v_mfma_f32_16x16x32_bf16 a[12:15], a[152:155], v[92:95], a[12:15]
  v_fma_f32 v192, v192, v13, v23
  v_fma_f32 v193, v193, v13, v23
  v_mfma_f32_16x16x32_bf16 a[16:19], a[160:163], v[92:95], a[16:19]
  v_fma_f32 v194, v194, v13, v23
  v_fma_f32 v195, v195, v13, v23
  v_mfma_f32_16x16x32_bf16 a[16:19], a[164:167], v[116:119], a[16:19]
  v_fma_f32 v196, v196, v13, v23
  v_fma_f32 v197, v197, v13, v23
  v_mfma_f32_16x16x32_bf16 a[20:23], a[172:175], v[116:119], a[20:23]
  v_fma_f32 v198, v198, v13, v23
  v_fma_f32 v199, v199, v13, v23
  v_mfma_f32_16x16x32_bf16 a[20:23], a[168:171], v[92:95], a[20:23]
  v_cvt_pk_bf16_f32 v192, v192, v193
  v_cvt_pk_bf16_f32 v193, v194, v195
  v_mfma_f32_16x16x32_bf16 a[24:27], a[176:179], v[92:95], a[24:27]
  v_cvt_pk_bf16_f32 v194, v196, v197
  v_cvt_pk_bf16_f32 v195, v198, v199
  v_mfma_f32_16x16x32_bf16 a[24:27], a[180:183], v[116:119], a[24:27]
  v_fma_f32 v200, v200, v13, v23
  v_fma_f32 v201, v201, v13, v23
  v_mfma_f32_16x16x32_bf16 a[28:31], a[188:191], v[116:119], a[28:31]
  v_fma_f32 v202, v202, v13, v23
  v_fma_f32 v203, v203, v13, v23
  v_mfma_f32_16x16x32_bf16 a[28:31], a[184:187], v[92:95], a[28:31]
  ds_write_b128 v11, v[184:187] offset:0
  v_mfma_f32_16x16x32_bf16 a[40:43], a[144:147], v[96:99], a[40:43]
  v_fma_f32 v204, v204, v13, v23
  v_fma_f32 v205, v205, v13, v23
  v_mfma_f32_16x16x32_bf16 a[40:43], a[148:151], v[100:103], a[40:43]
  v_fma_f32 v206, v206, v13, v23
  v_fma_f32 v207, v207, v13, v23
  v_mfma_f32_16x16x32_bf16 a[44:47], a[156:159], v[100:103], a[44:47]
  v_cvt_pk_bf16_f32 v200, v200, v201
  v_cvt_pk_bf16_f32 v201, v202, v203
  v_mfma_f32_16x16x32_bf16 a[44:47], a[152:155], v[96:99], a[44:47]
  v_cvt_pk_bf16_f32 v202, v204, v205
  v_cvt_pk_bf16_f32 v203, v206, v207
  v_mfma_f32_16x16x32_bf16 a[48:51], a[160:163], v[96:99], a[48:51]
  v_fma_f32 v208, v208, v13, v23
  v_fma_f32 v209, v209, v13, v23
  v_mfma_f32_16x16x32_bf16 a[48:51], a[164:167], v[100:103], a[48:51]
  v_fma_f32 v210, v210, v13, v23
  v_fma_f32 v211, v211, v13, v23
  v_mfma_f32_16x16x32_bf16 a[52:55], a[172:175], v[100:103], a[52:55]
  v_fma_f32 v212, v212, v13, v23
  v_fma_f32 v213, v213, v13, v23
  v_mfma_f32_16x16x32_bf16 a[52:55], a[168:171], v[96:99], a[52:55]
  v_fma_f32 v214, v214, v13, v23
  v_fma_f32 v215, v215, v13, v23
  v_mfma_f32_16x16x32_bf16 a[56:59], a[176:179], v[96:99], a[56:59]
  v_cvt_pk_bf16_f32 v208, v208, v209
  v_cvt_pk_bf16_f32 v209, v210, v211
  v_mfma_f32_16x16x32_bf16 a[56:59], a[180:183], v[100:103], a[56:59]
  v_cvt_pk_bf16_f32 v210, v212, v213
  v_cvt_pk_bf16_f32 v211, v214, v215
  v_mfma_f32_16x16x32_bf16 a[60:63], a[188:191], v[100:103], a[60:63]
  v_fma_f32 v216, v216, v13, v23
  v_fma_f32 v217, v217, v13, v23
  v_mfma_f32_16x16x32_bf16 a[60:63], a[184:187], v[96:99], a[60:63]
  s_waitcnt vmcnt(0)
  ds_write_b128 v8, v[192:195] offset:4096
  v_mfma_f32_16x16x32_bf16 v[152:155], a[192:195], a[96:99], 0
  s_barrier
  ds_read_b128 a[128:131], v8 offset:8192
  ds_read_b128 a[132:135], v9 offset:8192
  v_mfma_f32_16x16x32_bf16 v[152:155], a[196:199], a[100:103], v[152:155]
  s_mov_b32 s29, s90
  ds_read_b128 a[136:139], v10 offset:8192
  ds_read_b128 a[140:143], v11 offset:8192
  v_mfma_f32_16x16x32_bf16 v[152:155], a[200:203], a[104:107], v[152:155]
  s_xor_b32 s28, s90, 0x2000
  ds_read_b128 v[80:83], v2 offset:8448
  ds_read_b128 v[84:87], v2 offset:8512
  v_mfma_f32_16x16x32_bf16 v[152:155], a[204:207], a[108:111], v[152:155]
  s_addk_i32 s67, 0x4000
  ds_read_b128 v[88:91], v2 offset:8576
  ds_read_b128 v[92:95], v2 offset:8640
  v_mfma_f32_32x32x16_bf16 v[160:175], a[240:243], a[248:251], 0
  s_xor_b32 s90, s67, s66
  ds_read_b128 v[96:99], v2 offset:8704
  ds_read_b128 v[100:103], v2 offset:8768
  v_fma_f32 v218, v218, v13, v23
  v_fma_f32 v219, v219, v13, v23
  v_fma_f32 v220, v220, v13, v23
  v_fma_f32 v221, v221, v13, v23
  v_fma_f32 v222, v222, v13, v23
  v_fma_f32 v223, v223, v13, v23
  v_cvt_pk_bf16_f32 v216, v216, v217
  v_cvt_pk_bf16_f32 v217, v218, v219
  v_cvt_pk_bf16_f32 v218, v220, v221
  v_cvt_pk_bf16_f32 v219, v222, v223
  v_max3_f32 v18, v152, v153, v154
  v_max_f32 v18, v18, v155
  v_mov_b32 v19, v18
  ds_read_b128 v[104:107], v2 offset:8832
  ds_read_b128 v[108:111], v2 offset:8896
  v_permlane32_swap_b32 v18, v19
  v_max_f32 v18, v18, v19
  v_mov_b32 v19, v18
  ds_write_b128 v9, v[200:203] offset:4096
  v_mfma_f32_32x32x16_bf16 v[192:207], a[240:243], a[248:251], 0
  ds_write_b128 v10, v[208:211] offset:4096
  v_permlane16_swap_b32 v18, v19
  v_max_f32 v18, v18, v19
  v_sub_f32 v128, s81, v18
  v_sub_f32 v129, s81, v18
  v_sub_f32 v130, s81, v18
  v_sub_f32 v131, s81, v18
  v_add_f32 v152, v152, v128
  v_add_f32 v153, v153, v128
  v_mfma_f32_16x16x32_bf16 v[156:159], a[208:211], a[96:99], v[128:131]
  s_waitcnt lgkmcnt(2)
  ds_write_b128 v11, v[216:219] offset:4096
  v_mfma_f32_16x16x32_bf16 v[156:159], a[212:215], a[100:103], v[156:159]
  s_mov_b32 m0, 119552
  ds_read_b128 a[144:147], v8 offset:12288
  buffer_load_dwordx4 v1, s[4:7], s28 offen offset:0 nt lds
  v_mfma_f32_16x16x32_bf16 v[156:159], a[216:219], a[104:107], v[156:159]
  s_mov_b32 m0, 119584
  ds_read_b128 a[148:151], v9 offset:12288
  buffer_load_dwordx4 v1, s[4:7], s28 offen offset:1024 nt lds
  v_mfma_f32_16x16x32_bf16 v[156:159], a[220:223], a[108:111], v[156:159]
  s_mov_b32 m0, 119616
  ds_read_b128 a[152:155], v10 offset:12288
  buffer_load_dwordx4 v1, s[4:7], s28 offen offset:2048 nt lds
  v_mfma_f32_32x32x16_bf16 v[208:223], a[240:243], a[248:251], 0
  s_mov_b32 m0, 119648
  ds_read_b128 a[156:159], v11 offset:12288
  buffer_load_dwordx4 v1, s[4:7], s28 offen offset:3072 nt lds
  v_add_f32 v154, v154, v128
  v_add_f32 v155, v155, v128
  v_exp_f32 v152, v152
  v_exp_f32 v153, v153
  v_exp_f32 v154, v154
  v_exp_f32 v155, v155
  v_cvt_pk_bf16_f32 v32, v152, v153
  v_cvt_pk_bf16_f32 v33, v154, v155
  v_mfma_f32_16x16x32_bf16 v[176:179], v[80:83], a[96:99], v[128:131]
  s_mov_b32 m0, 123776
  v_exp_f32 v156, v156
  v_mfma_f32_16x16x32_bf16 v[176:179], v[84:87], a[100:103], v[176:179]
  buffer_load_dwordx4 v72, s[4:7], s28 offen offset:0 nt lds
  v_exp_f32 v157, v157
  v_mfma_f32_16x16x32_bf16 v[176:179], v[88:91], a[104:107], v[176:179]
  v_exp_f32 v158, v158
  v_mfma_f32_16x16x32_bf16 v[176:179], v[92:95], a[108:111], v[176:179]
  v_exp_f32 v159, v159
  v_cvt_pk_bf16_f32 v34, v156, v157
  v_cvt_pk_bf16_f32 v35, v158, v159
  v_fma_f32 v224, v224, v14, v25
  v_fma_f32 v225, v225, v14, v25
  v_fma_f32 v226, v226, v14, v25
  v_fma_f32 v227, v227, v14, v25
  v_fma_f32 v228, v228, v14, v25
  v_fma_f32 v229, v229, v14, v25
  v_fma_f32 v230, v230, v14, v25
  v_fma_f32 v231, v231, v14, v25
  v_cvt_pk_bf16_f32 v224, v224, v225
  v_cvt_pk_bf16_f32 v225, v226, v227
  v_cvt_pk_bf16_f32 v226, v228, v229
  v_cvt_pk_bf16_f32 v227, v230, v231
  v_mfma_f32_16x16x32_bf16 v[180:183], v[96:99], a[96:99], v[128:131]
  ds_write_b128 v8, v[224:227] offset:8192
  v_mfma_f32_16x16x32_bf16 v[180:183], v[100:103], a[100:103], v[180:183]
  s_mov_b32 m0, 123808
  v_exp_f32 v176, v176
  v_mfma_f32_16x16x32_bf16 v[180:183], v[104:107], a[104:107], v[180:183]
  s_mov_b32 s30, -4096
  buffer_load_dwordx4 v72, s[4:7], s28 offen offset:1024 nt lds
  v_exp_f32 v177, v177
  v_mfma_f32_16x16x32_bf16 v[180:183], v[108:111], a[108:111], v[180:183]
  s_mov_b32 m0, 123840
  v_exp_f32 v178, v178
  v_mfma_f32_16x16x32_bf16 v[184:187], a[192:195], a[112:115], 0
  s_mov_b32 s35, s62
  buffer_load_dwordx4 v72, s[4:7], s28 offen offset:2048 nt lds
  v_exp_f32 v179, v179
  v_cvt_pk_bf16_f32 v56, v176, v177
  v_cvt_pk_bf16_f32 v57, v178, v179
  v_fma_f32 v232, v232, v14, v25
  v_fma_f32 v233, v233, v14, v25
  v_fma_f32 v234, v234, v14, v25
  v_fma_f32 v235, v235, v14, v25
  v_fma_f32 v236, v236, v14, v25
  v_fma_f32 v237, v237, v14, v25
  v_fma_f32 v238, v238, v14, v25
  v_fma_f32 v239, v239, v14, v25
  v_cvt_pk_bf16_f32 v232, v232, v233
  v_cvt_pk_bf16_f32 v233, v234, v235
  v_cvt_pk_bf16_f32 v234, v236, v237
  v_cvt_pk_bf16_f32 v235, v238, v239
  v_mfma_f32_16x16x32_bf16 v[184:187], a[196:199], a[116:119], v[184:187]
  s_mov_b32 m0, 123872
  ds_write_b128 v9, v[232:235] offset:8192
  v_mfma_f32_16x16x32_bf16 v[184:187], a[200:203], a[120:123], v[184:187]
  s_mov_b32 s36, s62
  buffer_load_dwordx4 v72, s[4:7], s28 offen offset:3072 nt lds
  v_exp_f32 v180, v180
  v_exp_f32 v181, v181
  v_exp_f32 v182, v182
  v_exp_f32 v183, v183
  v_cvt_pk_bf16_f32 v58, v180, v181
  v_cvt_pk_bf16_f32 v59, v182, v183
  v_mfma_f32_16x16x32_bf16 v[184:187], a[204:207], a[124:127], v[184:187]
  s_mov_b32 m0, 94208
  ds_read_b128 a[160:163], v8 offset:16384
  buffer_load_dwordx4 v1, s[4:7], s90 offen offset:0 nt lds
  v_mov_b32 v4, v1
  v_mov_b32 v73, v1
  v_fma_f32 v240, v240, v14, v25
  v_fma_f32 v241, v241, v14, v25
  v_fma_f32 v242, v242, v14, v25
  v_max3_f32 v6, v184, v185, v186
  v_max_f32 v6, v6, v187
  v_mov_b32 v7, v6
  v_fma_f32 v243, v243, v14, v25
  v_fma_f32 v244, v244, v14, v25
  v_permlane32_swap_b32 v6, v7
  v_max_f32 v6, v6, v7
  v_mov_b32 v7, v6
  v_fma_f32 v245, v245, v14, v25
  v_fma_f32 v246, v246, v14, v25
  v_permlane16_swap_b32 v6, v7
  v_max_f32 v6, v6, v7
  v_sub_f32 v132, s81, v6
  v_sub_f32 v133, s81, v6
  v_sub_f32 v134, s81, v6
  v_sub_f32 v135, s81, v6
  v_add_f32 v184, v184, v132
  v_add_f32 v185, v185, v132
  v_mfma_f32_16x16x32_bf16 v[188:191], a[208:211], a[112:115], v[132:135]
  s_mov_b32 m0, 94240
  v_add_f32 v186, v186, v132
  v_add_f32 v187, v187, v132
  v_mfma_f32_16x16x32_bf16 v[188:191], a[212:215], a[116:119], v[188:191]
  buffer_load_dwordx4 v1, s[4:7], s90 offen offset:1024 nt lds
  v_exp_f32 v184, v184
  v_mfma_f32_16x16x32_bf16 v[188:191], a[216:219], a[120:123], v[188:191]
  s_mov_b32 m0, 94272
  v_exp_f32 v185, v185
  v_mfma_f32_16x16x32_bf16 v[188:191], a[220:223], a[124:127], v[188:191]
  s_mov_b32 s37, s62
  buffer_load_dwordx4 v1, s[4:7], s90 offen offset:2048 nt lds
  v_exp_f32 v186, v186
  v_exp_f32 v187, v187
  v_cvt_pk_bf16_f32 v36, v184, v185
  v_cvt_pk_bf16_f32 v37, v186, v187
  v_fma_f32 v247, v247, v14, v25
  v_cvt_pk_bf16_f32 v240, v240, v241
  v_cvt_pk_bf16_f32 v241, v242, v243
  v_cvt_pk_bf16_f32 v242, v244, v245
  v_cvt_pk_bf16_f32 v243, v246, v247
  v_mfma_f32_16x16x32_bf16 v[152:155], v[80:83], a[112:115], v[132:135]
  s_mov_b32 m0, 94304
  ds_write_b128 v10, v[240:243] offset:8192
  v_mfma_f32_16x16x32_bf16 v[152:155], v[84:87], a[116:119], v[152:155]
  s_mov_b32 s38, s62
  buffer_load_dwordx4 v1, s[4:7], s90 offen offset:3072 nt lds
  v_exp_f32 v188, v188
  v_mfma_f32_16x16x32_bf16 v[152:155], v[88:91], a[120:123], v[152:155]
  s_mov_b32 m0, 98432
  ds_read_b128 a[164:167], v9 offset:16384
  buffer_load_dwordx4 v72, s[4:7], s90 offen offset:0 nt lds
  v_mfma_f32_16x16x32_bf16 v[152:155], v[92:95], a[124:127], v[152:155]
  s_mov_b32 m0, 98464
  ds_read_b128 a[168:171], v10 offset:16384
  buffer_load_dwordx4 v72, s[4:7], s90 offen offset:1024 nt lds
  v_exp_f32 v189, v189
  v_exp_f32 v190, v190
  v_exp_f32 v191, v191
  v_cvt_pk_bf16_f32 v38, v188, v189
  v_cvt_pk_bf16_f32 v39, v190, v191
  s_mov_b32 m0, 98496
  v_mfma_f32_32x32x16_bf16 v[224:239], a[240:243], a[248:251], 0
  s_mov_b32 s39, 7
  buffer_load_dwordx4 v72, s[4:7], s90 offen offset:2048 nt lds
  s_mov_b32 m0, 98528
  ds_read_b128 a[172:175], v11 offset:16384
  buffer_load_dwordx4 v72, s[4:7], s90 offen offset:3072 nt lds
  s_mov_b32 m0, 161792
  v_fma_f32 v248, v248, v14, v25
  buffer_load_dwordx4 v1, s[12:15], s62 offen lds
  buffer_load_dwordx4 v1, s[12:15], s62 offen lds
  buffer_load_dwordx4 v1, s[12:15], s62 offen lds
  buffer_load_dwordx4 v1, s[12:15], s62 offen lds
  v_fma_f32 v249, v249, v14, v25
  v_fma_f32 v250, v250, v14, v25
  v_fma_f32 v251, v251, v14, v25
  v_fma_f32 v252, v252, v14, v25
  v_fma_f32 v253, v253, v14, v25
  v_fma_f32 v254, v254, v14, v25
  v_fma_f32 v255, v255, v14, v25
  v_cvt_pk_bf16_f32 v248, v248, v249
  v_cvt_pk_bf16_f32 v249, v250, v251
  v_cvt_pk_bf16_f32 v250, v252, v253
  v_cvt_pk_bf16_f32 v251, v254, v255
  v_mfma_f32_16x16x32_bf16 v[156:159], v[96:99], a[112:115], v[132:135]
  ds_write_b128 v11, v[248:251] offset:8192
  v_mfma_f32_32x32x16_bf16 v[240:255], a[240:243], a[248:251], 0
  s_mov_b32 m0, 144896
  v_exp_f32 v152, v152
  v_exp_f32 v153, v153
  v_exp_f32 v154, v154
  v_mfma_f32_16x16x32_bf16 v[156:159], v[100:103], a[116:119], v[156:159]
  s_waitcnt lgkmcnt(1)
  buffer_load_dwordx4 v1, s[8:11], s29 offen offset:0 nt lds
  v_exp_f32 v155, v155
  v_mfma_f32_16x16x32_bf16 v[156:159], v[104:107], a[120:123], v[156:159]
  s_mov_b32 m0, 144904
  v_cvt_pk_bf16_f32 v60, v152, v153
  v_cvt_pk_bf16_f32 v61, v154, v155
  v_mfma_f32_16x16x32_bf16 v[156:159], v[108:111], a[124:127], v[156:159]
  buffer_load_dwordx4 v1, s[8:11], s29 offen offset:1024 nt lds
  v_accvgpr_read_b32 v112, a0
  v_accvgpr_read_b32 v113, a1
  v_accvgpr_read_b32 v114, a2
  v_accvgpr_read_b32 v115, a3
  v_accvgpr_read_b32 v116, a4
  v_accvgpr_read_b32 v117, a5
  v_accvgpr_read_b32 v118, a6
  v_exp_f32 v156, v156
  v_exp_f32 v157, v157
  v_exp_f32 v158, v158
  v_exp_f32 v159, v159
  v_cvt_pk_bf16_f32 v62, v156, v157
  v_cvt_pk_bf16_f32 v63, v158, v159
  v_accvgpr_read_b32 v119, a7
  v_fma_f32 v112, v112, v15, v27
  v_fma_f32 v113, v113, v15, v27
  v_fma_f32 v114, v114, v15, v27
  v_fma_f32 v115, v115, v15, v27
  v_fma_f32 v116, v116, v15, v27
  v_fma_f32 v117, v117, v15, v27
  v_fma_f32 v118, v118, v15, v27
  v_fma_f32 v119, v119, v15, v27
  v_cvt_pk_bf16_f32 v112, v112, v113
  v_cvt_pk_bf16_f32 v113, v114, v115
  v_cvt_pk_bf16_f32 v114, v116, v117
  v_cvt_pk_bf16_f32 v115, v118, v119
  v_mfma_f32_16x16x32_bf16 v[176:179], a[192:195], a[128:131], 0
  s_mov_b32 m0, 144960
  ds_write_b128 v8, v[112:115] offset:12288
  v_mfma_f32_16x16x32_bf16 v[176:179], a[196:199], a[132:135], v[176:179]
  buffer_load_dwordx4 v1, s[8:11], s29 offen offset:2048 nt lds
  v_accvgpr_read_b32 v120, a8
  v_mfma_f32_16x16x32_bf16 v[176:179], a[200:203], a[136:139], v[176:179]
  s_mov_b32 m0, 144968
  v_accvgpr_read_b32 v121, a9
  v_accvgpr_read_b32 v122, a10
  v_mfma_f32_16x16x32_bf16 v[176:179], a[204:207], a[140:143], v[176:179]
  buffer_load_dwordx4 v1, s[8:11], s29 offen offset:3072 nt lds
  v_accvgpr_read_b32 v123, a11
  v_accvgpr_read_b32 v124, a12
  v_accvgpr_read_b32 v125, a13
  v_accvgpr_read_b32 v126, a14
  v_accvgpr_read_b32 v127, a15
  v_fma_f32 v120, v120, v15, v27
  v_fma_f32 v121, v121, v15, v27
  v_max3_f32 v18, v176, v177, v178
  v_max_f32 v18, v18, v179
  v_mov_b32 v19, v18
  v_fma_f32 v122, v122, v15, v27
  v_fma_f32 v123, v123, v15, v27
  v_permlane32_swap_b32 v18, v19
  v_max_f32 v18, v18, v19
  v_mov_b32 v19, v18
  v_fma_f32 v124, v124, v15, v27
  v_fma_f32 v125, v125, v15, v27
  v_permlane16_swap_b32 v18, v19
  v_max_f32 v18, v18, v19
  v_sub_f32 v136, s81, v18
  v_sub_f32 v137, s81, v18
  v_sub_f32 v138, s81, v18
  v_sub_f32 v139, s81, v18
  v_add_f32 v176, v176, v136
  v_add_f32 v177, v177, v136
  v_mfma_f32_16x16x32_bf16 v[180:183], a[208:211], a[128:131], v[136:139]
  s_mov_b32 m0, 149120
  v_add_f32 v178, v178, v136
  v_add_f32 v179, v179, v136
  v_mfma_f32_16x16x32_bf16 v[180:183], a[212:215], a[132:135], v[180:183]
  buffer_load_dwordx4 v72, s[8:11], s29 offen offset:0 nt lds
  v_exp_f32 v176, v176
  v_mfma_f32_16x16x32_bf16 v[180:183], a[216:219], a[136:139], v[180:183]
  s_mov_b32 m0, 149128
  v_exp_f32 v177, v177
  v_mfma_f32_16x16x32_bf16 v[180:183], a[220:223], a[140:143], v[180:183]
  buffer_load_dwordx4 v72, s[8:11], s29 offen offset:1024 nt lds
  v_exp_f32 v178, v178
  v_exp_f32 v179, v179
  v_cvt_pk_bf16_f32 v40, v176, v177
  v_cvt_pk_bf16_f32 v41, v178, v179
  v_fma_f32 v126, v126, v15, v27
  v_fma_f32 v127, v127, v15, v27
  v_cvt_pk_bf16_f32 v120, v120, v121
  v_cvt_pk_bf16_f32 v121, v122, v123
  v_cvt_pk_bf16_f32 v122, v124, v125
  v_cvt_pk_bf16_f32 v123, v126, v127
  v_mfma_f32_16x16x32_bf16 v[184:187], v[80:83], a[128:131], v[136:139]
  s_mov_b32 m0, 149184
  ds_write_b128 v9, v[120:123] offset:12288
  v_mfma_f32_16x16x32_bf16 v[184:187], v[84:87], a[132:135], v[184:187]
  buffer_load_dwordx4 v72, s[8:11], s29 offen offset:2048 nt lds
  v_exp_f32 v180, v180
  v_mfma_f32_16x16x32_bf16 v[184:187], v[88:91], a[136:139], v[184:187]
  s_mov_b32 m0, 149192
  v_exp_f32 v181, v181
  v_mfma_f32_16x16x32_bf16 v[184:187], v[92:95], a[140:143], v[184:187]
  buffer_load_dwordx4 v72, s[8:11], s29 offen offset:3072 nt lds
  v_exp_f32 v182, v182
  v_exp_f32 v183, v183
  v_cvt_pk_bf16_f32 v42, v180, v181
  v_cvt_pk_bf16_f32 v43, v182, v183
  s_mov_b32 m0, 153344
  v_mfma_f32_16x16x32_bf16 v[188:191], v[96:99], a[128:131], v[136:139]
  buffer_load_dwordx4 v1, s[8:11], s28 offen offset:0 nt lds
  s_mov_b32 m0, 153352
  v_mfma_f32_16x16x32_bf16 v[188:191], v[100:103], a[132:135], v[188:191]
  buffer_load_dwordx4 v1, s[8:11], s28 offen offset:1024 nt lds
  s_mov_b32 m0, 153408
  v_mfma_f32_16x16x32_bf16 v[188:191], v[104:107], a[136:139], v[188:191]
  buffer_load_dwordx4 v1, s[8:11], s28 offen offset:2048 nt lds
  s_mov_b32 m0, 153416
  v_mfma_f32_16x16x32_bf16 v[188:191], v[108:111], a[140:143], v[188:191]
  buffer_load_dwordx4 v1, s[8:11], s28 offen offset:3072 nt lds
  s_mov_b32 m0, 157568
  v_accvgpr_read_b32 v112, a16
  buffer_load_dwordx4 v72, s[8:11], s28 offen offset:0 nt lds
  s_mov_b32 m0, 157576
  v_accvgpr_read_b32 v113, a17
  buffer_load_dwordx4 v72, s[8:11], s28 offen offset:1024 nt lds
  s_mov_b32 m0, 157632
  v_accvgpr_read_b32 v114, a18
  buffer_load_dwordx4 v72, s[8:11], s28 offen offset:2048 nt lds
  s_mov_b32 m0, 157640
  v_accvgpr_read_b32 v115, a19
  buffer_load_dwordx4 v72, s[8:11], s28 offen offset:3072 nt lds
  s_mov_b32 m0, 161792
  v_accvgpr_read_b32 v116, a20
  buffer_load_dwordx4 v1, s[12:15], s62 offen lds
  buffer_load_dwordx4 v1, s[12:15], s62 offen lds
  buffer_load_dwordx4 v1, s[12:15], s62 offen lds
  buffer_load_dwordx4 v1, s[12:15], s62 offen lds
  v_accvgpr_read_b32 v117, a21
  v_accvgpr_read_b32 v118, a22
  v_accvgpr_read_b32 v119, a23
  v_fma_f32 v112, v112, v15, v27
  v_fma_f32 v113, v113, v15, v27
  v_fma_f32 v114, v114, v15, v27
  v_fma_f32 v115, v115, v15, v27
  v_fma_f32 v116, v116, v15, v27
  v_fma_f32 v117, v117, v15, v27
  v_fma_f32 v118, v118, v15, v27
  v_fma_f32 v119, v119, v15, v27
  v_cvt_pk_bf16_f32 v112, v112, v113
  v_cvt_pk_bf16_f32 v113, v114, v115
  v_cvt_pk_bf16_f32 v114, v116, v117
  v_cvt_pk_bf16_f32 v115, v118, v119
  v_mfma_f32_32x32x16_bf16 a[0:15], a[240:243], a[248:251], 0
  ds_write_b128 v10, v[112:115] offset:12288
  v_exp_f32 v184, v184
  v_exp_f32 v185, v185
  v_exp_f32 v186, v186
  v_exp_f32 v187, v187
  v_cvt_pk_bf16_f32 v64, v184, v185
  v_cvt_pk_bf16_f32 v65, v186, v187
  v_exp_f32 v188, v188
  v_exp_f32 v189, v189
  v_exp_f32 v190, v190
  v_exp_f32 v191, v191
  v_cvt_pk_bf16_f32 v66, v188, v189
  v_cvt_pk_bf16_f32 v67, v190, v191
  v_accvgpr_read_b32 v120, a24
  v_accvgpr_read_b32 v121, a25
  v_accvgpr_read_b32 v122, a26
  v_accvgpr_read_b32 v123, a27
  v_accvgpr_read_b32 v124, a28
  v_accvgpr_read_b32 v125, a29
  v_accvgpr_read_b32 v126, a30
  v_accvgpr_read_b32 v127, a31
  v_mfma_f32_32x32x16_bf16 a[16:31], a[240:243], a[248:251], 0
  ds_read_b64_tr_b16 a[224:225], v3 offset:0
  ds_read_b64_tr_b16 a[226:227], v3 offset:256
  v_fma_f32 v120, v120, v15, v27
  v_fma_f32 v121, v121, v15, v27
  v_fma_f32 v122, v122, v15, v27
  v_fma_f32 v123, v123, v15, v27
  v_mfma_f32_16x16x32_bf16 v[152:155], a[192:195], a[144:147], 0
  ds_read_b64_tr_b16 a[228:229], v3 offset:8448
  ds_read_b64_tr_b16 a[230:231], v3 offset:8704
  v_mfma_f32_16x16x32_bf16 v[152:155], a[196:199], a[148:151], v[152:155]
  ds_read_b64_tr_b16 a[236:237], v3 offset:8456
  v_fma_f32 v124, v124, v15, v27
  v_mfma_f32_16x16x32_bf16 v[152:155], a[200:203], a[152:155], v[152:155]
  v_fma_f32 v125, v125, v15, v27
  v_fma_f32 v126, v126, v15, v27
  v_mfma_f32_16x16x32_bf16 v[152:155], a[204:207], a[156:159], v[152:155]
  v_fma_f32 v127, v127, v15, v27
  v_cvt_pk_bf16_f32 v120, v120, v121
  v_cvt_pk_bf16_f32 v121, v122, v123
  v_cvt_pk_bf16_f32 v122, v124, v125
  v_cvt_pk_bf16_f32 v123, v126, v127
  v_mfma_f32_16x16x32_bf16 v[184:187], a[192:195], a[160:163], 0
  ds_write_b128 v11, v[120:123] offset:12288
  v_mfma_f32_16x16x32_bf16 v[184:187], a[196:199], a[164:167], v[184:187]
  ds_read_b128 a[192:195], v2 offset:16896
  ds_read_b128 a[196:199], v2 offset:16960
  v_max3_f32 v6, v152, v153, v154
  v_max_f32 v6, v6, v155
  v_mov_b32 v7, v6
  v_accvgpr_read_b32 v112, a32
  v_accvgpr_read_b32 v113, a33
  v_permlane32_swap_b32 v6, v7
  v_max_f32 v6, v6, v7
  v_mov_b32 v7, v6
  v_accvgpr_read_b32 v114, a34
  v_accvgpr_read_b32 v115, a35
  v_permlane16_swap_b32 v6, v7
  v_max_f32 v6, v6, v7
  v_sub_f32 v140, s81, v6
  v_sub_f32 v141, s81, v6
  v_sub_f32 v142, s81, v6
  v_sub_f32 v143, s81, v6
  v_add_f32 v152, v152, v140
  v_add_f32 v153, v153, v140
  v_mfma_f32_16x16x32_bf16 v[156:159], a[208:211], a[144:147], v[140:143]
  v_add_f32 v154, v154, v140
  v_add_f32 v155, v155, v140
  v_mfma_f32_16x16x32_bf16 v[156:159], a[212:215], a[148:151], v[156:159]
  v_exp_f32 v152, v152
  v_mfma_f32_16x16x32_bf16 v[156:159], a[216:219], a[152:155], v[156:159]
  v_exp_f32 v153, v153
  v_mfma_f32_16x16x32_bf16 v[156:159], a[220:223], a[156:159], v[156:159]
  v_exp_f32 v154, v154
  v_exp_f32 v155, v155
  v_cvt_pk_bf16_f32 v44, v152, v153
  v_cvt_pk_bf16_f32 v45, v154, v155
  v_mfma_f32_16x16x32_bf16 v[176:179], v[80:83], a[144:147], v[140:143]
  v_accvgpr_read_b32 v116, a36
  v_accvgpr_read_b32 v117, a37
  v_mfma_f32_16x16x32_bf16 v[176:179], v[84:87], a[148:151], v[176:179]
  v_accvgpr_read_b32 v118, a38
  v_accvgpr_read_b32 v119, a39
  v_mfma_f32_16x16x32_bf16 v[176:179], v[88:91], a[152:155], v[176:179]
  v_fma_f32 v112, v112, v16, v29
  v_fma_f32 v113, v113, v16, v29
  v_mfma_f32_16x16x32_bf16 v[176:179], v[92:95], a[156:159], v[176:179]
  v_fma_f32 v114, v114, v16, v29
  v_fma_f32 v115, v115, v16, v29
  v_fma_f32 v116, v116, v16, v29
  v_fma_f32 v117, v117, v16, v29
  v_fma_f32 v118, v118, v16, v29
  v_fma_f32 v119, v119, v16, v29
  v_cvt_pk_bf16_f32 v112, v112, v113
  v_cvt_pk_bf16_f32 v113, v114, v115
  v_cvt_pk_bf16_f32 v114, v116, v117
  v_cvt_pk_bf16_f32 v115, v118, v119
  v_mfma_f32_16x16x32_bf16 v[180:183], v[96:99], a[144:147], v[140:143]
  ds_write_b128 v8, v[112:115] offset:16384
  v_exp_f32 v156, v156
  v_exp_f32 v157, v157
  v_exp_f32 v158, v158
  v_exp_f32 v159, v159
  v_cvt_pk_bf16_f32 v46, v156, v157
  v_cvt_pk_bf16_f32 v47, v158, v159
  v_mfma_f32_16x16x32_bf16 v[180:183], v[100:103], a[148:151], v[180:183]
  v_exp_f32 v176, v176
  v_mfma_f32_16x16x32_bf16 v[180:183], v[104:107], a[152:155], v[180:183]
  v_exp_f32 v177, v177
  v_mfma_f32_16x16x32_bf16 v[180:183], v[108:111], a[156:159], v[180:183]
  v_exp_f32 v178, v178
  v_exp_f32 v179, v179
  v_cvt_pk_bf16_f32 v68, v176, v177
  v_cvt_pk_bf16_f32 v69, v178, v179
  v_accvgpr_read_b32 v120, a40
  v_accvgpr_read_b32 v121, a41
  v_accvgpr_read_b32 v122, a42
  v_accvgpr_read_b32 v123, a43
  v_accvgpr_read_b32 v124, a44
  v_accvgpr_read_b32 v125, a45
  v_accvgpr_read_b32 v126, a46
  v_accvgpr_read_b32 v127, a47
  v_fma_f32 v120, v120, v16, v29
  v_fma_f32 v121, v121, v16, v29
  v_fma_f32 v122, v122, v16, v29
  v_fma_f32 v123, v123, v16, v29
  v_fma_f32 v124, v124, v16, v29
  v_fma_f32 v125, v125, v16, v29
  v_fma_f32 v126, v126, v16, v29
  v_fma_f32 v127, v127, v16, v29
  v_cvt_pk_bf16_f32 v120, v120, v121
  v_cvt_pk_bf16_f32 v121, v122, v123
  v_cvt_pk_bf16_f32 v122, v124, v125
  v_cvt_pk_bf16_f32 v123, v126, v127
  v_mfma_f32_16x16x32_bf16 v[184:187], a[200:203], a[168:171], v[184:187]
  ds_write_b128 v9, v[120:123] offset:16384
  v_mfma_f32_16x16x32_bf16 v[184:187], a[204:207], a[172:175], v[184:187]
  ds_read_b128 a[200:203], v2 offset:17024
  ds_read_b128 a[204:207], v2 offset:17088
  v_exp_f32 v180, v180
  v_exp_f32 v181, v181
  v_exp_f32 v182, v182
  v_exp_f32 v183, v183
  v_cvt_pk_bf16_f32 v70, v180, v181
  v_cvt_pk_bf16_f32 v71, v182, v183
  v_max3_f32 v18, v184, v185, v186
  v_max_f32 v18, v18, v187
  v_mov_b32 v19, v18
  v_accvgpr_read_b32 v112, a48
  v_accvgpr_read_b32 v113, a49
  v_permlane32_swap_b32 v18, v19
  v_max_f32 v18, v18, v19
  v_mov_b32 v19, v18
  v_accvgpr_read_b32 v114, a50
  v_accvgpr_read_b32 v115, a51
  v_permlane16_swap_b32 v18, v19
  v_max_f32 v18, v18, v19
  v_sub_f32 v144, s81, v18
  v_sub_f32 v145, s81, v18
  v_sub_f32 v146, s81, v18
  v_sub_f32 v147, s81, v18
  v_accvgpr_read_b32 v116, a52
  v_accvgpr_read_b32 v117, a53
  v_accvgpr_read_b32 v118, a54
  v_accvgpr_read_b32 v119, a55
  v_fma_f32 v112, v112, v16, v29
  v_fma_f32 v113, v113, v16, v29
  v_fma_f32 v114, v114, v16, v29
  v_fma_f32 v115, v115, v16, v29
  v_fma_f32 v116, v116, v16, v29
  v_fma_f32 v117, v117, v16, v29
  v_fma_f32 v118, v118, v16, v29
  v_fma_f32 v119, v119, v16, v29
  v_cvt_pk_bf16_f32 v112, v112, v113
  v_cvt_pk_bf16_f32 v113, v114, v115
  v_cvt_pk_bf16_f32 v114, v116, v117
  v_cvt_pk_bf16_f32 v115, v118, v119
  v_mfma_f32_16x16x32_bf16 v[188:191], a[208:211], a[160:163], v[144:147]
  ds_write_b128 v10, v[112:115] offset:16384
  v_mfma_f32_16x16x32_bf16 v[188:191], a[212:215], a[164:167], v[188:191]
  v_add_f32 v184, v184, v144
  v_add_f32 v185, v185, v144
  v_mfma_f32_16x16x32_bf16 v[188:191], a[216:219], a[168:171], v[188:191]
  v_add_f32 v186, v186, v144
  v_add_f32 v187, v187, v144
  v_mfma_f32_16x16x32_bf16 v[188:191], a[220:223], a[172:175], v[188:191]
  v_exp_f32 v184, v184
  v_exp_f32 v185, v185
  v_exp_f32 v186, v186
  v_exp_f32 v187, v187
  v_cvt_pk_bf16_f32 v48, v184, v185
  v_cvt_pk_bf16_f32 v49, v186, v187
  v_mfma_f32_16x16x32_bf16 v[152:155], v[80:83], a[160:163], v[144:147]
  v_accvgpr_read_b32 v120, a56
  v_accvgpr_read_b32 v121, a57
  v_mfma_f32_16x16x32_bf16 v[152:155], v[84:87], a[164:167], v[152:155]
  v_accvgpr_read_b32 v122, a58
  v_accvgpr_read_b32 v123, a59
  v_mfma_f32_16x16x32_bf16 v[152:155], v[88:91], a[168:171], v[152:155]
  v_accvgpr_read_b32 v124, a60
  v_accvgpr_read_b32 v125, a61
  v_mfma_f32_16x16x32_bf16 v[152:155], v[92:95], a[172:175], v[152:155]
  v_accvgpr_read_b32 v126, a62
  v_accvgpr_read_b32 v127, a63
  v_mfma_f32_32x32x16_bf16 a[32:47], a[240:243], a[248:251], 0
  v_fma_f32 v120, v120, v16, v29
  v_fma_f32 v121, v121, v16, v29
  v_fma_f32 v122, v122, v16, v29
  v_fma_f32 v123, v123, v16, v29
  v_fma_f32 v124, v124, v16, v29
  v_fma_f32 v125, v125, v16, v29
  v_mfma_f32_32x32x16_bf16 a[48:63], a[240:243], a[248:251], 0
  v_fma_f32 v126, v126, v16, v29
  v_fma_f32 v127, v127, v16, v29
  v_cvt_pk_bf16_f32 v120, v120, v121
  v_cvt_pk_bf16_f32 v121, v122, v123
  v_cvt_pk_bf16_f32 v122, v124, v125
  v_cvt_pk_bf16_f32 v123, v126, v127
  v_mfma_f32_16x16x32_bf16 v[156:159], v[96:99], a[160:163], v[144:147]
  ds_write_b128 v11, v[120:123] offset:16384
  v_exp_f32 v188, v188
  v_exp_f32 v189, v189
  v_exp_f32 v190, v190
  v_exp_f32 v191, v191
  v_cvt_pk_bf16_f32 v50, v188, v189
  v_cvt_pk_bf16_f32 v51, v190, v191
  v_mfma_f32_16x16x32_bf16 v[156:159], v[100:103], a[164:167], v[156:159]
  v_exp_f32 v152, v152
  v_mfma_f32_16x16x32_bf16 v[156:159], v[104:107], a[168:171], v[156:159]
  v_exp_f32 v153, v153
  v_mfma_f32_16x16x32_bf16 v[156:159], v[108:111], a[172:175], v[156:159]
  v_exp_f32 v154, v154
  v_exp_f32 v155, v155
  v_cvt_pk_bf16_f32 v52, v152, v153
  v_cvt_pk_bf16_f32 v53, v154, v155
  v_mfma_f32_32x32x16_bf16 v[16:31], a[244:247], a[244:247], 0
  v_mfma_f32_32x32x16_bf16 v[176:191], a[240:243], a[248:251], 0
  s_waitcnt lgkmcnt(0)
  s_branch ENTRY1_5
.p2align 6
LOOP1_5:
  v_mfma_f32_16x16x32_bf16 v[152:155], a[192:195], a[96:99], v[128:131]
  s_waitcnt lgkmcnt(6)
  v_exp_f32 v156, v156
  v_mfma_f32_16x16x32_bf16 v[152:155], a[196:199], a[100:103], v[152:155]
  ds_read_b64_tr_b16 a[238:239], v3 offset:8840
  ds_read_b64_tr_b16 a[232:233], v3 offset:136
  v_mfma_f32_16x16x32_bf16 v[152:155], a[200:203], a[104:107], v[152:155]
  s_waitcnt lgkmcnt(5)
  v_exp_f32 v157, v157
  v_mfma_f32_16x16x32_bf16 v[152:155], a[204:207], a[108:111], v[152:155]
  ds_read_b64_tr_b16 a[234:235], v3 offset:392
  v_cvt_pk_bf16_f32 v98, v156, v157
  v_mfma_f32_16x16x32_bf16 v[176:179], a[224:227], v[32:35], v[176:179]
  s_waitcnt lgkmcnt(4)
  v_exp_f32 v158, v158
  v_mfma_f32_16x16x32_bf16 v[176:179], a[228:231], v[56:59], v[176:179]
  ds_read_b128 a[80:83], v4 offset:3072
  ds_read_b128 a[84:87], v4 offset:27648
  v_mfma_f32_16x16x32_bf16 v[208:211], a[228:231], v[60:63], v[208:211]
  v_exp_f32 v159, v159
  v_mfma_f32_16x16x32_bf16 v[208:211], a[224:227], v[36:39], v[208:211]
  ds_read_b128 a[208:211], v2 offset:25600
  v_cvt_pk_bf16_f32 v99, v158, v159
  v_mfma_f32_16x16x32_bf16 v[156:159], a[192:195], a[112:115], v[132:135]
  v_exp_f32 v152, v152
  v_mfma_f32_16x16x32_bf16 v[156:159], a[196:199], a[116:119], v[156:159]
  ds_read_b128 a[88:91], v4 offset:52224
  ds_read_b128 a[92:95], v73 offset:3072
  ds_read_b128 a[212:215], v2 offset:25664
  v_mfma_f32_16x16x32_bf16 v[156:159], a[200:203], a[120:123], v[156:159]
  v_exp_f32 v153, v153
  v_mfma_f32_16x16x32_bf16 v[156:159], a[204:207], a[124:127], v[156:159]
  ds_read_b128 a[216:219], v2 offset:25728
  v_cvt_pk_bf16_f32 v104, v152, v153
  v_mfma_f32_16x16x32_bf16 v[240:243], a[224:227], v[40:43], v[240:243]
  v_exp_f32 v154, v154
  v_mfma_f32_16x16x32_bf16 v[240:243], a[228:231], v[64:67], v[240:243]
  v_mfma_f32_16x16x32_bf16 a[16:19], a[228:231], v[68:71], a[16:19]
  v_exp_f32 v155, v155
  v_mfma_f32_16x16x32_bf16 a[16:19], a[224:227], v[44:47], a[16:19]
  ds_read_b128 a[220:223], v2 offset:25792
  v_cvt_pk_bf16_f32 v105, v154, v155
  v_smfmac_f32_16x16x64_bf16 v[20:23], a[240:243], v[56:63], v5
  v_mfma_f32_16x16x32_bf16 v[152:155], a[192:195], a[128:131], v[136:139]
  v_exp_f32 v156, v156
  v_mfma_f32_16x16x32_bf16 v[152:155], a[196:199], a[132:135], v[152:155]
  v_mfma_f32_16x16x32_bf16 v[152:155], a[200:203], a[136:139], v[152:155]
  v_exp_f32 v157, v157
  v_mfma_f32_16x16x32_bf16 v[152:155], a[204:207], a[140:143], v[152:155]
  v_cvt_pk_bf16_f32 v108, v156, v157
  v_mfma_f32_16x16x32_bf16 a[48:51], a[224:227], v[48:51], a[48:51]
  s_waitcnt lgkmcnt(10)
  v_exp_f32 v158, v158
  v_mfma_f32_16x16x32_bf16 a[48:51], a[228:231], v[52:55], a[48:51]
  v_mfma_f32_16x16x32_bf16 v[180:183], a[236:239], v[56:59], v[180:183]
  s_waitcnt lgkmcnt(8)
  v_exp_f32 v159, v159
  v_mfma_f32_16x16x32_bf16 v[180:183], a[232:235], v[32:35], v[180:183]
  ds_read_b64_tr_b16 a[224:225], v3 offset:192
  v_cvt_pk_bf16_f32 v109, v158, v159
  v_smfmac_f32_16x16x64_bf16 v[24:27], a[240:243], v[64:71], v5
  v_mfma_f32_16x16x32_bf16 v[156:159], a[192:195], a[144:147], v[140:143]
  v_exp_f32 v152, v152
  v_mfma_f32_16x16x32_bf16 v[156:159], a[196:199], a[148:151], v[156:159]
  v_mfma_f32_16x16x32_bf16 v[156:159], a[200:203], a[152:155], v[156:159]
  v_exp_f32 v153, v153
  v_mfma_f32_16x16x32_bf16 v[156:159], a[204:207], a[156:159], v[156:159]
  ds_read_b64_tr_b16 a[226:227], v3 offset:448
  ds_read_b64_tr_b16 a[228:229], v3 offset:8640
  v_cvt_pk_bf16_f32 v112, v152, v153
  v_mfma_f32_16x16x32_bf16 v[212:215], a[232:235], v[36:39], v[212:215]
  v_exp_f32 v154, v154
  v_mfma_f32_16x16x32_bf16 v[212:215], a[236:239], v[60:63], v[212:215]
  v_mfma_f32_16x16x32_bf16 v[244:247], a[236:239], v[64:67], v[244:247]
  v_exp_f32 v155, v155
  v_mfma_f32_16x16x32_bf16 v[244:247], a[232:235], v[40:43], v[244:247]
  ds_read_b64_tr_b16 a[230:231], v3 offset:8896
  v_cvt_pk_bf16_f32 v113, v154, v155
  v_mfma_f32_16x16x32_bf16 v[152:155], a[192:195], a[160:163], v[144:147]
  v_exp_f32 v156, v156
  v_mfma_f32_16x16x32_bf16 v[152:155], a[196:199], a[164:167], v[152:155]
  v_mfma_f32_16x16x32_bf16 v[152:155], a[200:203], a[168:171], v[152:155]
  v_exp_f32 v157, v157
  v_mfma_f32_16x16x32_bf16 v[152:155], a[204:207], a[172:175], v[152:155]
  v_cvt_pk_bf16_f32 v116, v156, v157
  v_mfma_f32_16x16x32_bf16 a[20:23], a[232:235], v[44:47], a[20:23]
  v_exp_f32 v158, v158
  v_mfma_f32_16x16x32_bf16 a[20:23], a[236:239], v[68:71], a[20:23]
  v_mfma_f32_16x16x32_bf16 a[52:55], a[236:239], v[52:55], a[52:55]
  s_waitcnt lgkmcnt(9)
  v_exp_f32 v159, v159
  v_mfma_f32_16x16x32_bf16 a[52:55], a[232:235], v[48:51], a[52:55]
  ds_read_b64_tr_b16 a[236:237], v3 offset:8648
  v_cvt_pk_bf16_f32 v117, v158, v159
  v_mfma_f32_16x16x32_bf16 v[156:159], a[208:211], a[96:99], v[128:131]
  s_waitcnt lgkmcnt(6)
  v_exp_f32 v152, v152
  v_mfma_f32_16x16x32_bf16 v[156:159], a[212:215], a[100:103], v[156:159]
  ds_read_b64_tr_b16 a[238:239], v3 offset:8904
  ds_read_b64_tr_b16 a[232:233], v3 offset:200
  v_mfma_f32_16x16x32_bf16 v[156:159], a[216:219], a[104:107], v[156:159]
  s_waitcnt lgkmcnt(5)
  v_exp_f32 v153, v153
  v_mfma_f32_16x16x32_bf16 v[156:159], a[220:223], a[108:111], v[156:159]
  ds_read_b64_tr_b16 a[234:235], v3 offset:456
  v_cvt_pk_bf16_f32 v100, v152, v153
  v_mfma_f32_16x16x32_bf16 v[184:187], a[224:227], v[32:35], v[184:187]
  s_waitcnt lgkmcnt(4)
  v_exp_f32 v154, v154
  v_mfma_f32_16x16x32_bf16 v[184:187], a[228:231], v[56:59], v[184:187]
  v_mfma_f32_16x16x32_bf16 v[216:219], a[228:231], v[60:63], v[216:219]
  v_exp_f32 v155, v155
  v_mfma_f32_16x16x32_bf16 v[216:219], a[224:227], v[36:39], v[216:219]
  v_cvt_pk_bf16_f32 v101, v154, v155
  v_mfma_f32_16x16x32_bf16 v[152:155], a[208:211], a[112:115], v[132:135]
  s_mov_b32 m0, 128000
  v_exp_f32 v156, v156
  v_mfma_f32_16x16x32_bf16 v[152:155], a[212:215], a[116:119], v[152:155]
  s_waitcnt vmcnt(24) lgkmcnt(0)
  s_barrier
  v_mfma_f32_16x16x32_bf16 v[152:155], a[216:219], a[120:123], v[152:155]
  buffer_load_dwordx4 v1, s[8:11], s29 offen offset:0 nt lds
  s_mov_b32 m0, 128008
  v_exp_f32 v157, v157
  v_mfma_f32_16x16x32_bf16 v[152:155], a[220:223], a[124:127], v[152:155]
  buffer_load_dwordx4 v1, s[8:11], s29 offen offset:1024 nt lds
  s_mov_b32 m0, 128064
  v_cvt_pk_bf16_f32 v106, v156, v157
  v_mfma_f32_16x16x32_bf16 v[248:251], a[224:227], v[40:43], v[248:251]
  buffer_load_dwordx4 v1, s[8:11], s29 offen offset:2048 nt lds
  s_mov_b32 m0, 128072
  v_exp_f32 v158, v158
  v_mfma_f32_16x16x32_bf16 v[248:251], a[228:231], v[64:67], v[248:251]
  buffer_load_dwordx4 v1, s[8:11], s29 offen offset:3072 nt lds
  ds_read_b128 a[192:195], v2 offset:0
  s_mov_b32 m0, 132224
  v_mfma_f32_16x16x32_bf16 a[24:27], a[228:231], v[68:71], a[24:27]
  buffer_load_dwordx4 v72, s[8:11], s29 offen offset:0 nt lds
  s_mov_b32 m0, 132232
  v_exp_f32 v159, v159
  v_mfma_f32_16x16x32_bf16 a[24:27], a[224:227], v[44:47], a[24:27]
  buffer_load_dwordx4 v72, s[8:11], s29 offen offset:1024 nt lds
  ds_read_b128 a[196:199], v2 offset:64
  v_cvt_pk_bf16_f32 v107, v158, v159
  v_mfma_f32_16x16x32_bf16 v[156:159], a[208:211], a[128:131], v[136:139]
  s_mov_b32 m0, 132288
  v_exp_f32 v152, v152
  v_mfma_f32_16x16x32_bf16 v[156:159], a[212:215], a[132:135], v[156:159]
  buffer_load_dwordx4 v72, s[8:11], s29 offen offset:2048 nt lds
  ds_read_b128 a[200:203], v2 offset:128
  v_mfma_f32_16x16x32_bf16 v[156:159], a[216:219], a[136:139], v[156:159]
  s_mov_b32 m0, 132296
  v_exp_f32 v153, v153
  v_mfma_f32_16x16x32_bf16 v[156:159], a[220:223], a[140:143], v[156:159]
  buffer_load_dwordx4 v72, s[8:11], s29 offen offset:3072 nt lds
  ds_read_b128 a[204:207], v2 offset:192
  v_cvt_pk_bf16_f32 v110, v152, v153
  v_mfma_f32_16x16x32_bf16 a[56:59], a[224:227], v[48:51], a[56:59]
  s_mov_b32 m0, 136448
  v_exp_f32 v154, v154
  v_mfma_f32_16x16x32_bf16 a[56:59], a[228:231], v[52:55], a[56:59]
  buffer_load_dwordx4 v1, s[8:11], s28 offen offset:0 nt lds
  ds_read_b64_tr_b16 a[224:225], v3 offset:16896
  v_mfma_f32_16x16x32_bf16 v[188:191], a[236:239], v[56:59], v[188:191]
  s_mov_b32 m0, 136456
  v_exp_f32 v155, v155
  v_mfma_f32_16x16x32_bf16 v[188:191], a[232:235], v[32:35], v[188:191]
  buffer_load_dwordx4 v1, s[8:11], s28 offen offset:1024 nt lds
  ds_read_b64_tr_b16 a[226:227], v3 offset:17152
  v_cvt_pk_bf16_f32 v111, v154, v155
  v_mfma_f32_16x16x32_bf16 v[152:155], a[208:211], a[144:147], v[140:143]
  s_mov_b32 m0, 136512
  v_exp_f32 v156, v156
  v_mfma_f32_16x16x32_bf16 v[152:155], a[212:215], a[148:151], v[152:155]
  buffer_load_dwordx4 v1, s[8:11], s28 offen offset:2048 nt lds
  ds_read_b64_tr_b16 a[228:229], v3 offset:25344
  v_mfma_f32_16x16x32_bf16 v[152:155], a[216:219], a[152:155], v[152:155]
  s_mov_b32 m0, 136520
  v_exp_f32 v157, v157
  v_mfma_f32_16x16x32_bf16 v[152:155], a[220:223], a[156:159], v[152:155]
  buffer_load_dwordx4 v1, s[8:11], s28 offen offset:3072 nt lds
  v_cvt_pk_bf16_f32 v114, v156, v157
  v_mfma_f32_16x16x32_bf16 v[220:223], a[232:235], v[36:39], v[220:223]
  s_mov_b32 m0, 140672
  v_exp_f32 v158, v158
  v_mfma_f32_16x16x32_bf16 v[220:223], a[236:239], v[60:63], v[220:223]
  buffer_load_dwordx4 v72, s[8:11], s28 offen offset:0 nt lds
  ds_read_b64_tr_b16 a[230:231], v3 offset:25600
  v_mfma_f32_16x16x32_bf16 v[252:255], a[236:239], v[64:67], v[252:255]
  s_mov_b32 m0, 140680
  v_exp_f32 v159, v159
  v_mfma_f32_16x16x32_bf16 v[252:255], a[232:235], v[40:43], v[252:255]
  buffer_load_dwordx4 v72, s[8:11], s28 offen offset:1024 nt lds
  v_cvt_pk_bf16_f32 v115, v158, v159
  v_mfma_f32_16x16x32_bf16 v[156:159], a[208:211], a[160:163], v[144:147]
  s_mov_b32 m0, 140736
  v_exp_f32 v152, v152
  v_mfma_f32_16x16x32_bf16 v[156:159], a[212:215], a[164:167], v[156:159]
  buffer_load_dwordx4 v72, s[8:11], s28 offen offset:2048 nt lds
  s_mov_b32 m0, 140744
  v_mfma_f32_16x16x32_bf16 v[156:159], a[216:219], a[168:171], v[156:159]
  buffer_load_dwordx4 v72, s[8:11], s28 offen offset:3072 nt lds
  v_exp_f32 v153, v153
  v_mfma_f32_16x16x32_bf16 v[156:159], a[220:223], a[172:175], v[156:159]
  buffer_store_dwordx4 a[80:83], v151, s[24:27], s35 offen offset:3072 nt
  v_cvt_pk_bf16_f32 v118, v152, v153
  v_mfma_f32_16x16x32_bf16 a[28:31], a[232:235], v[44:47], a[28:31]
  buffer_store_dwordx4 a[84:87], v151, s[24:27], s36 offen offset:3072 nt
  v_exp_f32 v154, v154
  v_mfma_f32_16x16x32_bf16 a[28:31], a[236:239], v[68:71], a[28:31]
  buffer_store_dwordx4 a[88:91], v151, s[24:27], s37 offen offset:3072 nt
  v_mfma_f32_16x16x32_bf16 a[60:63], a[236:239], v[52:55], a[60:63]
  buffer_store_dwordx4 a[92:95], v151, s[24:27], s38 offen offset:3072 nt
  v_exp_f32 v155, v155
  v_mfma_f32_16x16x32_bf16 a[60:63], a[232:235], v[48:51], a[60:63]
  s_waitcnt lgkmcnt(7)
  ds_read_b64_tr_b16 a[236:237], v3 offset:25352
  v_cvt_pk_bf16_f32 v119, v154, v155
  v_mfma_f32_16x16x32_bf16 v[152:155], a[192:195], a[96:99], v[128:131]
  s_waitcnt lgkmcnt(1)
  v_exp_f32 v156, v156
  v_mfma_f32_16x16x32_bf16 v[152:155], a[196:199], a[100:103], v[152:155]
  ds_read_b64_tr_b16 a[238:239], v3 offset:25608
  ds_read_b64_tr_b16 a[232:233], v3 offset:16904
  v_mfma_f32_16x16x32_bf16 v[152:155], a[200:203], a[104:107], v[152:155]
  s_addk_i32 s30, 0x1000
  v_exp_f32 v157, v157
  v_mfma_f32_16x16x32_bf16 v[152:155], a[204:207], a[108:111], v[152:155]
  ds_read_b64_tr_b16 a[234:235], v3 offset:17160
  v_cvt_pk_bf16_f32 v102, v156, v157
  v_add_u32 v4, s30, v1
  v_add_u32 v73, 73728, v4
  v_mfma_f32_16x16x32_bf16 v[160:163], a[224:227], v[80:83], v[160:163]
  s_cmp_lt_u32 s30, 24576
  v_exp_f32 v158, v158
  v_mfma_f32_16x16x32_bf16 v[160:163], a[228:231], v[104:107], v[160:163]
  ds_read_b128 a[64:67], v4 offset:0
  ds_read_b128 a[68:71], v4 offset:24576
  v_mfma_f32_16x16x32_bf16 v[192:195], a[228:231], v[108:111], v[192:195]
  s_cselect_b32 s35, s30, s62
  v_exp_f32 v159, v159
  v_mfma_f32_16x16x32_bf16 v[192:195], a[224:227], v[84:87], v[192:195]
  ds_read_b128 a[208:211], v2 offset:256
  v_cvt_pk_bf16_f32 v103, v158, v159
  v_mfma_f32_16x16x32_bf16 v[156:159], a[192:195], a[112:115], v[132:135]
  s_add_u32 s36, s35, 24576
  v_exp_f32 v152, v152
  v_mfma_f32_16x16x32_bf16 v[156:159], a[196:199], a[116:119], v[156:159]
  ds_read_b128 a[72:75], v4 offset:49152
  ds_read_b128 a[76:79], v73 offset:0
  ds_read_b128 a[212:215], v2 offset:320
  v_mfma_f32_16x16x32_bf16 v[156:159], a[200:203], a[120:123], v[156:159]
  s_add_u32 s37, s35, 49152
  v_exp_f32 v153, v153
  v_mfma_f32_16x16x32_bf16 v[156:159], a[204:207], a[124:127], v[156:159]
  ds_read_b128 a[216:219], v2 offset:384
  v_cvt_pk_bf16_f32 v32, v152, v153
  v_mfma_f32_16x16x32_bf16 v[224:227], a[224:227], v[88:91], v[224:227]
  s_add_u32 s38, s35, 73728
  v_exp_f32 v154, v154
  v_mfma_f32_16x16x32_bf16 v[224:227], a[228:231], v[112:115], v[224:227]
  v_mfma_f32_16x16x32_bf16 a[0:3], a[228:231], v[116:119], a[0:3]
  s_mov_b32 s29, s90
  v_exp_f32 v155, v155
  v_mfma_f32_16x16x32_bf16 a[0:3], a[224:227], v[92:95], a[0:3]
  ds_read_b128 a[220:223], v2 offset:448
  v_cvt_pk_bf16_f32 v33, v154, v155
  v_smfmac_f32_16x16x64_bf16 v[20:23], a[240:243], v[80:87], v5
  v_mfma_f32_16x16x32_bf16 v[152:155], a[192:195], a[128:131], v[136:139]
  s_xor_b32 s28, s90, 0x2000
  v_exp_f32 v156, v156
  v_mfma_f32_16x16x32_bf16 v[152:155], a[196:199], a[132:135], v[152:155]
  v_mfma_f32_16x16x32_bf16 v[152:155], a[200:203], a[136:139], v[152:155]
  s_addk_i32 s67, 0x4000
  v_exp_f32 v157, v157
  v_mfma_f32_16x16x32_bf16 v[152:155], a[204:207], a[140:143], v[152:155]
  v_cvt_pk_bf16_f32 v36, v156, v157
  v_mfma_f32_16x16x32_bf16 a[32:35], a[224:227], v[96:99], a[32:35]
  s_xor_b32 s90, s67, s66
  v_exp_f32 v158, v158
  v_mfma_f32_16x16x32_bf16 a[32:35], a[228:231], v[100:103], a[32:35]
  s_waitcnt lgkmcnt(10)
  v_mfma_f32_16x16x32_bf16 v[164:167], a[236:239], v[104:107], v[164:167]
  s_waitcnt lgkmcnt(8)
  v_exp_f32 v159, v159
  v_mfma_f32_16x16x32_bf16 v[164:167], a[232:235], v[80:83], v[164:167]
  ds_read_b64_tr_b16 a[224:225], v3 offset:16960
  v_cvt_pk_bf16_f32 v37, v158, v159
  v_smfmac_f32_16x16x64_bf16 v[24:27], a[240:243], v[88:95], v5
  v_mfma_f32_16x16x32_bf16 v[156:159], a[192:195], a[144:147], v[140:143]
  v_exp_f32 v152, v152
  v_mfma_f32_16x16x32_bf16 v[156:159], a[196:199], a[148:151], v[156:159]
  v_mfma_f32_16x16x32_bf16 v[156:159], a[200:203], a[152:155], v[156:159]
  v_exp_f32 v153, v153
  v_mfma_f32_16x16x32_bf16 v[156:159], a[204:207], a[156:159], v[156:159]
  ds_read_b64_tr_b16 a[226:227], v3 offset:17216
  ds_read_b64_tr_b16 a[228:229], v3 offset:25408
  v_cvt_pk_bf16_f32 v40, v152, v153
  v_mfma_f32_16x16x32_bf16 v[196:199], a[232:235], v[84:87], v[196:199]
  v_exp_f32 v154, v154
  v_mfma_f32_16x16x32_bf16 v[196:199], a[236:239], v[108:111], v[196:199]
  v_mfma_f32_16x16x32_bf16 v[228:231], a[236:239], v[112:115], v[228:231]
  v_exp_f32 v155, v155
  v_mfma_f32_16x16x32_bf16 v[228:231], a[232:235], v[88:91], v[228:231]
  ds_read_b64_tr_b16 a[230:231], v3 offset:25664
  v_cvt_pk_bf16_f32 v41, v154, v155
  v_mfma_f32_16x16x32_bf16 v[152:155], a[192:195], a[160:163], v[144:147]
  v_exp_f32 v156, v156
  v_mfma_f32_16x16x32_bf16 v[152:155], a[196:199], a[164:167], v[152:155]
  v_mfma_f32_16x16x32_bf16 v[152:155], a[200:203], a[168:171], v[152:155]
  v_exp_f32 v157, v157
  v_mfma_f32_16x16x32_bf16 v[152:155], a[204:207], a[172:175], v[152:155]
  v_cvt_pk_bf16_f32 v44, v156, v157
  v_mfma_f32_16x16x32_bf16 a[4:7], a[232:235], v[92:95], a[4:7]
  v_exp_f32 v158, v158
  v_mfma_f32_16x16x32_bf16 a[4:7], a[236:239], v[116:119], a[4:7]
  v_mfma_f32_16x16x32_bf16 a[36:39], a[236:239], v[100:103], a[36:39]
  s_waitcnt lgkmcnt(9)
  v_exp_f32 v159, v159
  v_mfma_f32_16x16x32_bf16 a[36:39], a[232:235], v[96:99], a[36:39]
  ds_read_b64_tr_b16 a[236:237], v3 offset:25416
  v_cvt_pk_bf16_f32 v45, v158, v159
  v_mfma_f32_16x16x32_bf16 v[156:159], a[208:211], a[96:99], v[128:131]
  s_waitcnt lgkmcnt(6)
  v_exp_f32 v152, v152
  v_mfma_f32_16x16x32_bf16 v[156:159], a[212:215], a[100:103], v[156:159]
  ds_read_b64_tr_b16 a[238:239], v3 offset:25672
  ds_read_b64_tr_b16 a[232:233], v3 offset:16968
  v_mfma_f32_16x16x32_bf16 v[156:159], a[216:219], a[104:107], v[156:159]
  s_waitcnt lgkmcnt(5)
  v_exp_f32 v153, v153
  v_mfma_f32_16x16x32_bf16 v[156:159], a[220:223], a[108:111], v[156:159]
  ds_read_b64_tr_b16 a[234:235], v3 offset:17224
  v_cvt_pk_bf16_f32 v48, v152, v153
  v_mfma_f32_16x16x32_bf16 v[168:171], a[224:227], v[80:83], v[168:171]
  s_waitcnt lgkmcnt(4)
  v_exp_f32 v154, v154
  v_mfma_f32_16x16x32_bf16 v[168:171], a[228:231], v[104:107], v[168:171]
  v_mfma_f32_16x16x32_bf16 v[200:203], a[228:231], v[108:111], v[200:203]
  v_exp_f32 v155, v155
  v_mfma_f32_16x16x32_bf16 v[200:203], a[224:227], v[84:87], v[200:203]
  v_cvt_pk_bf16_f32 v49, v154, v155
  v_smfmac_f32_16x16x64_bf16 v[28:31], a[240:243], v[96:103], v5
  v_mfma_f32_16x16x32_bf16 v[152:155], a[208:211], a[112:115], v[132:135]
  s_mov_b32 m0, 119552
  v_exp_f32 v156, v156
  v_mfma_f32_16x16x32_bf16 v[152:155], a[212:215], a[116:119], v[152:155]
  s_waitcnt vmcnt(32) lgkmcnt(0)
  s_barrier
  v_mfma_f32_16x16x32_bf16 v[152:155], a[216:219], a[120:123], v[152:155]
  buffer_load_dwordx4 v1, s[4:7], s28 offen offset:0 nt lds
  s_mov_b32 m0, 119584
  v_exp_f32 v157, v157
  v_mfma_f32_16x16x32_bf16 v[152:155], a[220:223], a[124:127], v[152:155]
  buffer_load_dwordx4 v1, s[4:7], s28 offen offset:1024 nt lds
  s_mov_b32 m0, 119616
  v_cvt_pk_bf16_f32 v34, v156, v157
  v_mfma_f32_16x16x32_bf16 v[232:235], a[224:227], v[88:91], v[232:235]
  buffer_load_dwordx4 v1, s[4:7], s28 offen offset:2048 nt lds
  s_mov_b32 m0, 119648
  v_exp_f32 v158, v158
  v_mfma_f32_16x16x32_bf16 v[232:235], a[228:231], v[112:115], v[232:235]
  buffer_load_dwordx4 v1, s[4:7], s28 offen offset:3072 nt lds
  ds_read_b128 a[192:195], v2 offset:8448
  s_mov_b32 m0, 123776
  v_mfma_f32_16x16x32_bf16 a[8:11], a[228:231], v[116:119], a[8:11]
  buffer_load_dwordx4 v72, s[4:7], s28 offen offset:0 nt lds
  s_mov_b32 m0, 123808
  v_exp_f32 v159, v159
  v_mfma_f32_16x16x32_bf16 a[8:11], a[224:227], v[92:95], a[8:11]
  buffer_load_dwordx4 v72, s[4:7], s28 offen offset:1024 nt lds
  ds_read_b128 a[196:199], v2 offset:8512
  v_cvt_pk_bf16_f32 v35, v158, v159
  v_mfma_f32_16x16x32_bf16 v[156:159], a[208:211], a[128:131], v[136:139]
  s_mov_b32 m0, 123840
  v_exp_f32 v152, v152
  v_mfma_f32_16x16x32_bf16 v[156:159], a[212:215], a[132:135], v[156:159]
  buffer_load_dwordx4 v72, s[4:7], s28 offen offset:2048 nt lds
  ds_read_b128 a[200:203], v2 offset:8576
  v_mfma_f32_16x16x32_bf16 v[156:159], a[216:219], a[136:139], v[156:159]
  s_mov_b32 m0, 123872
  v_exp_f32 v153, v153
  v_mfma_f32_16x16x32_bf16 v[156:159], a[220:223], a[140:143], v[156:159]
  buffer_load_dwordx4 v72, s[4:7], s28 offen offset:3072 nt lds
  ds_read_b128 a[204:207], v2 offset:8640
  v_cvt_pk_bf16_f32 v38, v152, v153
  v_mfma_f32_16x16x32_bf16 a[40:43], a[224:227], v[96:99], a[40:43]
  s_mov_b32 m0, 94208
  v_exp_f32 v154, v154
  v_mfma_f32_16x16x32_bf16 a[40:43], a[228:231], v[100:103], a[40:43]
  buffer_load_dwordx4 v1, s[4:7], s90 offen offset:0 nt lds
  ds_read_b64_tr_b16 a[224:225], v3 offset:17024
  v_mfma_f32_16x16x32_bf16 v[172:175], a[236:239], v[104:107], v[172:175]
  s_mov_b32 m0, 94240
  v_exp_f32 v155, v155
  v_mfma_f32_16x16x32_bf16 v[172:175], a[232:235], v[80:83], v[172:175]
  buffer_load_dwordx4 v1, s[4:7], s90 offen offset:1024 nt lds
  ds_read_b64_tr_b16 a[226:227], v3 offset:17280
  v_cvt_pk_bf16_f32 v39, v154, v155
  v_mfma_f32_16x16x32_bf16 v[152:155], a[208:211], a[144:147], v[140:143]
  s_mov_b32 m0, 94272
  v_exp_f32 v156, v156
  v_mfma_f32_16x16x32_bf16 v[152:155], a[212:215], a[148:151], v[152:155]
  buffer_load_dwordx4 v1, s[4:7], s90 offen offset:2048 nt lds
  ds_read_b64_tr_b16 a[228:229], v3 offset:25472
  v_mfma_f32_16x16x32_bf16 v[152:155], a[216:219], a[152:155], v[152:155]
  s_mov_b32 m0, 94304
  v_exp_f32 v157, v157
  v_mfma_f32_16x16x32_bf16 v[152:155], a[220:223], a[156:159], v[152:155]
  buffer_load_dwordx4 v1, s[4:7], s90 offen offset:3072 nt lds
  v_cvt_pk_bf16_f32 v42, v156, v157
  v_mfma_f32_16x16x32_bf16 v[204:207], a[232:235], v[84:87], v[204:207]
  s_mov_b32 m0, 98432
  v_exp_f32 v158, v158
  v_mfma_f32_16x16x32_bf16 v[204:207], a[236:239], v[108:111], v[204:207]
  buffer_load_dwordx4 v72, s[4:7], s90 offen offset:0 nt lds
  ds_read_b64_tr_b16 a[230:231], v3 offset:25728
  v_mfma_f32_16x16x32_bf16 v[236:239], a[236:239], v[112:115], v[236:239]
  s_mov_b32 m0, 98464
  v_exp_f32 v159, v159
  v_mfma_f32_16x16x32_bf16 v[236:239], a[232:235], v[88:91], v[236:239]
  buffer_load_dwordx4 v72, s[4:7], s90 offen offset:1024 nt lds
  v_cvt_pk_bf16_f32 v43, v158, v159
  v_mfma_f32_16x16x32_bf16 v[156:159], a[208:211], a[160:163], v[144:147]
  s_mov_b32 m0, 98496
  v_exp_f32 v152, v152
  v_mfma_f32_16x16x32_bf16 v[156:159], a[212:215], a[164:167], v[156:159]
  buffer_load_dwordx4 v72, s[4:7], s90 offen offset:2048 nt lds
  s_mov_b32 m0, 98528
  v_mfma_f32_16x16x32_bf16 v[156:159], a[216:219], a[168:171], v[156:159]
  buffer_load_dwordx4 v72, s[4:7], s90 offen offset:3072 nt lds
  v_exp_f32 v153, v153
  v_mfma_f32_16x16x32_bf16 v[156:159], a[220:223], a[172:175], v[156:159]
  buffer_store_dwordx4 a[64:67], v148, s[24:27], s35 offen offset:0 nt
  v_cvt_pk_bf16_f32 v46, v152, v153
  v_mfma_f32_16x16x32_bf16 a[12:15], a[232:235], v[92:95], a[12:15]
  buffer_store_dwordx4 a[68:71], v148, s[24:27], s36 offen offset:0 nt
  v_exp_f32 v154, v154
  v_mfma_f32_16x16x32_bf16 a[12:15], a[236:239], v[116:119], a[12:15]
  buffer_store_dwordx4 a[72:75], v148, s[24:27], s37 offen offset:0 nt
  v_mfma_f32_16x16x32_bf16 a[44:47], a[236:239], v[100:103], a[44:47]
  buffer_store_dwordx4 a[76:79], v148, s[24:27], s38 offen offset:0 nt
  v_exp_f32 v155, v155
  v_mfma_f32_16x16x32_bf16 a[44:47], a[232:235], v[96:99], a[44:47]
  s_waitcnt lgkmcnt(7)
  ds_read_b64_tr_b16 a[236:237], v3 offset:25480
  v_cvt_pk_bf16_f32 v47, v154, v155
  v_mfma_f32_16x16x32_bf16 v[152:155], a[192:195], a[96:99], v[128:131]
  s_waitcnt lgkmcnt(6)
  v_exp_f32 v156, v156
  v_mfma_f32_16x16x32_bf16 v[152:155], a[196:199], a[100:103], v[152:155]
  ds_read_b64_tr_b16 a[238:239], v3 offset:25736
  ds_read_b64_tr_b16 a[232:233], v3 offset:17032
  v_mfma_f32_16x16x32_bf16 v[152:155], a[200:203], a[104:107], v[152:155]
  s_waitcnt lgkmcnt(5)
  v_exp_f32 v157, v157
  v_mfma_f32_16x16x32_bf16 v[152:155], a[204:207], a[108:111], v[152:155]
  ds_read_b64_tr_b16 a[234:235], v3 offset:17288
  v_cvt_pk_bf16_f32 v50, v156, v157
  v_mfma_f32_16x16x32_bf16 v[176:179], a[224:227], v[80:83], v[176:179]
  s_waitcnt lgkmcnt(4)
  v_exp_f32 v158, v158
  v_mfma_f32_16x16x32_bf16 v[176:179], a[228:231], v[104:107], v[176:179]
  ds_read_b128 a[80:83], v4 offset:1024
  ds_read_b128 a[84:87], v4 offset:25600
  v_mfma_f32_16x16x32_bf16 v[208:211], a[228:231], v[108:111], v[208:211]
  v_exp_f32 v159, v159
  v_mfma_f32_16x16x32_bf16 v[208:211], a[224:227], v[84:87], v[208:211]
  ds_read_b128 a[208:211], v2 offset:8704
  v_cvt_pk_bf16_f32 v51, v158, v159
  v_mfma_f32_16x16x32_bf16 v[156:159], a[192:195], a[112:115], v[132:135]
  v_exp_f32 v152, v152
  v_mfma_f32_16x16x32_bf16 v[156:159], a[196:199], a[116:119], v[156:159]
  ds_read_b128 a[88:91], v4 offset:50176
  ds_read_b128 a[92:95], v73 offset:1024
  ds_read_b128 a[212:215], v2 offset:8768
  v_mfma_f32_16x16x32_bf16 v[156:159], a[200:203], a[120:123], v[156:159]
  v_exp_f32 v153, v153
  v_mfma_f32_16x16x32_bf16 v[156:159], a[204:207], a[124:127], v[156:159]
  ds_read_b128 a[216:219], v2 offset:8832
  v_cvt_pk_bf16_f32 v56, v152, v153
  v_mfma_f32_16x16x32_bf16 v[240:243], a[224:227], v[88:91], v[240:243]
  v_exp_f32 v154, v154
  v_mfma_f32_16x16x32_bf16 v[240:243], a[228:231], v[112:115], v[240:243]
  v_mfma_f32_16x16x32_bf16 a[16:19], a[228:231], v[116:119], a[16:19]
  v_exp_f32 v155, v155
  v_mfma_f32_16x16x32_bf16 a[16:19], a[224:227], v[92:95], a[16:19]
  ds_read_b128 a[220:223], v2 offset:8896
  v_cvt_pk_bf16_f32 v57, v154, v155
  v_smfmac_f32_16x16x64_bf16 v[20:23], a[240:243], v[104:111], v5
  v_mfma_f32_16x16x32_bf16 v[152:155], a[192:195], a[128:131], v[136:139]
  v_exp_f32 v156, v156
  v_mfma_f32_16x16x32_bf16 v[152:155], a[196:199], a[132:135], v[152:155]
  v_mfma_f32_16x16x32_bf16 v[152:155], a[200:203], a[136:139], v[152:155]
  v_exp_f32 v157, v157
  v_mfma_f32_16x16x32_bf16 v[152:155], a[204:207], a[140:143], v[152:155]
  v_cvt_pk_bf16_f32 v60, v156, v157
  v_mfma_f32_16x16x32_bf16 a[48:51], a[224:227], v[96:99], a[48:51]
  s_waitcnt lgkmcnt(10)
  v_exp_f32 v158, v158
  v_mfma_f32_16x16x32_bf16 a[48:51], a[228:231], v[100:103], a[48:51]
  v_mfma_f32_16x16x32_bf16 v[180:183], a[236:239], v[104:107], v[180:183]
  s_waitcnt lgkmcnt(8)
  v_exp_f32 v159, v159
  v_mfma_f32_16x16x32_bf16 v[180:183], a[232:235], v[80:83], v[180:183]
  ds_read_b64_tr_b16 a[224:225], v3 offset:17088
  v_cvt_pk_bf16_f32 v61, v158, v159
  v_smfmac_f32_16x16x64_bf16 v[24:27], a[240:243], v[112:119], v5
  v_mfma_f32_16x16x32_bf16 v[156:159], a[192:195], a[144:147], v[140:143]
  v_exp_f32 v152, v152
  v_mfma_f32_16x16x32_bf16 v[156:159], a[196:199], a[148:151], v[156:159]
  v_mfma_f32_16x16x32_bf16 v[156:159], a[200:203], a[152:155], v[156:159]
  v_exp_f32 v153, v153
  v_mfma_f32_16x16x32_bf16 v[156:159], a[204:207], a[156:159], v[156:159]
  ds_read_b64_tr_b16 a[226:227], v3 offset:17344
  ds_read_b64_tr_b16 a[228:229], v3 offset:25536
  v_cvt_pk_bf16_f32 v64, v152, v153
  v_mfma_f32_16x16x32_bf16 v[212:215], a[232:235], v[84:87], v[212:215]
  v_exp_f32 v154, v154
  v_mfma_f32_16x16x32_bf16 v[212:215], a[236:239], v[108:111], v[212:215]
  v_mfma_f32_16x16x32_bf16 v[244:247], a[236:239], v[112:115], v[244:247]
  v_exp_f32 v155, v155
  v_mfma_f32_16x16x32_bf16 v[244:247], a[232:235], v[88:91], v[244:247]
  ds_read_b64_tr_b16 a[230:231], v3 offset:25792
  v_cvt_pk_bf16_f32 v65, v154, v155
  v_mfma_f32_16x16x32_bf16 v[152:155], a[192:195], a[160:163], v[144:147]
  v_exp_f32 v156, v156
  v_mfma_f32_16x16x32_bf16 v[152:155], a[196:199], a[164:167], v[152:155]
  v_mfma_f32_16x16x32_bf16 v[152:155], a[200:203], a[168:171], v[152:155]
  v_exp_f32 v157, v157
  v_mfma_f32_16x16x32_bf16 v[152:155], a[204:207], a[172:175], v[152:155]
  v_cvt_pk_bf16_f32 v68, v156, v157
  v_mfma_f32_16x16x32_bf16 a[20:23], a[232:235], v[92:95], a[20:23]
  v_exp_f32 v158, v158
  v_mfma_f32_16x16x32_bf16 a[20:23], a[236:239], v[116:119], a[20:23]
  v_mfma_f32_16x16x32_bf16 a[52:55], a[236:239], v[100:103], a[52:55]
  s_waitcnt lgkmcnt(9)
  v_exp_f32 v159, v159
  v_mfma_f32_16x16x32_bf16 a[52:55], a[232:235], v[96:99], a[52:55]
  ds_read_b64_tr_b16 a[236:237], v3 offset:25544
  v_cvt_pk_bf16_f32 v69, v158, v159
  v_mfma_f32_16x16x32_bf16 v[156:159], a[208:211], a[96:99], v[128:131]
  s_waitcnt lgkmcnt(6)
  v_exp_f32 v152, v152
  v_mfma_f32_16x16x32_bf16 v[156:159], a[212:215], a[100:103], v[156:159]
  ds_read_b64_tr_b16 a[238:239], v3 offset:25800
  ds_read_b64_tr_b16 a[232:233], v3 offset:17096
  v_mfma_f32_16x16x32_bf16 v[156:159], a[216:219], a[104:107], v[156:159]
  s_waitcnt lgkmcnt(5)
  v_exp_f32 v153, v153
  v_mfma_f32_16x16x32_bf16 v[156:159], a[220:223], a[108:111], v[156:159]
  ds_read_b64_tr_b16 a[234:235], v3 offset:17352
  v_cvt_pk_bf16_f32 v52, v152, v153
  v_mfma_f32_16x16x32_bf16 v[184:187], a[224:227], v[80:83], v[184:187]
  s_waitcnt lgkmcnt(4)
  v_exp_f32 v154, v154
  v_mfma_f32_16x16x32_bf16 v[184:187], a[228:231], v[104:107], v[184:187]
  v_mfma_f32_16x16x32_bf16 v[216:219], a[228:231], v[108:111], v[216:219]
  v_exp_f32 v155, v155
  v_mfma_f32_16x16x32_bf16 v[216:219], a[224:227], v[84:87], v[216:219]
  v_cvt_pk_bf16_f32 v53, v154, v155
  v_mfma_f32_16x16x32_bf16 v[152:155], a[208:211], a[112:115], v[132:135]
  s_mov_b32 m0, 144896
  v_exp_f32 v156, v156
  v_mfma_f32_16x16x32_bf16 v[152:155], a[212:215], a[116:119], v[152:155]
  s_waitcnt vmcnt(24) lgkmcnt(0)
  s_barrier
  v_mfma_f32_16x16x32_bf16 v[152:155], a[216:219], a[120:123], v[152:155]
  buffer_load_dwordx4 v1, s[8:11], s29 offen offset:0 nt lds
  s_mov_b32 m0, 144904
  v_exp_f32 v157, v157
  v_mfma_f32_16x16x32_bf16 v[152:155], a[220:223], a[124:127], v[152:155]
  buffer_load_dwordx4 v1, s[8:11], s29 offen offset:1024 nt lds
  s_mov_b32 m0, 144960
  v_cvt_pk_bf16_f32 v58, v156, v157
  v_mfma_f32_16x16x32_bf16 v[248:251], a[224:227], v[88:91], v[248:251]
  buffer_load_dwordx4 v1, s[8:11], s29 offen offset:2048 nt lds
  s_mov_b32 m0, 144968
  v_exp_f32 v158, v158
  v_mfma_f32_16x16x32_bf16 v[248:251], a[228:231], v[112:115], v[248:251]
  buffer_load_dwordx4 v1, s[8:11], s29 offen offset:3072 nt lds
  ds_read_b128 a[192:195], v2 offset:16896
  s_mov_b32 m0, 149120
  v_mfma_f32_16x16x32_bf16 a[24:27], a[228:231], v[116:119], a[24:27]
  buffer_load_dwordx4 v72, s[8:11], s29 offen offset:0 nt lds
  s_mov_b32 m0, 149128
  v_exp_f32 v159, v159
  v_mfma_f32_16x16x32_bf16 a[24:27], a[224:227], v[92:95], a[24:27]
  buffer_load_dwordx4 v72, s[8:11], s29 offen offset:1024 nt lds
  ds_read_b128 a[196:199], v2 offset:16960
  v_cvt_pk_bf16_f32 v59, v158, v159
  v_mfma_f32_16x16x32_bf16 v[156:159], a[208:211], a[128:131], v[136:139]
  s_mov_b32 m0, 149184
  v_exp_f32 v152, v152
  v_mfma_f32_16x16x32_bf16 v[156:159], a[212:215], a[132:135], v[156:159]
  buffer_load_dwordx4 v72, s[8:11], s29 offen offset:2048 nt lds
  ds_read_b128 a[200:203], v2 offset:17024
  v_mfma_f32_16x16x32_bf16 v[156:159], a[216:219], a[136:139], v[156:159]
  s_mov_b32 m0, 149192
  v_exp_f32 v153, v153
  v_mfma_f32_16x16x32_bf16 v[156:159], a[220:223], a[140:143], v[156:159]
  buffer_load_dwordx4 v72, s[8:11], s29 offen offset:3072 nt lds
  ds_read_b128 a[204:207], v2 offset:17088
  v_cvt_pk_bf16_f32 v62, v152, v153
  v_mfma_f32_16x16x32_bf16 a[56:59], a[224:227], v[96:99], a[56:59]
  s_mov_b32 m0, 153344
  v_exp_f32 v154, v154
  v_mfma_f32_16x16x32_bf16 a[56:59], a[228:231], v[100:103], a[56:59]
  buffer_load_dwordx4 v1, s[8:11], s28 offen offset:0 nt lds
  ds_read_b64_tr_b16 a[224:225], v3 offset:0
  v_mfma_f32_16x16x32_bf16 v[188:191], a[236:239], v[104:107], v[188:191]
  s_mov_b32 m0, 153352
  v_exp_f32 v155, v155
  v_mfma_f32_16x16x32_bf16 v[188:191], a[232:235], v[80:83], v[188:191]
  buffer_load_dwordx4 v1, s[8:11], s28 offen offset:1024 nt lds
  ds_read_b64_tr_b16 a[226:227], v3 offset:256
  v_cvt_pk_bf16_f32 v63, v154, v155
  v_mfma_f32_16x16x32_bf16 v[152:155], a[208:211], a[144:147], v[140:143]
  s_mov_b32 m0, 153408
  v_exp_f32 v156, v156
  v_mfma_f32_16x16x32_bf16 v[152:155], a[212:215], a[148:151], v[152:155]
  buffer_load_dwordx4 v1, s[8:11], s28 offen offset:2048 nt lds
  ds_read_b64_tr_b16 a[228:229], v3 offset:8448
  v_mfma_f32_16x16x32_bf16 v[152:155], a[216:219], a[152:155], v[152:155]
  s_mov_b32 m0, 153416
  v_exp_f32 v157, v157
  v_mfma_f32_16x16x32_bf16 v[152:155], a[220:223], a[156:159], v[152:155]
  buffer_load_dwordx4 v1, s[8:11], s28 offen offset:3072 nt lds
  v_cvt_pk_bf16_f32 v66, v156, v157
  v_mfma_f32_16x16x32_bf16 v[220:223], a[232:235], v[84:87], v[220:223]
  s_mov_b32 m0, 157568
  v_exp_f32 v158, v158
  v_mfma_f32_16x16x32_bf16 v[220:223], a[236:239], v[108:111], v[220:223]
  buffer_load_dwordx4 v72, s[8:11], s28 offen offset:0 nt lds
  ds_read_b64_tr_b16 a[230:231], v3 offset:8704
  v_mfma_f32_16x16x32_bf16 v[252:255], a[236:239], v[112:115], v[252:255]
  s_mov_b32 m0, 157576
  v_exp_f32 v159, v159
  v_mfma_f32_16x16x32_bf16 v[252:255], a[232:235], v[88:91], v[252:255]
  buffer_load_dwordx4 v72, s[8:11], s28 offen offset:1024 nt lds
  v_cvt_pk_bf16_f32 v67, v158, v159
  v_mfma_f32_16x16x32_bf16 v[156:159], a[208:211], a[160:163], v[144:147]
  s_mov_b32 m0, 157632
  v_exp_f32 v152, v152
  v_mfma_f32_16x16x32_bf16 v[156:159], a[212:215], a[164:167], v[156:159]
  buffer_load_dwordx4 v72, s[8:11], s28 offen offset:2048 nt lds
  s_mov_b32 m0, 157640
  v_mfma_f32_16x16x32_bf16 v[156:159], a[216:219], a[168:171], v[156:159]
  buffer_load_dwordx4 v72, s[8:11], s28 offen offset:3072 nt lds
  v_exp_f32 v153, v153
  v_mfma_f32_16x16x32_bf16 v[156:159], a[220:223], a[172:175], v[156:159]
  buffer_store_dwordx4 a[80:83], v149, s[24:27], s35 offen offset:1024 nt
  v_cvt_pk_bf16_f32 v70, v152, v153
  v_mfma_f32_16x16x32_bf16 a[28:31], a[232:235], v[92:95], a[28:31]
  buffer_store_dwordx4 a[84:87], v149, s[24:27], s36 offen offset:1024 nt
  v_exp_f32 v154, v154
  v_mfma_f32_16x16x32_bf16 a[28:31], a[236:239], v[116:119], a[28:31]
  buffer_store_dwordx4 a[88:91], v149, s[24:27], s37 offen offset:1024 nt
  v_mfma_f32_16x16x32_bf16 a[60:63], a[236:239], v[100:103], a[60:63]
  buffer_store_dwordx4 a[92:95], v149, s[24:27], s38 offen offset:1024 nt
  v_exp_f32 v155, v155
  v_mfma_f32_16x16x32_bf16 a[60:63], a[232:235], v[96:99], a[60:63]
  s_waitcnt lgkmcnt(7)
  ds_read_b64_tr_b16 a[236:237], v3 offset:8456
  v_cvt_pk_bf16_f32 v71, v154, v155
ENTRY1_5:
  v_mfma_f32_16x16x32_bf16 v[152:155], a[192:195], a[96:99], v[128:131]
  s_waitcnt lgkmcnt(6)
  v_exp_f32 v156, v156
  v_mfma_f32_16x16x32_bf16 v[152:155], a[196:199], a[100:103], v[152:155]
  ds_read_b64_tr_b16 a[238:239], v3 offset:8712
  ds_read_b64_tr_b16 a[232:233], v3 offset:8
  v_mfma_f32_16x16x32_bf16 v[152:155], a[200:203], a[104:107], v[152:155]
  s_waitcnt lgkmcnt(5)
  v_exp_f32 v157, v157
  v_mfma_f32_16x16x32_bf16 v[152:155], a[204:207], a[108:111], v[152:155]
  ds_read_b64_tr_b16 a[234:235], v3 offset:264
  v_cvt_pk_bf16_f32 v54, v156, v157
  v_mfma_f32_16x16x32_bf16 v[160:163], a[224:227], v[32:35], v[160:163]
  s_waitcnt lgkmcnt(4)
  v_exp_f32 v158, v158
  v_mfma_f32_16x16x32_bf16 v[160:163], a[228:231], v[56:59], v[160:163]
  ds_read_b128 a[64:67], v4 offset:2048
  ds_read_b128 a[68:71], v4 offset:26624
  v_mfma_f32_16x16x32_bf16 v[192:195], a[228:231], v[60:63], v[192:195]
  v_exp_f32 v159, v159
  v_mfma_f32_16x16x32_bf16 v[192:195], a[224:227], v[36:39], v[192:195]
  ds_read_b128 a[208:211], v2 offset:17152
  v_cvt_pk_bf16_f32 v55, v158, v159
  v_mfma_f32_16x16x32_bf16 v[156:159], a[192:195], a[112:115], v[132:135]
  v_exp_f32 v152, v152
  v_mfma_f32_16x16x32_bf16 v[156:159], a[196:199], a[116:119], v[156:159]
  ds_read_b128 a[72:75], v4 offset:51200
  ds_read_b128 a[76:79], v73 offset:2048
  ds_read_b128 a[212:215], v2 offset:17216
  v_mfma_f32_16x16x32_bf16 v[156:159], a[200:203], a[120:123], v[156:159]
  v_exp_f32 v153, v153
  v_mfma_f32_16x16x32_bf16 v[156:159], a[204:207], a[124:127], v[156:159]
  ds_read_b128 a[216:219], v2 offset:17280
  v_cvt_pk_bf16_f32 v80, v152, v153
  v_mfma_f32_16x16x32_bf16 v[224:227], a[224:227], v[40:43], v[224:227]
  s_waitcnt lgkmcnt(9)
  v_exp_f32 v154, v154
  v_mfma_f32_16x16x32_bf16 v[224:227], a[228:231], v[64:67], v[224:227]
  v_mfma_f32_16x16x32_bf16 a[0:3], a[228:231], v[68:71], a[0:3]
  s_mov_b32 s29, s90
  v_exp_f32 v155, v155
  v_mfma_f32_16x16x32_bf16 a[0:3], a[224:227], v[44:47], a[0:3]
  ds_read_b128 a[220:223], v2 offset:17344
  v_cvt_pk_bf16_f32 v81, v154, v155
  v_smfmac_f32_16x16x64_bf16 v[20:23], a[240:243], v[32:39], v5
  v_mfma_f32_16x16x32_bf16 v[152:155], a[192:195], a[128:131], v[136:139]
  s_xor_b32 s28, s90, 0x2000
  v_exp_f32 v156, v156
  v_mfma_f32_16x16x32_bf16 v[152:155], a[196:199], a[132:135], v[152:155]
  v_mfma_f32_16x16x32_bf16 v[152:155], a[200:203], a[136:139], v[152:155]
  s_addk_i32 s67, 0x4000
  v_exp_f32 v157, v157
  v_mfma_f32_16x16x32_bf16 v[152:155], a[204:207], a[140:143], v[152:155]
  v_cvt_pk_bf16_f32 v84, v156, v157
  v_mfma_f32_16x16x32_bf16 a[32:35], a[224:227], v[48:51], a[32:35]
  s_xor_b32 s90, s67, s66
  v_exp_f32 v158, v158
  v_mfma_f32_16x16x32_bf16 a[32:35], a[228:231], v[52:55], a[32:35]
  v_mfma_f32_16x16x32_bf16 v[164:167], a[236:239], v[56:59], v[164:167]
  s_waitcnt lgkmcnt(8)
  v_exp_f32 v159, v159
  v_mfma_f32_16x16x32_bf16 v[164:167], a[232:235], v[32:35], v[164:167]
  ds_read_b64_tr_b16 a[224:225], v3 offset:64
  v_cvt_pk_bf16_f32 v85, v158, v159
  v_smfmac_f32_16x16x64_bf16 v[24:27], a[240:243], v[40:47], v5
  v_mfma_f32_16x16x32_bf16 v[156:159], a[192:195], a[144:147], v[140:143]
  v_exp_f32 v152, v152
  v_mfma_f32_16x16x32_bf16 v[156:159], a[196:199], a[148:151], v[156:159]
  v_mfma_f32_16x16x32_bf16 v[156:159], a[200:203], a[152:155], v[156:159]
  v_exp_f32 v153, v153
  v_mfma_f32_16x16x32_bf16 v[156:159], a[204:207], a[156:159], v[156:159]
  ds_read_b64_tr_b16 a[226:227], v3 offset:320
  ds_read_b64_tr_b16 a[228:229], v3 offset:8512
  v_cvt_pk_bf16_f32 v88, v152, v153
  v_mfma_f32_16x16x32_bf16 v[196:199], a[232:235], v[36:39], v[196:199]
  v_exp_f32 v154, v154
  v_mfma_f32_16x16x32_bf16 v[196:199], a[236:239], v[60:63], v[196:199]
  v_mfma_f32_16x16x32_bf16 v[228:231], a[236:239], v[64:67], v[228:231]
  v_exp_f32 v155, v155
  v_mfma_f32_16x16x32_bf16 v[228:231], a[232:235], v[40:43], v[228:231]
  ds_read_b64_tr_b16 a[230:231], v3 offset:8768
  v_cvt_pk_bf16_f32 v89, v154, v155
  v_mfma_f32_16x16x32_bf16 v[152:155], a[192:195], a[160:163], v[144:147]
  v_exp_f32 v156, v156
  v_mfma_f32_16x16x32_bf16 v[152:155], a[196:199], a[164:167], v[152:155]
  v_mfma_f32_16x16x32_bf16 v[152:155], a[200:203], a[168:171], v[152:155]
  v_exp_f32 v157, v157
  v_mfma_f32_16x16x32_bf16 v[152:155], a[204:207], a[172:175], v[152:155]
  v_cvt_pk_bf16_f32 v92, v156, v157
  v_mfma_f32_16x16x32_bf16 a[4:7], a[232:235], v[44:47], a[4:7]
  v_exp_f32 v158, v158
  v_mfma_f32_16x16x32_bf16 a[4:7], a[236:239], v[68:71], a[4:7]
  v_mfma_f32_16x16x32_bf16 a[36:39], a[236:239], v[52:55], a[36:39]
  s_waitcnt lgkmcnt(9)
  v_exp_f32 v159, v159
  v_mfma_f32_16x16x32_bf16 a[36:39], a[232:235], v[48:51], a[36:39]
  ds_read_b64_tr_b16 a[236:237], v3 offset:8520
  v_cvt_pk_bf16_f32 v93, v158, v159
  v_mfma_f32_16x16x32_bf16 v[156:159], a[208:211], a[96:99], v[128:131]
  s_waitcnt lgkmcnt(6)
  v_exp_f32 v152, v152
  v_mfma_f32_16x16x32_bf16 v[156:159], a[212:215], a[100:103], v[156:159]
  ds_read_b64_tr_b16 a[238:239], v3 offset:8776
  ds_read_b64_tr_b16 a[232:233], v3 offset:72
  v_mfma_f32_16x16x32_bf16 v[156:159], a[216:219], a[104:107], v[156:159]
  s_waitcnt lgkmcnt(5)
  v_exp_f32 v153, v153
  v_mfma_f32_16x16x32_bf16 v[156:159], a[220:223], a[108:111], v[156:159]
  ds_read_b64_tr_b16 a[234:235], v3 offset:328
  v_cvt_pk_bf16_f32 v96, v152, v153
  v_mfma_f32_16x16x32_bf16 v[168:171], a[224:227], v[32:35], v[168:171]
  s_waitcnt lgkmcnt(4)
  v_exp_f32 v154, v154
  v_mfma_f32_16x16x32_bf16 v[168:171], a[228:231], v[56:59], v[168:171]
  v_mfma_f32_16x16x32_bf16 v[200:203], a[228:231], v[60:63], v[200:203]
  v_exp_f32 v155, v155
  v_mfma_f32_16x16x32_bf16 v[200:203], a[224:227], v[36:39], v[200:203]
  v_cvt_pk_bf16_f32 v97, v154, v155
  v_smfmac_f32_16x16x64_bf16 v[28:31], a[240:243], v[48:55], v5
  v_mfma_f32_16x16x32_bf16 v[152:155], a[208:211], a[112:115], v[132:135]
  s_mov_b32 m0, 102656
  v_exp_f32 v156, v156
  v_mfma_f32_16x16x32_bf16 v[152:155], a[212:215], a[116:119], v[152:155]
  s_waitcnt vmcnt(32) lgkmcnt(0)
  s_barrier
  v_mfma_f32_16x16x32_bf16 v[152:155], a[216:219], a[120:123], v[152:155]
  buffer_load_dwordx4 v1, s[4:7], s28 offen offset:0 nt lds
  s_mov_b32 m0, 102688
  v_exp_f32 v157, v157
  v_mfma_f32_16x16x32_bf16 v[152:155], a[220:223], a[124:127], v[152:155]
  buffer_load_dwordx4 v1, s[4:7], s28 offen offset:1024 nt lds
  s_mov_b32 m0, 102720
  v_cvt_pk_bf16_f32 v82, v156, v157
  v_mfma_f32_16x16x32_bf16 v[232:235], a[224:227], v[40:43], v[232:235]
  buffer_load_dwordx4 v1, s[4:7], s28 offen offset:2048 nt lds
  s_mov_b32 m0, 102752
  v_exp_f32 v158, v158
  v_mfma_f32_16x16x32_bf16 v[232:235], a[228:231], v[64:67], v[232:235]
  buffer_load_dwordx4 v1, s[4:7], s28 offen offset:3072 nt lds
  ds_read_b128 a[192:195], v2 offset:25344
  s_mov_b32 m0, 106880
  v_mfma_f32_16x16x32_bf16 a[8:11], a[228:231], v[68:71], a[8:11]
  buffer_load_dwordx4 v72, s[4:7], s28 offen offset:0 nt lds
  s_mov_b32 m0, 106912
  v_exp_f32 v159, v159
  v_mfma_f32_16x16x32_bf16 a[8:11], a[224:227], v[44:47], a[8:11]
  buffer_load_dwordx4 v72, s[4:7], s28 offen offset:1024 nt lds
  ds_read_b128 a[196:199], v2 offset:25408
  v_cvt_pk_bf16_f32 v83, v158, v159
  v_mfma_f32_16x16x32_bf16 v[156:159], a[208:211], a[128:131], v[136:139]
  s_mov_b32 m0, 106944
  v_exp_f32 v152, v152
  v_mfma_f32_16x16x32_bf16 v[156:159], a[212:215], a[132:135], v[156:159]
  buffer_load_dwordx4 v72, s[4:7], s28 offen offset:2048 nt lds
  ds_read_b128 a[200:203], v2 offset:25472
  v_mfma_f32_16x16x32_bf16 v[156:159], a[216:219], a[136:139], v[156:159]
  s_mov_b32 m0, 106976
  v_exp_f32 v153, v153
  v_mfma_f32_16x16x32_bf16 v[156:159], a[220:223], a[140:143], v[156:159]
  buffer_load_dwordx4 v72, s[4:7], s28 offen offset:3072 nt lds
  ds_read_b128 a[204:207], v2 offset:25536
  v_cvt_pk_bf16_f32 v86, v152, v153
  v_mfma_f32_16x16x32_bf16 a[40:43], a[224:227], v[48:51], a[40:43]
  s_mov_b32 m0, 111104
  v_exp_f32 v154, v154
  v_mfma_f32_16x16x32_bf16 a[40:43], a[228:231], v[52:55], a[40:43]
  buffer_load_dwordx4 v1, s[4:7], s90 offen offset:0 nt lds
  ds_read_b64_tr_b16 a[224:225], v3 offset:128
  v_mfma_f32_16x16x32_bf16 v[172:175], a[236:239], v[56:59], v[172:175]
  s_mov_b32 m0, 111136
  v_exp_f32 v155, v155
  v_mfma_f32_16x16x32_bf16 v[172:175], a[232:235], v[32:35], v[172:175]
  buffer_load_dwordx4 v1, s[4:7], s90 offen offset:1024 nt lds
  ds_read_b64_tr_b16 a[226:227], v3 offset:384
  v_cvt_pk_bf16_f32 v87, v154, v155
  v_mfma_f32_16x16x32_bf16 v[152:155], a[208:211], a[144:147], v[140:143]
  s_mov_b32 m0, 111168
  v_exp_f32 v156, v156
  v_mfma_f32_16x16x32_bf16 v[152:155], a[212:215], a[148:151], v[152:155]
  buffer_load_dwordx4 v1, s[4:7], s90 offen offset:2048 nt lds
  ds_read_b64_tr_b16 a[228:229], v3 offset:8576
  v_mfma_f32_16x16x32_bf16 v[152:155], a[216:219], a[152:155], v[152:155]
  s_mov_b32 m0, 111200
  v_exp_f32 v157, v157
  v_mfma_f32_16x16x32_bf16 v[152:155], a[220:223], a[156:159], v[152:155]
  buffer_load_dwordx4 v1, s[4:7], s90 offen offset:3072 nt lds
  v_cvt_pk_bf16_f32 v90, v156, v157
  v_mfma_f32_16x16x32_bf16 v[204:207], a[232:235], v[36:39], v[204:207]
  s_mov_b32 m0, 115328
  v_exp_f32 v158, v158
  v_mfma_f32_16x16x32_bf16 v[204:207], a[236:239], v[60:63], v[204:207]
  buffer_load_dwordx4 v72, s[4:7], s90 offen offset:0 nt lds
  ds_read_b64_tr_b16 a[230:231], v3 offset:8832
  v_mfma_f32_16x16x32_bf16 v[236:239], a[236:239], v[64:67], v[236:239]
  s_mov_b32 m0, 115360
  v_exp_f32 v159, v159
  v_mfma_f32_16x16x32_bf16 v[236:239], a[232:235], v[40:43], v[236:239]
  buffer_load_dwordx4 v72, s[4:7], s90 offen offset:1024 nt lds
  v_cvt_pk_bf16_f32 v91, v158, v159
  v_mfma_f32_16x16x32_bf16 v[156:159], a[208:211], a[160:163], v[144:147]
  s_mov_b32 m0, 115392
  v_exp_f32 v152, v152
  v_mfma_f32_16x16x32_bf16 v[156:159], a[212:215], a[164:167], v[156:159]
  buffer_load_dwordx4 v72, s[4:7], s90 offen offset:2048 nt lds
  s_mov_b32 m0, 115424
  v_mfma_f32_16x16x32_bf16 v[156:159], a[216:219], a[168:171], v[156:159]
  buffer_load_dwordx4 v72, s[4:7], s90 offen offset:3072 nt lds
  v_exp_f32 v153, v153
  v_mfma_f32_16x16x32_bf16 v[156:159], a[220:223], a[172:175], v[156:159]
  buffer_store_dwordx4 a[64:67], v150, s[24:27], s35 offen offset:2048 nt
  v_cvt_pk_bf16_f32 v94, v152, v153
  v_mfma_f32_16x16x32_bf16 a[12:15], a[232:235], v[44:47], a[12:15]
  buffer_store_dwordx4 a[68:71], v150, s[24:27], s36 offen offset:2048 nt
  v_exp_f32 v154, v154
  v_mfma_f32_16x16x32_bf16 a[12:15], a[236:239], v[68:71], a[12:15]
  buffer_store_dwordx4 a[72:75], v150, s[24:27], s37 offen offset:2048 nt
  v_mfma_f32_16x16x32_bf16 a[44:47], a[236:239], v[52:55], a[44:47]
  buffer_store_dwordx4 a[76:79], v150, s[24:27], s38 offen offset:2048 nt
  v_exp_f32 v155, v155
  v_mfma_f32_16x16x32_bf16 a[44:47], a[232:235], v[48:51], a[44:47]
  s_waitcnt lgkmcnt(7)
  s_sub_u32 s39, s39, 1
  ds_read_b64_tr_b16 a[236:237], v3 offset:8584
  v_cvt_pk_bf16_f32 v95, v154, v155
  s_cbranch_scc0 LOOP1_5
FIN_5:
  v_mfma_f32_16x16x32_bf16 v[152:155], a[192:195], a[96:99], v[128:131]
  ds_read_b128 a[208:211], v2 offset:25600
  ds_read_b128 a[212:215], v2 offset:25664
  s_waitcnt lgkmcnt(9)
  v_mfma_f32_16x16x32_bf16 v[152:155], a[196:199], a[100:103], v[152:155]
  ds_read_b128 a[216:219], v2 offset:25728
  ds_read_b128 a[220:223], v2 offset:25792
  s_waitcnt lgkmcnt(10)
  v_mfma_f32_16x16x32_bf16 v[152:155], a[200:203], a[104:107], v[152:155]
  s_waitcnt lgkmcnt(4)
  ds_read_b64_tr_b16 a[238:239], v3 offset:8840
  ds_read_b64_tr_b16 a[232:233], v3 offset:136
  v_mfma_f32_16x16x32_bf16 v[152:155], a[204:207], a[108:111], v[152:155]
  s_waitcnt vmcnt(24)
  ds_read_b64_tr_b16 a[234:235], v3 offset:392
  ds_read_b64_tr_b16 a[184:185], v3 offset:200
  v_exp_f32 v156, v156
  v_exp_f32 v157, v157
  v_exp_f32 v158, v158
  v_exp_f32 v159, v159
  v_cvt_pk_bf16_f32 v98, v156, v157
  v_cvt_pk_bf16_f32 v99, v158, v159
  v_mfma_f32_16x16x32_bf16 v[156:159], a[192:195], a[112:115], v[132:135]
  s_barrier
  ds_read_b64_tr_b16 a[88:89], v3 offset:16968
  ds_read_b64_tr_b16 a[90:91], v3 offset:17224
  v_mfma_f32_16x16x32_bf16 v[156:159], a[196:199], a[116:119], v[156:159]
  ds_read_b64_tr_b16 a[92:93], v3 offset:25416
  ds_read_b64_tr_b16 a[94:95], v3 offset:25672
  v_mfma_f32_16x16x32_bf16 v[156:159], a[200:203], a[120:123], v[156:159]
  ds_read_b64_tr_b16 a[80:81], v3 offset:16960
  ds_read_b64_tr_b16 a[82:83], v3 offset:17216
  v_mfma_f32_16x16x32_bf16 v[156:159], a[204:207], a[124:127], v[156:159]
  s_waitcnt lgkmcnt(10)
  ds_read_b64_tr_b16 a[84:85], v3 offset:25408
  ds_read_b64_tr_b16 a[86:87], v3 offset:25664
  v_mfma_f32_16x16x32_bf16 v[16:19], a[208:211], a[96:99], v[128:131]
  ds_read_b64_tr_b16 a[96:97], v3 offset:17024
  ds_read_b64_tr_b16 a[98:99], v3 offset:17280
  v_mfma_f32_16x16x32_bf16 v[16:19], a[212:215], a[100:103], v[16:19]
  ds_read_b64_tr_b16 a[100:101], v3 offset:25472
  ds_read_b64_tr_b16 a[102:103], v3 offset:25728
  v_mfma_f32_16x16x32_bf16 v[16:19], a[216:219], a[104:107], v[16:19]
  ds_read_b64_tr_b16 a[104:105], v3 offset:17032
  ds_read_b64_tr_b16 a[106:107], v3 offset:17288
  v_mfma_f32_16x16x32_bf16 v[16:19], a[220:223], a[108:111], v[16:19]
  ds_read_b64_tr_b16 a[108:109], v3 offset:25480
  ds_read_b64_tr_b16 a[110:111], v3 offset:25736
  v_exp_f32 v152, v152
  v_exp_f32 v153, v153
  v_exp_f32 v154, v154
  v_exp_f32 v155, v155
  v_cvt_pk_bf16_f32 v104, v152, v153
  v_cvt_pk_bf16_f32 v105, v154, v155
  v_mfma_f32_16x16x32_bf16 v[152:155], a[208:211], a[112:115], v[132:135]
  ds_read_b64_tr_b16 a[112:113], v3 offset:17088
  ds_read_b64_tr_b16 a[114:115], v3 offset:17344
  v_mfma_f32_16x16x32_bf16 v[152:155], a[212:215], a[116:119], v[152:155]
  ds_read_b64_tr_b16 a[116:117], v3 offset:25536
  ds_read_b64_tr_b16 a[118:119], v3 offset:25792
  v_mfma_f32_16x16x32_bf16 v[152:155], a[216:219], a[120:123], v[152:155]
  ds_read_b64_tr_b16 a[120:121], v3 offset:17096
  ds_read_b64_tr_b16 a[122:123], v3 offset:17352
  v_mfma_f32_16x16x32_bf16 v[152:155], a[220:223], a[124:127], v[152:155]
  ds_read_b64_tr_b16 a[124:125], v3 offset:25544
  ds_read_b64_tr_b16 a[126:127], v3 offset:25800
  v_smfmac_f32_16x16x64_bf16 v[20:23], a[240:243], v[56:63], v5
  ds_read_b64_tr_b16 a[72:73], v3 offset:16904
  v_smfmac_f32_16x16x64_bf16 v[20:23], a[240:243], v[80:87], v5
  ds_read_b64_tr_b16 a[74:75], v3 offset:17160
  v_exp_f32 v16, v16
  v_exp_f32 v17, v17
  v_exp_f32 v18, v18
  v_exp_f32 v19, v19
  v_cvt_pk_bf16_f32 v106, v16, v17
  v_cvt_pk_bf16_f32 v107, v18, v19
  v_exp_f32 v156, v156
  v_exp_f32 v157, v157
  v_exp_f32 v158, v158
  v_exp_f32 v159, v159
  v_cvt_pk_bf16_f32 v108, v156, v157
  v_cvt_pk_bf16_f32 v109, v158, v159
  v_exp_f32 v152, v152
  v_exp_f32 v153, v153
  v_exp_f32 v154, v154
  v_exp_f32 v155, v155
  v_cvt_pk_bf16_f32 v110, v152, v153
  v_cvt_pk_bf16_f32 v111, v154, v155
  ds_read_b64_tr_b16 a[76:77], v3 offset:25352
  ds_read_b64_tr_b16 a[78:79], v3 offset:25608
  v_smfmac_f32_16x16x64_bf16 v[20:23], a[240:243], v[104:111], v5
  s_waitcnt lgkmcnt(2)
  ds_read_b64_tr_b16 a[64:65], v3 offset:16896
  ds_read_b64_tr_b16 a[66:67], v3 offset:17152
  ds_read_b64_tr_b16 a[68:69], v3 offset:25344
  ds_read_b64_tr_b16 a[70:71], v3 offset:25600
  v_mfma_f32_16x16x32_bf16 v[164:167], a[72:75], v[80:83], v[164:167]
  ds_read_b64_tr_b16 a[186:187], v3 offset:456
  ds_read_b64_tr_b16 a[188:189], v3 offset:8648
  v_mfma_f32_16x16x32_bf16 v[168:171], a[80:83], v[80:83], v[168:171]
  ds_read_b64_tr_b16 a[190:191], v3 offset:8904
  ds_read_b64_tr_b16 a[176:177], v3 offset:192
  v_mfma_f32_16x16x32_bf16 v[168:171], a[84:87], v[104:107], v[168:171]
  ds_read_b64_tr_b16 a[178:179], v3 offset:448
  ds_read_b64_tr_b16 a[180:181], v3 offset:8640
  v_mfma_f32_16x16x32_bf16 v[172:175], a[88:91], v[80:83], v[172:175]
  ds_read_b64_tr_b16 a[182:183], v3 offset:8896
  v_add_f32 v20, v20, v21
  v_mfma_f32_16x16x32_bf16 v[172:175], a[92:95], v[104:107], v[172:175]
  s_add_u32 s63, s45, 94208
  v_rcp_f32 v12, v20
  v_mfma_f32_16x16x32_bf16 v[176:179], a[224:227], v[32:35], v[176:179]
  v_mul_f32 v21, s83, v12
  v_fma_f32 v168, v168, v12, v21
  v_mfma_f32_16x16x32_bf16 v[176:179], a[228:231], v[56:59], v[176:179]
  s_waitcnt lgkmcnt(11)
  v_fma_f32 v169, v169, v12, v21
  v_fma_f32 v170, v170, v12, v21
  v_mfma_f32_16x16x32_bf16 v[164:167], a[76:79], v[104:107], v[164:167]
  s_waitcnt lgkmcnt(8)
  v_fma_f32 v171, v171, v12, v21
  v_fma_f32 v172, v172, v12, v21
  v_mfma_f32_16x16x32_bf16 v[160:163], a[64:67], v[80:83], v[160:163]
  s_waitcnt lgkmcnt(6)
  v_fma_f32 v173, v173, v12, v21
  v_fma_f32 v174, v174, v12, v21
  v_mfma_f32_16x16x32_bf16 v[160:163], a[68:71], v[104:107], v[160:163]
  v_fma_f32 v164, v164, v12, v21
  v_fma_f32 v165, v165, v12, v21
  v_mfma_f32_16x16x32_bf16 v[176:179], a[96:99], v[80:83], v[176:179]
  s_waitcnt lgkmcnt(2)
  v_fma_f32 v166, v166, v12, v21
  v_fma_f32 v167, v167, v12, v21
  v_mfma_f32_16x16x32_bf16 v[176:179], a[100:103], v[104:107], v[176:179]
  s_waitcnt lgkmcnt(0)
  v_fma_f32 v160, v160, v12, v21
  v_fma_f32 v161, v161, v12, v21
  v_mfma_f32_16x16x32_bf16 v[180:183], a[232:235], v[32:35], v[180:183]
  v_fma_f32 v162, v162, v12, v21
  v_fma_f32 v163, v163, v12, v21
  v_mfma_f32_16x16x32_bf16 v[180:183], a[236:239], v[56:59], v[180:183]
  v_cvt_pk_bf16_f32 v160, v160, v161
  v_cvt_pk_bf16_f32 v161, v162, v163
  v_mfma_f32_16x16x32_bf16 v[180:183], a[104:107], v[80:83], v[180:183]
  v_cvt_pk_bf16_f32 v162, v164, v165
  v_cvt_pk_bf16_f32 v163, v166, v167
  v_mfma_f32_16x16x32_bf16 v[180:183], a[108:111], v[104:107], v[180:183]
  ds_write_b128 v8, v[160:163] offset:0
  v_mfma_f32_16x16x32_bf16 v[184:187], a[176:179], v[32:35], v[184:187]
  v_fma_f32 v175, v175, v12, v21
  v_cvt_pk_bf16_f32 v168, v168, v169
  v_mfma_f32_16x16x32_bf16 v[184:187], a[180:183], v[56:59], v[184:187]
  v_cvt_pk_bf16_f32 v169, v170, v171
  v_cvt_pk_bf16_f32 v170, v172, v173
  v_mfma_f32_16x16x32_bf16 v[184:187], a[112:115], v[80:83], v[184:187]
  v_cvt_pk_bf16_f32 v171, v174, v175
  v_fma_f32 v176, v176, v12, v21
  v_mfma_f32_16x16x32_bf16 v[184:187], a[116:119], v[104:107], v[184:187]
  ds_write_b128 v9, v[168:171] offset:0
  v_mfma_f32_16x16x32_bf16 v[188:191], a[184:187], v[32:35], v[188:191]
  v_fma_f32 v177, v177, v12, v21
  v_fma_f32 v178, v178, v12, v21
  v_mfma_f32_16x16x32_bf16 v[188:191], a[188:191], v[56:59], v[188:191]
  v_fma_f32 v179, v179, v12, v21
  v_fma_f32 v180, v180, v12, v21
  v_mfma_f32_16x16x32_bf16 v[188:191], a[120:123], v[80:83], v[188:191]
  v_fma_f32 v181, v181, v12, v21
  v_fma_f32 v182, v182, v12, v21
  v_mfma_f32_16x16x32_bf16 v[188:191], a[124:127], v[104:107], v[188:191]
  v_fma_f32 v183, v183, v12, v21
  v_cvt_pk_bf16_f32 v176, v176, v177
  v_mfma_f32_16x16x32_bf16 v[208:211], a[224:227], v[36:39], v[208:211]
  v_cvt_pk_bf16_f32 v177, v178, v179
  v_cvt_pk_bf16_f32 v178, v180, v181
  v_mfma_f32_16x16x32_bf16 v[208:211], a[228:231], v[60:63], v[208:211]
  v_cvt_pk_bf16_f32 v179, v182, v183
  v_fma_f32 v184, v184, v12, v21
  v_mfma_f32_16x16x32_bf16 v[212:215], a[232:235], v[36:39], v[212:215]
  ds_write_b128 v10, v[176:179] offset:0
  v_mfma_f32_16x16x32_bf16 v[212:215], a[236:239], v[60:63], v[212:215]
  v_fma_f32 v185, v185, v12, v21
  v_fma_f32 v186, v186, v12, v21
  v_mfma_f32_16x16x32_bf16 v[216:219], a[176:179], v[36:39], v[216:219]
  v_fma_f32 v187, v187, v12, v21
  v_fma_f32 v188, v188, v12, v21
  v_mfma_f32_16x16x32_bf16 v[216:219], a[180:183], v[60:63], v[216:219]
  v_fma_f32 v189, v189, v12, v21
  v_fma_f32 v190, v190, v12, v21
  v_mfma_f32_16x16x32_bf16 v[220:223], a[184:187], v[36:39], v[220:223]
  v_fma_f32 v191, v191, v12, v21
  v_cvt_pk_bf16_f32 v184, v184, v185
  v_mfma_f32_16x16x32_bf16 v[220:223], a[188:191], v[60:63], v[220:223]
  v_cvt_pk_bf16_f32 v185, v186, v187
  v_cvt_pk_bf16_f32 v186, v188, v189
  v_cvt_pk_bf16_f32 v187, v190, v191
  v_mfma_f32_16x16x32_bf16 v[192:195], a[64:67], v[84:87], v[192:195]
  ds_write_b128 v11, v[184:187] offset:0
  v_add_u32 v4, s45, v1
  v_mfma_f32_16x16x32_bf16 v[192:195], a[68:71], v[108:111], v[192:195]
  ds_read_b128 v[32:35], v4 offset:0
  ds_read_b128 v[56:59], v4 offset:1024
  v_mfma_f32_16x16x32_bf16 v[196:199], a[72:75], v[84:87], v[196:199]
  ds_read_b128 v[80:83], v4 offset:2048
  ds_read_b128 v[104:107], v4 offset:3072
  v_mfma_f32_16x16x32_bf16 v[196:199], a[76:79], v[108:111], v[196:199]
  v_add_f32 v22, v22, v23
  v_rcp_f32 v13, v22
  v_mfma_f32_16x16x32_bf16 v[200:203], a[80:83], v[84:87], v[200:203]
  v_mul_f32 v23, s83, v13
  v_fma_f32 v192, v192, v13, v23
  v_mfma_f32_16x16x32_bf16 v[200:203], a[84:87], v[108:111], v[200:203]
  v_fma_f32 v193, v193, v13, v23
  v_fma_f32 v194, v194, v13, v23
  v_mfma_f32_16x16x32_bf16 v[204:207], a[88:91], v[84:87], v[204:207]
  v_fma_f32 v195, v195, v13, v23
  v_fma_f32 v196, v196, v13, v23
  v_mfma_f32_16x16x32_bf16 v[204:207], a[92:95], v[108:111], v[204:207]
  v_fma_f32 v197, v197, v13, v23
  v_fma_f32 v198, v198, v13, v23
  v_mfma_f32_16x16x32_bf16 v[208:211], a[96:99], v[84:87], v[208:211]
  v_fma_f32 v199, v199, v13, v23
  v_cvt_pk_bf16_f32 v192, v192, v193
  v_mfma_f32_16x16x32_bf16 v[208:211], a[100:103], v[108:111], v[208:211]
  v_cvt_pk_bf16_f32 v193, v194, v195
  v_cvt_pk_bf16_f32 v194, v196, v197
  v_mfma_f32_16x16x32_bf16 v[212:215], a[104:107], v[84:87], v[212:215]
  s_waitcnt lgkmcnt(0)
  buffer_store_dwordx4 v[32:35], v148, s[20:23], s63 offen offset:0 nt
  v_mfma_f32_16x16x32_bf16 v[212:215], a[108:111], v[108:111], v[212:215]
  v_cvt_pk_bf16_f32 v195, v198, v199
  v_fma_f32 v200, v200, v13, v23
  v_mfma_f32_16x16x32_bf16 v[216:219], a[112:115], v[84:87], v[216:219]
  v_fma_f32 v201, v201, v13, v23
  v_fma_f32 v202, v202, v13, v23
  v_mfma_f32_16x16x32_bf16 v[216:219], a[116:119], v[108:111], v[216:219]
  buffer_store_dwordx4 v[56:59], v149, s[20:23], s63 offen offset:1024 nt
  v_mfma_f32_16x16x32_bf16 v[220:223], a[120:123], v[84:87], v[220:223]
  v_fma_f32 v203, v203, v13, v23
  v_fma_f32 v204, v204, v13, v23
  v_mfma_f32_16x16x32_bf16 v[220:223], a[124:127], v[108:111], v[220:223]
  ds_write_b128 v8, v[192:195] offset:4096
  buffer_store_dwordx4 v[80:83], v150, s[20:23], s63 offen offset:2048 nt
  v_mfma_f32_16x16x32_bf16 v[16:19], a[192:195], a[128:131], v[136:139]
  v_fma_f32 v205, v205, v13, v23
  v_fma_f32 v206, v206, v13, v23
  v_mfma_f32_16x16x32_bf16 v[16:19], a[196:199], a[132:135], v[16:19]
  v_fma_f32 v207, v207, v13, v23
  v_cvt_pk_bf16_f32 v200, v200, v201
  v_mfma_f32_16x16x32_bf16 v[16:19], a[200:203], a[136:139], v[16:19]
  buffer_store_dwordx4 v[104:107], v151, s[20:23], s63 offen offset:3072 nt
  v_mfma_f32_16x16x32_bf16 v[16:19], a[204:207], a[140:143], v[16:19]
  s_add_u32 s63, s45, 98304
  v_cvt_pk_bf16_f32 v201, v202, v203
  v_cvt_pk_bf16_f32 v202, v204, v205
  v_mfma_f32_16x16x32_bf16 v[156:159], a[208:211], a[128:131], v[136:139]
  v_cvt_pk_bf16_f32 v203, v206, v207
  v_fma_f32 v208, v208, v13, v23
  v_mfma_f32_16x16x32_bf16 v[156:159], a[212:215], a[132:135], v[156:159]
  ds_write_b128 v9, v[200:203] offset:4096
  v_mfma_f32_16x16x32_bf16 v[156:159], a[216:219], a[136:139], v[156:159]
  v_exp_f32 v16, v16
  v_mfma_f32_16x16x32_bf16 v[156:159], a[220:223], a[140:143], v[156:159]
  v_exp_f32 v17, v17
  v_exp_f32 v18, v18
  v_exp_f32 v19, v19
  v_cvt_pk_bf16_f32 v112, v16, v17
  v_cvt_pk_bf16_f32 v113, v18, v19
  v_mfma_f32_16x16x32_bf16 v[152:155], a[192:195], a[144:147], v[140:143]
  v_fma_f32 v209, v209, v13, v23
  v_fma_f32 v210, v210, v13, v23
  v_exp_f32 v156, v156
  v_exp_f32 v157, v157
  v_exp_f32 v158, v158
  v_exp_f32 v159, v159
  v_cvt_pk_bf16_f32 v114, v156, v157
  v_cvt_pk_bf16_f32 v115, v158, v159
  v_mfma_f32_16x16x32_bf16 v[152:155], a[196:199], a[148:151], v[152:155]
  v_fma_f32 v211, v211, v13, v23
  v_fma_f32 v212, v212, v13, v23
  v_mfma_f32_16x16x32_bf16 v[152:155], a[200:203], a[152:155], v[152:155]
  v_fma_f32 v213, v213, v13, v23
  v_fma_f32 v214, v214, v13, v23
  v_mfma_f32_16x16x32_bf16 v[152:155], a[204:207], a[156:159], v[152:155]
  v_fma_f32 v215, v215, v13, v23
  v_cvt_pk_bf16_f32 v208, v208, v209
  v_mfma_f32_16x16x32_bf16 v[16:19], a[208:211], a[144:147], v[140:143]
  v_cvt_pk_bf16_f32 v209, v210, v211
  v_cvt_pk_bf16_f32 v210, v212, v213
  v_mfma_f32_16x16x32_bf16 v[16:19], a[212:215], a[148:151], v[16:19]
  v_cvt_pk_bf16_f32 v211, v214, v215
  v_fma_f32 v216, v216, v13, v23
  v_mfma_f32_16x16x32_bf16 v[16:19], a[216:219], a[152:155], v[16:19]
  ds_write_b128 v10, v[208:211] offset:4096
  v_mfma_f32_16x16x32_bf16 v[16:19], a[220:223], a[156:159], v[16:19]
  v_exp_f32 v152, v152
  v_exp_f32 v153, v153
  v_exp_f32 v154, v154
  v_exp_f32 v155, v155
  v_cvt_pk_bf16_f32 v116, v152, v153
  v_cvt_pk_bf16_f32 v117, v154, v155
  v_smfmac_f32_16x16x64_bf16 v[24:27], a[240:243], v[64:71], v5
  v_fma_f32 v217, v217, v13, v23
  v_exp_f32 v16, v16
  v_exp_f32 v17, v17
  v_exp_f32 v18, v18
  v_exp_f32 v19, v19
  v_cvt_pk_bf16_f32 v118, v16, v17
  v_cvt_pk_bf16_f32 v119, v18, v19
  v_smfmac_f32_16x16x64_bf16 v[24:27], a[240:243], v[88:95], v5
  v_fma_f32 v218, v218, v13, v23
  v_smfmac_f32_16x16x64_bf16 v[24:27], a[240:243], v[112:119], v5
  v_fma_f32 v219, v219, v13, v23
  v_fma_f32 v220, v220, v13, v23
  v_fma_f32 v221, v221, v13, v23
  v_fma_f32 v222, v222, v13, v23
  v_fma_f32 v223, v223, v13, v23
  v_cvt_pk_bf16_f32 v216, v216, v217
  v_cvt_pk_bf16_f32 v217, v218, v219
  v_cvt_pk_bf16_f32 v218, v220, v221
  v_cvt_pk_bf16_f32 v219, v222, v223
  v_mfma_f32_16x16x32_bf16 v[224:227], a[64:67], v[88:91], v[224:227]
  ds_write_b128 v11, v[216:219] offset:4096
  v_mfma_f32_16x16x32_bf16 v[224:227], a[68:71], v[112:115], v[224:227]
  ds_read_b128 v[36:39], v4 offset:4096
  ds_read_b128 v[60:63], v4 offset:5120
  v_mfma_f32_16x16x32_bf16 v[228:231], a[72:75], v[88:91], v[228:231]
  ds_read_b128 v[84:87], v4 offset:6144
  ds_read_b128 v[108:111], v4 offset:7168
  v_mfma_f32_16x16x32_bf16 v[228:231], a[76:79], v[112:115], v[228:231]
  v_add_f32 v24, v24, v25
  v_rcp_f32 v14, v24
  v_mfma_f32_16x16x32_bf16 v[232:235], a[80:83], v[88:91], v[232:235]
  v_mul_f32 v25, s83, v14
  v_fma_f32 v224, v224, v14, v25
  v_mfma_f32_16x16x32_bf16 v[232:235], a[84:87], v[112:115], v[232:235]
  v_fma_f32 v225, v225, v14, v25
  v_fma_f32 v226, v226, v14, v25
  v_fma_f32 v227, v227, v14, v25
  v_fma_f32 v228, v228, v14, v25
  v_fma_f32 v229, v229, v14, v25
  v_fma_f32 v230, v230, v14, v25
  v_fma_f32 v231, v231, v14, v25
  v_cvt_pk_bf16_f32 v224, v224, v225
  v_cvt_pk_bf16_f32 v225, v226, v227
  v_cvt_pk_bf16_f32 v226, v228, v229
  v_cvt_pk_bf16_f32 v227, v230, v231
  v_mfma_f32_16x16x32_bf16 v[236:239], a[88:91], v[88:91], v[236:239]
  ds_write_b128 v8, v[224:227] offset:8192
  v_mfma_f32_16x16x32_bf16 v[236:239], a[92:95], v[112:115], v[236:239]
  s_waitcnt lgkmcnt(1)
  buffer_store_dwordx4 v[36:39], v148, s[20:23], s63 offen offset:0 nt
  v_mfma_f32_16x16x32_bf16 v[240:243], a[224:227], v[40:43], v[240:243]
  v_fma_f32 v232, v232, v14, v25
  v_fma_f32 v233, v233, v14, v25
  v_mfma_f32_16x16x32_bf16 v[240:243], a[228:231], v[64:67], v[240:243]
  v_fma_f32 v234, v234, v14, v25
  v_fma_f32 v235, v235, v14, v25
  v_mfma_f32_16x16x32_bf16 v[240:243], a[96:99], v[88:91], v[240:243]
  buffer_store_dwordx4 v[60:63], v149, s[20:23], s63 offen offset:1024 nt
  v_mfma_f32_16x16x32_bf16 v[240:243], a[100:103], v[112:115], v[240:243]
  v_fma_f32 v236, v236, v14, v25
  v_fma_f32 v237, v237, v14, v25
  v_mfma_f32_16x16x32_bf16 v[244:247], a[232:235], v[40:43], v[244:247]
  v_fma_f32 v238, v238, v14, v25
  v_fma_f32 v239, v239, v14, v25
  v_mfma_f32_16x16x32_bf16 v[244:247], a[236:239], v[64:67], v[244:247]
  buffer_store_dwordx4 v[84:87], v150, s[20:23], s63 offen offset:2048 nt
  v_mfma_f32_16x16x32_bf16 v[244:247], a[104:107], v[88:91], v[244:247]
  v_cvt_pk_bf16_f32 v232, v232, v233
  v_cvt_pk_bf16_f32 v233, v234, v235
  v_mfma_f32_16x16x32_bf16 v[244:247], a[108:111], v[112:115], v[244:247]
  v_cvt_pk_bf16_f32 v234, v236, v237
  v_cvt_pk_bf16_f32 v235, v238, v239
  v_mfma_f32_16x16x32_bf16 v[248:251], a[176:179], v[40:43], v[248:251]
  buffer_store_dwordx4 v[108:111], v151, s[20:23], s63 offen offset:3072 nt
  v_mfma_f32_16x16x32_bf16 v[248:251], a[180:183], v[64:67], v[248:251]
  s_add_u32 s63, s45, 102400
  ds_write_b128 v9, v[232:235] offset:8192
  v_mfma_f32_16x16x32_bf16 v[248:251], a[112:115], v[88:91], v[248:251]
  v_fma_f32 v240, v240, v14, v25
  v_fma_f32 v241, v241, v14, v25
  v_mfma_f32_16x16x32_bf16 v[248:251], a[116:119], v[112:115], v[248:251]
  v_fma_f32 v242, v242, v14, v25
  v_fma_f32 v243, v243, v14, v25
  v_mfma_f32_16x16x32_bf16 v[252:255], a[184:187], v[40:43], v[252:255]
  v_fma_f32 v244, v244, v14, v25
  v_fma_f32 v245, v245, v14, v25
  v_mfma_f32_16x16x32_bf16 v[252:255], a[188:191], v[64:67], v[252:255]
  v_fma_f32 v246, v246, v14, v25
  v_fma_f32 v247, v247, v14, v25
  v_mfma_f32_16x16x32_bf16 v[252:255], a[120:123], v[88:91], v[252:255]
  v_cvt_pk_bf16_f32 v240, v240, v241
  v_cvt_pk_bf16_f32 v241, v242, v243
  v_mfma_f32_16x16x32_bf16 v[252:255], a[124:127], v[112:115], v[252:255]
  v_cvt_pk_bf16_f32 v242, v244, v245
  v_cvt_pk_bf16_f32 v243, v246, v247
  v_mfma_f32_16x16x32_bf16 a[0:3], a[64:67], v[92:95], a[0:3]
  ds_write_b128 v10, v[240:243] offset:8192
  v_fma_f32 v248, v248, v14, v25
  v_fma_f32 v249, v249, v14, v25
  v_fma_f32 v250, v250, v14, v25
  v_fma_f32 v251, v251, v14, v25
  v_fma_f32 v252, v252, v14, v25
  v_fma_f32 v253, v253, v14, v25
  v_fma_f32 v254, v254, v14, v25
  v_fma_f32 v255, v255, v14, v25
  v_cvt_pk_bf16_f32 v248, v248, v249
  v_cvt_pk_bf16_f32 v249, v250, v251
  v_cvt_pk_bf16_f32 v250, v252, v253
  v_cvt_pk_bf16_f32 v251, v254, v255
  v_mfma_f32_16x16x32_bf16 a[0:3], a[68:71], v[116:119], a[0:3]
  ds_write_b128 v11, v[248:251] offset:8192
  v_mfma_f32_16x16x32_bf16 v[156:159], a[192:195], a[160:163], v[144:147]
  ds_read_b128 v[40:43], v4 offset:8192
  ds_read_b128 v[64:67], v4 offset:9216
  v_mfma_f32_16x16x32_bf16 v[156:159], a[196:199], a[164:167], v[156:159]
  ds_read_b128 v[88:91], v4 offset:10240
  ds_read_b128 v[112:115], v4 offset:11264
  v_mfma_f32_16x16x32_bf16 v[156:159], a[200:203], a[168:171], v[156:159]
  v_add_f32 v26, v26, v27
  v_rcp_f32 v15, v26
  v_mfma_f32_16x16x32_bf16 v[156:159], a[204:207], a[172:175], v[156:159]
  v_mul_f32 v27, s83, v15
  v_accvgpr_read_b32 v32, a0
  v_mfma_f32_16x16x32_bf16 a[4:7], a[72:75], v[92:95], a[4:7]
  v_accvgpr_read_b32 v33, a1
  v_accvgpr_read_b32 v34, a2
  v_mfma_f32_16x16x32_bf16 a[4:7], a[76:79], v[116:119], a[4:7]
  v_accvgpr_read_b32 v35, a3
  v_fma_f32 v32, v32, v15, v27
  v_mfma_f32_16x16x32_bf16 v[152:155], a[208:211], a[160:163], v[144:147]
  v_exp_f32 v156, v156
  v_mfma_f32_16x16x32_bf16 v[152:155], a[212:215], a[164:167], v[152:155]
  v_exp_f32 v157, v157
  v_mfma_f32_16x16x32_bf16 v[152:155], a[216:219], a[168:171], v[152:155]
  v_exp_f32 v158, v158
  v_mfma_f32_16x16x32_bf16 v[152:155], a[220:223], a[172:175], v[152:155]
  s_waitcnt lgkmcnt(0)
  buffer_store_dwordx4 v[40:43], v148, s[20:23], s63 offen offset:0 nt
  v_exp_f32 v159, v159
  v_cvt_pk_bf16_f32 v100, v156, v157
  v_cvt_pk_bf16_f32 v101, v158, v159
  v_mfma_f32_16x16x32_bf16 a[8:11], a[80:83], v[92:95], a[8:11]
  v_accvgpr_read_b32 v36, a4
  v_accvgpr_read_b32 v37, a5
  v_mfma_f32_16x16x32_bf16 a[8:11], a[84:87], v[116:119], a[8:11]
  buffer_store_dwordx4 v[64:67], v149, s[20:23], s63 offen offset:1024 nt
  v_accvgpr_read_b32 v38, a6
  v_accvgpr_read_b32 v39, a7
  v_fma_f32 v33, v33, v15, v27
  v_fma_f32 v34, v34, v15, v27
  v_fma_f32 v35, v35, v15, v27
  v_fma_f32 v36, v36, v15, v27
  v_fma_f32 v37, v37, v15, v27
  v_fma_f32 v38, v38, v15, v27
  v_fma_f32 v39, v39, v15, v27
  v_cvt_pk_bf16_f32 v32, v32, v33
  v_mfma_f32_16x16x32_bf16 a[12:15], a[88:91], v[92:95], a[12:15]
  buffer_store_dwordx4 v[88:91], v150, s[20:23], s63 offen offset:2048 nt
  v_cvt_pk_bf16_f32 v33, v34, v35
  v_cvt_pk_bf16_f32 v34, v36, v37
  v_cvt_pk_bf16_f32 v35, v38, v39
  v_mfma_f32_16x16x32_bf16 a[12:15], a[92:95], v[116:119], a[12:15]
  ds_write_b128 v8, v[32:35] offset:12288
  v_mfma_f32_16x16x32_bf16 a[16:19], a[224:227], v[44:47], a[16:19]
  buffer_store_dwordx4 v[112:115], v151, s[20:23], s63 offen offset:3072 nt
  v_exp_f32 v152, v152
  v_exp_f32 v153, v153
  v_exp_f32 v154, v154
  v_exp_f32 v155, v155
  v_cvt_pk_bf16_f32 v102, v152, v153
  v_cvt_pk_bf16_f32 v103, v154, v155
  v_mfma_f32_16x16x32_bf16 a[16:19], a[228:231], v[68:71], a[16:19]
  s_add_u32 s63, s45, 106496
  v_accvgpr_read_b32 v40, a8
  v_accvgpr_read_b32 v41, a9
  v_mfma_f32_16x16x32_bf16 a[16:19], a[96:99], v[92:95], a[16:19]
  v_accvgpr_read_b32 v42, a10
  v_accvgpr_read_b32 v43, a11
  v_mfma_f32_16x16x32_bf16 a[16:19], a[100:103], v[116:119], a[16:19]
  v_fma_f32 v40, v40, v15, v27
  v_fma_f32 v41, v41, v15, v27
  v_mfma_f32_16x16x32_bf16 a[20:23], a[232:235], v[44:47], a[20:23]
  v_fma_f32 v42, v42, v15, v27
  v_fma_f32 v43, v43, v15, v27
  v_mfma_f32_16x16x32_bf16 a[20:23], a[236:239], v[68:71], a[20:23]
  v_cvt_pk_bf16_f32 v40, v40, v41
  v_cvt_pk_bf16_f32 v41, v42, v43
  v_mfma_f32_16x16x32_bf16 a[20:23], a[104:107], v[92:95], a[20:23]
  v_accvgpr_read_b32 v32, a16
  v_accvgpr_read_b32 v33, a17
  v_mfma_f32_16x16x32_bf16 a[20:23], a[108:111], v[116:119], a[20:23]
  v_accvgpr_read_b32 v34, a18
  v_accvgpr_read_b32 v35, a19
  v_mfma_f32_16x16x32_bf16 a[24:27], a[176:179], v[44:47], a[24:27]
  v_fma_f32 v32, v32, v15, v27
  v_fma_f32 v33, v33, v15, v27
  v_mfma_f32_16x16x32_bf16 a[28:31], a[184:187], v[44:47], a[28:31]
  v_accvgpr_read_b32 v44, a12
  v_accvgpr_read_b32 v45, a13
  v_accvgpr_read_b32 v46, a14
  v_accvgpr_read_b32 v47, a15
  v_fma_f32 v44, v44, v15, v27
  v_fma_f32 v45, v45, v15, v27
  v_fma_f32 v46, v46, v15, v27
  v_fma_f32 v47, v47, v15, v27
  v_cvt_pk_bf16_f32 v42, v44, v45
  v_cvt_pk_bf16_f32 v43, v46, v47
  v_mfma_f32_16x16x32_bf16 a[24:27], a[180:183], v[68:71], a[24:27]
  ds_write_b128 v9, v[40:43] offset:12288
  v_mfma_f32_16x16x32_bf16 a[24:27], a[112:115], v[92:95], a[24:27]
  v_accvgpr_read_b32 v36, a20
  v_accvgpr_read_b32 v37, a21
  v_mfma_f32_16x16x32_bf16 a[24:27], a[116:119], v[116:119], a[24:27]
  v_accvgpr_read_b32 v38, a22
  v_accvgpr_read_b32 v39, a23
  v_mfma_f32_16x16x32_bf16 a[28:31], a[188:191], v[68:71], a[28:31]
  v_fma_f32 v34, v34, v15, v27
  v_fma_f32 v35, v35, v15, v27
  v_mfma_f32_16x16x32_bf16 a[28:31], a[120:123], v[92:95], a[28:31]
  v_fma_f32 v36, v36, v15, v27
  v_fma_f32 v37, v37, v15, v27
  v_mfma_f32_16x16x32_bf16 a[28:31], a[124:127], v[116:119], a[28:31]
  v_fma_f32 v38, v38, v15, v27
  v_fma_f32 v39, v39, v15, v27
  v_smfmac_f32_16x16x64_bf16 v[28:31], a[240:243], v[96:103], v5
  v_cvt_pk_bf16_f32 v32, v32, v33
  v_cvt_pk_bf16_f32 v33, v34, v35
  v_cvt_pk_bf16_f32 v34, v36, v37
  v_cvt_pk_bf16_f32 v35, v38, v39
  v_mfma_f32_16x16x32_bf16 a[32:35], a[64:67], v[96:99], a[32:35]
  ds_write_b128 v10, v[32:35] offset:12288
  v_add_f32 v6, v20, v22
  v_add_f32 v6, v6, v24
  v_add_f32 v6, v6, v26
  v_accvgpr_read_b32 v40, a24
  v_accvgpr_read_b32 v41, a25
  v_accvgpr_read_b32 v42, a26
  v_add_f32 v28, v28, v30
  v_add_f32 v29, v29, v31
  v_add_f32 v28, v28, v29
  v_rcp_f32 v16, v28
  v_add_f32 v6, v6, v28
  v_mul_f32 v29, s83, v16
  v_cmp_nge_f32 s[42:43], s49, v6
  v_accvgpr_read_b32 v43, a27
  v_accvgpr_read_b32 v44, a28
  v_accvgpr_read_b32 v45, a29
  v_accvgpr_read_b32 v46, a30
  v_accvgpr_read_b32 v47, a31
  v_fma_f32 v40, v40, v15, v27
  v_fma_f32 v41, v41, v15, v27
  v_fma_f32 v42, v42, v15, v27
  v_fma_f32 v43, v43, v15, v27
  v_fma_f32 v44, v44, v15, v27
  v_fma_f32 v45, v45, v15, v27
  v_fma_f32 v46, v46, v15, v27
  v_fma_f32 v47, v47, v15, v27
  v_cvt_pk_bf16_f32 v40, v40, v41
  v_cvt_pk_bf16_f32 v41, v42, v43
  v_cvt_pk_bf16_f32 v42, v44, v45
  v_cvt_pk_bf16_f32 v43, v46, v47
  v_mfma_f32_16x16x32_bf16 a[32:35], a[68:71], v[100:103], a[32:35]
  ds_write_b128 v11, v[40:43] offset:12288
  v_mfma_f32_16x16x32_bf16 a[36:39], a[72:75], v[96:99], a[36:39]
  ds_read_b128 v[44:47], v4 offset:12288
  ds_read_b128 v[68:71], v4 offset:13312
  v_mfma_f32_16x16x32_bf16 a[36:39], a[76:79], v[100:103], a[36:39]
  ds_read_b128 v[92:95], v4 offset:14336
  ds_read_b128 v[116:119], v4 offset:15360
  v_mfma_f32_16x16x32_bf16 a[40:43], a[80:83], v[96:99], a[40:43]
  v_accvgpr_read_b32 v32, a32
  v_accvgpr_read_b32 v33, a33
  v_mfma_f32_16x16x32_bf16 a[40:43], a[84:87], v[100:103], a[40:43]
  v_accvgpr_read_b32 v34, a34
  v_accvgpr_read_b32 v35, a35
  v_accvgpr_read_b32 v36, a36
  v_accvgpr_read_b32 v37, a37
  v_accvgpr_read_b32 v38, a38
  v_accvgpr_read_b32 v39, a39
  v_fma_f32 v32, v32, v16, v29
  v_fma_f32 v33, v33, v16, v29
  v_fma_f32 v34, v34, v16, v29
  v_fma_f32 v35, v35, v16, v29
  v_fma_f32 v36, v36, v16, v29
  v_fma_f32 v37, v37, v16, v29
  v_fma_f32 v38, v38, v16, v29
  v_fma_f32 v39, v39, v16, v29
  v_cvt_pk_bf16_f32 v32, v32, v33
  v_cvt_pk_bf16_f32 v33, v34, v35
  v_cvt_pk_bf16_f32 v34, v36, v37
  v_cvt_pk_bf16_f32 v35, v38, v39
  v_mfma_f32_16x16x32_bf16 a[44:47], a[88:91], v[96:99], a[44:47]
  ds_write_b128 v8, v[32:35] offset:16384
  v_mfma_f32_16x16x32_bf16 a[44:47], a[92:95], v[100:103], a[44:47]
  s_waitcnt lgkmcnt(1)
  buffer_store_dwordx4 v[44:47], v148, s[20:23], s63 offen offset:0 nt
  v_mfma_f32_16x16x32_bf16 a[48:51], a[224:227], v[48:51], a[48:51]
  v_accvgpr_read_b32 v40, a40
  v_accvgpr_read_b32 v41, a41
  v_mfma_f32_16x16x32_bf16 a[48:51], a[228:231], v[52:55], a[48:51]
  v_accvgpr_read_b32 v42, a42
  v_accvgpr_read_b32 v43, a43
  v_mfma_f32_16x16x32_bf16 a[48:51], a[96:99], v[96:99], a[48:51]
  buffer_store_dwordx4 v[68:71], v149, s[20:23], s63 offen offset:1024 nt
  v_mfma_f32_16x16x32_bf16 a[48:51], a[100:103], v[100:103], a[48:51]
  v_accvgpr_read_b32 v44, a44
  v_accvgpr_read_b32 v45, a45
  v_mfma_f32_16x16x32_bf16 a[52:55], a[232:235], v[48:51], a[52:55]
  v_accvgpr_read_b32 v46, a46
  v_accvgpr_read_b32 v47, a47
  v_mfma_f32_16x16x32_bf16 a[52:55], a[236:239], v[52:55], a[52:55]
  buffer_store_dwordx4 v[92:95], v150, s[20:23], s63 offen offset:2048 nt
  v_mfma_f32_16x16x32_bf16 a[52:55], a[104:107], v[96:99], a[52:55]
  v_fma_f32 v40, v40, v16, v29
  v_fma_f32 v41, v41, v16, v29
  v_mfma_f32_16x16x32_bf16 a[52:55], a[108:111], v[100:103], a[52:55]
  v_fma_f32 v42, v42, v16, v29
  v_fma_f32 v43, v43, v16, v29
  v_fma_f32 v44, v44, v16, v29
  v_fma_f32 v45, v45, v16, v29
  v_mfma_f32_16x16x32_bf16 a[56:59], a[176:179], v[48:51], a[56:59]
  buffer_store_dwordx4 v[116:119], v151, s[20:23], s63 offen offset:3072 nt
  v_fma_f32 v46, v46, v16, v29
  v_fma_f32 v47, v47, v16, v29
  v_cvt_pk_bf16_f32 v40, v40, v41
  v_cvt_pk_bf16_f32 v41, v42, v43
  v_cvt_pk_bf16_f32 v42, v44, v45
  v_cvt_pk_bf16_f32 v43, v46, v47
  v_mfma_f32_16x16x32_bf16 a[56:59], a[180:183], v[52:55], a[56:59]
  s_add_u32 s63, s45, 110592
  ds_write_b128 v9, v[40:43] offset:16384
  v_mfma_f32_16x16x32_bf16 a[56:59], a[112:115], v[96:99], a[56:59]
  v_accvgpr_read_b32 v32, a48
  v_accvgpr_read_b32 v33, a49
  v_mfma_f32_16x16x32_bf16 a[56:59], a[116:119], v[100:103], a[56:59]
  v_accvgpr_read_b32 v34, a50
  v_accvgpr_read_b32 v35, a51
  v_mfma_f32_16x16x32_bf16 a[60:63], a[184:187], v[48:51], a[60:63]
  v_accvgpr_read_b32 v36, a52
  v_accvgpr_read_b32 v37, a53
  v_mfma_f32_16x16x32_bf16 a[60:63], a[188:191], v[52:55], a[60:63]
  v_accvgpr_read_b32 v38, a54
  v_accvgpr_read_b32 v39, a55
  v_mfma_f32_16x16x32_bf16 a[60:63], a[120:123], v[96:99], a[60:63]
  v_fma_f32 v32, v32, v16, v29
  v_fma_f32 v33, v33, v16, v29
  v_mfma_f32_16x16x32_bf16 a[60:63], a[124:127], v[100:103], a[60:63]
  v_fma_f32 v34, v34, v16, v29
  v_fma_f32 v35, v35, v16, v29
  v_fma_f32 v36, v36, v16, v29
  v_fma_f32 v37, v37, v16, v29
  v_fma_f32 v38, v38, v16, v29
  v_fma_f32 v39, v39, v16, v29
  v_cvt_pk_bf16_f32 v32, v32, v33
  v_cvt_pk_bf16_f32 v33, v34, v35
  v_cvt_pk_bf16_f32 v34, v36, v37
  v_cvt_pk_bf16_f32 v35, v38, v39
  v_accvgpr_read_b32 v40, a56
  v_accvgpr_read_b32 v41, a57
  v_accvgpr_read_b32 v42, a58
  v_accvgpr_read_b32 v43, a59
  v_accvgpr_read_b32 v44, a60
  v_accvgpr_read_b32 v45, a61
  v_accvgpr_read_b32 v46, a62
  v_accvgpr_read_b32 v47, a63
  v_fma_f32 v40, v40, v16, v29
  v_fma_f32 v41, v41, v16, v29
  v_fma_f32 v42, v42, v16, v29
  v_fma_f32 v43, v43, v16, v29
  v_fma_f32 v44, v44, v16, v29
  v_fma_f32 v45, v45, v16, v29
  v_fma_f32 v46, v46, v16, v29
  v_fma_f32 v47, v47, v16, v29
  v_cvt_pk_bf16_f32 v40, v40, v41
  v_cvt_pk_bf16_f32 v41, v42, v43
  v_cvt_pk_bf16_f32 v42, v44, v45
  v_cvt_pk_bf16_f32 v43, v46, v47
  ds_write_b128 v10, v[32:35] offset:16384
  ds_write_b128 v11, v[40:43] offset:16384
  ds_read_b128 v[48:51], v4 offset:16384
  ds_read_b128 v[52:55], v4 offset:17408
  ds_read_b128 v[96:99], v4 offset:18432
  ds_read_b128 v[100:103], v4 offset:19456
  s_waitcnt lgkmcnt(3)
  buffer_store_dwordx4 v[48:51], v148, s[20:23], s63 offen offset:0 nt
  s_waitcnt lgkmcnt(2)
  buffer_store_dwordx4 v[52:55], v149, s[20:23], s63 offen offset:1024 nt
  s_waitcnt lgkmcnt(1)
  buffer_store_dwordx4 v[96:99], v150, s[20:23], s63 offen offset:2048 nt
  s_waitcnt lgkmcnt(0)
  buffer_store_dwordx4 v[100:103], v151, s[20:23], s63 offen offset:3072 nt
  s_branch DONE
.p2align 6
EVEN:
  s_add_u32 m0, s64, 102656
  s_nop 0
  buffer_load_dwordx4 v1, s[4:7], s28 offen offset:0 nt lds
  s_add_u32 m0, s64, 102688
  s_nop 0
  buffer_load_dwordx4 v1, s[4:7], s28 offen offset:1024 nt lds
  s_waitcnt vmcnt(0)
  s_add_u32 m0, s45, 0
  s_nop 0
  buffer_load_dwordx4 v148, s[12:15], m0 offen offset:0 nt lds
  buffer_load_dwordx4 v149, s[12:15], m0 offen offset:1024 nt lds
  buffer_load_dwordx4 v150, s[12:15], m0 offen offset:2048 nt lds
  buffer_load_dwordx4 v151, s[12:15], m0 offen offset:3072 nt lds
  s_cmp_eq_u32 s44, 3
  s_cbranch_scc1 PATHE_5
PATHE_6:
  s_add_u32 s20, s74, s63
  s_addc_u32 s21, s75, 0
  s_mov_b32 s22, 188416
  s_mov_b32 s23, 0x20000
  s_mov_b32 s24, s20
  s_mov_b32 s25, s21
  s_mov_b32 s26, 94208
  s_mov_b32 s27, 0x20000
  s_add_u32 s16, s12, 94208
  s_addc_u32 s17, s13, 0
  s_mov_b32 s18, 94208
  s_mov_b32 s19, 0x20000
  s_mov_b32 s48, 0xffff0000
  s_mov_b32 s46, 0x3e0293ee
  s_mov_b32 s47, 0x3e0293ee
  s_mov_b32 s49, 0x44800000
  v_lshl_add_u32 v8, v12, 8, v14
  v_add_u32 v8, s45, v8
  v_xor_b32 v9, 64, v8
  v_xor_b32 v10, 0x80, v8
  v_xor_b32 v11, 0xc0, v8
  v_and_b32 v15, 7, v0
  v_mul_u32_u24 v15, 1056, v15
  v_bfe_u32 v16, v0, 3, 1
  v_lshl_add_u32 v15, v16, 9, v15
  v_lshl_add_u32 v15, v13, 4, v15
  v_add_u32 v2, 94208, v15
  v_bfe_u32 v15, v0, 3, 2
  v_mul_u32_u24 v15, 2112, v15
  v_bfe_u32 v16, v0, 2, 1
  v_mul_u32_u24 v16, 1032, v16
  v_lshrrev_b32 v17, 5, v0
  v_lshl_add_u32 v15, v17, 9, v15
  v_and_b32 v18, 3, v0
  v_lshl_add_u32 v16, v18, 4, v16
  v_add_u32 v15, v15, v16
  v_add_u32 v3, 128000, v15
  v_bfe_u32 v16, v0, 1, 1
  v_mov_b32 v19, 0x3f803f80
  v_cmp_eq_u32 vcc, v16, v17
  s_nop 1
  v_cndmask_b32 v19, 0, v19, vcc
  v_and_b32 v16, 1, v0
  v_mul_u32_u24 v16, 0xaaaa, v16
  v_add_u32 v5, 0x4444, v16
  v_accvgpr_write_b32 a240, v19
  v_accvgpr_write_b32 a244, 0
  v_accvgpr_write_b32 a241, v19
  v_accvgpr_write_b32 a245, 0
  v_accvgpr_write_b32 a242, v19
  v_accvgpr_write_b32 a246, 0
  v_accvgpr_write_b32 a243, v19
  v_accvgpr_write_b32 a247, 0
  s_mov_b32 s81, 0xc1980000
  s_add_u32 s51, s45, 24576
  s_add_u32 s50, s45, 20480
  s_mov_b32 s65, 6
  s_mov_b32 s39, 1
  s_mov_b32 s61, 0
  v_lshl_add_u32 v4, v0, 2, s50
  v_mfma_f32_32x32x16_bf16 v[16:31], a[244:247], a[244:247], 0
  s_waitcnt vmcnt(8)
  v_max3_f16 v56, |v224|, |v228|, |v232| op_sel:[0,0,0,0]
  v_max3_f16 v57, |v224|, |v228|, |v232| op_sel:[1,1,1,0]
  v_max3_f16 v58, |v225|, |v229|, |v233| op_sel:[0,0,0,0]
  v_max3_f16 v59, |v225|, |v229|, |v233| op_sel:[1,1,1,0]
  v_max3_f16 v60, |v226|, |v230|, |v234| op_sel:[0,0,0,0]
  v_max3_f16 v61, |v226|, |v230|, |v234| op_sel:[1,1,1,0]
  v_max3_f16 v62, |v227|, |v231|, |v235| op_sel:[0,0,0,0]
  v_max3_f16 v63, |v227|, |v231|, |v235| op_sel:[1,1,1,0]
  s_waitcnt vmcnt(6)
  v_max3_f16 v56, v56, |v236|, |v240| op_sel:[0,0,0,0]
  v_max3_f16 v57, v57, |v236|, |v240| op_sel:[0,1,1,0]
  v_max3_f16 v58, v58, |v237|, |v241| op_sel:[0,0,0,0]
  v_max3_f16 v59, v59, |v237|, |v241| op_sel:[0,1,1,0]
  v_max3_f16 v60, v60, |v238|, |v242| op_sel:[0,0,0,0]
  v_max3_f16 v61, v61, |v238|, |v242| op_sel:[0,1,1,0]
  v_max3_f16 v62, v62, |v239|, |v243| op_sel:[0,0,0,0]
  v_max3_f16 v63, v63, |v239|, |v243| op_sel:[0,1,1,0]
  v_min3_f16 v56, v56, v57, v58
  v_min3_f16 v59, v59, v60, v61
  v_min3_f16 v56, v56, v62, v63
  s_nop 0
  v_min_f16 v56, v56, v59
  s_nop 0
  v_and_b32 v56, 0x7f80, v56
  s_nop 1
  v_min_u32_dpp v56, v56, v56 row_ror:8 row_mask:0xf bank_mask:0xf
  s_nop 1
  v_min_u32_dpp v56, v56, v56 row_ror:4 row_mask:0xf bank_mask:0xf
  s_nop 1
  v_min_u32_dpp v56, v56, v56 row_ror:2 row_mask:0xf bank_mask:0xf
  s_nop 1
  v_min_u32_dpp v56, v56, v56 row_ror:1 row_mask:0xf bank_mask:0xf
  s_nop 0
  v_readlane_b32 s82, v56, 0
  v_readlane_b32 s88, v56, 16
  v_readlane_b32 s83, v56, 32
  v_readlane_b32 s89, v56, 48
  s_min_u32 s88, s88, s82
  s_sub_u32 s88, s88, 1877
  s_lshl_b32 s82, s88, 16
  s_add_u32 s82, s82, 0x81800000
  s_cmp_ge_i32 s88, 0x80
  s_cselect_b32 s88, s88, 0
  s_cselect_b32 s82, s82, 0
  s_pack_ll_b32_b16 s88, s88, s88
  s_min_u32 s89, s89, s83
  s_sub_u32 s89, s89, 1877
  s_lshl_b32 s83, s89, 16
  s_add_u32 s83, s83, 0x81800000
  s_cmp_ge_i32 s89, 0x80
  s_cselect_b32 s89, s89, 0
  s_cselect_b32 s83, s83, 0
  s_pack_ll_b32_b16 s89, s89, s89
  v_accvgpr_write_b32 a248, s88
  v_accvgpr_write_b32 a249, s88
  v_accvgpr_write_b32 a250, s88
  v_accvgpr_write_b32 a251, s88
  s_waitcnt vmcnt(4)
  s_barrier
  ds_read_b128 a[192:195], v2 offset:0
  ds_read_b128 a[196:199], v2 offset:64
  ds_read_b128 a[200:203], v2 offset:128
  ds_read_b128 a[204:207], v2 offset:192
  ds_read_b128 a[208:211], v2 offset:256
  ds_read_b128 a[212:215], v2 offset:320
  ds_read_b128 a[216:219], v2 offset:384
  ds_read_b128 a[220:223], v2 offset:448
  s_waitcnt vmcnt(0)
  ds_read_b128 v[160:163], v8 offset:0
  ds_read_b128 v[164:167], v9 offset:0
  ds_read_b128 v[168:171], v10 offset:0
  ds_read_b128 v[172:175], v11 offset:0
  v_mfma_f32_32x32x16_bf16 v[208:223], a[240:243], a[248:251], 0
  s_add_u32 m0, s45, 4096
  s_nop 0
  buffer_load_dwordx4 v148, s[12:15], m0 offen offset:0 nt lds
  buffer_load_dwordx4 v149, s[12:15], m0 offen offset:1024 nt lds
  buffer_load_dwordx4 v150, s[12:15], m0 offen offset:2048 nt lds
  buffer_load_dwordx4 v151, s[12:15], m0 offen offset:3072 nt lds
  v_mfma_f32_32x32x16_bf16 v[224:239], a[240:243], a[248:251], 0
  ds_read_b128 v[80:83], v2 offset:8448
  ds_read_b128 v[84:87], v2 offset:8512
  ds_read_b128 v[88:91], v2 offset:8576
  ds_read_b128 v[92:95], v2 offset:8640
  ds_read_b128 v[96:99], v2 offset:8704
  ds_read_b128 v[100:103], v2 offset:8768
  ds_read_b128 v[104:107], v2 offset:8832
  ds_read_b128 v[108:111], v2 offset:8896
  s_waitcnt lgkmcnt(11)
  v_lshlrev_b32 v192, 16, v160
  v_and_b32 v193, s48, v160
  v_lshlrev_b32 v194, 16, v161
  v_and_b32 v195, s48, v161
  v_lshlrev_b32 v196, 16, v162
  v_and_b32 v197, s48, v162
  v_lshlrev_b32 v198, 16, v163
  v_and_b32 v199, s48, v163
  v_pk_mul_f32 v[192:193], v[192:193], s[46:47]
  v_pk_mul_f32 v[194:195], v[194:195], s[46:47]
  v_pk_mul_f32 v[196:197], v[196:197], s[46:47]
  v_pk_mul_f32 v[198:199], v[198:199], s[46:47]
  v_cvt_pk_bf16_f32 v160, v192, v193
  v_cvt_pk_bf16_f32 v161, v194, v195
  v_cvt_pk_bf16_f32 v162, v196, v197
  v_cvt_pk_bf16_f32 v163, v198, v199
  v_accvgpr_write_b32 a96, v160
  v_accvgpr_write_b32 a97, v161
  v_accvgpr_write_b32 a98, v162
  v_accvgpr_write_b32 a99, v163
  s_waitcnt lgkmcnt(10)
  v_lshlrev_b32 v200, 16, v164
  v_and_b32 v201, s48, v164
  v_lshlrev_b32 v202, 16, v165
  v_and_b32 v203, s48, v165
  v_lshlrev_b32 v204, 16, v166
  v_and_b32 v205, s48, v166
  v_lshlrev_b32 v206, 16, v167
  v_and_b32 v207, s48, v167
  v_pk_mul_f32 v[200:201], v[200:201], s[46:47]
  v_pk_mul_f32 v[202:203], v[202:203], s[46:47]
  v_pk_mul_f32 v[204:205], v[204:205], s[46:47]
  v_pk_mul_f32 v[206:207], v[206:207], s[46:47]
  v_cvt_pk_bf16_f32 v164, v200, v201
  v_cvt_pk_bf16_f32 v165, v202, v203
  v_cvt_pk_bf16_f32 v166, v204, v205
  v_cvt_pk_bf16_f32 v167, v206, v207
  v_accvgpr_write_b32 a100, v164
  v_accvgpr_write_b32 a101, v165
  v_accvgpr_write_b32 a102, v166
  v_accvgpr_write_b32 a103, v167
  s_waitcnt lgkmcnt(9)
  v_lshlrev_b32 v192, 16, v168
  v_and_b32 v193, s48, v168
  v_lshlrev_b32 v194, 16, v169
  v_and_b32 v195, s48, v169
  v_lshlrev_b32 v196, 16, v170
  v_and_b32 v197, s48, v170
  v_lshlrev_b32 v198, 16, v171
  v_and_b32 v199, s48, v171
  v_pk_mul_f32 v[192:193], v[192:193], s[46:47]
  v_pk_mul_f32 v[194:195], v[194:195], s[46:47]
  v_pk_mul_f32 v[196:197], v[196:197], s[46:47]
  v_pk_mul_f32 v[198:199], v[198:199], s[46:47]
  v_cvt_pk_bf16_f32 v168, v192, v193
  v_cvt_pk_bf16_f32 v169, v194, v195
  v_cvt_pk_bf16_f32 v170, v196, v197
  v_cvt_pk_bf16_f32 v171, v198, v199
  v_accvgpr_write_b32 a104, v168
  v_accvgpr_write_b32 a105, v169
  v_accvgpr_write_b32 a106, v170
  v_accvgpr_write_b32 a107, v171
  s_waitcnt lgkmcnt(8)
  v_lshlrev_b32 v200, 16, v172
  v_and_b32 v201, s48, v172
  v_lshlrev_b32 v202, 16, v173
  v_and_b32 v203, s48, v173
  v_lshlrev_b32 v204, 16, v174
  v_and_b32 v205, s48, v174
  v_lshlrev_b32 v206, 16, v175
  v_and_b32 v207, s48, v175
  v_pk_mul_f32 v[200:201], v[200:201], s[46:47]
  v_pk_mul_f32 v[202:203], v[202:203], s[46:47]
  v_pk_mul_f32 v[204:205], v[204:205], s[46:47]
  v_pk_mul_f32 v[206:207], v[206:207], s[46:47]
  v_cvt_pk_bf16_f32 v172, v200, v201
  v_cvt_pk_bf16_f32 v173, v202, v203
  v_cvt_pk_bf16_f32 v174, v204, v205
  v_cvt_pk_bf16_f32 v175, v206, v207
  v_accvgpr_write_b32 a108, v172
  v_accvgpr_write_b32 a109, v173
  v_accvgpr_write_b32 a110, v174
  v_accvgpr_write_b32 a111, v175
  v_mfma_f32_16x16x32_bf16 v[112:115], a[192:195], a[96:99], 0
  s_waitcnt lgkmcnt(0)
  v_mfma_f32_16x16x32_bf16 v[112:115], a[196:199], a[100:103], v[112:115]
  v_mfma_f32_16x16x32_bf16 v[112:115], a[200:203], a[104:107], v[112:115]
  v_mfma_f32_16x16x32_bf16 v[112:115], a[204:207], a[108:111], v[112:115]
  s_nop 7
  v_max3_f32 v18, v112, v113, v114
  v_max_f32 v18, v18, v115
  v_mov_b32 v19, v18
  s_nop 1
  v_permlane32_swap_b32 v18, v19
  v_max_f32 v18, v18, v19
  v_mov_b32 v19, v18
  s_nop 1
  v_permlane16_swap_b32 v18, v19
  v_max_f32 v18, v18, v19
  v_sub_f32 v128, s81, v18
  v_sub_f32 v129, s81, v18
  v_sub_f32 v130, s81, v18
  v_sub_f32 v131, s81, v18
  v_add_f32 v112, v112, v128
  v_add_f32 v113, v113, v128
  v_mfma_f32_16x16x32_bf16 v[116:119], a[208:211], a[96:99], v[128:131]
  v_add_f32 v114, v114, v128
  v_add_f32 v115, v115, v128
  v_mfma_f32_16x16x32_bf16 v[116:119], a[212:215], a[100:103], v[116:119]
  v_exp_f32 v112, v112
  v_mfma_f32_16x16x32_bf16 v[116:119], a[216:219], a[104:107], v[116:119]
  v_exp_f32 v113, v113
  v_mfma_f32_16x16x32_bf16 v[116:119], a[220:223], a[108:111], v[116:119]
  v_exp_f32 v114, v114
  v_mfma_f32_16x16x32_bf16 v[120:123], v[80:83], a[96:99], v[128:131]
  v_exp_f32 v115, v115
  v_mfma_f32_16x16x32_bf16 v[120:123], v[84:87], a[100:103], v[120:123]
  v_cvt_pk_bf16_f32 v32, v112, v113
  v_cvt_pk_bf16_f32 v33, v114, v115
  v_mfma_f32_16x16x32_bf16 v[120:123], v[88:91], a[104:107], v[120:123]
  v_mfma_f32_16x16x32_bf16 v[120:123], v[92:95], a[108:111], v[120:123]
  v_exp_f32 v116, v116
  v_mfma_f32_16x16x32_bf16 v[124:127], v[96:99], a[96:99], v[128:131]
  v_exp_f32 v117, v117
  v_mfma_f32_16x16x32_bf16 v[124:127], v[100:103], a[100:103], v[124:127]
  v_exp_f32 v118, v118
  v_mfma_f32_16x16x32_bf16 v[124:127], v[104:107], a[104:107], v[124:127]
  v_exp_f32 v119, v119
  v_mfma_f32_16x16x32_bf16 v[124:127], v[108:111], a[108:111], v[124:127]
  v_cvt_pk_bf16_f32 v34, v116, v117
  v_cvt_pk_bf16_f32 v35, v118, v119
  s_waitcnt vmcnt(0)
  ds_read_b128 v[176:179], v8 offset:4096
  ds_read_b128 v[180:183], v9 offset:4096
  ds_read_b128 v[184:187], v10 offset:4096
  ds_read_b128 v[188:191], v11 offset:4096
  v_mfma_f32_32x32x16_bf16 v[240:255], a[240:243], a[248:251], 0
  s_add_u32 m0, s45, 8192
  s_nop 0
  buffer_load_dwordx4 v148, s[12:15], m0 offen offset:0 nt lds
  buffer_load_dwordx4 v149, s[12:15], m0 offen offset:1024 nt lds
  v_exp_f32 v120, v120
  v_mfma_f32_32x32x16_bf16 a[0:15], a[240:243], a[248:251], 0
  buffer_load_dwordx4 v150, s[12:15], m0 offen offset:2048 nt lds
  buffer_load_dwordx4 v151, s[12:15], m0 offen offset:3072 nt lds
  v_exp_f32 v121, v121
  v_exp_f32 v122, v122
  v_exp_f32 v123, v123
  v_cvt_pk_bf16_f32 v56, v120, v121
  v_cvt_pk_bf16_f32 v57, v122, v123
  v_exp_f32 v124, v124
  v_exp_f32 v125, v125
  v_exp_f32 v126, v126
  v_exp_f32 v127, v127
  v_cvt_pk_bf16_f32 v58, v124, v125
  v_cvt_pk_bf16_f32 v59, v126, v127
  s_waitcnt lgkmcnt(3)
  v_lshlrev_b32 v192, 16, v176
  v_and_b32 v193, s48, v176
  v_lshlrev_b32 v194, 16, v177
  v_and_b32 v195, s48, v177
  v_lshlrev_b32 v196, 16, v178
  v_and_b32 v197, s48, v178
  v_lshlrev_b32 v198, 16, v179
  v_and_b32 v199, s48, v179
  v_pk_mul_f32 v[192:193], v[192:193], s[46:47]
  v_pk_mul_f32 v[194:195], v[194:195], s[46:47]
  v_pk_mul_f32 v[196:197], v[196:197], s[46:47]
  v_pk_mul_f32 v[198:199], v[198:199], s[46:47]
  v_cvt_pk_bf16_f32 v176, v192, v193
  v_cvt_pk_bf16_f32 v177, v194, v195
  v_cvt_pk_bf16_f32 v178, v196, v197
  v_cvt_pk_bf16_f32 v179, v198, v199
  v_accvgpr_write_b32 a112, v176
  v_accvgpr_write_b32 a113, v177
  v_accvgpr_write_b32 a114, v178
  v_accvgpr_write_b32 a115, v179
  s_waitcnt lgkmcnt(2)
  v_lshlrev_b32 v200, 16, v180
  v_and_b32 v201, s48, v180
  v_lshlrev_b32 v202, 16, v181
  v_and_b32 v203, s48, v181
  v_lshlrev_b32 v204, 16, v182
  v_and_b32 v205, s48, v182
  v_lshlrev_b32 v206, 16, v183
  v_and_b32 v207, s48, v183
  v_pk_mul_f32 v[200:201], v[200:201], s[46:47]
  v_pk_mul_f32 v[202:203], v[202:203], s[46:47]
  v_pk_mul_f32 v[204:205], v[204:205], s[46:47]
  v_pk_mul_f32 v[206:207], v[206:207], s[46:47]
  v_cvt_pk_bf16_f32 v180, v200, v201
  v_cvt_pk_bf16_f32 v181, v202, v203
  v_cvt_pk_bf16_f32 v182, v204, v205
  v_cvt_pk_bf16_f32 v183, v206, v207
  v_accvgpr_write_b32 a116, v180
  v_accvgpr_write_b32 a117, v181
  v_accvgpr_write_b32 a118, v182
  v_accvgpr_write_b32 a119, v183
  s_waitcnt lgkmcnt(1)
  v_lshlrev_b32 v192, 16, v184
  v_and_b32 v193, s48, v184
  v_lshlrev_b32 v194, 16, v185
  v_and_b32 v195, s48, v185
  v_lshlrev_b32 v196, 16, v186
  v_and_b32 v197, s48, v186
  v_lshlrev_b32 v198, 16, v187
  v_and_b32 v199, s48, v187
  v_pk_mul_f32 v[192:193], v[192:193], s[46:47]
  v_pk_mul_f32 v[194:195], v[194:195], s[46:47]
  v_pk_mul_f32 v[196:197], v[196:197], s[46:47]
  v_pk_mul_f32 v[198:199], v[198:199], s[46:47]
  v_cvt_pk_bf16_f32 v184, v192, v193
  v_cvt_pk_bf16_f32 v185, v194, v195
  v_cvt_pk_bf16_f32 v186, v196, v197
  v_cvt_pk_bf16_f32 v187, v198, v199
  v_accvgpr_write_b32 a120, v184
  v_accvgpr_write_b32 a121, v185
  v_accvgpr_write_b32 a122, v186
  v_accvgpr_write_b32 a123, v187
  s_waitcnt lgkmcnt(0)
  v_lshlrev_b32 v200, 16, v188
  v_and_b32 v201, s48, v188
  v_lshlrev_b32 v202, 16, v189
  v_and_b32 v203, s48, v189
  v_lshlrev_b32 v204, 16, v190
  v_and_b32 v205, s48, v190
  v_lshlrev_b32 v206, 16, v191
  v_and_b32 v207, s48, v191
  v_pk_mul_f32 v[200:201], v[200:201], s[46:47]
  v_pk_mul_f32 v[202:203], v[202:203], s[46:47]
  v_pk_mul_f32 v[204:205], v[204:205], s[46:47]
  v_pk_mul_f32 v[206:207], v[206:207], s[46:47]
  v_cvt_pk_bf16_f32 v188, v200, v201
  v_cvt_pk_bf16_f32 v189, v202, v203
  v_cvt_pk_bf16_f32 v190, v204, v205
  v_cvt_pk_bf16_f32 v191, v206, v207
  v_accvgpr_write_b32 a124, v188
  v_accvgpr_write_b32 a125, v189
  v_accvgpr_write_b32 a126, v190
  v_accvgpr_write_b32 a127, v191
  v_mfma_f32_16x16x32_bf16 v[152:155], a[192:195], a[112:115], 0
  v_mfma_f32_16x16x32_bf16 v[152:155], a[196:199], a[116:119], v[152:155]
  v_mfma_f32_16x16x32_bf16 v[152:155], a[200:203], a[120:123], v[152:155]
  v_mfma_f32_16x16x32_bf16 v[152:155], a[204:207], a[124:127], v[152:155]
  s_nop 7
  v_max3_f32 v6, v152, v153, v154
  v_max_f32 v6, v6, v155
  v_mov_b32 v7, v6
  s_nop 1
  v_permlane32_swap_b32 v6, v7
  v_max_f32 v6, v6, v7
  v_mov_b32 v7, v6
  s_nop 1
  v_permlane16_swap_b32 v6, v7
  v_max_f32 v6, v6, v7
  v_sub_f32 v132, s81, v6
  v_sub_f32 v133, s81, v6
  v_sub_f32 v134, s81, v6
  v_sub_f32 v135, s81, v6
  v_add_f32 v152, v152, v132
  v_add_f32 v153, v153, v132
  v_mfma_f32_16x16x32_bf16 v[156:159], a[208:211], a[112:115], v[132:135]
  v_add_f32 v154, v154, v132
  v_add_f32 v155, v155, v132
  v_mfma_f32_16x16x32_bf16 v[156:159], a[212:215], a[116:119], v[156:159]
  v_exp_f32 v152, v152
  v_mfma_f32_16x16x32_bf16 v[156:159], a[216:219], a[120:123], v[156:159]
  v_exp_f32 v153, v153
  v_mfma_f32_16x16x32_bf16 v[156:159], a[220:223], a[124:127], v[156:159]
  v_exp_f32 v154, v154
  v_mfma_f32_16x16x32_bf16 v[112:115], v[80:83], a[112:115], v[132:135]
  v_exp_f32 v155, v155
  v_mfma_f32_16x16x32_bf16 v[112:115], v[84:87], a[116:119], v[112:115]
  v_cvt_pk_bf16_f32 v36, v152, v153
  v_cvt_pk_bf16_f32 v37, v154, v155
  v_mfma_f32_16x16x32_bf16 v[112:115], v[88:91], a[120:123], v[112:115]
  v_mfma_f32_16x16x32_bf16 v[112:115], v[92:95], a[124:127], v[112:115]
  v_exp_f32 v156, v156
  v_mfma_f32_16x16x32_bf16 v[116:119], v[96:99], a[112:115], v[132:135]
  v_exp_f32 v157, v157
  v_mfma_f32_16x16x32_bf16 v[116:119], v[100:103], a[116:119], v[116:119]
  v_exp_f32 v158, v158
  v_mfma_f32_16x16x32_bf16 v[116:119], v[104:107], a[120:123], v[116:119]
  v_exp_f32 v159, v159
  v_mfma_f32_16x16x32_bf16 v[116:119], v[108:111], a[124:127], v[116:119]
  v_cvt_pk_bf16_f32 v38, v156, v157
  v_cvt_pk_bf16_f32 v39, v158, v159
  s_waitcnt vmcnt(0)
  ds_read_b128 v[160:163], v8 offset:8192
  ds_read_b128 v[164:167], v9 offset:8192
  ds_read_b128 v[168:171], v10 offset:8192
  ds_read_b128 v[172:175], v11 offset:8192
  v_mfma_f32_32x32x16_bf16 a[16:31], a[240:243], a[248:251], 0
  s_add_u32 m0, s45, 12288
  s_nop 0
  buffer_load_dwordx4 v148, s[12:15], m0 offen offset:0 nt lds
  buffer_load_dwordx4 v149, s[12:15], m0 offen offset:1024 nt lds
  v_exp_f32 v112, v112
  v_mfma_f32_32x32x16_bf16 a[32:47], a[240:243], a[248:251], 0
  buffer_load_dwordx4 v150, s[12:15], m0 offen offset:2048 nt lds
  buffer_load_dwordx4 v151, s[12:15], m0 offen offset:3072 nt lds
  v_exp_f32 v113, v113
  v_exp_f32 v114, v114
  v_exp_f32 v115, v115
  v_cvt_pk_bf16_f32 v60, v112, v113
  v_cvt_pk_bf16_f32 v61, v114, v115
  v_exp_f32 v116, v116
  v_exp_f32 v117, v117
  v_exp_f32 v118, v118
  v_exp_f32 v119, v119
  v_cvt_pk_bf16_f32 v62, v116, v117
  v_cvt_pk_bf16_f32 v63, v118, v119
  s_waitcnt lgkmcnt(3)
  v_lshlrev_b32 v192, 16, v160
  v_and_b32 v193, s48, v160
  v_lshlrev_b32 v194, 16, v161
  v_and_b32 v195, s48, v161
  v_lshlrev_b32 v196, 16, v162
  v_and_b32 v197, s48, v162
  v_lshlrev_b32 v198, 16, v163
  v_and_b32 v199, s48, v163
  v_pk_mul_f32 v[192:193], v[192:193], s[46:47]
  v_pk_mul_f32 v[194:195], v[194:195], s[46:47]
  v_pk_mul_f32 v[196:197], v[196:197], s[46:47]
  v_pk_mul_f32 v[198:199], v[198:199], s[46:47]
  v_cvt_pk_bf16_f32 v160, v192, v193
  v_cvt_pk_bf16_f32 v161, v194, v195
  v_cvt_pk_bf16_f32 v162, v196, v197
  v_cvt_pk_bf16_f32 v163, v198, v199
  v_accvgpr_write_b32 a128, v160
  v_accvgpr_write_b32 a129, v161
  v_accvgpr_write_b32 a130, v162
  v_accvgpr_write_b32 a131, v163
  s_waitcnt lgkmcnt(2)
  v_lshlrev_b32 v200, 16, v164
  v_and_b32 v201, s48, v164
  v_mfma_f32_16x16x32_bf16 v[120:123], a[192:195], a[128:131], 0
  s_waitcnt lgkmcnt(0)
  s_add_u32 m0, s45, 16384
  s_nop 0
  buffer_load_dwordx4 v148, s[12:15], m0 offen offset:0 nt lds
  buffer_load_dwordx4 v149, s[12:15], m0 offen offset:1024 nt lds
  v_lshlrev_b32 v202, 16, v165
  v_and_b32 v203, s48, v165
  v_lshlrev_b32 v204, 16, v166
  v_and_b32 v205, s48, v166
  v_lshlrev_b32 v206, 16, v167
  v_and_b32 v207, s48, v167
  v_pk_mul_f32 v[200:201], v[200:201], s[46:47]
  v_pk_mul_f32 v[202:203], v[202:203], s[46:47]
  v_pk_mul_f32 v[204:205], v[204:205], s[46:47]
  v_pk_mul_f32 v[206:207], v[206:207], s[46:47]
  v_cvt_pk_bf16_f32 v164, v200, v201
  v_cvt_pk_bf16_f32 v165, v202, v203
  v_cvt_pk_bf16_f32 v166, v204, v205
  v_cvt_pk_bf16_f32 v167, v206, v207
  v_accvgpr_write_b32 a132, v164
  v_accvgpr_write_b32 a133, v165
  v_accvgpr_write_b32 a134, v166
  v_accvgpr_write_b32 a135, v167
  v_lshlrev_b32 v192, 16, v168
  v_and_b32 v193, s48, v168
  v_mfma_f32_16x16x32_bf16 v[120:123], a[196:199], a[132:135], v[120:123]
  buffer_load_dwordx4 v150, s[12:15], m0 offen offset:2048 nt lds
  buffer_load_dwordx4 v151, s[12:15], m0 offen offset:3072 nt lds
  v_lshlrev_b32 v194, 16, v169
  v_and_b32 v195, s48, v169
  v_lshlrev_b32 v196, 16, v170
  v_and_b32 v197, s48, v170
  v_lshlrev_b32 v198, 16, v171
  v_and_b32 v199, s48, v171
  v_pk_mul_f32 v[192:193], v[192:193], s[46:47]
  v_pk_mul_f32 v[194:195], v[194:195], s[46:47]
  v_pk_mul_f32 v[196:197], v[196:197], s[46:47]
  v_pk_mul_f32 v[198:199], v[198:199], s[46:47]
  v_cvt_pk_bf16_f32 v168, v192, v193
  v_cvt_pk_bf16_f32 v169, v194, v195
  v_cvt_pk_bf16_f32 v170, v196, v197
  v_cvt_pk_bf16_f32 v171, v198, v199
  v_accvgpr_write_b32 a136, v168
  v_accvgpr_write_b32 a137, v169
  v_accvgpr_write_b32 a138, v170
  v_accvgpr_write_b32 a139, v171
  v_lshlrev_b32 v200, 16, v172
  v_and_b32 v201, s48, v172
  v_lshlrev_b32 v202, 16, v173
  v_and_b32 v203, s48, v173
  v_lshlrev_b32 v204, 16, v174
  v_and_b32 v205, s48, v174
  v_lshlrev_b32 v206, 16, v175
  v_and_b32 v207, s48, v175
  v_pk_mul_f32 v[200:201], v[200:201], s[46:47]
  v_pk_mul_f32 v[202:203], v[202:203], s[46:47]
  v_pk_mul_f32 v[204:205], v[204:205], s[46:47]
  v_pk_mul_f32 v[206:207], v[206:207], s[46:47]
  v_cvt_pk_bf16_f32 v172, v200, v201
  v_cvt_pk_bf16_f32 v173, v202, v203
  v_cvt_pk_bf16_f32 v174, v204, v205
  v_cvt_pk_bf16_f32 v175, v206, v207
  v_accvgpr_write_b32 a140, v172
  v_accvgpr_write_b32 a141, v173
  v_accvgpr_write_b32 a142, v174
  v_accvgpr_write_b32 a143, v175
  v_mfma_f32_16x16x32_bf16 v[120:123], a[200:203], a[136:139], v[120:123]
  s_nop 0
  v_mfma_f32_16x16x32_bf16 v[120:123], a[204:207], a[140:143], v[120:123]
  s_nop 7
  v_max3_f32 v18, v120, v121, v122
  v_max_f32 v18, v18, v123
  v_mov_b32 v19, v18
  s_nop 1
  v_permlane32_swap_b32 v18, v19
  v_max_f32 v18, v18, v19
  v_mov_b32 v19, v18
  s_nop 1
  v_permlane16_swap_b32 v18, v19
  v_max_f32 v18, v18, v19
  v_sub_f32 v136, s81, v18
  v_sub_f32 v137, s81, v18
  v_sub_f32 v138, s81, v18
  v_sub_f32 v139, s81, v18
  v_add_f32 v120, v120, v136
  v_add_f32 v121, v121, v136
  v_mfma_f32_16x16x32_bf16 v[124:127], a[208:211], a[128:131], v[136:139]
  v_add_f32 v122, v122, v136
  v_add_f32 v123, v123, v136
  v_mfma_f32_16x16x32_bf16 v[124:127], a[212:215], a[132:135], v[124:127]
  v_exp_f32 v120, v120
  v_mfma_f32_16x16x32_bf16 v[124:127], a[216:219], a[136:139], v[124:127]
  v_exp_f32 v121, v121
  v_mfma_f32_16x16x32_bf16 v[124:127], a[220:223], a[140:143], v[124:127]
  v_exp_f32 v122, v122
  v_mfma_f32_16x16x32_bf16 v[152:155], v[80:83], a[128:131], v[136:139]
  v_exp_f32 v123, v123
  v_mfma_f32_16x16x32_bf16 v[152:155], v[84:87], a[132:135], v[152:155]
  v_cvt_pk_bf16_f32 v40, v120, v121
  v_cvt_pk_bf16_f32 v41, v122, v123
  v_mfma_f32_16x16x32_bf16 v[152:155], v[88:91], a[136:139], v[152:155]
  v_mfma_f32_16x16x32_bf16 v[152:155], v[92:95], a[140:143], v[152:155]
  v_exp_f32 v124, v124
  v_mfma_f32_16x16x32_bf16 v[156:159], v[96:99], a[128:131], v[136:139]
  v_exp_f32 v125, v125
  v_mfma_f32_16x16x32_bf16 v[156:159], v[100:103], a[132:135], v[156:159]
  v_exp_f32 v126, v126
  v_mfma_f32_16x16x32_bf16 v[156:159], v[104:107], a[136:139], v[156:159]
  v_exp_f32 v127, v127
  v_mfma_f32_16x16x32_bf16 v[156:159], v[108:111], a[140:143], v[156:159]
  v_cvt_pk_bf16_f32 v42, v124, v125
  v_cvt_pk_bf16_f32 v43, v126, v127
  s_waitcnt vmcnt(4)
  ds_read_b128 v[176:179], v8 offset:12288
  ds_read_b128 v[180:183], v9 offset:12288
  ds_read_b128 v[184:187], v10 offset:12288
  ds_read_b128 v[188:191], v11 offset:12288
  s_add_u32 m0, s45, 20480
  s_nop 0
  buffer_load_dwordx4 v148, s[12:15], m0 offen offset:0 nt lds
  buffer_load_dwordx4 v149, s[12:15], m0 offen offset:1024 nt lds
  buffer_load_dwordx4 v150, s[12:15], m0 offen offset:2048 nt lds
  buffer_load_dwordx4 v151, s[12:15], m0 offen offset:3072 nt lds
  s_xor_b32 s28, s29, 0x4000
  s_add_u32 m0, s64, 111104
  s_nop 0
  buffer_load_dwordx4 v1, s[4:7], s28 offen offset:0 nt lds
  s_add_u32 m0, s64, 111136
  s_nop 0
  buffer_load_dwordx4 v1, s[4:7], s28 offen offset:1024 nt lds
  s_add_u32 m0, s64, 128000
  s_nop 0
  buffer_load_dwordx4 v1, s[8:11], s29 offen offset:0 nt lds
  s_add_u32 m0, s64, 128008
  s_nop 0
  buffer_load_dwordx4 v1, s[8:11], s29 offen offset:1024 nt lds
  v_exp_f32 v152, v152
  v_exp_f32 v153, v153
  v_exp_f32 v154, v154
  v_exp_f32 v155, v155
  v_cvt_pk_bf16_f32 v64, v152, v153
  v_cvt_pk_bf16_f32 v65, v154, v155
  v_exp_f32 v156, v156
  v_exp_f32 v157, v157
  v_exp_f32 v158, v158
  v_exp_f32 v159, v159
  v_cvt_pk_bf16_f32 v66, v156, v157
  v_cvt_pk_bf16_f32 v67, v158, v159
  s_waitcnt lgkmcnt(3)
  v_lshlrev_b32 v192, 16, v176
  v_and_b32 v193, s48, v176
  v_lshlrev_b32 v194, 16, v177
  v_and_b32 v195, s48, v177
  v_lshlrev_b32 v196, 16, v178
  v_and_b32 v197, s48, v178
  v_lshlrev_b32 v198, 16, v179
  v_and_b32 v199, s48, v179
  v_pk_mul_f32 v[192:193], v[192:193], s[46:47]
  v_pk_mul_f32 v[194:195], v[194:195], s[46:47]
  v_pk_mul_f32 v[196:197], v[196:197], s[46:47]
  v_pk_mul_f32 v[198:199], v[198:199], s[46:47]
  v_cvt_pk_bf16_f32 v176, v192, v193
  v_cvt_pk_bf16_f32 v177, v194, v195
  v_cvt_pk_bf16_f32 v178, v196, v197
  v_cvt_pk_bf16_f32 v179, v198, v199
  v_accvgpr_write_b32 a144, v176
  v_accvgpr_write_b32 a145, v177
  v_accvgpr_write_b32 a146, v178
  v_accvgpr_write_b32 a147, v179
  v_mfma_f32_32x32x16_bf16 a[48:63], a[240:243], a[248:251], 0
  s_waitcnt lgkmcnt(0)
  v_lshlrev_b32 v200, 16, v180
  v_and_b32 v201, s48, v180
  v_lshlrev_b32 v202, 16, v181
  v_and_b32 v203, s48, v181
  v_lshlrev_b32 v204, 16, v182
  v_and_b32 v205, s48, v182
  v_mfma_f32_16x16x32_bf16 v[112:115], a[192:195], a[144:147], 0
  v_lshlrev_b32 v206, 16, v183
  v_and_b32 v207, s48, v183
  v_lshlrev_b32 v192, 16, v184
  v_and_b32 v193, s48, v184
  v_lshlrev_b32 v194, 16, v185
  v_pk_mul_f32 v[200:201], v[200:201], s[46:47]
  v_pk_mul_f32 v[202:203], v[202:203], s[46:47]
  v_pk_mul_f32 v[204:205], v[204:205], s[46:47]
  v_pk_mul_f32 v[206:207], v[206:207], s[46:47]
  v_cvt_pk_bf16_f32 v180, v200, v201
  v_cvt_pk_bf16_f32 v181, v202, v203
  v_cvt_pk_bf16_f32 v182, v204, v205
  v_cvt_pk_bf16_f32 v183, v206, v207
  v_accvgpr_write_b32 a148, v180
  v_accvgpr_write_b32 a149, v181
  v_accvgpr_write_b32 a150, v182
  v_accvgpr_write_b32 a151, v183
  v_and_b32 v195, s48, v185
  v_lshlrev_b32 v196, 16, v186
  v_mfma_f32_16x16x32_bf16 v[112:115], a[196:199], a[148:151], v[112:115]
  v_and_b32 v197, s48, v186
  v_lshlrev_b32 v198, 16, v187
  v_and_b32 v199, s48, v187
  v_mfma_f32_32x32x16_bf16 a[64:79], a[240:243], a[248:251], 0
  v_lshlrev_b32 v200, 16, v188
  v_and_b32 v201, s48, v188
  v_lshlrev_b32 v202, 16, v189
  v_and_b32 v203, s48, v189
  v_lshlrev_b32 v204, 16, v190
  v_and_b32 v205, s48, v190
  v_lshlrev_b32 v206, 16, v191
  v_and_b32 v207, s48, v191
  v_pk_mul_f32 v[192:193], v[192:193], s[46:47]
  v_pk_mul_f32 v[194:195], v[194:195], s[46:47]
  v_pk_mul_f32 v[196:197], v[196:197], s[46:47]
  v_pk_mul_f32 v[198:199], v[198:199], s[46:47]
  v_cvt_pk_bf16_f32 v184, v192, v193
  v_cvt_pk_bf16_f32 v185, v194, v195
  v_cvt_pk_bf16_f32 v186, v196, v197
  v_cvt_pk_bf16_f32 v187, v198, v199
  v_accvgpr_write_b32 a152, v184
  v_accvgpr_write_b32 a153, v185
  v_accvgpr_write_b32 a154, v186
  v_accvgpr_write_b32 a155, v187
  v_pk_mul_f32 v[200:201], v[200:201], s[46:47]
  v_pk_mul_f32 v[202:203], v[202:203], s[46:47]
  v_pk_mul_f32 v[204:205], v[204:205], s[46:47]
  v_pk_mul_f32 v[206:207], v[206:207], s[46:47]
  v_cvt_pk_bf16_f32 v188, v200, v201
  v_cvt_pk_bf16_f32 v189, v202, v203
  v_mfma_f32_16x16x32_bf16 v[112:115], a[200:203], a[152:155], v[112:115]
  v_cvt_pk_bf16_f32 v190, v204, v205
  v_cvt_pk_bf16_f32 v191, v206, v207
  v_accvgpr_write_b32 a156, v188
  v_accvgpr_write_b32 a157, v189
  v_accvgpr_write_b32 a158, v190
  v_accvgpr_write_b32 a159, v191
  s_nop 1
  v_mfma_f32_16x16x32_bf16 v[112:115], a[204:207], a[156:159], v[112:115]
  s_nop 7
  v_max3_f32 v6, v112, v113, v114
  v_max_f32 v6, v6, v115
  v_mov_b32 v7, v6
  s_nop 1
  v_permlane32_swap_b32 v6, v7
  v_max_f32 v6, v6, v7
  v_mov_b32 v7, v6
  s_nop 1
  v_permlane16_swap_b32 v6, v7
  v_max_f32 v6, v6, v7
  v_sub_f32 v140, s81, v6
  v_sub_f32 v141, s81, v6
  v_sub_f32 v142, s81, v6
  v_sub_f32 v143, s81, v6
  v_add_f32 v112, v112, v140
  v_add_f32 v113, v113, v140
  v_mfma_f32_16x16x32_bf16 v[116:119], a[208:211], a[144:147], v[140:143]
  v_add_f32 v114, v114, v140
  v_add_f32 v115, v115, v140
  v_mfma_f32_16x16x32_bf16 v[116:119], a[212:215], a[148:151], v[116:119]
  v_exp_f32 v112, v112
  v_mfma_f32_16x16x32_bf16 v[116:119], a[216:219], a[152:155], v[116:119]
  v_exp_f32 v113, v113
  v_mfma_f32_16x16x32_bf16 v[116:119], a[220:223], a[156:159], v[116:119]
  v_exp_f32 v114, v114
  v_mfma_f32_16x16x32_bf16 v[120:123], v[80:83], a[144:147], v[140:143]
  v_exp_f32 v115, v115
  v_mfma_f32_16x16x32_bf16 v[120:123], v[84:87], a[148:151], v[120:123]
  v_cvt_pk_bf16_f32 v44, v112, v113
  v_cvt_pk_bf16_f32 v45, v114, v115
  v_mfma_f32_16x16x32_bf16 v[120:123], v[88:91], a[152:155], v[120:123]
  v_mfma_f32_16x16x32_bf16 v[120:123], v[92:95], a[156:159], v[120:123]
  v_exp_f32 v116, v116
  v_mfma_f32_16x16x32_bf16 v[124:127], v[96:99], a[144:147], v[140:143]
  v_exp_f32 v117, v117
  v_mfma_f32_16x16x32_bf16 v[124:127], v[100:103], a[148:151], v[124:127]
  v_exp_f32 v118, v118
  v_mfma_f32_16x16x32_bf16 v[124:127], v[104:107], a[152:155], v[124:127]
  v_exp_f32 v119, v119
  v_mfma_f32_16x16x32_bf16 v[124:127], v[108:111], a[156:159], v[124:127]
  v_cvt_pk_bf16_f32 v46, v116, v117
  v_cvt_pk_bf16_f32 v47, v118, v119
  s_waitcnt vmcnt(8)
  ds_read_b128 v[160:163], v8 offset:16384
  ds_read_b128 v[164:167], v9 offset:16384
  ds_read_b128 v[168:171], v10 offset:16384
  ds_read_b128 v[172:175], v11 offset:16384
  v_exp_f32 v120, v120
  v_exp_f32 v121, v121
  v_exp_f32 v122, v122
  v_exp_f32 v123, v123
  v_cvt_pk_bf16_f32 v68, v120, v121
  v_cvt_pk_bf16_f32 v69, v122, v123
  v_exp_f32 v124, v124
  v_exp_f32 v125, v125
  v_exp_f32 v126, v126
  v_exp_f32 v127, v127
  v_cvt_pk_bf16_f32 v70, v124, v125
  v_cvt_pk_bf16_f32 v71, v126, v127
  v_mfma_f32_32x32x16_bf16 a[80:95], a[240:243], a[248:251], 0
  s_waitcnt lgkmcnt(3)
  v_lshlrev_b32 v192, 16, v160
  v_and_b32 v193, s48, v160
  v_lshlrev_b32 v194, 16, v161
  v_and_b32 v195, s48, v161
  v_lshlrev_b32 v196, 16, v162
  v_and_b32 v197, s48, v162
  v_lshlrev_b32 v198, 16, v163
  v_and_b32 v199, s48, v163
  v_pk_mul_f32 v[192:193], v[192:193], s[46:47]
  v_pk_mul_f32 v[194:195], v[194:195], s[46:47]
  v_pk_mul_f32 v[196:197], v[196:197], s[46:47]
  v_pk_mul_f32 v[198:199], v[198:199], s[46:47]
  v_cvt_pk_bf16_f32 v160, v192, v193
  v_cvt_pk_bf16_f32 v161, v194, v195
  v_cvt_pk_bf16_f32 v162, v196, v197
  v_cvt_pk_bf16_f32 v163, v198, v199
  v_accvgpr_write_b32 a160, v160
  v_accvgpr_write_b32 a161, v161
  v_accvgpr_write_b32 a162, v162
  v_accvgpr_write_b32 a163, v163
  s_waitcnt lgkmcnt(2)
  v_lshlrev_b32 v200, 16, v164
  v_and_b32 v201, s48, v164
  v_mfma_f32_16x16x32_bf16 v[152:155], a[192:195], a[160:163], 0
  s_waitcnt lgkmcnt(0)
  v_lshlrev_b32 v202, 16, v165
  v_and_b32 v203, s48, v165
  v_lshlrev_b32 v204, 16, v166
  v_and_b32 v205, s48, v166
  v_lshlrev_b32 v206, 16, v167
  v_and_b32 v207, s48, v167
  v_pk_mul_f32 v[200:201], v[200:201], s[46:47]
  v_pk_mul_f32 v[202:203], v[202:203], s[46:47]
  v_pk_mul_f32 v[204:205], v[204:205], s[46:47]
  v_pk_mul_f32 v[206:207], v[206:207], s[46:47]
  v_cvt_pk_bf16_f32 v164, v200, v201
  v_cvt_pk_bf16_f32 v165, v202, v203
  v_cvt_pk_bf16_f32 v166, v204, v205
  v_cvt_pk_bf16_f32 v167, v206, v207
  v_accvgpr_write_b32 a164, v164
  v_accvgpr_write_b32 a165, v165
  v_accvgpr_write_b32 a166, v166
  v_accvgpr_write_b32 a167, v167
  v_lshlrev_b32 v192, 16, v168
  v_and_b32 v193, s48, v168
  v_mfma_f32_16x16x32_bf16 v[152:155], a[196:199], a[164:167], v[152:155]
  v_lshlrev_b32 v194, 16, v169
  v_and_b32 v195, s48, v169
  v_lshlrev_b32 v196, 16, v170
  v_and_b32 v197, s48, v170
  v_lshlrev_b32 v198, 16, v171
  v_and_b32 v199, s48, v171
  v_pk_mul_f32 v[192:193], v[192:193], s[46:47]
  v_pk_mul_f32 v[194:195], v[194:195], s[46:47]
  v_pk_mul_f32 v[196:197], v[196:197], s[46:47]
  v_pk_mul_f32 v[198:199], v[198:199], s[46:47]
  v_cvt_pk_bf16_f32 v168, v192, v193
  v_cvt_pk_bf16_f32 v169, v194, v195
  v_cvt_pk_bf16_f32 v170, v196, v197
  v_cvt_pk_bf16_f32 v171, v198, v199
  v_accvgpr_write_b32 a168, v168
  v_accvgpr_write_b32 a169, v169
  v_accvgpr_write_b32 a170, v170
  v_accvgpr_write_b32 a171, v171
  v_lshlrev_b32 v200, 16, v172
  v_and_b32 v201, s48, v172
  v_mfma_f32_16x16x32_bf16 v[152:155], a[200:203], a[168:171], v[152:155]
  v_lshlrev_b32 v202, 16, v173
  v_and_b32 v203, s48, v173
  v_lshlrev_b32 v204, 16, v174
  v_and_b32 v205, s48, v174
  v_lshlrev_b32 v206, 16, v175
  v_and_b32 v207, s48, v175
  v_pk_mul_f32 v[200:201], v[200:201], s[46:47]
  v_pk_mul_f32 v[202:203], v[202:203], s[46:47]
  v_pk_mul_f32 v[204:205], v[204:205], s[46:47]
  v_pk_mul_f32 v[206:207], v[206:207], s[46:47]
  v_cvt_pk_bf16_f32 v172, v200, v201
  v_cvt_pk_bf16_f32 v173, v202, v203
  v_cvt_pk_bf16_f32 v174, v204, v205
  v_cvt_pk_bf16_f32 v175, v206, v207
  v_accvgpr_write_b32 a172, v172
  v_accvgpr_write_b32 a173, v173
  v_accvgpr_write_b32 a174, v174
  v_accvgpr_write_b32 a175, v175
  s_nop 1
  v_mfma_f32_16x16x32_bf16 v[152:155], a[204:207], a[172:175], v[152:155]
  s_nop 7
  v_max3_f32 v18, v152, v153, v154
  v_max_f32 v18, v18, v155
  v_mov_b32 v19, v18
  s_nop 1
  v_permlane32_swap_b32 v18, v19
  v_max_f32 v18, v18, v19
  v_mov_b32 v19, v18
  s_nop 1
  v_permlane16_swap_b32 v18, v19
  v_max_f32 v18, v18, v19
  v_sub_f32 v144, s81, v18
  v_sub_f32 v145, s81, v18
  v_sub_f32 v146, s81, v18
  v_sub_f32 v147, s81, v18
  v_add_f32 v152, v152, v144
  v_add_f32 v153, v153, v144
  v_mfma_f32_16x16x32_bf16 v[156:159], a[208:211], a[160:163], v[144:147]
  v_add_f32 v154, v154, v144
  v_add_f32 v155, v155, v144
  v_mfma_f32_16x16x32_bf16 v[156:159], a[212:215], a[164:167], v[156:159]
  v_exp_f32 v152, v152
  v_mfma_f32_16x16x32_bf16 v[156:159], a[216:219], a[168:171], v[156:159]
  v_exp_f32 v153, v153
  v_mfma_f32_16x16x32_bf16 v[156:159], a[220:223], a[172:175], v[156:159]
  v_exp_f32 v154, v154
  v_mfma_f32_16x16x32_bf16 v[112:115], v[80:83], a[160:163], v[144:147]
  v_exp_f32 v155, v155
  v_mfma_f32_16x16x32_bf16 v[112:115], v[84:87], a[164:167], v[112:115]
  v_cvt_pk_bf16_f32 v48, v152, v153
  v_cvt_pk_bf16_f32 v49, v154, v155
  v_mfma_f32_16x16x32_bf16 v[112:115], v[88:91], a[168:171], v[112:115]
  v_mfma_f32_16x16x32_bf16 v[112:115], v[92:95], a[172:175], v[112:115]
  v_exp_f32 v156, v156
  v_mfma_f32_16x16x32_bf16 v[116:119], v[96:99], a[160:163], v[144:147]
  v_exp_f32 v157, v157
  v_mfma_f32_16x16x32_bf16 v[116:119], v[100:103], a[164:167], v[116:119]
  v_exp_f32 v158, v158
  v_mfma_f32_16x16x32_bf16 v[116:119], v[104:107], a[168:171], v[116:119]
  v_exp_f32 v159, v159
  v_mfma_f32_16x16x32_bf16 v[116:119], v[108:111], a[172:175], v[116:119]
  v_cvt_pk_bf16_f32 v50, v156, v157
  v_cvt_pk_bf16_f32 v51, v158, v159
  s_waitcnt vmcnt(4)
  ds_read_b128 v[176:179], v8 offset:20480
  ds_read_b128 v[180:183], v9 offset:20480
  ds_read_b128 v[184:187], v10 offset:20480
  ds_read_b128 v[188:191], v11 offset:20480
  v_exp_f32 v112, v112
  v_exp_f32 v113, v113
  v_exp_f32 v114, v114
  v_exp_f32 v115, v115
  v_cvt_pk_bf16_f32 v72, v112, v113
  v_cvt_pk_bf16_f32 v73, v114, v115
  v_exp_f32 v116, v116
  v_exp_f32 v117, v117
  v_exp_f32 v118, v118
  v_exp_f32 v119, v119
  v_cvt_pk_bf16_f32 v74, v116, v117
  v_cvt_pk_bf16_f32 v75, v118, v119
  v_mfma_f32_32x32x16_bf16 v[160:175], a[240:243], a[248:251], 0
  s_waitcnt lgkmcnt(3)
  v_lshlrev_b32 v192, 16, v176
  v_and_b32 v193, s48, v176
  v_lshlrev_b32 v194, 16, v177
  v_and_b32 v195, s48, v177
  v_lshlrev_b32 v196, 16, v178
  v_and_b32 v197, s48, v178
  v_lshlrev_b32 v198, 16, v179
  v_and_b32 v199, s48, v179
  v_pk_mul_f32 v[192:193], v[192:193], s[46:47]
  v_pk_mul_f32 v[194:195], v[194:195], s[46:47]
  v_pk_mul_f32 v[196:197], v[196:197], s[46:47]
  v_pk_mul_f32 v[198:199], v[198:199], s[46:47]
  v_cvt_pk_bf16_f32 v176, v192, v193
  v_cvt_pk_bf16_f32 v177, v194, v195
  v_cvt_pk_bf16_f32 v178, v196, v197
  v_cvt_pk_bf16_f32 v179, v198, v199
  v_accvgpr_write_b32 a176, v176
  v_accvgpr_write_b32 a177, v177
  v_accvgpr_write_b32 a178, v178
  v_accvgpr_write_b32 a179, v179
  s_waitcnt lgkmcnt(2)
  v_lshlrev_b32 v200, 16, v180
  v_and_b32 v201, s48, v180
  v_mfma_f32_16x16x32_bf16 v[120:123], a[192:195], a[176:179], 0
  s_waitcnt lgkmcnt(0)
  v_lshlrev_b32 v202, 16, v181
  v_and_b32 v203, s48, v181
  v_lshlrev_b32 v204, 16, v182
  v_and_b32 v205, s48, v182
  v_lshlrev_b32 v206, 16, v183
  v_and_b32 v207, s48, v183
  v_pk_mul_f32 v[200:201], v[200:201], s[46:47]
  v_pk_mul_f32 v[202:203], v[202:203], s[46:47]
  v_pk_mul_f32 v[204:205], v[204:205], s[46:47]
  v_pk_mul_f32 v[206:207], v[206:207], s[46:47]
  v_cvt_pk_bf16_f32 v180, v200, v201
  v_cvt_pk_bf16_f32 v181, v202, v203
  v_cvt_pk_bf16_f32 v182, v204, v205
  v_cvt_pk_bf16_f32 v183, v206, v207
  v_accvgpr_write_b32 a180, v180
  v_accvgpr_write_b32 a181, v181
  v_accvgpr_write_b32 a182, v182
  v_accvgpr_write_b32 a183, v183
  v_lshlrev_b32 v192, 16, v184
  v_and_b32 v193, s48, v184
  v_mfma_f32_16x16x32_bf16 v[120:123], a[196:199], a[180:183], v[120:123]
  v_lshlrev_b32 v194, 16, v185
  v_and_b32 v195, s48, v185
  v_lshlrev_b32 v196, 16, v186
  v_and_b32 v197, s48, v186
  v_lshlrev_b32 v198, 16, v187
  v_and_b32 v199, s48, v187
  v_pk_mul_f32 v[192:193], v[192:193], s[46:47]
  v_pk_mul_f32 v[194:195], v[194:195], s[46:47]
  v_pk_mul_f32 v[196:197], v[196:197], s[46:47]
  v_pk_mul_f32 v[198:199], v[198:199], s[46:47]
  v_cvt_pk_bf16_f32 v184, v192, v193
  v_cvt_pk_bf16_f32 v185, v194, v195
  v_cvt_pk_bf16_f32 v186, v196, v197
  v_cvt_pk_bf16_f32 v187, v198, v199
  v_accvgpr_write_b32 a184, v184
  v_accvgpr_write_b32 a185, v185
  v_accvgpr_write_b32 a186, v186
  v_accvgpr_write_b32 a187, v187
  v_lshlrev_b32 v200, 16, v188
  v_and_b32 v201, s48, v188
  v_mfma_f32_16x16x32_bf16 v[120:123], a[200:203], a[184:187], v[120:123]
  v_lshlrev_b32 v202, 16, v189
  v_and_b32 v203, s48, v189
  v_lshlrev_b32 v204, 16, v190
  v_and_b32 v205, s48, v190
  v_lshlrev_b32 v206, 16, v191
  v_and_b32 v207, s48, v191
  v_pk_mul_f32 v[200:201], v[200:201], s[46:47]
  v_pk_mul_f32 v[202:203], v[202:203], s[46:47]
  v_pk_mul_f32 v[204:205], v[204:205], s[46:47]
  v_pk_mul_f32 v[206:207], v[206:207], s[46:47]
  v_cvt_pk_bf16_f32 v188, v200, v201
  v_cvt_pk_bf16_f32 v189, v202, v203
  v_cvt_pk_bf16_f32 v190, v204, v205
  v_cvt_pk_bf16_f32 v191, v206, v207
  v_accvgpr_write_b32 a188, v188
  v_accvgpr_write_b32 a189, v189
  v_accvgpr_write_b32 a190, v190
  v_accvgpr_write_b32 a191, v191
  v_mfma_f32_32x32x16_bf16 v[176:191], a[240:243], a[248:251], 0
  v_mfma_f32_32x32x16_bf16 v[192:207], a[240:243], a[248:251], 0
  v_mfma_f32_16x16x32_bf16 v[120:123], a[204:207], a[188:191], v[120:123]
  s_waitcnt vmcnt(0)
  s_barrier
  ds_read_b128 a[192:195], v2 offset:16896
  ds_read_b128 a[196:199], v2 offset:16960
  ds_read_b128 a[200:203], v2 offset:17024
  ds_read_b128 a[204:207], v2 offset:17088
  ds_read_b64_tr_b16 a[224:225], v3 offset:0
  ds_read_b64_tr_b16 a[226:227], v3 offset:256
  ds_read_b64_tr_b16 a[228:229], v3 offset:8448
  v_max3_f32 v6, v120, v121, v122
  v_max_f32 v6, v6, v123
  v_mov_b32 v7, v6
  ds_read_b64_tr_b16 a[230:231], v3 offset:8704
  ds_read_b64_tr_b16 a[236:237], v3 offset:8456
  v_permlane32_swap_b32 v6, v7
  v_max_f32 v6, v6, v7
  v_mov_b32 v7, v6
  s_nop 1
  v_permlane16_swap_b32 v6, v7
  v_max_f32 v6, v6, v7
  v_sub_f32 v148, s81, v6
  v_sub_f32 v149, s81, v6
  v_sub_f32 v150, s81, v6
  v_sub_f32 v151, s81, v6
  v_add_f32 v120, v120, v148
  v_add_f32 v121, v121, v148
  v_mfma_f32_16x16x32_bf16 v[124:127], a[208:211], a[176:179], v[148:151]
  v_add_f32 v122, v122, v148
  v_add_f32 v123, v123, v148
  v_mfma_f32_16x16x32_bf16 v[124:127], a[212:215], a[180:183], v[124:127]
  v_exp_f32 v120, v120
  v_mfma_f32_16x16x32_bf16 v[124:127], a[216:219], a[184:187], v[124:127]
  v_exp_f32 v121, v121
  v_mfma_f32_16x16x32_bf16 v[124:127], a[220:223], a[188:191], v[124:127]
  v_exp_f32 v122, v122
  v_mfma_f32_16x16x32_bf16 v[152:155], v[80:83], a[176:179], v[148:151]
  s_waitcnt lgkmcnt(0)
  v_exp_f32 v123, v123
  v_mfma_f32_16x16x32_bf16 v[152:155], v[84:87], a[180:183], v[152:155]
  v_cvt_pk_bf16_f32 v52, v120, v121
  v_cvt_pk_bf16_f32 v53, v122, v123
  v_mfma_f32_16x16x32_bf16 v[152:155], v[88:91], a[184:187], v[152:155]
  v_exp_f32 v124, v124
  v_mfma_f32_16x16x32_bf16 v[152:155], v[92:95], a[188:191], v[152:155]
  v_exp_f32 v125, v125
  v_mfma_f32_16x16x32_bf16 v[156:159], v[96:99], a[176:179], v[148:151]
  v_exp_f32 v126, v126
  v_mfma_f32_16x16x32_bf16 v[156:159], v[100:103], a[180:183], v[156:159]
  v_exp_f32 v127, v127
  v_mfma_f32_16x16x32_bf16 v[156:159], v[104:107], a[184:187], v[156:159]
  v_cvt_pk_bf16_f32 v54, v124, v125
  v_cvt_pk_bf16_f32 v55, v126, v127
  v_mfma_f32_16x16x32_bf16 v[156:159], v[108:111], a[188:191], v[156:159]
  v_exp_f32 v152, v152
  v_exp_f32 v153, v153
  v_exp_f32 v154, v154
  v_exp_f32 v155, v155
  v_cvt_pk_bf16_f32 v76, v152, v153
  v_cvt_pk_bf16_f32 v77, v154, v155
  s_waitcnt lgkmcnt(0)
  s_branch ENTRY1_6
PATHE_5:
  s_add_u32 s20, s74, s63
  s_addc_u32 s21, s75, 0
  s_mov_b32 s22, 188416
  s_mov_b32 s23, 0x20000
  s_mov_b32 s24, s20
  s_mov_b32 s25, s21
  s_mov_b32 s26, 94208
  s_mov_b32 s27, 0x20000
  s_add_u32 s16, s12, 94208
  s_addc_u32 s17, s13, 0
  s_mov_b32 s18, 94208
  s_mov_b32 s19, 0x20000
  s_mov_b32 s48, 0xffff0000
  s_mov_b32 s46, 0x3e0293ee
  s_mov_b32 s47, 0x3e0293ee
  s_mov_b32 s49, 0x44800000
  v_lshl_add_u32 v8, v12, 8, v14
  v_add_u32 v8, s45, v8
  v_xor_b32 v9, 64, v8
  v_xor_b32 v10, 0x80, v8
  v_xor_b32 v11, 0xc0, v8
  v_and_b32 v15, 7, v0
  v_mul_u32_u24 v15, 1056, v15
  v_bfe_u32 v16, v0, 3, 1
  v_lshl_add_u32 v15, v16, 9, v15
  v_lshl_add_u32 v15, v13, 4, v15
  v_add_u32 v2, 94208, v15
  v_bfe_u32 v15, v0, 3, 2
  v_mul_u32_u24 v15, 2112, v15
  v_bfe_u32 v16, v0, 2, 1
  v_mul_u32_u24 v16, 1032, v16
  v_lshrrev_b32 v17, 5, v0
  v_lshl_add_u32 v15, v17, 9, v15
  v_and_b32 v18, 3, v0
  v_lshl_add_u32 v16, v18, 4, v16
  v_add_u32 v15, v15, v16
  v_add_u32 v3, 128000, v15
  v_bfe_u32 v16, v0, 1, 1
  v_mov_b32 v19, 0x3f803f80
  v_cmp_eq_u32 vcc, v16, v17
  s_nop 1
  v_cndmask_b32 v19, 0, v19, vcc
  v_and_b32 v16, 1, v0
  v_mul_u32_u24 v16, 0xaaaa, v16
  v_add_u32 v5, 0x4444, v16
  v_accvgpr_write_b32 a240, v19
  v_accvgpr_write_b32 a244, 0
  v_accvgpr_write_b32 a241, v19
  v_accvgpr_write_b32 a245, 0
  v_accvgpr_write_b32 a242, v19
  v_accvgpr_write_b32 a246, 0
  v_accvgpr_write_b32 a243, v19
  v_accvgpr_write_b32 a247, 0
  s_mov_b32 s81, 0xc1980000
  s_add_u32 s51, s45, 20480
  s_add_u32 s50, s45, 8192
  s_mov_b32 s65, 5
  s_mov_b32 s39, 7
  s_mov_b32 s61, 0
  v_lshl_add_u32 v4, v0, 2, s50
  s_mov_b32 s34, -8192
  s_mov_b32 s33, 65536
  v_add_u32 v72, 0x1000, v1
  s_mov_b32 s30, -4096
  s_mov_b32 s31, 20480
  s_mov_b32 s32, 45056
  s_mov_b32 s67, 0x8000
  s_xor_b32 s90, s67, s66
  v_mfma_f32_32x32x16_bf16 v[16:31], a[244:247], a[244:247], 0
  s_waitcnt vmcnt(8)
  v_max3_f16 v56, |v224|, |v228|, |v232| op_sel:[0,0,0,0]
  v_max3_f16 v57, |v224|, |v228|, |v232| op_sel:[1,1,1,0]
  v_max3_f16 v58, |v225|, |v229|, |v233| op_sel:[0,0,0,0]
  v_max3_f16 v59, |v225|, |v229|, |v233| op_sel:[1,1,1,0]
  v_max3_f16 v60, |v226|, |v230|, |v234| op_sel:[0,0,0,0]
  v_max3_f16 v61, |v226|, |v230|, |v234| op_sel:[1,1,1,0]
  v_max3_f16 v62, |v227|, |v231|, |v235| op_sel:[0,0,0,0]
  v_max3_f16 v63, |v227|, |v231|, |v235| op_sel:[1,1,1,0]
  s_waitcnt vmcnt(6)
  v_max3_f16 v56, v56, |v236|, |v240| op_sel:[0,0,0,0]
  v_max3_f16 v57, v57, |v236|, |v240| op_sel:[0,1,1,0]
  v_max3_f16 v58, v58, |v237|, |v241| op_sel:[0,0,0,0]
  v_max3_f16 v59, v59, |v237|, |v241| op_sel:[0,1,1,0]
  v_max3_f16 v60, v60, |v238|, |v242| op_sel:[0,0,0,0]
  v_max3_f16 v61, v61, |v238|, |v242| op_sel:[0,1,1,0]
  v_max3_f16 v62, v62, |v239|, |v243| op_sel:[0,0,0,0]
  v_max3_f16 v63, v63, |v239|, |v243| op_sel:[0,1,1,0]
  v_min3_f16 v56, v56, v57, v58
  v_min3_f16 v59, v59, v60, v61
  v_min3_f16 v56, v56, v62, v63
  s_nop 0
  v_min_f16 v56, v56, v59
  s_nop 0
  v_and_b32 v56, 0x7f80, v56
  s_nop 1
  v_min_u32_dpp v56, v56, v56 row_ror:8 row_mask:0xf bank_mask:0xf
  s_nop 1
  v_min_u32_dpp v56, v56, v56 row_ror:4 row_mask:0xf bank_mask:0xf
  s_nop 1
  v_min_u32_dpp v56, v56, v56 row_ror:2 row_mask:0xf bank_mask:0xf
  s_nop 1
  v_min_u32_dpp v56, v56, v56 row_ror:1 row_mask:0xf bank_mask:0xf
  s_nop 0
  v_readlane_b32 s82, v56, 0
  v_readlane_b32 s88, v56, 16
  v_readlane_b32 s83, v56, 32
  v_readlane_b32 s89, v56, 48
  s_min_u32 s88, s88, s82
  s_sub_u32 s88, s88, 1877
  s_lshl_b32 s82, s88, 16
  s_add_u32 s82, s82, 0x81800000
  s_cmp_ge_i32 s88, 0x80
  s_cselect_b32 s88, s88, 0
  s_cselect_b32 s82, s82, 0
  s_pack_ll_b32_b16 s88, s88, s88
  s_min_u32 s89, s89, s83
  s_sub_u32 s89, s89, 1877
  s_lshl_b32 s83, s89, 16
  s_add_u32 s83, s83, 0x81800000
  s_cmp_ge_i32 s89, 0x80
  s_cselect_b32 s89, s89, 0
  s_cselect_b32 s83, s83, 0
  s_pack_ll_b32_b16 s89, s89, s89
  v_accvgpr_write_b32 a248, s88
  v_accvgpr_write_b32 a249, s88
  v_accvgpr_write_b32 a250, s88
  v_accvgpr_write_b32 a251, s88
  s_waitcnt vmcnt(4)
  s_barrier
  ds_read_b128 a[192:195], v2 offset:0
  ds_read_b128 a[196:199], v2 offset:64
  ds_read_b128 a[200:203], v2 offset:128
  ds_read_b128 a[204:207], v2 offset:192
  ds_read_b128 a[208:211], v2 offset:256
  ds_read_b128 a[212:215], v2 offset:320
  ds_read_b128 a[216:219], v2 offset:384
  ds_read_b128 a[220:223], v2 offset:448
  s_waitcnt vmcnt(0)
  ds_read_b128 v[160:163], v8 offset:0
  ds_read_b128 v[164:167], v9 offset:0
  ds_read_b128 v[168:171], v10 offset:0
  ds_read_b128 v[172:175], v11 offset:0
  v_mfma_f32_32x32x16_bf16 v[208:223], a[240:243], a[248:251], 0
  s_add_u32 m0, s45, 4096
  s_nop 0
  buffer_load_dwordx4 v148, s[12:15], m0 offen offset:0 nt lds
  buffer_load_dwordx4 v149, s[12:15], m0 offen offset:1024 nt lds
  buffer_load_dwordx4 v150, s[12:15], m0 offen offset:2048 nt lds
  buffer_load_dwordx4 v151, s[12:15], m0 offen offset:3072 nt lds
  v_mfma_f32_32x32x16_bf16 v[224:239], a[240:243], a[248:251], 0
  ds_read_b128 v[80:83], v2 offset:8448
  ds_read_b128 v[84:87], v2 offset:8512
  ds_read_b128 v[88:91], v2 offset:8576
  ds_read_b128 v[92:95], v2 offset:8640
  ds_read_b128 v[96:99], v2 offset:8704
  ds_read_b128 v[100:103], v2 offset:8768
  ds_read_b128 v[104:107], v2 offset:8832
  ds_read_b128 v[108:111], v2 offset:8896
  s_waitcnt lgkmcnt(11)
  v_lshlrev_b32 v192, 16, v160
  v_and_b32 v193, s48, v160
  v_lshlrev_b32 v194, 16, v161
  v_and_b32 v195, s48, v161
  v_lshlrev_b32 v196, 16, v162
  v_and_b32 v197, s48, v162
  v_lshlrev_b32 v198, 16, v163
  v_and_b32 v199, s48, v163
  v_pk_mul_f32 v[192:193], v[192:193], s[46:47]
  v_pk_mul_f32 v[194:195], v[194:195], s[46:47]
  v_pk_mul_f32 v[196:197], v[196:197], s[46:47]
  v_pk_mul_f32 v[198:199], v[198:199], s[46:47]
  v_cvt_pk_bf16_f32 v160, v192, v193
  v_cvt_pk_bf16_f32 v161, v194, v195
  v_cvt_pk_bf16_f32 v162, v196, v197
  v_cvt_pk_bf16_f32 v163, v198, v199
  v_accvgpr_write_b32 a96, v160
  v_accvgpr_write_b32 a97, v161
  v_accvgpr_write_b32 a98, v162
  v_accvgpr_write_b32 a99, v163
  s_waitcnt lgkmcnt(10)
  v_lshlrev_b32 v200, 16, v164
  v_and_b32 v201, s48, v164
  v_lshlrev_b32 v202, 16, v165
  v_and_b32 v203, s48, v165
  v_lshlrev_b32 v204, 16, v166
  v_and_b32 v205, s48, v166
  v_lshlrev_b32 v206, 16, v167
  v_and_b32 v207, s48, v167
  v_pk_mul_f32 v[200:201], v[200:201], s[46:47]
  v_pk_mul_f32 v[202:203], v[202:203], s[46:47]
  v_pk_mul_f32 v[204:205], v[204:205], s[46:47]
  v_pk_mul_f32 v[206:207], v[206:207], s[46:47]
  v_cvt_pk_bf16_f32 v164, v200, v201
  v_cvt_pk_bf16_f32 v165, v202, v203
  v_cvt_pk_bf16_f32 v166, v204, v205
  v_cvt_pk_bf16_f32 v167, v206, v207
  v_accvgpr_write_b32 a100, v164
  v_accvgpr_write_b32 a101, v165
  v_accvgpr_write_b32 a102, v166
  v_accvgpr_write_b32 a103, v167
  s_waitcnt lgkmcnt(9)
  v_lshlrev_b32 v192, 16, v168
  v_and_b32 v193, s48, v168
  v_lshlrev_b32 v194, 16, v169
  v_and_b32 v195, s48, v169
  v_lshlrev_b32 v196, 16, v170
  v_and_b32 v197, s48, v170
  v_lshlrev_b32 v198, 16, v171
  v_and_b32 v199, s48, v171
  v_pk_mul_f32 v[192:193], v[192:193], s[46:47]
  v_pk_mul_f32 v[194:195], v[194:195], s[46:47]
  v_pk_mul_f32 v[196:197], v[196:197], s[46:47]
  v_pk_mul_f32 v[198:199], v[198:199], s[46:47]
  v_cvt_pk_bf16_f32 v168, v192, v193
  v_cvt_pk_bf16_f32 v169, v194, v195
  v_cvt_pk_bf16_f32 v170, v196, v197
  v_cvt_pk_bf16_f32 v171, v198, v199
  v_accvgpr_write_b32 a104, v168
  v_accvgpr_write_b32 a105, v169
  v_accvgpr_write_b32 a106, v170
  v_accvgpr_write_b32 a107, v171
  s_waitcnt lgkmcnt(8)
  v_lshlrev_b32 v200, 16, v172
  v_and_b32 v201, s48, v172
  v_lshlrev_b32 v202, 16, v173
  v_and_b32 v203, s48, v173
  v_lshlrev_b32 v204, 16, v174
  v_and_b32 v205, s48, v174
  v_lshlrev_b32 v206, 16, v175
  v_and_b32 v207, s48, v175
  v_pk_mul_f32 v[200:201], v[200:201], s[46:47]
  v_pk_mul_f32 v[202:203], v[202:203], s[46:47]
  v_pk_mul_f32 v[204:205], v[204:205], s[46:47]
  v_pk_mul_f32 v[206:207], v[206:207], s[46:47]
  v_cvt_pk_bf16_f32 v172, v200, v201
  v_cvt_pk_bf16_f32 v173, v202, v203
  v_cvt_pk_bf16_f32 v174, v204, v205
  v_cvt_pk_bf16_f32 v175, v206, v207
  v_accvgpr_write_b32 a108, v172
  v_accvgpr_write_b32 a109, v173
  v_accvgpr_write_b32 a110, v174
  v_accvgpr_write_b32 a111, v175
  v_mfma_f32_16x16x32_bf16 v[152:155], a[192:195], a[96:99], 0
  s_waitcnt lgkmcnt(0)
  v_mfma_f32_16x16x32_bf16 v[152:155], a[196:199], a[100:103], v[152:155]
  v_mfma_f32_16x16x32_bf16 v[152:155], a[200:203], a[104:107], v[152:155]
  v_mfma_f32_16x16x32_bf16 v[152:155], a[204:207], a[108:111], v[152:155]
  s_nop 7
  v_max3_f32 v18, v152, v153, v154
  v_max_f32 v18, v18, v155
  v_mov_b32 v19, v18
  s_nop 1
  v_permlane32_swap_b32 v18, v19
  v_max_f32 v18, v18, v19
  v_mov_b32 v19, v18
  s_nop 1
  v_permlane16_swap_b32 v18, v19
  v_max_f32 v18, v18, v19
  v_sub_f32 v128, s81, v18
  v_sub_f32 v129, s81, v18
  v_sub_f32 v130, s81, v18
  v_sub_f32 v131, s81, v18
  v_add_f32 v152, v152, v128
  v_add_f32 v153, v153, v128
  v_mfma_f32_16x16x32_bf16 v[156:159], a[208:211], a[96:99], v[128:131]
  v_add_f32 v154, v154, v128
  v_add_f32 v155, v155, v128
  v_mfma_f32_16x16x32_bf16 v[156:159], a[212:215], a[100:103], v[156:159]
  v_exp_f32 v152, v152
  v_mfma_f32_16x16x32_bf16 v[156:159], a[216:219], a[104:107], v[156:159]
  v_exp_f32 v153, v153
  v_mfma_f32_16x16x32_bf16 v[156:159], a[220:223], a[108:111], v[156:159]
  v_exp_f32 v154, v154
  v_mfma_f32_16x16x32_bf16 v[112:115], v[80:83], a[96:99], v[128:131]
  v_exp_f32 v155, v155
  v_mfma_f32_16x16x32_bf16 v[112:115], v[84:87], a[100:103], v[112:115]
  v_cvt_pk_bf16_f32 v32, v152, v153
  v_cvt_pk_bf16_f32 v33, v154, v155
  v_mfma_f32_16x16x32_bf16 v[112:115], v[88:91], a[104:107], v[112:115]
  v_mfma_f32_16x16x32_bf16 v[112:115], v[92:95], a[108:111], v[112:115]
  v_exp_f32 v156, v156
  v_mfma_f32_16x16x32_bf16 v[116:119], v[96:99], a[96:99], v[128:131]
  v_exp_f32 v157, v157
  v_mfma_f32_16x16x32_bf16 v[116:119], v[100:103], a[100:103], v[116:119]
  v_exp_f32 v158, v158
  v_mfma_f32_16x16x32_bf16 v[116:119], v[104:107], a[104:107], v[116:119]
  v_exp_f32 v159, v159
  v_mfma_f32_16x16x32_bf16 v[116:119], v[108:111], a[108:111], v[116:119]
  v_cvt_pk_bf16_f32 v34, v156, v157
  v_cvt_pk_bf16_f32 v35, v158, v159
  s_waitcnt vmcnt(0)
  ds_read_b128 v[176:179], v8 offset:4096
  ds_read_b128 v[180:183], v9 offset:4096
  ds_read_b128 v[184:187], v10 offset:4096
  ds_read_b128 v[188:191], v11 offset:4096
  v_mfma_f32_32x32x16_bf16 v[240:255], a[240:243], a[248:251], 0
  s_add_u32 m0, s45, 8192
  s_nop 0
  buffer_load_dwordx4 v148, s[12:15], m0 offen offset:0 nt lds
  buffer_load_dwordx4 v149, s[12:15], m0 offen offset:1024 nt lds
  v_exp_f32 v112, v112
  v_mfma_f32_32x32x16_bf16 a[0:15], a[240:243], a[248:251], 0
  buffer_load_dwordx4 v150, s[12:15], m0 offen offset:2048 nt lds
  buffer_load_dwordx4 v151, s[12:15], m0 offen offset:3072 nt lds
  v_exp_f32 v113, v113
  v_exp_f32 v114, v114
  v_exp_f32 v115, v115
  v_cvt_pk_bf16_f32 v56, v112, v113
  v_cvt_pk_bf16_f32 v57, v114, v115
  v_exp_f32 v116, v116
  v_exp_f32 v117, v117
  v_exp_f32 v118, v118
  v_exp_f32 v119, v119
  v_cvt_pk_bf16_f32 v58, v116, v117
  v_cvt_pk_bf16_f32 v59, v118, v119
  s_waitcnt lgkmcnt(3)
  v_lshlrev_b32 v192, 16, v176
  v_and_b32 v193, s48, v176
  v_lshlrev_b32 v194, 16, v177
  v_and_b32 v195, s48, v177
  v_lshlrev_b32 v196, 16, v178
  v_and_b32 v197, s48, v178
  v_lshlrev_b32 v198, 16, v179
  v_and_b32 v199, s48, v179
  v_pk_mul_f32 v[192:193], v[192:193], s[46:47]
  v_pk_mul_f32 v[194:195], v[194:195], s[46:47]
  v_pk_mul_f32 v[196:197], v[196:197], s[46:47]
  v_pk_mul_f32 v[198:199], v[198:199], s[46:47]
  v_cvt_pk_bf16_f32 v176, v192, v193
  v_cvt_pk_bf16_f32 v177, v194, v195
  v_cvt_pk_bf16_f32 v178, v196, v197
  v_cvt_pk_bf16_f32 v179, v198, v199
  v_accvgpr_write_b32 a112, v176
  v_accvgpr_write_b32 a113, v177
  v_accvgpr_write_b32 a114, v178
  v_accvgpr_write_b32 a115, v179
  s_waitcnt lgkmcnt(2)
  v_lshlrev_b32 v200, 16, v180
  v_and_b32 v201, s48, v180
  v_lshlrev_b32 v202, 16, v181
  v_and_b32 v203, s48, v181
  v_lshlrev_b32 v204, 16, v182
  v_and_b32 v205, s48, v182
  v_lshlrev_b32 v206, 16, v183
  v_and_b32 v207, s48, v183
  v_pk_mul_f32 v[200:201], v[200:201], s[46:47]
  v_pk_mul_f32 v[202:203], v[202:203], s[46:47]
  v_pk_mul_f32 v[204:205], v[204:205], s[46:47]
  v_pk_mul_f32 v[206:207], v[206:207], s[46:47]
  v_cvt_pk_bf16_f32 v180, v200, v201
  v_cvt_pk_bf16_f32 v181, v202, v203
  v_cvt_pk_bf16_f32 v182, v204, v205
  v_cvt_pk_bf16_f32 v183, v206, v207
  v_accvgpr_write_b32 a116, v180
  v_accvgpr_write_b32 a117, v181
  v_accvgpr_write_b32 a118, v182
  v_accvgpr_write_b32 a119, v183
  s_waitcnt lgkmcnt(1)
  v_lshlrev_b32 v192, 16, v184
  v_and_b32 v193, s48, v184
  v_lshlrev_b32 v194, 16, v185
  v_and_b32 v195, s48, v185
  v_lshlrev_b32 v196, 16, v186
  v_and_b32 v197, s48, v186
  v_lshlrev_b32 v198, 16, v187
  v_and_b32 v199, s48, v187
  v_pk_mul_f32 v[192:193], v[192:193], s[46:47]
  v_pk_mul_f32 v[194:195], v[194:195], s[46:47]
  v_pk_mul_f32 v[196:197], v[196:197], s[46:47]
  v_pk_mul_f32 v[198:199], v[198:199], s[46:47]
  v_cvt_pk_bf16_f32 v184, v192, v193
  v_cvt_pk_bf16_f32 v185, v194, v195
  v_cvt_pk_bf16_f32 v186, v196, v197
  v_cvt_pk_bf16_f32 v187, v198, v199
  v_accvgpr_write_b32 a120, v184
  v_accvgpr_write_b32 a121, v185
  v_accvgpr_write_b32 a122, v186
  v_accvgpr_write_b32 a123, v187
  s_waitcnt lgkmcnt(0)
  v_lshlrev_b32 v200, 16, v188
  v_and_b32 v201, s48, v188
  v_lshlrev_b32 v202, 16, v189
  v_and_b32 v203, s48, v189
  v_lshlrev_b32 v204, 16, v190
  v_and_b32 v205, s48, v190
  v_lshlrev_b32 v206, 16, v191
  v_and_b32 v207, s48, v191
  v_pk_mul_f32 v[200:201], v[200:201], s[46:47]
  v_pk_mul_f32 v[202:203], v[202:203], s[46:47]
  v_pk_mul_f32 v[204:205], v[204:205], s[46:47]
  v_pk_mul_f32 v[206:207], v[206:207], s[46:47]
  v_cvt_pk_bf16_f32 v188, v200, v201
  v_cvt_pk_bf16_f32 v189, v202, v203
  v_cvt_pk_bf16_f32 v190, v204, v205
  v_cvt_pk_bf16_f32 v191, v206, v207
  v_accvgpr_write_b32 a124, v188
  v_accvgpr_write_b32 a125, v189
  v_accvgpr_write_b32 a126, v190
  v_accvgpr_write_b32 a127, v191
  v_mfma_f32_16x16x32_bf16 v[120:123], a[192:195], a[112:115], 0
  v_mfma_f32_16x16x32_bf16 v[120:123], a[196:199], a[116:119], v[120:123]
  v_mfma_f32_16x16x32_bf16 v[120:123], a[200:203], a[120:123], v[120:123]
  v_mfma_f32_16x16x32_bf16 v[120:123], a[204:207], a[124:127], v[120:123]
  s_nop 7
  v_max3_f32 v6, v120, v121, v122
  v_max_f32 v6, v6, v123
  v_mov_b32 v7, v6
  s_nop 1
  v_permlane32_swap_b32 v6, v7
  v_max_f32 v6, v6, v7
  v_mov_b32 v7, v6
  s_nop 1
  v_permlane16_swap_b32 v6, v7
  v_max_f32 v6, v6, v7
  v_sub_f32 v132, s81, v6
  v_sub_f32 v133, s81, v6
  v_sub_f32 v134, s81, v6
  v_sub_f32 v135, s81, v6
  v_add_f32 v120, v120, v132
  v_add_f32 v121, v121, v132
  v_mfma_f32_16x16x32_bf16 v[124:127], a[208:211], a[112:115], v[132:135]
  v_add_f32 v122, v122, v132
  v_add_f32 v123, v123, v132
  v_mfma_f32_16x16x32_bf16 v[124:127], a[212:215], a[116:119], v[124:127]
  v_exp_f32 v120, v120
  v_mfma_f32_16x16x32_bf16 v[124:127], a[216:219], a[120:123], v[124:127]
  v_exp_f32 v121, v121
  v_mfma_f32_16x16x32_bf16 v[124:127], a[220:223], a[124:127], v[124:127]
  v_exp_f32 v122, v122
  v_mfma_f32_16x16x32_bf16 v[152:155], v[80:83], a[112:115], v[132:135]
  v_exp_f32 v123, v123
  v_mfma_f32_16x16x32_bf16 v[152:155], v[84:87], a[116:119], v[152:155]
  v_cvt_pk_bf16_f32 v36, v120, v121
  v_cvt_pk_bf16_f32 v37, v122, v123
  v_mfma_f32_16x16x32_bf16 v[152:155], v[88:91], a[120:123], v[152:155]
  v_mfma_f32_16x16x32_bf16 v[152:155], v[92:95], a[124:127], v[152:155]
  v_exp_f32 v124, v124
  v_mfma_f32_16x16x32_bf16 v[156:159], v[96:99], a[112:115], v[132:135]
  v_exp_f32 v125, v125
  v_mfma_f32_16x16x32_bf16 v[156:159], v[100:103], a[116:119], v[156:159]
  v_exp_f32 v126, v126
  v_mfma_f32_16x16x32_bf16 v[156:159], v[104:107], a[120:123], v[156:159]
  v_exp_f32 v127, v127
  v_mfma_f32_16x16x32_bf16 v[156:159], v[108:111], a[124:127], v[156:159]
  v_cvt_pk_bf16_f32 v38, v124, v125
  v_cvt_pk_bf16_f32 v39, v126, v127
  s_waitcnt vmcnt(0)
  ds_read_b128 v[160:163], v8 offset:8192
  ds_read_b128 v[164:167], v9 offset:8192
  ds_read_b128 v[168:171], v10 offset:8192
  ds_read_b128 v[172:175], v11 offset:8192
  v_mfma_f32_32x32x16_bf16 a[16:31], a[240:243], a[248:251], 0
  s_add_u32 m0, s45, 12288
  s_nop 0
  buffer_load_dwordx4 v148, s[12:15], m0 offen offset:0 nt lds
  buffer_load_dwordx4 v149, s[12:15], m0 offen offset:1024 nt lds
  v_exp_f32 v152, v152
  v_mfma_f32_32x32x16_bf16 a[32:47], a[240:243], a[248:251], 0
  buffer_load_dwordx4 v150, s[12:15], m0 offen offset:2048 nt lds
  buffer_load_dwordx4 v151, s[12:15], m0 offen offset:3072 nt lds
  v_exp_f32 v153, v153
  v_exp_f32 v154, v154
  v_exp_f32 v155, v155
  v_cvt_pk_bf16_f32 v60, v152, v153
  v_cvt_pk_bf16_f32 v61, v154, v155
  v_exp_f32 v156, v156
  v_exp_f32 v157, v157
  v_exp_f32 v158, v158
  v_exp_f32 v159, v159
  v_cvt_pk_bf16_f32 v62, v156, v157
  v_cvt_pk_bf16_f32 v63, v158, v159
  s_waitcnt lgkmcnt(3)
  v_lshlrev_b32 v192, 16, v160
  v_and_b32 v193, s48, v160
  v_lshlrev_b32 v194, 16, v161
  v_and_b32 v195, s48, v161
  v_lshlrev_b32 v196, 16, v162
  v_and_b32 v197, s48, v162
  v_lshlrev_b32 v198, 16, v163
  v_and_b32 v199, s48, v163
  v_pk_mul_f32 v[192:193], v[192:193], s[46:47]
  v_pk_mul_f32 v[194:195], v[194:195], s[46:47]
  v_pk_mul_f32 v[196:197], v[196:197], s[46:47]
  v_pk_mul_f32 v[198:199], v[198:199], s[46:47]
  v_cvt_pk_bf16_f32 v160, v192, v193
  v_cvt_pk_bf16_f32 v161, v194, v195
  v_cvt_pk_bf16_f32 v162, v196, v197
  v_cvt_pk_bf16_f32 v163, v198, v199
  v_accvgpr_write_b32 a128, v160
  v_accvgpr_write_b32 a129, v161
  v_accvgpr_write_b32 a130, v162
  v_accvgpr_write_b32 a131, v163
  s_waitcnt lgkmcnt(2)
  v_lshlrev_b32 v200, 16, v164
  v_and_b32 v201, s48, v164
  v_mfma_f32_16x16x32_bf16 v[112:115], a[192:195], a[128:131], 0
  s_waitcnt lgkmcnt(0)
  s_add_u32 m0, s45, 16384
  s_nop 0
  buffer_load_dwordx4 v148, s[12:15], m0 offen offset:0 nt lds
  buffer_load_dwordx4 v149, s[12:15], m0 offen offset:1024 nt lds
  v_lshlrev_b32 v202, 16, v165
  v_and_b32 v203, s48, v165
  v_lshlrev_b32 v204, 16, v166
  v_and_b32 v205, s48, v166
  v_lshlrev_b32 v206, 16, v167
  v_and_b32 v207, s48, v167
  v_pk_mul_f32 v[200:201], v[200:201], s[46:47]
  v_pk_mul_f32 v[202:203], v[202:203], s[46:47]
  v_pk_mul_f32 v[204:205], v[204:205], s[46:47]
  v_pk_mul_f32 v[206:207], v[206:207], s[46:47]
  v_cvt_pk_bf16_f32 v164, v200, v201
  v_cvt_pk_bf16_f32 v165, v202, v203
  v_cvt_pk_bf16_f32 v166, v204, v205
  v_cvt_pk_bf16_f32 v167, v206, v207
  v_accvgpr_write_b32 a132, v164
  v_accvgpr_write_b32 a133, v165
  v_accvgpr_write_b32 a134, v166
  v_accvgpr_write_b32 a135, v167
  v_lshlrev_b32 v192, 16, v168
  v_and_b32 v193, s48, v168
  v_mfma_f32_16x16x32_bf16 v[112:115], a[196:199], a[132:135], v[112:115]
  buffer_load_dwordx4 v150, s[12:15], m0 offen offset:2048 nt lds
  buffer_load_dwordx4 v151, s[12:15], m0 offen offset:3072 nt lds
  v_lshlrev_b32 v194, 16, v169
  v_and_b32 v195, s48, v169
  v_lshlrev_b32 v196, 16, v170
  v_and_b32 v197, s48, v170
  v_lshlrev_b32 v198, 16, v171
  v_and_b32 v199, s48, v171
  v_pk_mul_f32 v[192:193], v[192:193], s[46:47]
  v_pk_mul_f32 v[194:195], v[194:195], s[46:47]
  v_pk_mul_f32 v[196:197], v[196:197], s[46:47]
  v_pk_mul_f32 v[198:199], v[198:199], s[46:47]
  v_cvt_pk_bf16_f32 v168, v192, v193
  v_cvt_pk_bf16_f32 v169, v194, v195
  v_cvt_pk_bf16_f32 v170, v196, v197
  v_cvt_pk_bf16_f32 v171, v198, v199
  v_accvgpr_write_b32 a136, v168
  v_accvgpr_write_b32 a137, v169
  v_accvgpr_write_b32 a138, v170
  v_accvgpr_write_b32 a139, v171
  v_lshlrev_b32 v200, 16, v172
  v_and_b32 v201, s48, v172
  v_lshlrev_b32 v202, 16, v173
  v_and_b32 v203, s48, v173
  v_lshlrev_b32 v204, 16, v174
  v_and_b32 v205, s48, v174
  v_lshlrev_b32 v206, 16, v175
  v_and_b32 v207, s48, v175
  v_pk_mul_f32 v[200:201], v[200:201], s[46:47]
  v_pk_mul_f32 v[202:203], v[202:203], s[46:47]
  v_pk_mul_f32 v[204:205], v[204:205], s[46:47]
  v_pk_mul_f32 v[206:207], v[206:207], s[46:47]
  v_cvt_pk_bf16_f32 v172, v200, v201
  v_cvt_pk_bf16_f32 v173, v202, v203
  v_cvt_pk_bf16_f32 v174, v204, v205
  v_cvt_pk_bf16_f32 v175, v206, v207
  v_accvgpr_write_b32 a140, v172
  v_accvgpr_write_b32 a141, v173
  v_accvgpr_write_b32 a142, v174
  v_accvgpr_write_b32 a143, v175
  v_mfma_f32_16x16x32_bf16 v[112:115], a[200:203], a[136:139], v[112:115]
  s_nop 0
  v_mfma_f32_16x16x32_bf16 v[112:115], a[204:207], a[140:143], v[112:115]
  s_nop 7
  v_max3_f32 v18, v112, v113, v114
  v_max_f32 v18, v18, v115
  v_mov_b32 v19, v18
  s_nop 1
  v_permlane32_swap_b32 v18, v19
  v_max_f32 v18, v18, v19
  v_mov_b32 v19, v18
  s_nop 1
  v_permlane16_swap_b32 v18, v19
  v_max_f32 v18, v18, v19
  v_sub_f32 v136, s81, v18
  v_sub_f32 v137, s81, v18
  v_sub_f32 v138, s81, v18
  v_sub_f32 v139, s81, v18
  v_add_f32 v112, v112, v136
  v_add_f32 v113, v113, v136
  v_mfma_f32_16x16x32_bf16 v[116:119], a[208:211], a[128:131], v[136:139]
  v_add_f32 v114, v114, v136
  v_add_f32 v115, v115, v136
  v_mfma_f32_16x16x32_bf16 v[116:119], a[212:215], a[132:135], v[116:119]
  v_exp_f32 v112, v112
  v_mfma_f32_16x16x32_bf16 v[116:119], a[216:219], a[136:139], v[116:119]
  v_exp_f32 v113, v113
  v_mfma_f32_16x16x32_bf16 v[116:119], a[220:223], a[140:143], v[116:119]
  v_exp_f32 v114, v114
  v_mfma_f32_16x16x32_bf16 v[120:123], v[80:83], a[128:131], v[136:139]
  v_exp_f32 v115, v115
  v_mfma_f32_16x16x32_bf16 v[120:123], v[84:87], a[132:135], v[120:123]
  v_cvt_pk_bf16_f32 v40, v112, v113
  v_cvt_pk_bf16_f32 v41, v114, v115
  v_mfma_f32_16x16x32_bf16 v[120:123], v[88:91], a[136:139], v[120:123]
  v_mfma_f32_16x16x32_bf16 v[120:123], v[92:95], a[140:143], v[120:123]
  v_exp_f32 v116, v116
  v_mfma_f32_16x16x32_bf16 v[124:127], v[96:99], a[128:131], v[136:139]
  v_exp_f32 v117, v117
  v_mfma_f32_16x16x32_bf16 v[124:127], v[100:103], a[132:135], v[124:127]
  v_exp_f32 v118, v118
  v_mfma_f32_16x16x32_bf16 v[124:127], v[104:107], a[136:139], v[124:127]
  v_exp_f32 v119, v119
  v_mfma_f32_16x16x32_bf16 v[124:127], v[108:111], a[140:143], v[124:127]
  v_cvt_pk_bf16_f32 v42, v116, v117
  v_cvt_pk_bf16_f32 v43, v118, v119
  s_waitcnt vmcnt(4)
  ds_read_b128 v[176:179], v8 offset:12288
  ds_read_b128 v[180:183], v9 offset:12288
  ds_read_b128 v[184:187], v10 offset:12288
  ds_read_b128 v[188:191], v11 offset:12288
  s_xor_b32 s28, s29, 0x4000
  s_add_u32 m0, s64, 111104
  s_nop 0
  buffer_load_dwordx4 v1, s[4:7], s28 offen offset:0 nt lds
  s_add_u32 m0, s64, 111136
  s_nop 0
  buffer_load_dwordx4 v1, s[4:7], s28 offen offset:1024 nt lds
  s_add_u32 m0, s64, 128000
  s_nop 0
  buffer_load_dwordx4 v1, s[8:11], s29 offen offset:0 nt lds
  s_add_u32 m0, s64, 128008
  s_nop 0
  buffer_load_dwordx4 v1, s[8:11], s29 offen offset:1024 nt lds
  s_xor_b32 s28, s66, 8192
  s_mov_b32 m0, 136448
  s_nop 0
  buffer_load_dwordx4 v1, s[8:11], s28 offen offset:0 nt lds
  s_mov_b32 m0, 136456
  s_nop 0
  buffer_load_dwordx4 v1, s[8:11], s28 offen offset:1024 nt lds
  s_mov_b32 m0, 136512
  s_nop 0
  buffer_load_dwordx4 v1, s[8:11], s28 offen offset:2048 nt lds
  s_mov_b32 m0, 136520
  s_nop 0
  buffer_load_dwordx4 v1, s[8:11], s28 offen offset:3072 nt lds
  s_mov_b32 m0, 140672
  s_nop 0
  buffer_load_dwordx4 v72, s[8:11], s28 offen offset:0 nt lds
  s_mov_b32 m0, 140680
  s_nop 0
  buffer_load_dwordx4 v72, s[8:11], s28 offen offset:1024 nt lds
  s_mov_b32 m0, 140736
  s_nop 0
  buffer_load_dwordx4 v72, s[8:11], s28 offen offset:2048 nt lds
  s_mov_b32 m0, 140744
  s_nop 0
  buffer_load_dwordx4 v72, s[8:11], s28 offen offset:3072 nt lds
  v_exp_f32 v120, v120
  v_exp_f32 v121, v121
  v_exp_f32 v122, v122
  v_exp_f32 v123, v123
  v_cvt_pk_bf16_f32 v64, v120, v121
  v_cvt_pk_bf16_f32 v65, v122, v123
  v_exp_f32 v124, v124
  v_exp_f32 v125, v125
  v_exp_f32 v126, v126
  v_exp_f32 v127, v127
  v_cvt_pk_bf16_f32 v66, v124, v125
  v_cvt_pk_bf16_f32 v67, v126, v127
  s_waitcnt lgkmcnt(3)
  v_lshlrev_b32 v192, 16, v176
  v_and_b32 v193, s48, v176
  v_lshlrev_b32 v194, 16, v177
  v_and_b32 v195, s48, v177
  v_lshlrev_b32 v196, 16, v178
  v_and_b32 v197, s48, v178
  v_lshlrev_b32 v198, 16, v179
  v_and_b32 v199, s48, v179
  v_pk_mul_f32 v[192:193], v[192:193], s[46:47]
  v_pk_mul_f32 v[194:195], v[194:195], s[46:47]
  v_pk_mul_f32 v[196:197], v[196:197], s[46:47]
  v_pk_mul_f32 v[198:199], v[198:199], s[46:47]
  v_cvt_pk_bf16_f32 v176, v192, v193
  v_cvt_pk_bf16_f32 v177, v194, v195
  v_cvt_pk_bf16_f32 v178, v196, v197
  v_cvt_pk_bf16_f32 v179, v198, v199
  v_accvgpr_write_b32 a144, v176
  v_accvgpr_write_b32 a145, v177
  v_accvgpr_write_b32 a146, v178
  v_accvgpr_write_b32 a147, v179
  v_mfma_f32_32x32x16_bf16 a[48:63], a[240:243], a[248:251], 0
  s_waitcnt lgkmcnt(0)
  v_lshlrev_b32 v200, 16, v180
  v_and_b32 v201, s48, v180
  v_lshlrev_b32 v202, 16, v181
  v_and_b32 v203, s48, v181
  v_lshlrev_b32 v204, 16, v182
  v_and_b32 v205, s48, v182
  v_mfma_f32_16x16x32_bf16 v[152:155], a[192:195], a[144:147], 0
  v_lshlrev_b32 v206, 16, v183
  v_and_b32 v207, s48, v183
  v_lshlrev_b32 v192, 16, v184
  v_and_b32 v193, s48, v184
  v_lshlrev_b32 v194, 16, v185
  v_pk_mul_f32 v[200:201], v[200:201], s[46:47]
  v_pk_mul_f32 v[202:203], v[202:203], s[46:47]
  v_pk_mul_f32 v[204:205], v[204:205], s[46:47]
  v_pk_mul_f32 v[206:207], v[206:207], s[46:47]
  v_cvt_pk_bf16_f32 v180, v200, v201
  v_cvt_pk_bf16_f32 v181, v202, v203
  v_cvt_pk_bf16_f32 v182, v204, v205
  v_cvt_pk_bf16_f32 v183, v206, v207
  v_accvgpr_write_b32 a148, v180
  v_accvgpr_write_b32 a149, v181
  v_accvgpr_write_b32 a150, v182
  v_accvgpr_write_b32 a151, v183
  v_and_b32 v195, s48, v185
  v_lshlrev_b32 v196, 16, v186
  v_mfma_f32_16x16x32_bf16 v[152:155], a[196:199], a[148:151], v[152:155]
  v_and_b32 v197, s48, v186
  v_lshlrev_b32 v198, 16, v187
  v_and_b32 v199, s48, v187
  v_lshlrev_b32 v200, 16, v188
  v_and_b32 v201, s48, v188
  v_pk_mul_f32 v[192:193], v[192:193], s[46:47]
  v_pk_mul_f32 v[194:195], v[194:195], s[46:47]
  v_pk_mul_f32 v[196:197], v[196:197], s[46:47]
  v_pk_mul_f32 v[198:199], v[198:199], s[46:47]
  v_cvt_pk_bf16_f32 v184, v192, v193
  v_cvt_pk_bf16_f32 v185, v194, v195
  v_cvt_pk_bf16_f32 v186, v196, v197
  v_cvt_pk_bf16_f32 v187, v198, v199
  v_accvgpr_write_b32 a152, v184
  v_accvgpr_write_b32 a153, v185
  v_accvgpr_write_b32 a154, v186
  v_accvgpr_write_b32 a155, v187
  v_lshlrev_b32 v202, 16, v189
  v_and_b32 v203, s48, v189
  v_mfma_f32_16x16x32_bf16 v[152:155], a[200:203], a[152:155], v[152:155]
  v_lshlrev_b32 v204, 16, v190
  v_and_b32 v205, s48, v190
  v_lshlrev_b32 v206, 16, v191
  v_and_b32 v207, s48, v191
  v_pk_mul_f32 v[200:201], v[200:201], s[46:47]
  v_pk_mul_f32 v[202:203], v[202:203], s[46:47]
  v_pk_mul_f32 v[204:205], v[204:205], s[46:47]
  v_pk_mul_f32 v[206:207], v[206:207], s[46:47]
  v_cvt_pk_bf16_f32 v188, v200, v201
  v_cvt_pk_bf16_f32 v189, v202, v203
  v_cvt_pk_bf16_f32 v190, v204, v205
  v_cvt_pk_bf16_f32 v191, v206, v207
  v_accvgpr_write_b32 a156, v188
  v_accvgpr_write_b32 a157, v189
  v_accvgpr_write_b32 a158, v190
  v_accvgpr_write_b32 a159, v191
  s_nop 1
  v_mfma_f32_16x16x32_bf16 v[152:155], a[204:207], a[156:159], v[152:155]
  s_nop 7
  v_max3_f32 v6, v152, v153, v154
  v_max_f32 v6, v6, v155
  v_mov_b32 v7, v6
  s_nop 1
  v_permlane32_swap_b32 v6, v7
  v_max_f32 v6, v6, v7
  v_mov_b32 v7, v6
  s_nop 1
  v_permlane16_swap_b32 v6, v7
  v_max_f32 v6, v6, v7
  v_sub_f32 v140, s81, v6
  v_sub_f32 v141, s81, v6
  v_sub_f32 v142, s81, v6
  v_sub_f32 v143, s81, v6
  v_add_f32 v152, v152, v140
  v_add_f32 v153, v153, v140
  v_mfma_f32_16x16x32_bf16 v[156:159], a[208:211], a[144:147], v[140:143]
  v_add_f32 v154, v154, v140
  v_add_f32 v155, v155, v140
  v_mfma_f32_16x16x32_bf16 v[156:159], a[212:215], a[148:151], v[156:159]
  v_exp_f32 v152, v152
  v_mfma_f32_16x16x32_bf16 v[156:159], a[216:219], a[152:155], v[156:159]
  v_exp_f32 v153, v153
  v_mfma_f32_16x16x32_bf16 v[156:159], a[220:223], a[156:159], v[156:159]
  v_exp_f32 v154, v154
  v_mfma_f32_16x16x32_bf16 v[112:115], v[80:83], a[144:147], v[140:143]
  v_exp_f32 v155, v155
  v_mfma_f32_16x16x32_bf16 v[112:115], v[84:87], a[148:151], v[112:115]
  v_cvt_pk_bf16_f32 v44, v152, v153
  v_cvt_pk_bf16_f32 v45, v154, v155
  v_mfma_f32_16x16x32_bf16 v[112:115], v[88:91], a[152:155], v[112:115]
  v_mfma_f32_16x16x32_bf16 v[112:115], v[92:95], a[156:159], v[112:115]
  v_exp_f32 v156, v156
  v_mfma_f32_16x16x32_bf16 v[116:119], v[96:99], a[144:147], v[140:143]
  v_exp_f32 v157, v157
  v_mfma_f32_16x16x32_bf16 v[116:119], v[100:103], a[148:151], v[116:119]
  v_exp_f32 v158, v158
  v_mfma_f32_16x16x32_bf16 v[116:119], v[104:107], a[152:155], v[116:119]
  v_exp_f32 v159, v159
  v_mfma_f32_16x16x32_bf16 v[116:119], v[108:111], a[156:159], v[116:119]
  v_cvt_pk_bf16_f32 v46, v156, v157
  v_cvt_pk_bf16_f32 v47, v158, v159
  s_waitcnt vmcnt(12)
  ds_read_b128 v[160:163], v8 offset:16384
  ds_read_b128 v[164:167], v9 offset:16384
  ds_read_b128 v[168:171], v10 offset:16384
  ds_read_b128 v[172:175], v11 offset:16384
  v_exp_f32 v112, v112
  v_exp_f32 v113, v113
  v_exp_f32 v114, v114
  v_exp_f32 v115, v115
  v_cvt_pk_bf16_f32 v68, v112, v113
  v_cvt_pk_bf16_f32 v69, v114, v115
  v_exp_f32 v116, v116
  v_exp_f32 v117, v117
  v_exp_f32 v118, v118
  v_exp_f32 v119, v119
  v_cvt_pk_bf16_f32 v70, v116, v117
  v_cvt_pk_bf16_f32 v71, v118, v119
  v_mfma_f32_32x32x16_bf16 v[176:191], a[240:243], a[248:251], 0
  s_xor_b32 s28, s66, 24576
  s_waitcnt lgkmcnt(3)
  v_lshlrev_b32 v192, 16, v160
  v_and_b32 v193, s48, v160
  v_lshlrev_b32 v194, 16, v161
  v_and_b32 v195, s48, v161
  v_lshlrev_b32 v196, 16, v162
  v_and_b32 v197, s48, v162
  v_lshlrev_b32 v198, 16, v163
  v_and_b32 v199, s48, v163
  v_pk_mul_f32 v[192:193], v[192:193], s[46:47]
  v_pk_mul_f32 v[194:195], v[194:195], s[46:47]
  v_pk_mul_f32 v[196:197], v[196:197], s[46:47]
  v_pk_mul_f32 v[198:199], v[198:199], s[46:47]
  v_cvt_pk_bf16_f32 v160, v192, v193
  v_cvt_pk_bf16_f32 v161, v194, v195
  v_cvt_pk_bf16_f32 v162, v196, v197
  v_cvt_pk_bf16_f32 v163, v198, v199
  v_accvgpr_write_b32 a160, v160
  v_accvgpr_write_b32 a161, v161
  v_accvgpr_write_b32 a162, v162
  v_accvgpr_write_b32 a163, v163
  s_waitcnt lgkmcnt(2)
  v_lshlrev_b32 v200, 16, v164
  v_and_b32 v201, s48, v164
  v_mfma_f32_16x16x32_bf16 v[120:123], a[192:195], a[160:163], 0
  s_waitcnt lgkmcnt(0)
  v_lshlrev_b32 v202, 16, v165
  v_and_b32 v203, s48, v165
  v_lshlrev_b32 v204, 16, v166
  v_and_b32 v205, s48, v166
  v_lshlrev_b32 v206, 16, v167
  v_and_b32 v207, s48, v167
  v_pk_mul_f32 v[200:201], v[200:201], s[46:47]
  v_pk_mul_f32 v[202:203], v[202:203], s[46:47]
  v_pk_mul_f32 v[204:205], v[204:205], s[46:47]
  v_pk_mul_f32 v[206:207], v[206:207], s[46:47]
  v_cvt_pk_bf16_f32 v164, v200, v201
  v_cvt_pk_bf16_f32 v165, v202, v203
  v_cvt_pk_bf16_f32 v166, v204, v205
  v_cvt_pk_bf16_f32 v167, v206, v207
  v_accvgpr_write_b32 a164, v164
  v_accvgpr_write_b32 a165, v165
  v_accvgpr_write_b32 a166, v166
  v_accvgpr_write_b32 a167, v167
  v_lshlrev_b32 v192, 16, v168
  v_and_b32 v193, s48, v168
  v_mfma_f32_16x16x32_bf16 v[120:123], a[196:199], a[164:167], v[120:123]
  v_lshlrev_b32 v194, 16, v169
  v_and_b32 v195, s48, v169
  v_lshlrev_b32 v196, 16, v170
  v_and_b32 v197, s48, v170
  v_lshlrev_b32 v198, 16, v171
  v_and_b32 v199, s48, v171
  v_pk_mul_f32 v[192:193], v[192:193], s[46:47]
  v_pk_mul_f32 v[194:195], v[194:195], s[46:47]
  v_pk_mul_f32 v[196:197], v[196:197], s[46:47]
  v_pk_mul_f32 v[198:199], v[198:199], s[46:47]
  v_cvt_pk_bf16_f32 v168, v192, v193
  v_cvt_pk_bf16_f32 v169, v194, v195
  v_cvt_pk_bf16_f32 v170, v196, v197
  v_cvt_pk_bf16_f32 v171, v198, v199
  v_accvgpr_write_b32 a168, v168
  v_accvgpr_write_b32 a169, v169
  v_accvgpr_write_b32 a170, v170
  v_accvgpr_write_b32 a171, v171
  v_lshlrev_b32 v200, 16, v172
  v_and_b32 v201, s48, v172
  v_mfma_f32_16x16x32_bf16 v[120:123], a[200:203], a[168:171], v[120:123]
  v_lshlrev_b32 v202, 16, v173
  v_and_b32 v203, s48, v173
  v_lshlrev_b32 v204, 16, v174
  v_and_b32 v205, s48, v174
  v_lshlrev_b32 v206, 16, v175
  v_and_b32 v207, s48, v175
  v_pk_mul_f32 v[200:201], v[200:201], s[46:47]
  v_pk_mul_f32 v[202:203], v[202:203], s[46:47]
  v_pk_mul_f32 v[204:205], v[204:205], s[46:47]
  v_pk_mul_f32 v[206:207], v[206:207], s[46:47]
  v_cvt_pk_bf16_f32 v172, v200, v201
  v_cvt_pk_bf16_f32 v173, v202, v203
  v_cvt_pk_bf16_f32 v174, v204, v205
  v_cvt_pk_bf16_f32 v175, v206, v207
  v_accvgpr_write_b32 a172, v172
  v_accvgpr_write_b32 a173, v173
  v_accvgpr_write_b32 a174, v174
  v_accvgpr_write_b32 a175, v175
  v_mfma_f32_32x32x16_bf16 v[160:175], a[240:243], a[248:251], 0
  v_mfma_f32_32x32x16_bf16 v[192:207], a[240:243], a[248:251], 0
  v_mfma_f32_16x16x32_bf16 v[120:123], a[204:207], a[172:175], v[120:123]
  s_waitcnt vmcnt(0)
  s_barrier
  ds_read_b128 a[192:195], v2 offset:16896
  ds_read_b128 a[196:199], v2 offset:16960
  ds_read_b128 a[200:203], v2 offset:17024
  ds_read_b128 a[204:207], v2 offset:17088
  ds_read_b64_tr_b16 a[224:225], v3 offset:0
  ds_read_b64_tr_b16 a[226:227], v3 offset:256
  ds_read_b64_tr_b16 a[228:229], v3 offset:8448
  v_max3_f32 v18, v120, v121, v122
  v_max_f32 v18, v18, v123
  v_mov_b32 v19, v18
  ds_read_b64_tr_b16 a[230:231], v3 offset:8704
  ds_read_b64_tr_b16 a[236:237], v3 offset:8456
  v_permlane32_swap_b32 v18, v19
  v_max_f32 v18, v18, v19
  v_mov_b32 v19, v18
  s_mov_b32 m0, 119552
  s_nop 0
  buffer_load_dwordx4 v1, s[4:7], s28 offen offset:0 nt lds
  v_permlane16_swap_b32 v18, v19
  v_max_f32 v18, v18, v19
  v_sub_f32 v144, s81, v18
  v_sub_f32 v145, s81, v18
  v_sub_f32 v146, s81, v18
  v_sub_f32 v147, s81, v18
  v_add_f32 v120, v120, v144
  v_add_f32 v121, v121, v144
  v_mfma_f32_16x16x32_bf16 v[124:127], a[208:211], a[160:163], v[144:147]
  s_mov_b32 m0, 119584
  s_nop 0
  buffer_load_dwordx4 v1, s[4:7], s28 offen offset:1024 nt lds
  s_mov_b32 m0, 119616
  s_nop 0
  buffer_load_dwordx4 v1, s[4:7], s28 offen offset:2048 nt lds
  v_mfma_f32_16x16x32_bf16 v[124:127], a[212:215], a[164:167], v[124:127]
  s_mov_b32 m0, 119648
  s_nop 0
  buffer_load_dwordx4 v1, s[4:7], s28 offen offset:3072 nt lds
  s_mov_b32 m0, 123776
  s_nop 0
  buffer_load_dwordx4 v72, s[4:7], s28 offen offset:0 nt lds
  v_mfma_f32_16x16x32_bf16 v[124:127], a[216:219], a[168:171], v[124:127]
  s_mov_b32 m0, 123808
  s_nop 0
  buffer_load_dwordx4 v72, s[4:7], s28 offen offset:1024 nt lds
  s_mov_b32 m0, 123840
  s_nop 0
  buffer_load_dwordx4 v72, s[4:7], s28 offen offset:2048 nt lds
  v_mfma_f32_16x16x32_bf16 v[124:127], a[220:223], a[172:175], v[124:127]
  s_mov_b32 m0, 123872
  s_nop 0
  buffer_load_dwordx4 v72, s[4:7], s28 offen offset:3072 nt lds
  v_mfma_f32_16x16x32_bf16 v[152:155], v[80:83], a[160:163], v[144:147]
  s_xor_b32 s28, s66, 16384
  s_mov_b32 m0, 144896
  s_nop 0
  buffer_load_dwordx4 v1, s[8:11], s28 offen offset:0 nt lds
  s_mov_b32 m0, 144904
  s_nop 0
  buffer_load_dwordx4 v1, s[8:11], s28 offen offset:1024 nt lds
  v_mfma_f32_16x16x32_bf16 v[152:155], v[84:87], a[164:167], v[152:155]
  s_mov_b32 m0, 144960
  s_nop 0
  buffer_load_dwordx4 v1, s[8:11], s28 offen offset:2048 nt lds
  s_mov_b32 m0, 144968
  s_nop 0
  buffer_load_dwordx4 v1, s[8:11], s28 offen offset:3072 nt lds
  v_mfma_f32_16x16x32_bf16 v[152:155], v[88:91], a[168:171], v[152:155]
  s_mov_b32 m0, 149120
  s_nop 0
  buffer_load_dwordx4 v72, s[8:11], s28 offen offset:0 nt lds
  s_mov_b32 m0, 149128
  s_nop 0
  buffer_load_dwordx4 v72, s[8:11], s28 offen offset:1024 nt lds
  v_mfma_f32_16x16x32_bf16 v[152:155], v[92:95], a[172:175], v[152:155]
  s_mov_b32 m0, 149184
  s_nop 0
  buffer_load_dwordx4 v72, s[8:11], s28 offen offset:2048 nt lds
  s_mov_b32 m0, 149192
  s_nop 0
  buffer_load_dwordx4 v72, s[8:11], s28 offen offset:3072 nt lds
  v_mfma_f32_16x16x32_bf16 v[156:159], v[96:99], a[160:163], v[144:147]
  s_xor_b32 s28, s66, 32768
  s_mov_b32 m0, 161792
  s_nop 0
  buffer_load_dwordx4 v1, s[12:15], s62 offen lds
  buffer_load_dwordx4 v1, s[12:15], s62 offen lds
  v_mfma_f32_16x16x32_bf16 v[156:159], v[100:103], a[164:167], v[156:159]
  buffer_load_dwordx4 v1, s[12:15], s62 offen lds
  buffer_load_dwordx4 v1, s[12:15], s62 offen lds
  v_mfma_f32_16x16x32_bf16 v[156:159], v[104:107], a[168:171], v[156:159]
  s_mov_b32 m0, 94208
  s_nop 0
  buffer_load_dwordx4 v1, s[4:7], s28 offen offset:0 nt lds
  s_mov_b32 m0, 94240
  s_nop 0
  buffer_load_dwordx4 v1, s[4:7], s28 offen offset:1024 nt lds
  v_mfma_f32_16x16x32_bf16 v[156:159], v[108:111], a[172:175], v[156:159]
  s_mov_b32 m0, 94272
  s_nop 0
  buffer_load_dwordx4 v1, s[4:7], s28 offen offset:2048 nt lds
  s_mov_b32 m0, 94304
  s_nop 0
  buffer_load_dwordx4 v1, s[4:7], s28 offen offset:3072 nt lds
  v_add_f32 v122, v122, v144
  v_add_f32 v123, v123, v144
  v_exp_f32 v120, v120
  v_exp_f32 v121, v121
  v_exp_f32 v122, v122
  v_exp_f32 v123, v123
  v_cvt_pk_bf16_f32 v48, v120, v121
  v_cvt_pk_bf16_f32 v49, v122, v123
  v_exp_f32 v124, v124
  v_exp_f32 v125, v125
  v_exp_f32 v126, v126
  v_exp_f32 v127, v127
  v_cvt_pk_bf16_f32 v50, v124, v125
  v_cvt_pk_bf16_f32 v51, v126, v127
  v_exp_f32 v152, v152
  v_exp_f32 v153, v153
  v_exp_f32 v154, v154
  v_exp_f32 v155, v155
  v_cvt_pk_bf16_f32 v52, v152, v153
  v_cvt_pk_bf16_f32 v53, v154, v155
  s_mov_b32 m0, 98432
  s_nop 0
  buffer_load_dwordx4 v72, s[4:7], s28 offen offset:0 nt lds
  s_mov_b32 m0, 98464
  s_nop 0
  buffer_load_dwordx4 v72, s[4:7], s28 offen offset:1024 nt lds
  s_mov_b32 m0, 98496
  s_nop 0
  buffer_load_dwordx4 v72, s[4:7], s28 offen offset:2048 nt lds
  s_mov_b32 m0, 98528
  s_nop 0
  buffer_load_dwordx4 v72, s[4:7], s28 offen offset:3072 nt lds
  s_xor_b32 s28, s66, 24576
  s_mov_b32 m0, 153344
  s_nop 0
  buffer_load_dwordx4 v1, s[8:11], s28 offen offset:0 nt lds
  s_mov_b32 m0, 153352
  s_nop 0
  buffer_load_dwordx4 v1, s[8:11], s28 offen offset:1024 nt lds
  s_mov_b32 m0, 153408
  s_nop 0
  buffer_load_dwordx4 v1, s[8:11], s28 offen offset:2048 nt lds
  s_mov_b32 m0, 153416
  s_nop 0
  buffer_load_dwordx4 v1, s[8:11], s28 offen offset:3072 nt lds
  s_mov_b32 m0, 157568
  s_nop 0
  buffer_load_dwordx4 v72, s[8:11], s28 offen offset:0 nt lds
  s_mov_b32 m0, 157576
  s_nop 0
  buffer_load_dwordx4 v72, s[8:11], s28 offen offset:1024 nt lds
  s_mov_b32 m0, 157632
  s_nop 0
  buffer_load_dwordx4 v72, s[8:11], s28 offen offset:2048 nt lds
  s_mov_b32 m0, 157640
  s_nop 0
  buffer_load_dwordx4 v72, s[8:11], s28 offen offset:3072 nt lds
  s_mov_b32 m0, 161792
  s_nop 0
  buffer_load_dwordx4 v1, s[12:15], s62 offen lds
  buffer_load_dwordx4 v1, s[12:15], s62 offen lds
  buffer_load_dwordx4 v1, s[12:15], s62 offen lds
  buffer_load_dwordx4 v1, s[12:15], s62 offen lds
  s_waitcnt lgkmcnt(0)
  s_branch ENTRY0_5
DONE:
  s_or_b64 s[68:69], s[40:41], s[42:43]
  s_cbranch_scc0 EXIT2
  s_waitcnt vmcnt(0) lgkmcnt(0)
  s_sub_u32 s79, s45, 94208
  v_add_u32 v164, s79, v2
  s_sub_u32 s79, s45, 119552
  v_add_u32 v165, s79, v3
  v_and_b32 v166, 15, v0
  v_lshlrev_b32 v166, 8, v166
  v_and_b32 v168, 48, v0
  v_add_u32 v166, v166, v168
  v_mov_b32 v168, 0x3f803f80
  v_mov_b32 v169, 0x3f803f80
  v_mov_b32 v170, 0x3f803f80
  v_mov_b32 v171, 0x3f803f80
  s_mov_b32 s76, 0
SL_HEAD:
  s_cmp_eq_u64 s[40:41], 0
  s_cbranch_scc1 SL_NEXTH
  s_mov_b32 s77, 0
SL_TILE:
  s_mul_i32 s63, s76, 94208
  s_lshl_b32 s79, s77, 12
  s_add_u32 s63, s63, s79
  s_add_u32 s63, s63, s45
  buffer_load_dwordx4 v[16:19], v166, s[12:15], s63 offen offset:0
  buffer_load_dwordx4 v[20:23], v166, s[12:15], s63 offen offset:64
  buffer_load_dwordx4 v[24:27], v166, s[12:15], s63 offen offset:128
  buffer_load_dwordx4 v[28:31], v166, s[12:15], s63 offen offset:192
  s_waitcnt vmcnt(3)
  v_lshlrev_b32 v80, 16, v16
  v_and_b32 v81, s48, v16
  v_pk_mul_f32 v[80:81], v[80:81], s[46:47]
  v_cvt_pk_bf16_f32 v16, v80, v81
  v_lshlrev_b32 v80, 16, v17
  v_and_b32 v81, s48, v17
  v_pk_mul_f32 v[80:81], v[80:81], s[46:47]
  v_cvt_pk_bf16_f32 v17, v80, v81
  v_lshlrev_b32 v80, 16, v18
  v_and_b32 v81, s48, v18
  v_pk_mul_f32 v[80:81], v[80:81], s[46:47]
  v_cvt_pk_bf16_f32 v18, v80, v81
  v_lshlrev_b32 v80, 16, v19
  v_and_b32 v81, s48, v19
  v_pk_mul_f32 v[80:81], v[80:81], s[46:47]
  v_cvt_pk_bf16_f32 v19, v80, v81
  s_waitcnt vmcnt(2)
  v_lshlrev_b32 v80, 16, v20
  v_and_b32 v81, s48, v20
  v_pk_mul_f32 v[80:81], v[80:81], s[46:47]
  v_cvt_pk_bf16_f32 v20, v80, v81
  v_lshlrev_b32 v80, 16, v21
  v_and_b32 v81, s48, v21
  v_pk_mul_f32 v[80:81], v[80:81], s[46:47]
  v_cvt_pk_bf16_f32 v21, v80, v81
  v_lshlrev_b32 v80, 16, v22
  v_and_b32 v81, s48, v22
  v_pk_mul_f32 v[80:81], v[80:81], s[46:47]
  v_cvt_pk_bf16_f32 v22, v80, v81
  v_lshlrev_b32 v80, 16, v23
  v_and_b32 v81, s48, v23
  v_pk_mul_f32 v[80:81], v[80:81], s[46:47]
  v_cvt_pk_bf16_f32 v23, v80, v81
  s_waitcnt vmcnt(1)
  v_lshlrev_b32 v80, 16, v24
  v_and_b32 v81, s48, v24
  v_pk_mul_f32 v[80:81], v[80:81], s[46:47]
  v_cvt_pk_bf16_f32 v24, v80, v81
  v_lshlrev_b32 v80, 16, v25
  v_and_b32 v81, s48, v25
  v_pk_mul_f32 v[80:81], v[80:81], s[46:47]
  v_cvt_pk_bf16_f32 v25, v80, v81
  v_lshlrev_b32 v80, 16, v26
  v_and_b32 v81, s48, v26
  v_pk_mul_f32 v[80:81], v[80:81], s[46:47]
  v_cvt_pk_bf16_f32 v26, v80, v81
  v_lshlrev_b32 v80, 16, v27
  v_and_b32 v81, s48, v27
  v_pk_mul_f32 v[80:81], v[80:81], s[46:47]
  v_cvt_pk_bf16_f32 v27, v80, v81
  s_waitcnt vmcnt(0)
  v_lshlrev_b32 v80, 16, v28
  v_and_b32 v81, s48, v28
  v_pk_mul_f32 v[80:81], v[80:81], s[46:47]
  v_cvt_pk_bf16_f32 v28, v80, v81
  v_lshlrev_b32 v80, 16, v29
  v_and_b32 v81, s48, v29
  v_pk_mul_f32 v[80:81], v[80:81], s[46:47]
  v_cvt_pk_bf16_f32 v29, v80, v81
  v_lshlrev_b32 v80, 16, v30
  v_and_b32 v81, s48, v30
  v_pk_mul_f32 v[80:81], v[80:81], s[46:47]
  v_cvt_pk_bf16_f32 v30, v80, v81
  v_lshlrev_b32 v80, 16, v31
  v_and_b32 v81, s48, v31
  v_pk_mul_f32 v[80:81], v[80:81], s[46:47]
  v_cvt_pk_bf16_f32 v31, v80, v81
  v_mov_b32 v80, 0xff800000
  s_lshl_b32 s79, s76, 18
  s_mov_b32 s78, 32
SL_P1:
  s_add_u32 m0, s45, 0
  s_add_u32 s80, s79, 0
  buffer_load_dwordx4 v1, s[4:7], s80 offen lds
  s_add_u32 m0, s45, 1056
  s_add_u32 s80, s79, 1024
  buffer_load_dwordx4 v1, s[4:7], s80 offen lds
  s_add_u32 m0, s45, 2112
  s_add_u32 s80, s79, 2048
  buffer_load_dwordx4 v1, s[4:7], s80 offen lds
  s_add_u32 m0, s45, 3168
  s_add_u32 s80, s79, 3072
  buffer_load_dwordx4 v1, s[4:7], s80 offen lds
  s_add_u32 m0, s45, 4224
  s_add_u32 s80, s79, 4096
  buffer_load_dwordx4 v1, s[4:7], s80 offen lds
  s_add_u32 m0, s45, 5280
  s_add_u32 s80, s79, 5120
  buffer_load_dwordx4 v1, s[4:7], s80 offen lds
  s_add_u32 m0, s45, 6336
  s_add_u32 s80, s79, 6144
  buffer_load_dwordx4 v1, s[4:7], s80 offen lds
  s_add_u32 m0, s45, 7392
  s_add_u32 s80, s79, 7168
  buffer_load_dwordx4 v1, s[4:7], s80 offen lds
  s_waitcnt vmcnt(0)
  ds_read_b128 v[96:99], v164 offset:0
  ds_read_b128 v[100:103], v164 offset:64
  ds_read_b128 v[104:107], v164 offset:128
  ds_read_b128 v[108:111], v164 offset:192
  ds_read_b128 v[112:115], v164 offset:256
  ds_read_b128 v[116:119], v164 offset:320
  ds_read_b128 v[120:123], v164 offset:384
  ds_read_b128 v[124:127], v164 offset:448
  s_waitcnt lgkmcnt(7)
  v_mfma_f32_16x16x32_bf16 v[64:67], v[96:99], v[16:19], 0
  s_waitcnt lgkmcnt(6)
  v_mfma_f32_16x16x32_bf16 v[64:67], v[100:103], v[20:23], v[64:67]
  s_waitcnt lgkmcnt(5)
  v_mfma_f32_16x16x32_bf16 v[64:67], v[104:107], v[24:27], v[64:67]
  s_waitcnt lgkmcnt(4)
  v_mfma_f32_16x16x32_bf16 v[64:67], v[108:111], v[28:31], v[64:67]
  s_waitcnt lgkmcnt(3)
  v_mfma_f32_16x16x32_bf16 v[68:71], v[112:115], v[16:19], 0
  s_waitcnt lgkmcnt(2)
  v_mfma_f32_16x16x32_bf16 v[68:71], v[116:119], v[20:23], v[68:71]
  s_waitcnt lgkmcnt(1)
  v_mfma_f32_16x16x32_bf16 v[68:71], v[120:123], v[24:27], v[68:71]
  s_waitcnt lgkmcnt(0)
  v_mfma_f32_16x16x32_bf16 v[68:71], v[124:127], v[28:31], v[68:71]
  v_max3_f32 v80, v80, v64, v65
  v_max3_f32 v80, v80, v66, v67
  s_nop 5
  v_max3_f32 v80, v80, v68, v69
  v_max3_f32 v80, v80, v70, v71
  s_add_u32 s79, s79, 8192
  s_sub_u32 s78, s78, 1
  s_cmp_lg_u32 s78, 0
  s_cbranch_scc1 SL_P1
  v_mov_b32 v81, v80
  s_nop 1
  v_permlane32_swap_b32 v80, v81
  v_max_f32 v80, v80, v81
  v_mov_b32 v81, v80
  s_nop 1
  v_permlane16_swap_b32 v80, v81
  v_min_f32 v76, -v80, -v81
  v_min_f32 v77, -v80, -v81
  v_min_f32 v78, -v80, -v81
  v_min_f32 v79, -v80, -v81
  v_mov_b32 v32, 0
  v_mov_b32 v33, 0
  v_mov_b32 v34, 0
  v_mov_b32 v35, 0
  v_mov_b32 v36, 0
  v_mov_b32 v37, 0
  v_mov_b32 v38, 0
  v_mov_b32 v39, 0
  v_mov_b32 v40, 0
  v_mov_b32 v41, 0
  v_mov_b32 v42, 0
  v_mov_b32 v43, 0
  v_mov_b32 v44, 0
  v_mov_b32 v45, 0
  v_mov_b32 v46, 0
  v_mov_b32 v47, 0
  v_mov_b32 v48, 0
  v_mov_b32 v49, 0
  v_mov_b32 v50, 0
  v_mov_b32 v51, 0
  v_mov_b32 v52, 0
  v_mov_b32 v53, 0
  v_mov_b32 v54, 0
  v_mov_b32 v55, 0
  v_mov_b32 v56, 0
  v_mov_b32 v57, 0
  v_mov_b32 v58, 0
  v_mov_b32 v59, 0
  v_mov_b32 v60, 0
  v_mov_b32 v61, 0
  v_mov_b32 v62, 0
  v_mov_b32 v63, 0
  v_mov_b32 v160, 0
  v_mov_b32 v161, 0
  v_mov_b32 v162, 0
  v_mov_b32 v163, 0
  s_lshl_b32 s79, s76, 18
  s_mov_b32 s78, 32
SL_P2:
  s_add_u32 m0, s45, 0
  s_add_u32 s80, s79, 0
  buffer_load_dwordx4 v1, s[4:7], s80 offen lds
  s_add_u32 m0, s45, 1056
  s_add_u32 s80, s79, 1024
  buffer_load_dwordx4 v1, s[4:7], s80 offen lds
  s_add_u32 m0, s45, 2112
  s_add_u32 s80, s79, 2048
  buffer_load_dwordx4 v1, s[4:7], s80 offen lds
  s_add_u32 m0, s45, 3168
  s_add_u32 s80, s79, 3072
  buffer_load_dwordx4 v1, s[4:7], s80 offen lds
  s_add_u32 m0, s45, 4224
  s_add_u32 s80, s79, 4096
  buffer_load_dwordx4 v1, s[4:7], s80 offen lds
  s_add_u32 m0, s45, 5280
  s_add_u32 s80, s79, 5120
  buffer_load_dwordx4 v1, s[4:7], s80 offen lds
  s_add_u32 m0, s45, 6336
  s_add_u32 s80, s79, 6144
  buffer_load_dwordx4 v1, s[4:7], s80 offen lds
  s_add_u32 m0, s45, 7392
  s_add_u32 s80, s79, 7168
  buffer_load_dwordx4 v1, s[4:7], s80 offen lds
  s_add_u32 m0, s45, 8448
  s_add_u32 s80, s79, 0
  buffer_load_dwordx4 v1, s[8:11], s80 offen lds
  s_add_u32 m0, s45, 9480
  s_add_u32 s80, s79, 1024
  buffer_load_dwordx4 v1, s[8:11], s80 offen lds
  s_add_u32 m0, s45, 10560
  s_add_u32 s80, s79, 2048
  buffer_load_dwordx4 v1, s[8:11], s80 offen lds
  s_add_u32 m0, s45, 11592
  s_add_u32 s80, s79, 3072
  buffer_load_dwordx4 v1, s[8:11], s80 offen lds
  s_add_u32 m0, s45, 12672
  s_add_u32 s80, s79, 4096
  buffer_load_dwordx4 v1, s[8:11], s80 offen lds
  s_add_u32 m0, s45, 13704
  s_add_u32 s80, s79, 5120
  buffer_load_dwordx4 v1, s[8:11], s80 offen lds
  s_add_u32 m0, s45, 14784
  s_add_u32 s80, s79, 6144
  buffer_load_dwordx4 v1, s[8:11], s80 offen lds
  s_add_u32 m0, s45, 15816
  s_add_u32 s80, s79, 7168
  buffer_load_dwordx4 v1, s[8:11], s80 offen lds
  s_waitcnt vmcnt(0)
  ds_read_b128 v[96:99], v164 offset:0
  ds_read_b128 v[100:103], v164 offset:64
  ds_read_b128 v[104:107], v164 offset:128
  ds_read_b128 v[108:111], v164 offset:192
  ds_read_b128 v[112:115], v164 offset:256
  ds_read_b128 v[116:119], v164 offset:320
  ds_read_b128 v[120:123], v164 offset:384
  ds_read_b128 v[124:127], v164 offset:448
  s_waitcnt lgkmcnt(7)
  v_mfma_f32_16x16x32_bf16 v[64:67], v[96:99], v[16:19], v[76:79]
  s_waitcnt lgkmcnt(6)
  v_mfma_f32_16x16x32_bf16 v[64:67], v[100:103], v[20:23], v[64:67]
  s_waitcnt lgkmcnt(5)
  v_mfma_f32_16x16x32_bf16 v[64:67], v[104:107], v[24:27], v[64:67]
  s_waitcnt lgkmcnt(4)
  v_mfma_f32_16x16x32_bf16 v[64:67], v[108:111], v[28:31], v[64:67]
  s_waitcnt lgkmcnt(3)
  v_mfma_f32_16x16x32_bf16 v[68:71], v[112:115], v[16:19], v[76:79]
  s_waitcnt lgkmcnt(2)
  v_mfma_f32_16x16x32_bf16 v[68:71], v[116:119], v[20:23], v[68:71]
  s_waitcnt lgkmcnt(1)
  v_mfma_f32_16x16x32_bf16 v[68:71], v[120:123], v[24:27], v[68:71]
  s_waitcnt lgkmcnt(0)
  v_mfma_f32_16x16x32_bf16 v[68:71], v[124:127], v[28:31], v[68:71]
  ds_read_b64_tr_b16 v[128:129], v165 offset:0
  ds_read_b64_tr_b16 v[130:131], v165 offset:256
  ds_read_b64_tr_b16 v[132:133], v165 offset:8
  ds_read_b64_tr_b16 v[134:135], v165 offset:264
  ds_read_b64_tr_b16 v[136:137], v165 offset:64
  ds_read_b64_tr_b16 v[138:139], v165 offset:320
  ds_read_b64_tr_b16 v[140:141], v165 offset:72
  ds_read_b64_tr_b16 v[142:143], v165 offset:328
  ds_read_b64_tr_b16 v[144:145], v165 offset:128
  ds_read_b64_tr_b16 v[146:147], v165 offset:384
  ds_read_b64_tr_b16 v[148:149], v165 offset:136
  ds_read_b64_tr_b16 v[150:151], v165 offset:392
  ds_read_b64_tr_b16 v[152:153], v165 offset:192
  ds_read_b64_tr_b16 v[154:155], v165 offset:448
  ds_read_b64_tr_b16 v[156:157], v165 offset:200
  ds_read_b64_tr_b16 v[158:159], v165 offset:456
  v_exp_f32 v64, v64
  v_exp_f32 v65, v65
  v_exp_f32 v66, v66
  v_exp_f32 v67, v67
  v_exp_f32 v68, v68
  v_exp_f32 v69, v69
  v_exp_f32 v70, v70
  v_exp_f32 v71, v71
  v_cvt_pk_bf16_f32 v72, v64, v65
  v_cvt_pk_bf16_f32 v73, v66, v67
  v_cvt_pk_bf16_f32 v74, v68, v69
  v_cvt_pk_bf16_f32 v75, v70, v71
  s_waitcnt lgkmcnt(0)
  s_nop 0
  v_mfma_f32_16x16x32_bf16 v[32:35], v[128:131], v[72:75], v[32:35]
  v_mfma_f32_16x16x32_bf16 v[36:39], v[132:135], v[72:75], v[36:39]
  v_mfma_f32_16x16x32_bf16 v[40:43], v[136:139], v[72:75], v[40:43]
  v_mfma_f32_16x16x32_bf16 v[44:47], v[140:143], v[72:75], v[44:47]
  v_mfma_f32_16x16x32_bf16 v[48:51], v[144:147], v[72:75], v[48:51]
  v_mfma_f32_16x16x32_bf16 v[52:55], v[148:151], v[72:75], v[52:55]
  v_mfma_f32_16x16x32_bf16 v[56:59], v[152:155], v[72:75], v[56:59]
  v_mfma_f32_16x16x32_bf16 v[60:63], v[156:159], v[72:75], v[60:63]
  v_mfma_f32_16x16x32_bf16 v[160:163], v[168:171], v[72:75], v[160:163]
  s_add_u32 s79, s79, 8192
  s_sub_u32 s78, s78, 1
  s_cmp_lg_u32 s78, 0
  s_cbranch_scc1 SL_P2
  s_nop 3
  v_rcp_f32 v160, v160
  s_nop 0
  v_mul_f32 v32, v32, v160
  v_mul_f32 v33, v33, v160
  v_mul_f32 v34, v34, v160
  v_mul_f32 v35, v35, v160
  v_mul_f32 v36, v36, v160
  v_mul_f32 v37, v37, v160
  v_mul_f32 v38, v38, v160
  v_mul_f32 v39, v39, v160
  v_mul_f32 v40, v40, v160
  v_mul_f32 v41, v41, v160
  v_mul_f32 v42, v42, v160
  v_mul_f32 v43, v43, v160
  v_mul_f32 v44, v44, v160
  v_mul_f32 v45, v45, v160
  v_mul_f32 v46, v46, v160
  v_mul_f32 v47, v47, v160
  v_mul_f32 v48, v48, v160
  v_mul_f32 v49, v49, v160
  v_mul_f32 v50, v50, v160
  v_mul_f32 v51, v51, v160
  v_mul_f32 v52, v52, v160
  v_mul_f32 v53, v53, v160
  v_mul_f32 v54, v54, v160
  v_mul_f32 v55, v55, v160
  v_mul_f32 v56, v56, v160
  v_mul_f32 v57, v57, v160
  v_mul_f32 v58, v58, v160
  v_mul_f32 v59, v59, v160
  v_mul_f32 v60, v60, v160
  v_mul_f32 v61, v61, v160
  v_mul_f32 v62, v62, v160
  v_mul_f32 v63, v63, v160
  v_cvt_pk_bf16_f32 v96, v32, v33
  v_cvt_pk_bf16_f32 v97, v34, v35
  v_cvt_pk_bf16_f32 v98, v36, v37
  v_cvt_pk_bf16_f32 v99, v38, v39
  v_cvt_pk_bf16_f32 v100, v40, v41
  v_cvt_pk_bf16_f32 v101, v42, v43
  v_cvt_pk_bf16_f32 v102, v44, v45
  v_cvt_pk_bf16_f32 v103, v46, v47
  v_cvt_pk_bf16_f32 v104, v48, v49
  v_cvt_pk_bf16_f32 v105, v50, v51
  v_cvt_pk_bf16_f32 v106, v52, v53
  v_cvt_pk_bf16_f32 v107, v54, v55
  v_cvt_pk_bf16_f32 v108, v56, v57
  v_cvt_pk_bf16_f32 v109, v58, v59
  v_cvt_pk_bf16_f32 v110, v60, v61
  v_cvt_pk_bf16_f32 v111, v62, v63
  buffer_store_dwordx4 v[96:99], v166, s[20:23], s63 offen offset:0
  buffer_store_dwordx4 v[100:103], v166, s[20:23], s63 offen offset:64
  buffer_store_dwordx4 v[104:107], v166, s[20:23], s63 offen offset:128
  buffer_store_dwordx4 v[108:111], v166, s[20:23], s63 offen offset:192
  s_waitcnt vmcnt(0)
  s_add_u32 s77, s77, 1
  s_cmp_lt_u32 s77, s65
  s_cbranch_scc1 SL_TILE
SL_NEXTH:
  s_mov_b64 s[40:41], s[42:43]
  s_add_u32 s76, s76, 1
  s_cmp_lt_u32 s76, 2
  s_cbranch_scc1 SL_HEAD
EXIT2:
EXIT:
  s_endpgm
.section .rodata,"a"
.p2align 6
.amdhsa_kernel standalone__mha_softmax__near_ridge_kernel
  .amdhsa_next_free_vgpr 512
  .amdhsa_next_free_sgpr 102
  .amdhsa_accum_offset 256
  .amdhsa_group_segment_fixed_size 0
  .amdhsa_kernarg_size 48
  .amdhsa_user_sgpr_count 2
  .amdhsa_user_sgpr_kernarg_segment_ptr 1
  .amdhsa_system_sgpr_workgroup_id_x 1
.end_amdhsa_kernel
```
